```python
import torch

def _softmax(x, axis=-1):
    return torch.softmax(x, dim=axis)
def _gelu(x):
    return torch.nn.functional.gelu(x, approximate="tanh")
def _silu(x):
    return torch.nn.functional.silu(x)
def _sigmoid(x):
    return torch.sigmoid(x)
def _layernorm(x, axis=-1, eps=1e-5):
    m = x.mean(dim=axis, keepdim=True)
    v = x.var(dim=axis, keepdim=True, unbiased=False)
    return (x - m) / torch.sqrt(v + eps)
def _scatter_add(tgt, idx, src, axis=0):
    return tgt.clone().index_add_(axis, idx, src)
def _segment_sum(src, seg, n):
    out = torch.zeros((n,) + src.shape[1:], dtype=src.dtype)
    return out.index_add_(0, seg, src)
def _pad(x, pw):
    flat = tuple(v for pair in reversed(pw) for v in pair)
    return torch.nn.functional.pad(x, flat)

kernel_name = 'sequential_preLN__grouped_kv_mqa__glu_gated_swiglu__prompt'

def setup_inputs():

    _w = (lambda a: (lambda t: t.to(torch.bfloat16) if t.is_floating_point() else t)(torch.as_tensor(a)))
    def _A_setup():
        B, S, D, H = 1, 2048, 640, 32
        Dh = D // H
        return {
            "x": _w((lambda *s: torch.randn(*s, dtype=torch.bfloat16) * 0.05)(B, S, D)),
            "wq": _w((lambda *s: torch.randn(*s, dtype=torch.bfloat16) * 0.05)(D, H * Dh)),
            "wk": _w((lambda *s: torch.randn(*s, dtype=torch.bfloat16) * 0.05)(D, Dh)),
            "wv": _w((lambda *s: torch.randn(*s, dtype=torch.bfloat16) * 0.05)(D, Dh)),
            "wo": _w((lambda *s: torch.randn(*s, dtype=torch.bfloat16) * 0.05)(H * Dh, D)),
        }
    _A_in = _A_setup()

    def _B_setup():
        B, S, D, F = 1, 2048, 640, 1536
        return {
            "x": _w((lambda *s: torch.randn(*s, dtype=torch.bfloat16) * 0.05)(B, S, D)),
            "w1": _w((lambda *s: torch.randn(*s, dtype=torch.bfloat16) * 0.4)(D, F) * (2.0 / D) ** 0.5),
            "w3": _w((lambda *s: torch.randn(*s, dtype=torch.bfloat16) * 0.4)(D, F) * (2.0 / D) ** 0.5),
            "w2": _w((lambda *s: torch.randn(*s, dtype=torch.bfloat16) * 0.4)(F, D) * (2.0 / F) ** 0.5),
        }
    _B_in = _B_setup()

    return {
        "A_x": _A_in["x"],
        "A_wq": _A_in["wq"],
        "A_wk": _A_in["wk"],
        "A_wv": _A_in["wv"],
        "A_wo": _A_in["wo"],
        "B_x": _B_in["x"],
        "B_w1": _B_in["w1"],
        "B_w3": _B_in["w3"],
        "B_w2": _B_in["w2"],
    }

def reference(A_x, A_wq, A_wk, A_wv, A_wo, B_x, B_w1, B_w3, B_w2):
    def _A_ref(x, wq, wk, wv, wo):
        B, S, D = x.shape
        H = 32
        Dh = D // H
        q = (lambda x, *d: x.permute(*d))((x @ wq).reshape(B, S, H, Dh), 0, 2, 1, 3)
        k = x @ wk
        v = x @ wv
        scores = torch.einsum("bhqd,bkd->bhqk", q, k) * (Dh ** -0.5)
        p = _softmax(scores, axis=-1)
        o = torch.einsum("bhqk,bkd->bhqd", p, v)
        return (lambda x, *d: x.permute(*d))(o, 0, 2, 1, 3).reshape(B, S, H * Dh) @ wo

    def _B_ref(x, w1, w3, w2):
        gate = torch.einsum("bsd,df->bsf", x, w1)
        up = torch.einsum("bsd,df->bsf", x, w3)
        h = _silu(gate) * up
        out = torch.einsum("bsf,fd->bsd", h, w2)
        return out

    x = A_x
    h = x + _A_ref(_layernorm(x, axis=-1), A_wq, A_wk, A_wv, A_wo)
    h2 = h + _B_ref(_layernorm(h, axis=-1), B_w1, B_w3, B_w2)
    return h2
```

```asm
; @launch grid=(256,1,1) block=(256,1,1) lds=163840
.amdgcn_target "amdgcn-amd-amdhsa--gfx950"
.text
.globl sequential_preLN__grouped_kv_mqa__glu_gated_swiglu__prompt_kernel
.p2align 8
.type sequential_preLN__grouped_kv_mqa__glu_gated_swiglu__prompt_kernel,@function
sequential_preLN__grouped_kv_mqa__glu_gated_swiglu__prompt_kernel:
  s_cmp_ge_u32 s2, 256
  s_cbranch_scc1 L_exit
  s_load_dwordx16 s[4:19], s[0:1], 0
  s_load_dwordx8 s[20:27], s[0:1], 64
  v_lshrrev_b32 v4, 6, v0
  v_and_b32 v1, 63, v0
  v_readfirstlane_b32 s68, v4
  s_getpc_b64 s[98:99]
L_pc:
  s_lshr_b32 s93, s2, 3
  s_lshl_b32 s93, s93, 2
  s_nop 0
  s_add_u32 s93, s93, s68
  s_lshl_b32 s93, s93, 9
  v_and_b32 v20, 3, v1
  v_lshl_add_u32 v20, v20, 7, s93
  v_min_u32 v20, L_tailG-L_pc, v20
  v_and_b32 v20, -4, v20
  v_add_co_u32 v22, vcc, s98, v20
  v_mov_b32 v23, s99
  s_nop 0
  v_addc_co_u32 v23, vcc, 0, v23, vcc
  global_load_dword v226, v[22:23], off
  v_and_b32 v2, 15, v1
  v_lshrrev_b32 v3, 4, v1
  s_and_b32 s78, s2, 7
  s_lshr_b32 s79, s2, 3
  s_lshr_b32 s80, s79, 4
  s_lshl_b32 s69, s78, 1
  s_add_u32 s69, s69, s80
  s_and_b32 s73, s79, 15
  s_lshr_b32 s70, s73, 3
  s_and_b32 s71, s73, 7
  s_lshl_b32 s72, s69, 1
  s_add_u32 s72, s72, s70
  s_mov_b32 s74, 0x00003f80
  s_mov_b32 s75, 0x3f800000
  s_mov_b32 s76, 0x3f803f80
  s_waitcnt lgkmcnt(0)
  s_mov_b32 s28, s4
  s_and_b32 s29, s5, 0xffff
  s_mov_b32 s30, 2621440
  s_mov_b32 s31, 0x20000
  s_lshl_b32 s90, s72, 2
  s_add_u32 s90, s90, s68
  s_lshl_b32 s99, s90, 4
  v_lshrrev_b32 v20, 2, v1
  v_add_u32 v20, s99, v20
  v_mul_u32_u24 v20, 1280, v20
  v_sub_u32 v21, 0, v3
  v_xor_b32 v21, v21, v1
  v_and_b32 v21, 3, v21
  v_lshl_add_u32 v20, v21, 4, v20
  v_lshlrev_b32 v11, 4, v1
  s_add_u32 s84, s68, 1
  s_mul_i32 s84, s84, 20480
  s_mul_i32 s94, s72, 1
  s_mul_i32 s93, s71, 2
  s_add_u32 s94, s94, s93
  s_mul_hi_u32 s93, s94, 858993460
  s_mul_i32 s93, s93, 5
  s_sub_u32 s94, s94, s93
  v_mov_b32 v221, v20
  s_mov_b32 s99, s84
  v_lshl_add_u32 v222, s94, 8, v221
  s_add_u32 m0, s99, 0
  s_nop 0
  buffer_load_dwordx4 v222, s[28:31], 0 offen offset:0 lds
  s_add_u32 m0, s99, 960
  s_nop 0
  buffer_load_dwordx4 v222, s[28:31], 0 offen offset:64 lds
  s_add_u32 m0, s99, 1920
  s_nop 0
  buffer_load_dwordx4 v222, s[28:31], 0 offen offset:128 lds
  s_add_u32 m0, s99, 2880
  s_nop 0
  buffer_load_dwordx4 v222, s[28:31], 0 offen offset:192 lds
  s_add_u32 s95, s94, 1
  s_cmp_eq_u32 s95, 5
  s_cselect_b32 s95, 0, s95
  v_lshl_add_u32 v223, s95, 8, v221
  s_add_u32 m0, s99, 4096
  s_nop 0
  buffer_load_dwordx4 v223, s[28:31], 0 offen offset:0 lds
  s_add_u32 m0, s99, 5056
  s_nop 0
  buffer_load_dwordx4 v223, s[28:31], 0 offen offset:64 lds
  s_add_u32 m0, s99, 6016
  s_nop 0
  buffer_load_dwordx4 v223, s[28:31], 0 offen offset:128 lds
  s_add_u32 m0, s99, 6976
  s_nop 0
  buffer_load_dwordx4 v223, s[28:31], 0 offen offset:192 lds
  s_mov_b32 s32, s6
  s_and_b32 s33, s7, 0xffff
  s_mov_b32 s34, 819200
  s_mov_b32 s35, 0x20000
  s_bitcmp1_b32 s71, 0
  s_cselect_b32 s36, s10, s8
  s_cselect_b32 s37, s11, s9
  s_and_b32 s37, s37, 0xffff
  s_mov_b32 s38, 25600
  s_mov_b32 s39, 0x20000
  s_mov_b32 s40, s12
  s_and_b32 s41, s13, 0xffff
  s_mov_b32 s42, 819200
  s_mov_b32 s43, 0x20000
  s_mov_b32 s44, s16
  s_and_b32 s45, s17, 0xffff
  s_mov_b32 s46, 1966080
  s_mov_b32 s47, 0x20000
  s_mov_b32 s48, s18
  s_and_b32 s49, s19, 0xffff
  s_mov_b32 s50, 1966080
  s_mov_b32 s51, 0x20000
  s_mov_b32 s52, s20
  s_and_b32 s53, s21, 0xffff
  s_mov_b32 s54, 1966080
  s_mov_b32 s55, 0x20000
  s_mov_b32 s56, s22
  s_and_b32 s57, s23, 0xffff
  s_mov_b32 s58, 2621440
  s_mov_b32 s59, 0x20000
  s_mov_b32 s60, s26
  s_and_b32 s61, s27, 0xffff
  s_mov_b32 s62, 29360128
  s_mov_b32 s63, 0x20000
  s_mov_b32 s12, 18874368
  s_load_dword s77, s[26:27], s12
  s_lshr_b32 s15, s71, 1
  s_mul_i32 s12, s71, 160
  v_add_u32 v20, 0, v1
  v_mul_u32_u24 v21, 0xcd, v20
  v_lshrrev_b32 v21, 11, v21
  v_mul_u32_u24 v22, 10, v21
  v_sub_u32 v20, v20, v22
  v_lshlrev_b32 v20, 4, v20
  v_lshrrev_b32 v22, 2, v21
  v_lshrrev_b32 v4, 3, v21
  v_xor_b32 v22, v22, v4
  v_and_b32 v22, 1, v22
  v_mul_u32_u24 v22, 12, v22
  v_xor_b32 v21, v21, v22
  v_mul_u32_u24 v21, 1280, v21
  v_add3_u32 v4, v20, v21, s12
  v_add_u32 v20, 64, v1
  v_mul_u32_u24 v21, 0xcd, v20
  v_lshrrev_b32 v21, 11, v21
  v_mul_u32_u24 v22, 10, v21
  v_sub_u32 v20, v20, v22
  v_lshlrev_b32 v20, 4, v20
  v_lshrrev_b32 v22, 2, v21
  v_lshrrev_b32 v5, 3, v21
  v_xor_b32 v22, v22, v5
  v_and_b32 v22, 1, v22
  v_mul_u32_u24 v22, 12, v22
  v_xor_b32 v21, v21, v22
  v_mul_u32_u24 v21, 1280, v21
  v_add3_u32 v5, v20, v21, s12
  v_subrev_u32 v5, 1024, v5
  v_add_u32 v20, 128, v1
  v_mul_u32_u24 v21, 0xcd, v20
  v_lshrrev_b32 v21, 11, v21
  v_mul_u32_u24 v22, 10, v21
  v_sub_u32 v20, v20, v22
  v_lshlrev_b32 v20, 4, v20
  v_lshrrev_b32 v22, 2, v21
  v_lshrrev_b32 v6, 3, v21
  v_xor_b32 v22, v22, v6
  v_and_b32 v22, 1, v22
  v_mul_u32_u24 v22, 12, v22
  v_xor_b32 v21, v21, v22
  v_mul_u32_u24 v21, 1280, v21
  v_add3_u32 v6, v20, v21, s12
  v_subrev_u32 v6, 2048, v6
  v_add_u32 v20, 192, v1
  v_mul_u32_u24 v21, 0xcd, v20
  v_lshrrev_b32 v21, 11, v21
  v_mul_u32_u24 v22, 10, v21
  v_sub_u32 v20, v20, v22
  v_lshlrev_b32 v20, 4, v20
  v_lshrrev_b32 v22, 2, v21
  v_lshrrev_b32 v7, 3, v21
  v_xor_b32 v22, v22, v7
  v_and_b32 v22, 1, v22
  v_mul_u32_u24 v22, 12, v22
  v_xor_b32 v21, v21, v22
  v_mul_u32_u24 v21, 1280, v21
  v_add3_u32 v7, v20, v21, s12
  v_subrev_u32 v7, 3072, v7
  v_add_u32 v20, 256, v1
  v_mul_u32_u24 v21, 0xcd, v20
  v_lshrrev_b32 v21, 11, v21
  v_mul_u32_u24 v22, 10, v21
  v_sub_u32 v20, v20, v22
  v_lshlrev_b32 v20, 4, v20
  v_lshrrev_b32 v22, 2, v21
  v_lshrrev_b32 v8, 3, v21
  v_xor_b32 v22, v22, v8
  v_and_b32 v22, 1, v22
  v_mul_u32_u24 v22, 12, v22
  v_xor_b32 v21, v21, v22
  v_mul_u32_u24 v21, 1280, v21
  v_add3_u32 v8, v20, v21, s12
  v_lshrrev_b32 v20, 1, v3
  v_lshlrev_b32 v20, 4, v20
  v_and_b32 v21, 1, v3
  v_lshl_add_u32 v20, v21, 2, v20
  v_lshrrev_b32 v21, 2, v2
  v_add_u32 v20, v20, v21
  v_mul_u32_u24 v20, 160, v20
  v_and_b32 v21, 3, v2
  v_lshl_add_u32 v9, v21, 3, v20
  v_add_u32 v10, 51200, v9
  s_mul_i32 s86, s68, 25600
  s_and_b32 s78, s68, 1
  s_lshr_b32 s79, s68, 1
  s_mul_i32 s81, s78, 114688
  s_add_u32 s81, s81, 0
  s_lshr_b32 s3, s2, 3
  s_mul_i32 s3, s3, 1
  v_lshrrev_b32 v20, 2, v2
  v_lshl_add_u32 v244, v20, 4, v2
  v_lshlrev_b32 v244, 2, v244
  v_sub_u32 v20, 0, v20
  v_xor_b32 v20, v20, v3
  v_and_b32 v20, 3, v20
  v_lshl_add_u32 v20, v2, 2, v20
  v_lshl_add_u32 v245, v20, 4, s84
  v_mov_b32 v168, s76
  v_mov_b32 v169, s76
  v_mov_b32 v170, s76
  v_mov_b32 v171, s76
  v_lshrrev_b32 v20, 2, v2
  v_and_b32 v21, 1, v2
  v_lshlrev_b32 v21, 4, v21
  v_lshlrev_b32 v21, v21, s74
  v_cmp_eq_u32 vcc, v20, v3
  s_nop 1
  v_cndmask_b32 v21, 0, v21, vcc
  v_and_b32 v20, 2, v2
  v_cmp_eq_u32 vcc, 0, v20
  s_nop 1
  v_cndmask_b32 v197, v21, 0, vcc
  v_cndmask_b32 v196, 0, v21, vcc
  v_mov_b32 v198, 0
  v_mov_b32 v199, 0
  v_mov_b32 v200, 0
  v_mov_b32 v201, 0
  v_mov_b32 v202, v196
  v_mov_b32 v203, v197
  s_mul_i32 s84, s68, 6144
  s_add_u32 s84, s84, 128000
  v_lshrrev_b32 v20, 2, v2
  v_lshl_add_u32 v20, v3, 3, v20
  v_mul_u32_u24 v20, 40, v20
  v_and_b32 v21, 3, v2
  v_lshl_add_u32 v20, v21, 3, v20
  v_add_u32 v241, 102400, v20
  v_and_b32 v20, 31, v1
  v_lshrrev_b32 v21, 5, v1
  v_lshlrev_b32 v17, 4, v20
  v_lshl_add_u32 v17, v21, 3, v17
  v_add_u32 v17, 1024, v17
  v_mov_b32 v18, 0xdddd
  v_min_u32 v0, 23, v20
  v_lshl_add_u32 v0, v21, 5, v0
  v_lshlrev_b32 v0, 4, v0
  s_lshl_b32 s12, s79, 5
  v_add_u32 v20, s12, v20
  v_mul_u32_u24 v20, 168, v20
  v_lshl_add_u32 v20, v21, 4, v20
  s_mul_i32 s12, s78, 80
  s_add_u32 s14, s12, 152576
  v_add_u32 v232, s14, v20
  s_sub_u32 s14, 152656, s12
  v_add_u32 v233, s14, v20
  v_mul_u32_u24 v22, 24, v21
  v_add_u32 v234, v232, v22
  v_add_u32 v235, v233, v22
  s_lshr_b32 s12, s71, 2
  s_lshl_b32 s14, s72, 1
  s_add_u32 s12, s12, s14
  s_lshl_b32 s14, s12, 2
  s_and_b32 s16, s71, 3
  s_add_u32 s14, s14, s16
  s_lshl_b32 s14, s14, 6
  s_add_u32 s14, s14, 18878464
  v_mov_b32 v30, 1073741824
  v_mov_b32 v20, s14
  v_cmp_eq_u32 vcc, 0, v1
  s_nop 1
  v_cndmask_b32 v30, v30, v20, vcc
  s_mul_i32 s12, s12, 3584
  s_and_b32 s14, s15, 1
  s_bitcmp1_b32 s71, 0
  s_cselect_b32 s16, 10, 8
  s_cselect_b32 s18, 8, 10
  s_cselect_b32 s19, 1536, 0
  s_cselect_b32 s22, 4, 3
  s_lshl_b32 s14, s14, s16
  s_add_u32 s12, s12, s14
  s_add_u32 s12, s12, s19
  s_add_u32 s12, s12, 0
  v_lshrrev_b32 v20, 1, v3
  v_lshlrev_b32 v20, 9, v20
  v_and_b32 v21, 1, v3
  v_lshlrev_b32 v21, s18, v21
  v_add3_u32 v20, v20, v21, s12
  v_lshl_add_u32 v20, v2, 4, v20
  v_mov_b32 v24, 1073741824
  v_cmp_eq_u32 vcc, s22, v3
  s_nop 1
  v_cndmask_b32 v220, v20, v24, vcc
  s_lshl_b32 s12, s68, 4
  v_add_u32 v20, s12, v2
  v_mul_u32_u24 v20, 168, v20
  v_lshl_add_u32 v20, v3, 3, v20
  v_add_u32 v236, 152576, v20
  s_waitcnt lgkmcnt(0)
  s_mul_i32 s77, s77, 0x9e3779b1
  s_add_u32 s77, s77, 0x7f4a7c15
  v_mov_b32 v19, s77
  s_getreg_b32 s0, hwreg(HW_REG_XCC_ID, 0, 4)
  v_mov_b32 v242, s77
  v_mov_b32 v243, s0
  s_add_u32 s96, s95, 1
  s_cmp_eq_u32 s96, 5
  s_cselect_b32 s96, 0, s96
  v_lshl_add_u32 v222, s96, 8, v221
  s_add_u32 m0, s99, 8192
  s_nop 0
  buffer_load_dwordx4 v222, s[28:31], 0 offen offset:0 lds
  s_add_u32 m0, s99, 9152
  s_nop 0
  buffer_load_dwordx4 v222, s[28:31], 0 offen offset:64 lds
  s_add_u32 m0, s99, 10112
  s_nop 0
  buffer_load_dwordx4 v222, s[28:31], 0 offen offset:128 lds
  s_add_u32 m0, s99, 11072
  s_nop 0
  buffer_load_dwordx4 v222, s[28:31], 0 offen offset:192 lds
  s_add_u32 s97, s96, 1
  s_cmp_eq_u32 s97, 5
  s_cselect_b32 s97, 0, s97
  v_lshl_add_u32 v223, s97, 8, v221
  s_add_u32 m0, s99, 12288
  s_nop 0
  buffer_load_dwordx4 v223, s[28:31], 0 offen offset:0 lds
  s_add_u32 m0, s99, 13248
  s_nop 0
  buffer_load_dwordx4 v223, s[28:31], 0 offen offset:64 lds
  s_add_u32 m0, s99, 14208
  s_nop 0
  buffer_load_dwordx4 v223, s[28:31], 0 offen offset:128 lds
  s_add_u32 m0, s99, 15168
  s_nop 0
  buffer_load_dwordx4 v223, s[28:31], 0 offen offset:192 lds
  s_add_u32 s98, s97, 1
  s_cmp_eq_u32 s98, 5
  s_cselect_b32 s98, 0, s98
  v_lshl_add_u32 v222, s98, 8, v221
  s_add_u32 m0, s99, 16384
  s_nop 0
  buffer_load_dwordx4 v222, s[28:31], 0 offen offset:0 lds
  s_add_u32 m0, s99, 17344
  s_nop 0
  buffer_load_dwordx4 v222, s[28:31], 0 offen offset:64 lds
  s_add_u32 m0, s99, 18304
  s_nop 0
  buffer_load_dwordx4 v222, s[28:31], 0 offen offset:128 lds
  s_add_u32 m0, s99, 19264
  s_nop 0
  buffer_load_dwordx4 v222, s[28:31], 0 offen offset:192 lds
  s_cmp_eq_u32 s15, s68
  s_cbranch_scc1 L_owner
  s_sub_u32 s16, s68, s15
  s_sub_u32 s16, s16, 1
  s_and_b32 s16, s16, 3
  s_lshl_b32 s18, s94, 2
  s_add_u32 s19, s16, 0
  s_min_u32 s19, s19, 4
  s_add_u32 s22, s19, s94
  s_cmp_ge_u32 s22, 5
  s_cselect_b32 s23, 5, 0
  s_sub_u32 s22, s22, s23
  s_mul_i32 s19, s19, 5120
  s_mul_i32 s22, s22, 5120
  s_add_u32 m0, s19, 102400
  s_nop 0
  buffer_load_dwordx4 v11, s[36:39], s22 offen offset:0 lds
  buffer_load_dwordx4 v11, s[36:39], s22 offen offset:1024 lds
  buffer_load_dwordx4 v11, s[36:39], s22 offen offset:2048 lds
  buffer_load_dwordx4 v11, s[36:39], s22 offen offset:3072 lds
  s_add_u32 s22, s22, 4096
  s_add_u32 m0, s19, 106496
  s_nop 0
  buffer_load_dwordx4 v11, s[36:39], s22 offen offset:0 lds
  s_add_u32 s19, s16, 3
  s_min_u32 s19, s19, 4
  s_add_u32 s22, s19, s94
  s_cmp_ge_u32 s22, 5
  s_cselect_b32 s23, 5, 0
  s_sub_u32 s22, s22, s23
  s_mul_i32 s19, s19, 5120
  s_mul_i32 s22, s22, 5120
  s_add_u32 m0, s19, 102400
  s_nop 0
  buffer_load_dwordx4 v11, s[36:39], s22 offen offset:0 lds
  buffer_load_dwordx4 v11, s[36:39], s22 offen offset:1024 lds
  buffer_load_dwordx4 v11, s[36:39], s22 offen offset:2048 lds
  buffer_load_dwordx4 v11, s[36:39], s22 offen offset:3072 lds
  s_add_u32 s22, s22, 4096
  s_add_u32 m0, s19, 106496
  s_nop 0
  buffer_load_dwordx4 v11, s[36:39], s22 offen offset:0 lds
  s_min_u32 s19, s16, 19
  s_add_u32 s22, s19, s18
  s_mul_i32 s19, s19, 5120
  s_cmp_ge_u32 s22, 20
  s_cselect_b32 s23, 20, 0
  s_sub_u32 s22, s22, s23
  s_mul_i32 s22, s22, 40960
  s_add_u32 s16, s16, 3
  s_add_u32 m0, s19, 0
  s_nop 0
  buffer_load_dwordx4 v4, s[32:35], s22 offen offset:0 lds
  buffer_load_dwordx4 v5, s[32:35], s22 offen offset:1024 lds
  buffer_load_dwordx4 v6, s[32:35], s22 offen offset:2048 lds
  buffer_load_dwordx4 v7, s[32:35], s22 offen offset:3072 lds
  s_add_u32 m0, s19, 4096
  s_nop 0
  buffer_load_dwordx4 v8, s[32:35], s22 offen offset:0 lds
  v_mov_b32 v24, 1073741824
  s_lshl_b32 s12, s73, 2
  s_add_u32 s12, s12, s68
  s_mul_i32 s83, s12, 61440
  s_add_u32 s83, s83, 20971520
  s_lshl_b32 s12, s12, 8
  s_add_u32 s12, s12, 19005440
  v_min_u32 v20, 9, v2
  v_lshl_add_u32 v13, v20, 4, s12
  s_lshl_b32 s14, s71, 2
  s_add_u32 s14, s14, s68
  s_mul_i32 s89, s14, 61440
  s_add_u32 s89, s89, 25165824
  s_lshl_b32 s14, s14, 8
  s_add_u32 s27, s14, 19021824
  v_add_u32 v248, s84, v11
  s_xor_b32 s12, s68, 1
  s_mul_i32 s12, s12, 6144
  s_add_u32 s12, s12, 128000
  v_add_u32 v249, s12, v11
  s_lshl_b32 s12, s72, 2
  s_lshl_b32 s14, s79, 1
  s_add_u32 s12, s12, s14
  v_and_b32 v22, 1, v3
  v_add_u32 v22, s12, v22
  v_mul_u32_u24 v22, 20480, v22
  s_mul_i32 s12, s71, 10
  s_mul_i32 s14, s78, 5
  s_add_u32 s12, s12, s14
  v_lshrrev_b32 v21, 5, v1
  v_add_u32 v23, s12, v21
  v_lshl_add_u32 v22, v23, 8, v22
  v_lshl_add_u32 v22, v2, 4, v22
  v_add_u32 v250, 4194304, v22
  v_cmp_lt_u32 vcc, 31, v1
  s_nop 1
  v_cndmask_b32 v251, v24, v250, vcc
  s_lshl_b32 s12, s72, 1
  s_add_u32 s12, s12, s79
  s_lshl_b32 s12, s12, 8
  s_add_u32 s17, s12, 18907136
  s_lshl_b32 s14, s71, 1
  s_add_u32 s14, s14, s78
  s_lshl_b32 s14, s14, 4
  s_add_u32 s12, s17, s14
  v_mov_b32 v253, 1073741824
  v_mov_b32 v20, s12
  v_cmp_eq_u32 vcc, 0, v1
  s_nop 1
  v_cndmask_b32 v253, v253, v20, vcc
  s_lshl_b32 s12, s90, 4
  v_add_u32 v20, s12, v2
  v_mul_u32_u24 v21, 1280, v20
  s_mul_i32 s12, s71, 160
  v_lshl_add_u32 v21, v3, 3, v21
  v_add_u32 v14, s12, v21
  s_mul_i32 s12, s71, 2560
  s_mul_i32 s14, s90, 20480
  s_add_u32 s12, s12, s14
  s_add_u32 s12, s12, 7340032
  v_and_b32 v21, 1, v3
  v_lshrrev_b32 v22, 1, v3
  v_lshl_add_u32 v23, v21, 1, v22
  v_lshlrev_b32 v23, 8, v23
  v_lshl_add_u32 v23, v2, 4, v23
  v_add_u32 v252, s12, v23
  v_mov_b32 v24, 1073741824
  s_cmp_ge_u32 s69, 10
  s_mov_b32 s4, s44
  s_mov_b32 s5, s45
  s_cselect_b32 s6, 0, s46
  s_mov_b32 s7, 0x20000
  s_mov_b32 s8, s48
  s_mov_b32 s9, s49
  s_cselect_b32 s10, 0, s50
  s_mov_b32 s11, 0x20000
  s_cselect_b32 s54, s54, 0
  s_mul_i32 s12, s73, 192
  s_mul_i32 s14, s68, 48
  s_add_u32 s12, s12, s14
  v_add_u32 v20, 0, v1
  v_mul_u32_u24 v22, 0xab, v20
  v_lshrrev_b32 v22, 9, v22
  v_mul_u32_u24 v23, 3, v22
  v_sub_u32 v20, v20, v23
  v_mul_u32_u24 v22, 3072, v22
  v_lshl_add_u32 v20, v20, 4, v22
  v_add_u32 v26, s12, v20
  v_add_u32 v20, 64, v1
  v_mul_u32_u24 v22, 0xab, v20
  v_lshrrev_b32 v22, 9, v22
  v_mul_u32_u24 v23, 3, v22
  v_sub_u32 v20, v20, v23
  v_mul_u32_u24 v22, 3072, v22
  v_lshl_add_u32 v20, v20, 4, v22
  v_add_u32 v27, s12, v20
  v_add_u32 v20, 128, v1
  v_mul_u32_u24 v22, 0xab, v20
  v_lshrrev_b32 v22, 9, v22
  v_mul_u32_u24 v23, 3, v22
  v_sub_u32 v20, v20, v23
  v_mul_u32_u24 v22, 3072, v22
  v_lshl_add_u32 v20, v20, 4, v22
  v_add_u32 v28, s12, v20
  s_mul_i32 s21, s69, 196608
  s_max_u32 s26, s69, 10
  s_sub_u32 s26, s26, 10
  s_lshl_b32 s26, s26, 1
  s_add_u32 s26, s26, s70
  s_mul_i32 s12, s68, 12
  s_add_u32 s26, s26, s12
  s_mul_i32 s26, s26, 40960
  s_lshr_b32 s13, s2, 3
  s_lshl_b32 s13, s13, 2
  s_add_u32 s13, s13, s68
  s_mul_i32 s13, s13, 6400
  v_min_u32 v29, 49, v1
  v_lshlrev_b32 v29, 7, v29
  s_lshl_b32 s12, s69, 10
  s_add_u32 s12, s12, 18878464
  v_lshl_add_u32 v31, v2, 6, s12
  v_lshlrev_b32 v20, 7, v1
  v_add_u32 v16, s17, v20
  s_lshl_b32 s12, s69, 10
  s_add_u32 s12, s12, 18923264
  v_add_u32 v22, s12, v20
  v_cmp_le_u32 vcc, 2, v1
  s_nop 1
  v_cndmask_b32 v16, v16, v22, vcc
  s_lshl_b32 s12, s69, 12
  s_add_u32 s12, s12, 18938624
  v_add_u32 v22, s12, v20
  v_cmp_le_u32 vcc, 10, v1
  s_nop 1
  v_cndmask_b32 v16, v16, v22, vcc
  v_cmp_le_u32 vcc, 42, v1
  s_nop 1
  v_cndmask_b32 v16, v16, v24, vcc
  s_waitcnt vmcnt(34)
  ds_read_b128 v[32:35], v245 offset:0
  s_waitcnt vmcnt(33)
  ds_read_b128 v[36:39], v245 offset:1024
  s_waitcnt vmcnt(32)
  ds_read_b128 v[40:43], v245 offset:2048
  s_waitcnt lgkmcnt(2)
  v_mfma_f32_16x16x32_bf16 v[160:163], v[168:171], v[32:35], 0
  s_waitcnt vmcnt(31)
  ds_read_b128 v[44:47], v245 offset:3072
  v_mfma_f32_16x16x32_bf16 v[164:167], v[32:35], v[32:35], 0
  s_waitcnt lgkmcnt(2)
  v_mfma_f32_16x16x32_bf16 v[160:163], v[168:171], v[36:39], v[160:163]
  s_waitcnt vmcnt(30)
  ds_read_b128 v[48:51], v245 offset:4096
  v_mfma_f32_16x16x32_bf16 v[164:167], v[36:39], v[36:39], v[164:167]
  s_waitcnt lgkmcnt(2)
  v_mfma_f32_16x16x32_bf16 v[160:163], v[168:171], v[40:43], v[160:163]
  s_waitcnt vmcnt(29)
  ds_read_b128 v[52:55], v245 offset:5120
  v_mfma_f32_16x16x32_bf16 v[164:167], v[40:43], v[40:43], v[164:167]
  s_waitcnt lgkmcnt(2)
  v_mfma_f32_16x16x32_bf16 v[160:163], v[168:171], v[44:47], v[160:163]
  s_waitcnt vmcnt(28)
  ds_read_b128 v[56:59], v245 offset:6144
  v_mfma_f32_16x16x32_bf16 v[164:167], v[44:47], v[44:47], v[164:167]
  s_waitcnt lgkmcnt(2)
  v_mfma_f32_16x16x32_bf16 v[160:163], v[168:171], v[48:51], v[160:163]
  s_waitcnt vmcnt(27)
  ds_read_b128 v[60:63], v245 offset:7168
  v_mfma_f32_16x16x32_bf16 v[164:167], v[48:51], v[48:51], v[164:167]
  s_waitcnt lgkmcnt(2)
  v_mfma_f32_16x16x32_bf16 v[160:163], v[168:171], v[52:55], v[160:163]
  s_waitcnt vmcnt(26)
  ds_read_b128 v[64:67], v245 offset:8192
  v_mfma_f32_16x16x32_bf16 v[164:167], v[52:55], v[52:55], v[164:167]
  s_waitcnt lgkmcnt(2)
  v_mfma_f32_16x16x32_bf16 v[160:163], v[168:171], v[56:59], v[160:163]
  s_waitcnt vmcnt(25)
  ds_read_b128 v[68:71], v245 offset:9216
  v_mfma_f32_16x16x32_bf16 v[164:167], v[56:59], v[56:59], v[164:167]
  s_waitcnt lgkmcnt(2)
  v_mfma_f32_16x16x32_bf16 v[160:163], v[168:171], v[60:63], v[160:163]
  s_waitcnt vmcnt(24)
  ds_read_b128 v[72:75], v245 offset:10240
  v_mfma_f32_16x16x32_bf16 v[164:167], v[60:63], v[60:63], v[164:167]
  s_waitcnt lgkmcnt(2)
  v_mfma_f32_16x16x32_bf16 v[160:163], v[168:171], v[64:67], v[160:163]
  s_waitcnt vmcnt(23)
  ds_read_b128 v[76:79], v245 offset:11264
  v_mfma_f32_16x16x32_bf16 v[164:167], v[64:67], v[64:67], v[164:167]
  s_waitcnt lgkmcnt(2)
  v_mfma_f32_16x16x32_bf16 v[160:163], v[168:171], v[68:71], v[160:163]
  s_waitcnt vmcnt(22)
  ds_read_b128 v[80:83], v245 offset:12288
  v_mfma_f32_16x16x32_bf16 v[164:167], v[68:71], v[68:71], v[164:167]
  s_waitcnt lgkmcnt(2)
  v_mfma_f32_16x16x32_bf16 v[160:163], v[168:171], v[72:75], v[160:163]
  s_waitcnt vmcnt(21)
  ds_read_b128 v[84:87], v245 offset:13312
  v_mfma_f32_16x16x32_bf16 v[164:167], v[72:75], v[72:75], v[164:167]
  s_waitcnt lgkmcnt(2)
  v_mfma_f32_16x16x32_bf16 v[160:163], v[168:171], v[76:79], v[160:163]
  s_waitcnt vmcnt(20)
  ds_read_b128 v[88:91], v245 offset:14336
  v_mfma_f32_16x16x32_bf16 v[164:167], v[76:79], v[76:79], v[164:167]
  s_waitcnt lgkmcnt(2)
  v_mfma_f32_16x16x32_bf16 v[160:163], v[168:171], v[80:83], v[160:163]
  s_waitcnt vmcnt(19)
  ds_read_b128 v[92:95], v245 offset:15360
  v_mfma_f32_16x16x32_bf16 v[164:167], v[80:83], v[80:83], v[164:167]
  s_waitcnt lgkmcnt(2)
  v_mfma_f32_16x16x32_bf16 v[160:163], v[168:171], v[84:87], v[160:163]
  s_waitcnt vmcnt(18)
  ds_read_b128 v[96:99], v245 offset:16384
  v_mfma_f32_16x16x32_bf16 v[164:167], v[84:87], v[84:87], v[164:167]
  s_waitcnt lgkmcnt(2)
  v_mfma_f32_16x16x32_bf16 v[160:163], v[168:171], v[88:91], v[160:163]
  s_waitcnt vmcnt(17)
  ds_read_b128 v[100:103], v245 offset:17408
  v_mfma_f32_16x16x32_bf16 v[164:167], v[88:91], v[88:91], v[164:167]
  s_waitcnt lgkmcnt(2)
  v_mfma_f32_16x16x32_bf16 v[160:163], v[168:171], v[92:95], v[160:163]
  s_waitcnt vmcnt(16)
  ds_read_b128 v[104:107], v245 offset:18432
  v_mfma_f32_16x16x32_bf16 v[164:167], v[92:95], v[92:95], v[164:167]
  s_waitcnt lgkmcnt(2)
  v_mfma_f32_16x16x32_bf16 v[160:163], v[168:171], v[96:99], v[160:163]
  s_waitcnt vmcnt(15)
  ds_read_b128 v[108:111], v245 offset:19456
  v_mfma_f32_16x16x32_bf16 v[164:167], v[96:99], v[96:99], v[164:167]
  s_waitcnt lgkmcnt(2)
  v_mfma_f32_16x16x32_bf16 v[160:163], v[168:171], v[100:103], v[160:163]
  v_mfma_f32_16x16x32_bf16 v[164:167], v[100:103], v[100:103], v[164:167]
  s_waitcnt lgkmcnt(1)
  v_mfma_f32_16x16x32_bf16 v[160:163], v[168:171], v[104:107], v[160:163]
  v_mfma_f32_16x16x32_bf16 v[164:167], v[104:107], v[104:107], v[164:167]
  s_waitcnt lgkmcnt(0)
  v_mfma_f32_16x16x32_bf16 v[160:163], v[168:171], v[108:111], v[160:163]
  v_mfma_f32_16x16x32_bf16 v[164:167], v[108:111], v[108:111], v[164:167]
  s_waitcnt vmcnt(5)
  s_barrier
  s_mov_b32 s94, 0x22222222
  s_min_u32 s19, s16, 19
  s_add_u32 s22, s19, s18
  s_mov_b32 s95, 0x22222222
  s_mul_i32 s19, s19, 5120
  s_mov_b32 s96, 0x44444444
  s_cmp_ge_u32 s22, 20
  s_cselect_b32 s23, 20, 0
  s_mov_b32 s97, 0x44444444
  s_sub_u32 s22, s22, s23
  s_mul_i32 s22, s22, 40960
  s_mov_b32 s98, 0x88888888
  s_add_u32 s16, s16, 3
  s_add_u32 m0, s19, 0
  s_mov_b32 s99, 0x88888888
  buffer_load_dwordx4 v4, s[32:35], s22 offen offset:0 lds
  v_cndmask_b32 v164, v164, v165, s[94:95]
  buffer_load_dwordx4 v5, s[32:35], s22 offen offset:1024 lds
  v_cndmask_b32 v164, v164, v166, s[96:97]
  v_cndmask_b32 v164, v164, v167, s[98:99]
  ds_bpermute_b32 v22, v244, v164
  v_mul_f32 v12, 0x3acccccd, v160
  v_mul_f32 v25, v12, v12
  v_mov_b32 v15, 0x3acccccd
  buffer_load_dwordx4 v6, s[32:35], s22 offen offset:2048 lds
  s_waitcnt lgkmcnt(0)
  v_fma_f32 v25, v22, v15, -v25
  v_max_f32 v25, 0, v25
  v_add_f32 v25, 0x3727c5ac, v25
  v_rsq_f32 v15, v25
  v_sub_f32 v204, 0, v12
  v_sub_f32 v205, 0, v12
  buffer_load_dwordx4 v7, s[32:35], s22 offen offset:3072 lds
  v_sub_f32 v206, 0, v12
  v_sub_f32 v207, 0, v12
  s_nop 1
  v_mfma_f32_16x16x32_bf16 v[172:175], v[196:199], v[32:35], v[204:207]
  v_mfma_f32_16x16x32_bf16 v[176:179], v[200:203], v[32:35], v[204:207]
  v_mfma_f32_16x16x32_bf16 v[180:183], v[196:199], v[36:39], v[204:207]
  v_mfma_f32_16x16x32_bf16 v[184:187], v[200:203], v[36:39], v[204:207]
  s_add_u32 m0, s19, 4096
  v_mfma_f32_16x16x32_bf16 v[188:191], v[196:199], v[40:43], v[204:207]
  buffer_load_dwordx4 v8, s[32:35], s22 offen offset:0 lds
  s_nop 1
  v_cvt_pk_bf16_f32 v32, v172, v173
  v_cvt_pk_bf16_f32 v33, v174, v175
  v_mfma_f32_16x16x32_bf16 v[192:195], v[200:203], v[40:43], v[204:207]
  v_cvt_pk_bf16_f32 v34, v176, v177
  v_cvt_pk_bf16_f32 v35, v178, v179
  s_min_u32 s19, s16, 19
  s_add_u32 s22, s19, s18
  v_mfma_f32_16x16x32_bf16 v[172:175], v[196:199], v[44:47], v[204:207]
  s_mul_i32 s19, s19, 5120
  v_cvt_pk_bf16_f32 v36, v180, v181
  s_cmp_ge_u32 s22, 20
  s_cselect_b32 s23, 20, 0
  v_cvt_pk_bf16_f32 v37, v182, v183
  s_sub_u32 s22, s22, s23
  s_mul_i32 s22, s22, 40960
  v_mfma_f32_16x16x32_bf16 v[176:179], v[200:203], v[44:47], v[204:207]
  s_add_u32 s16, s16, 3
  s_add_u32 m0, s19, 0
  v_cvt_pk_bf16_f32 v38, v184, v185
  buffer_load_dwordx4 v4, s[32:35], s22 offen offset:0 lds
  v_cvt_pk_bf16_f32 v39, v186, v187
  buffer_load_dwordx4 v5, s[32:35], s22 offen offset:1024 lds
  v_mfma_f32_16x16x32_bf16 v[180:183], v[196:199], v[48:51], v[204:207]
  v_cvt_pk_bf16_f32 v40, v188, v189
  v_cvt_pk_bf16_f32 v41, v190, v191
  v_mfma_f32_16x16x32_bf16 v[184:187], v[200:203], v[48:51], v[204:207]
  v_cvt_pk_bf16_f32 v42, v192, v193
  v_cvt_pk_bf16_f32 v43, v194, v195
  buffer_load_dwordx4 v6, s[32:35], s22 offen offset:2048 lds
  v_mfma_f32_16x16x32_bf16 v[188:191], v[196:199], v[52:55], v[204:207]
  v_cvt_pk_bf16_f32 v44, v172, v173
  v_cvt_pk_bf16_f32 v45, v174, v175
  v_mfma_f32_16x16x32_bf16 v[192:195], v[200:203], v[52:55], v[204:207]
  v_cvt_pk_bf16_f32 v46, v176, v177
  v_cvt_pk_bf16_f32 v47, v178, v179
  buffer_load_dwordx4 v7, s[32:35], s22 offen offset:3072 lds
  v_mfma_f32_16x16x32_bf16 v[172:175], v[196:199], v[56:59], v[204:207]
  v_cvt_pk_bf16_f32 v48, v180, v181
  v_cvt_pk_bf16_f32 v49, v182, v183
  v_mfma_f32_16x16x32_bf16 v[176:179], v[200:203], v[56:59], v[204:207]
  v_cvt_pk_bf16_f32 v50, v184, v185
  v_cvt_pk_bf16_f32 v51, v186, v187
  s_add_u32 m0, s19, 4096
  v_mfma_f32_16x16x32_bf16 v[180:183], v[196:199], v[60:63], v[204:207]
  buffer_load_dwordx4 v8, s[32:35], s22 offen offset:0 lds
  v_cvt_pk_bf16_f32 v52, v188, v189
  v_cvt_pk_bf16_f32 v53, v190, v191
  v_mfma_f32_16x16x32_bf16 v[184:187], v[200:203], v[60:63], v[204:207]
  v_cvt_pk_bf16_f32 v54, v192, v193
  v_cvt_pk_bf16_f32 v55, v194, v195
  s_min_u32 s19, s16, 19
  s_add_u32 s22, s19, s18
  v_mfma_f32_16x16x32_bf16 v[188:191], v[196:199], v[64:67], v[204:207]
  s_mul_i32 s19, s19, 5120
  v_cvt_pk_bf16_f32 v56, v172, v173
  s_cmp_ge_u32 s22, 20
  s_cselect_b32 s23, 20, 0
  v_cvt_pk_bf16_f32 v57, v174, v175
  s_sub_u32 s22, s22, s23
  s_mul_i32 s22, s22, 40960
  v_mfma_f32_16x16x32_bf16 v[192:195], v[200:203], v[64:67], v[204:207]
  s_add_u32 s16, s16, 3
  s_add_u32 m0, s19, 0
  v_cvt_pk_bf16_f32 v58, v176, v177
  buffer_load_dwordx4 v4, s[32:35], s22 offen offset:0 lds
  v_cvt_pk_bf16_f32 v59, v178, v179
  buffer_load_dwordx4 v5, s[32:35], s22 offen offset:1024 lds
  v_mfma_f32_16x16x32_bf16 v[172:175], v[196:199], v[68:71], v[204:207]
  v_cvt_pk_bf16_f32 v60, v180, v181
  v_cvt_pk_bf16_f32 v61, v182, v183
  v_mfma_f32_16x16x32_bf16 v[176:179], v[200:203], v[68:71], v[204:207]
  v_cvt_pk_bf16_f32 v62, v184, v185
  v_cvt_pk_bf16_f32 v63, v186, v187
  buffer_load_dwordx4 v6, s[32:35], s22 offen offset:2048 lds
  v_mfma_f32_16x16x32_bf16 v[180:183], v[196:199], v[72:75], v[204:207]
  v_cvt_pk_bf16_f32 v64, v188, v189
  v_cvt_pk_bf16_f32 v65, v190, v191
  v_mfma_f32_16x16x32_bf16 v[184:187], v[200:203], v[72:75], v[204:207]
  v_cvt_pk_bf16_f32 v66, v192, v193
  v_cvt_pk_bf16_f32 v67, v194, v195
  buffer_load_dwordx4 v7, s[32:35], s22 offen offset:3072 lds
  v_mfma_f32_16x16x32_bf16 v[188:191], v[196:199], v[76:79], v[204:207]
  v_cvt_pk_bf16_f32 v68, v172, v173
  v_cvt_pk_bf16_f32 v69, v174, v175
  v_mfma_f32_16x16x32_bf16 v[192:195], v[200:203], v[76:79], v[204:207]
  v_cvt_pk_bf16_f32 v70, v176, v177
  v_cvt_pk_bf16_f32 v71, v178, v179
  s_add_u32 m0, s19, 4096
  v_mfma_f32_16x16x32_bf16 v[172:175], v[196:199], v[80:83], v[204:207]
  buffer_load_dwordx4 v8, s[32:35], s22 offen offset:0 lds
  v_cvt_pk_bf16_f32 v72, v180, v181
  v_cvt_pk_bf16_f32 v73, v182, v183
  v_mfma_f32_16x16x32_bf16 v[176:179], v[200:203], v[80:83], v[204:207]
  v_cvt_pk_bf16_f32 v74, v184, v185
  v_cvt_pk_bf16_f32 v75, v186, v187
  s_min_u32 s19, s16, 19
  s_add_u32 s22, s19, s18
  v_mfma_f32_16x16x32_bf16 v[180:183], v[196:199], v[84:87], v[204:207]
  s_mul_i32 s19, s19, 5120
  v_cvt_pk_bf16_f32 v76, v188, v189
  s_cmp_ge_u32 s22, 20
  s_cselect_b32 s23, 20, 0
  v_cvt_pk_bf16_f32 v77, v190, v191
  s_sub_u32 s22, s22, s23
  s_mul_i32 s22, s22, 40960
  v_mfma_f32_16x16x32_bf16 v[184:187], v[200:203], v[84:87], v[204:207]
  s_add_u32 s16, s16, 3
  s_add_u32 m0, s19, 0
  v_cvt_pk_bf16_f32 v78, v192, v193
  buffer_load_dwordx4 v4, s[32:35], s22 offen offset:0 lds
  v_cvt_pk_bf16_f32 v79, v194, v195
  buffer_load_dwordx4 v5, s[32:35], s22 offen offset:1024 lds
  v_mfma_f32_16x16x32_bf16 v[188:191], v[196:199], v[88:91], v[204:207]
  v_cvt_pk_bf16_f32 v80, v172, v173
  v_cvt_pk_bf16_f32 v81, v174, v175
  v_mfma_f32_16x16x32_bf16 v[192:195], v[200:203], v[88:91], v[204:207]
  v_cvt_pk_bf16_f32 v82, v176, v177
  v_cvt_pk_bf16_f32 v83, v178, v179
  buffer_load_dwordx4 v6, s[32:35], s22 offen offset:2048 lds
  v_mfma_f32_16x16x32_bf16 v[172:175], v[196:199], v[92:95], v[204:207]
  v_cvt_pk_bf16_f32 v84, v180, v181
  v_cvt_pk_bf16_f32 v85, v182, v183
  v_mfma_f32_16x16x32_bf16 v[176:179], v[200:203], v[92:95], v[204:207]
  v_cvt_pk_bf16_f32 v86, v184, v185
  v_cvt_pk_bf16_f32 v87, v186, v187
  buffer_load_dwordx4 v7, s[32:35], s22 offen offset:3072 lds
  v_mfma_f32_16x16x32_bf16 v[180:183], v[196:199], v[96:99], v[204:207]
  v_cvt_pk_bf16_f32 v88, v188, v189
  v_cvt_pk_bf16_f32 v89, v190, v191
  v_mfma_f32_16x16x32_bf16 v[184:187], v[200:203], v[96:99], v[204:207]
  v_cvt_pk_bf16_f32 v90, v192, v193
  v_cvt_pk_bf16_f32 v91, v194, v195
  s_add_u32 m0, s19, 4096
  v_mfma_f32_16x16x32_bf16 v[188:191], v[196:199], v[100:103], v[204:207]
  buffer_load_dwordx4 v8, s[32:35], s22 offen offset:0 lds
  v_cvt_pk_bf16_f32 v92, v172, v173
  v_cvt_pk_bf16_f32 v93, v174, v175
  v_mfma_f32_16x16x32_bf16 v[192:195], v[200:203], v[100:103], v[204:207]
  v_cvt_pk_bf16_f32 v94, v176, v177
  v_cvt_pk_bf16_f32 v95, v178, v179
  v_mfma_f32_16x16x32_bf16 v[172:175], v[196:199], v[104:107], v[204:207]
  v_cvt_pk_bf16_f32 v96, v180, v181
  v_cvt_pk_bf16_f32 v97, v182, v183
  v_mfma_f32_16x16x32_bf16 v[176:179], v[200:203], v[104:107], v[204:207]
  v_cvt_pk_bf16_f32 v98, v184, v185
  v_cvt_pk_bf16_f32 v99, v186, v187
  v_mfma_f32_16x16x32_bf16 v[180:183], v[196:199], v[108:111], v[204:207]
  v_cvt_pk_bf16_f32 v100, v188, v189
  v_cvt_pk_bf16_f32 v101, v190, v191
  v_mfma_f32_16x16x32_bf16 v[184:187], v[200:203], v[108:111], v[204:207]
  v_cvt_pk_bf16_f32 v102, v192, v193
  v_cvt_pk_bf16_f32 v103, v194, v195
  v_cvt_pk_bf16_f32 v104, v172, v173
  v_cvt_pk_bf16_f32 v105, v174, v175
  v_cvt_pk_bf16_f32 v106, v176, v177
  v_cvt_pk_bf16_f32 v107, v178, v179
  v_cvt_pk_bf16_f32 v108, v180, v181
  v_cvt_pk_bf16_f32 v109, v182, v183
  v_cvt_pk_bf16_f32 v110, v184, v185
  v_cvt_pk_bf16_f32 v111, v186, v187
  s_waitcnt vmcnt(15)
  s_barrier
  ds_read_b64_tr_b16 v[112:113], v9 offset:0
  ds_read_b64_tr_b16 v[114:115], v9 offset:1280
  ds_read_b64_tr_b16 v[116:117], v9 offset:32
  ds_read_b64_tr_b16 v[118:119], v9 offset:1312
  ds_read_b64_tr_b16 v[120:121], v9 offset:64
  ds_read_b64_tr_b16 v[122:123], v9 offset:1344
  ds_read_b64_tr_b16 v[124:125], v9 offset:96
  ds_read_b64_tr_b16 v[126:127], v9 offset:1376
  ds_read_b64_tr_b16 v[128:129], v9 offset:128
  ds_read_b64_tr_b16 v[130:131], v9 offset:1408
  ds_read_b64_tr_b16 v[132:133], v9 offset:5120
  ds_read_b64_tr_b16 v[134:135], v9 offset:6400
  ds_read_b64_tr_b16 v[136:137], v9 offset:5152
  ds_read_b64_tr_b16 v[138:139], v9 offset:6432
  s_min_u32 s19, s16, 19
  s_add_u32 s22, s19, s18
  s_mul_i32 s19, s19, 5120
  s_cmp_ge_u32 s22, 20
  s_cselect_b32 s23, 20, 0
  s_sub_u32 s22, s22, s23
  s_mul_i32 s22, s22, 40960
  s_add_u32 s16, s16, 3
  s_add_u32 m0, s19, 0
  s_nop 0
  buffer_load_dwordx4 v4, s[32:35], s22 offen offset:0 lds
  buffer_load_dwordx4 v5, s[32:35], s22 offen offset:1024 lds
  buffer_load_dwordx4 v6, s[32:35], s22 offen offset:2048 lds
  buffer_load_dwordx4 v7, s[32:35], s22 offen offset:3072 lds
  s_add_u32 m0, s19, 4096
  s_nop 0
  buffer_load_dwordx4 v8, s[32:35], s22 offen offset:0 lds
  s_waitcnt lgkmcnt(12)
  v_mfma_f32_16x16x32_bf16 v[144:147], v[112:115], v[32:35], 0
  s_waitcnt lgkmcnt(10)
  ds_read_b64_tr_b16 v[140:141], v9 offset:5184
  ds_read_b64_tr_b16 v[142:143], v9 offset:6464
  v_mfma_f32_16x16x32_bf16 v[148:151], v[116:119], v[32:35], 0
  s_waitcnt lgkmcnt(10)
  ds_read_b64_tr_b16 v[112:113], v9 offset:5216
  ds_read_b64_tr_b16 v[114:115], v9 offset:6496
  v_mfma_f32_16x16x32_bf16 v[152:155], v[120:123], v[32:35], 0
  s_waitcnt lgkmcnt(10)
  ds_read_b64_tr_b16 v[116:117], v9 offset:5248
  ds_read_b64_tr_b16 v[118:119], v9 offset:6528
  v_mfma_f32_16x16x32_bf16 v[156:159], v[124:127], v[32:35], 0
  s_waitcnt lgkmcnt(10)
  ds_read_b64_tr_b16 v[120:121], v9 offset:10240
  ds_read_b64_tr_b16 v[122:123], v9 offset:11520
  v_mfma_f32_16x16x32_bf16 v[160:163], v[128:131], v[32:35], 0
  ds_read_b64_tr_b16 v[124:125], v9 offset:10272
  ds_read_b64_tr_b16 v[126:127], v9 offset:11552
  s_min_u32 s19, s16, 19
  s_add_u32 s22, s19, s18
  s_mul_i32 s19, s19, 5120
  s_cmp_ge_u32 s22, 20
  s_cselect_b32 s23, 20, 0
  s_sub_u32 s22, s22, s23
  s_mul_i32 s22, s22, 40960
  s_add_u32 s16, s16, 3
  s_add_u32 m0, s19, 0
  s_nop 0
  buffer_load_dwordx4 v4, s[32:35], s22 offen offset:0 lds
  buffer_load_dwordx4 v5, s[32:35], s22 offen offset:1024 lds
  buffer_load_dwordx4 v6, s[32:35], s22 offen offset:2048 lds
  buffer_load_dwordx4 v7, s[32:35], s22 offen offset:3072 lds
  s_add_u32 m0, s19, 4096
  s_nop 0
  buffer_load_dwordx4 v8, s[32:35], s22 offen offset:0 lds
  s_waitcnt lgkmcnt(12)
  v_mfma_f32_16x16x32_bf16 v[144:147], v[132:135], v[36:39], v[144:147]
  s_waitcnt lgkmcnt(10)
  ds_read_b64_tr_b16 v[128:129], v9 offset:10304
  ds_read_b64_tr_b16 v[130:131], v9 offset:11584
  v_mfma_f32_16x16x32_bf16 v[148:151], v[136:139], v[36:39], v[148:151]
  s_waitcnt lgkmcnt(10)
  ds_read_b64_tr_b16 v[132:133], v9 offset:10336
  ds_read_b64_tr_b16 v[134:135], v9 offset:11616
  v_mfma_f32_16x16x32_bf16 v[152:155], v[140:143], v[36:39], v[152:155]
  s_waitcnt lgkmcnt(10)
  ds_read_b64_tr_b16 v[136:137], v9 offset:10368
  ds_read_b64_tr_b16 v[138:139], v9 offset:11648
  v_mfma_f32_16x16x32_bf16 v[156:159], v[112:115], v[36:39], v[156:159]
  s_waitcnt lgkmcnt(10)
  ds_read_b64_tr_b16 v[140:141], v9 offset:15360
  ds_read_b64_tr_b16 v[142:143], v9 offset:16640
  v_mfma_f32_16x16x32_bf16 v[160:163], v[116:119], v[36:39], v[160:163]
  s_waitcnt lgkmcnt(10)
  ds_read_b64_tr_b16 v[112:113], v9 offset:15392
  ds_read_b64_tr_b16 v[114:115], v9 offset:16672
  v_mfma_f32_16x16x32_bf16 v[144:147], v[120:123], v[40:43], v[144:147]
  s_waitcnt lgkmcnt(10)
  ds_read_b64_tr_b16 v[116:117], v9 offset:15424
  ds_read_b64_tr_b16 v[118:119], v9 offset:16704
  v_mfma_f32_16x16x32_bf16 v[148:151], v[124:127], v[40:43], v[148:151]
  s_waitcnt lgkmcnt(10)
  ds_read_b64_tr_b16 v[120:121], v9 offset:15456
  ds_read_b64_tr_b16 v[122:123], v9 offset:16736
  v_mfma_f32_16x16x32_bf16 v[152:155], v[128:131], v[40:43], v[152:155]
  s_waitcnt lgkmcnt(10)
  ds_read_b64_tr_b16 v[124:125], v9 offset:15488
  ds_read_b64_tr_b16 v[126:127], v9 offset:16768
  v_mfma_f32_16x16x32_bf16 v[156:159], v[132:135], v[40:43], v[156:159]
  s_waitcnt lgkmcnt(10)
  ds_read_b64_tr_b16 v[128:129], v9 offset:20480
  ds_read_b64_tr_b16 v[130:131], v9 offset:21760
  v_mfma_f32_16x16x32_bf16 v[160:163], v[136:139], v[40:43], v[160:163]
  s_waitcnt lgkmcnt(10)
  ds_read_b64_tr_b16 v[132:133], v9 offset:20512
  ds_read_b64_tr_b16 v[134:135], v9 offset:21792
  v_mfma_f32_16x16x32_bf16 v[144:147], v[140:143], v[44:47], v[144:147]
  s_waitcnt lgkmcnt(10)
  ds_read_b64_tr_b16 v[136:137], v9 offset:20544
  ds_read_b64_tr_b16 v[138:139], v9 offset:21824
  v_mfma_f32_16x16x32_bf16 v[148:151], v[112:115], v[44:47], v[148:151]
  s_waitcnt lgkmcnt(10)
  ds_read_b64_tr_b16 v[140:141], v9 offset:20576
  ds_read_b64_tr_b16 v[142:143], v9 offset:21856
  v_mfma_f32_16x16x32_bf16 v[152:155], v[116:119], v[44:47], v[152:155]
  s_waitcnt lgkmcnt(10)
  ds_read_b64_tr_b16 v[112:113], v9 offset:20608
  ds_read_b64_tr_b16 v[114:115], v9 offset:21888
  v_mfma_f32_16x16x32_bf16 v[156:159], v[120:123], v[44:47], v[156:159]
  s_waitcnt lgkmcnt(10)
  ds_read_b64_tr_b16 v[116:117], v9 offset:25600
  ds_read_b64_tr_b16 v[118:119], v9 offset:26880
  v_mfma_f32_16x16x32_bf16 v[160:163], v[124:127], v[44:47], v[160:163]
  ds_read_b64_tr_b16 v[120:121], v9 offset:25632
  ds_read_b64_tr_b16 v[122:123], v9 offset:26912
  s_waitcnt vmcnt(15)
  s_barrier
  s_waitcnt lgkmcnt(12)
  v_mfma_f32_16x16x32_bf16 v[144:147], v[128:131], v[48:51], v[144:147]
  s_waitcnt lgkmcnt(10)
  ds_read_b64_tr_b16 v[124:125], v9 offset:25664
  ds_read_b64_tr_b16 v[126:127], v9 offset:26944
  v_mfma_f32_16x16x32_bf16 v[148:151], v[132:135], v[48:51], v[148:151]
  s_waitcnt lgkmcnt(10)
  ds_read_b64_tr_b16 v[128:129], v9 offset:25696
  ds_read_b64_tr_b16 v[130:131], v9 offset:26976
  v_mfma_f32_16x16x32_bf16 v[152:155], v[136:139], v[48:51], v[152:155]
  s_waitcnt lgkmcnt(10)
  ds_read_b64_tr_b16 v[132:133], v9 offset:25728
  ds_read_b64_tr_b16 v[134:135], v9 offset:27008
  v_mfma_f32_16x16x32_bf16 v[156:159], v[140:143], v[48:51], v[156:159]
  s_waitcnt lgkmcnt(10)
  ds_read_b64_tr_b16 v[136:137], v9 offset:30720
  ds_read_b64_tr_b16 v[138:139], v9 offset:32000
  v_mfma_f32_16x16x32_bf16 v[160:163], v[112:115], v[48:51], v[160:163]
  s_waitcnt lgkmcnt(10)
  ds_read_b64_tr_b16 v[140:141], v9 offset:30752
  ds_read_b64_tr_b16 v[142:143], v9 offset:32032
  v_mfma_f32_16x16x32_bf16 v[144:147], v[116:119], v[52:55], v[144:147]
  s_waitcnt lgkmcnt(10)
  ds_read_b64_tr_b16 v[112:113], v9 offset:30784
  ds_read_b64_tr_b16 v[114:115], v9 offset:32064
  v_mfma_f32_16x16x32_bf16 v[148:151], v[120:123], v[52:55], v[148:151]
  s_waitcnt lgkmcnt(10)
  ds_read_b64_tr_b16 v[116:117], v9 offset:30816
  ds_read_b64_tr_b16 v[118:119], v9 offset:32096
  v_mfma_f32_16x16x32_bf16 v[152:155], v[124:127], v[52:55], v[152:155]
  s_waitcnt lgkmcnt(10)
  ds_read_b64_tr_b16 v[120:121], v9 offset:30848
  ds_read_b64_tr_b16 v[122:123], v9 offset:32128
  v_mfma_f32_16x16x32_bf16 v[156:159], v[128:131], v[52:55], v[156:159]
  s_waitcnt lgkmcnt(10)
  ds_read_b64_tr_b16 v[124:125], v9 offset:35840
  ds_read_b64_tr_b16 v[126:127], v9 offset:37120
  v_mfma_f32_16x16x32_bf16 v[160:163], v[132:135], v[52:55], v[160:163]
  s_waitcnt lgkmcnt(10)
  ds_read_b64_tr_b16 v[128:129], v9 offset:35872
  ds_read_b64_tr_b16 v[130:131], v9 offset:37152
  v_mfma_f32_16x16x32_bf16 v[144:147], v[136:139], v[56:59], v[144:147]
  s_waitcnt lgkmcnt(10)
  ds_read_b64_tr_b16 v[132:133], v9 offset:35904
  ds_read_b64_tr_b16 v[134:135], v9 offset:37184
  v_mfma_f32_16x16x32_bf16 v[148:151], v[140:143], v[56:59], v[148:151]
  s_waitcnt lgkmcnt(10)
  ds_read_b64_tr_b16 v[136:137], v9 offset:35936
  ds_read_b64_tr_b16 v[138:139], v9 offset:37216
  v_mfma_f32_16x16x32_bf16 v[152:155], v[112:115], v[56:59], v[152:155]
  s_waitcnt lgkmcnt(10)
  ds_read_b64_tr_b16 v[140:141], v9 offset:35968
  ds_read_b64_tr_b16 v[142:143], v9 offset:37248
  v_mfma_f32_16x16x32_bf16 v[156:159], v[116:119], v[56:59], v[156:159]
  s_waitcnt lgkmcnt(10)
  ds_read_b64_tr_b16 v[112:113], v9 offset:40960
  ds_read_b64_tr_b16 v[114:115], v9 offset:42240
  v_mfma_f32_16x16x32_bf16 v[160:163], v[120:123], v[56:59], v[160:163]
  s_waitcnt lgkmcnt(10)
  ds_read_b64_tr_b16 v[116:117], v9 offset:40992
  ds_read_b64_tr_b16 v[118:119], v9 offset:42272
  v_mfma_f32_16x16x32_bf16 v[144:147], v[124:127], v[60:63], v[144:147]
  s_waitcnt lgkmcnt(10)
  ds_read_b64_tr_b16 v[120:121], v9 offset:41024
  ds_read_b64_tr_b16 v[122:123], v9 offset:42304
  v_mfma_f32_16x16x32_bf16 v[148:151], v[128:131], v[60:63], v[148:151]
  s_waitcnt lgkmcnt(10)
  ds_read_b64_tr_b16 v[124:125], v9 offset:41056
  ds_read_b64_tr_b16 v[126:127], v9 offset:42336
  v_mfma_f32_16x16x32_bf16 v[152:155], v[132:135], v[60:63], v[152:155]
  s_waitcnt lgkmcnt(10)
  ds_read_b64_tr_b16 v[128:129], v9 offset:41088
  ds_read_b64_tr_b16 v[130:131], v9 offset:42368
  v_mfma_f32_16x16x32_bf16 v[156:159], v[136:139], v[60:63], v[156:159]
  s_waitcnt lgkmcnt(10)
  ds_read_b64_tr_b16 v[132:133], v9 offset:46080
  ds_read_b64_tr_b16 v[134:135], v9 offset:47360
  v_mfma_f32_16x16x32_bf16 v[160:163], v[140:143], v[60:63], v[160:163]
  s_waitcnt lgkmcnt(10)
  ds_read_b64_tr_b16 v[136:137], v9 offset:46112
  ds_read_b64_tr_b16 v[138:139], v9 offset:47392
  v_mfma_f32_16x16x32_bf16 v[144:147], v[112:115], v[64:67], v[144:147]
  s_waitcnt lgkmcnt(10)
  ds_read_b64_tr_b16 v[140:141], v9 offset:46144
  ds_read_b64_tr_b16 v[142:143], v9 offset:47424
  v_mfma_f32_16x16x32_bf16 v[148:151], v[116:119], v[64:67], v[148:151]
  s_waitcnt lgkmcnt(10)
  ds_read_b64_tr_b16 v[112:113], v9 offset:46176
  ds_read_b64_tr_b16 v[114:115], v9 offset:47456
  v_mfma_f32_16x16x32_bf16 v[152:155], v[120:123], v[64:67], v[152:155]
  s_waitcnt lgkmcnt(10)
  ds_read_b64_tr_b16 v[116:117], v9 offset:46208
  ds_read_b64_tr_b16 v[118:119], v9 offset:47488
  v_mfma_f32_16x16x32_bf16 v[156:159], v[124:127], v[64:67], v[156:159]
  s_waitcnt lgkmcnt(10)
  ds_read_b64_tr_b16 v[120:121], v10 offset:0
  ds_read_b64_tr_b16 v[122:123], v10 offset:1280
  v_mfma_f32_16x16x32_bf16 v[160:163], v[128:131], v[64:67], v[160:163]
  s_waitcnt lgkmcnt(10)
  ds_read_b64_tr_b16 v[124:125], v10 offset:32
  ds_read_b64_tr_b16 v[126:127], v10 offset:1312
  v_mfma_f32_16x16x32_bf16 v[144:147], v[132:135], v[68:71], v[144:147]
  s_waitcnt lgkmcnt(10)
  ds_read_b64_tr_b16 v[128:129], v10 offset:64
  ds_read_b64_tr_b16 v[130:131], v10 offset:1344
  v_mfma_f32_16x16x32_bf16 v[148:151], v[136:139], v[68:71], v[148:151]
  s_waitcnt lgkmcnt(10)
  ds_read_b64_tr_b16 v[132:133], v10 offset:96
  ds_read_b64_tr_b16 v[134:135], v10 offset:1376
  v_mfma_f32_16x16x32_bf16 v[152:155], v[140:143], v[68:71], v[152:155]
  s_waitcnt lgkmcnt(10)
  ds_read_b64_tr_b16 v[136:137], v10 offset:128
  ds_read_b64_tr_b16 v[138:139], v10 offset:1408
  v_mfma_f32_16x16x32_bf16 v[156:159], v[112:115], v[68:71], v[156:159]
  s_waitcnt lgkmcnt(10)
  ds_read_b64_tr_b16 v[140:141], v10 offset:5120
  ds_read_b64_tr_b16 v[142:143], v10 offset:6400
  v_mfma_f32_16x16x32_bf16 v[160:163], v[116:119], v[68:71], v[160:163]
  ds_read_b64_tr_b16 v[112:113], v10 offset:5152
  ds_read_b64_tr_b16 v[114:115], v10 offset:6432
  s_waitcnt vmcnt(5)
  s_barrier
  s_waitcnt lgkmcnt(12)
  v_mfma_f32_16x16x32_bf16 v[144:147], v[120:123], v[72:75], v[144:147]
  s_waitcnt lgkmcnt(10)
  ds_read_b64_tr_b16 v[116:117], v10 offset:5184
  ds_read_b64_tr_b16 v[118:119], v10 offset:6464
  v_mfma_f32_16x16x32_bf16 v[148:151], v[124:127], v[72:75], v[148:151]
  s_waitcnt lgkmcnt(10)
  ds_read_b64_tr_b16 v[120:121], v10 offset:5216
  ds_read_b64_tr_b16 v[122:123], v10 offset:6496
  v_mfma_f32_16x16x32_bf16 v[152:155], v[128:131], v[72:75], v[152:155]
  s_waitcnt lgkmcnt(10)
  ds_read_b64_tr_b16 v[124:125], v10 offset:5248
  ds_read_b64_tr_b16 v[126:127], v10 offset:6528
  v_mfma_f32_16x16x32_bf16 v[156:159], v[132:135], v[72:75], v[156:159]
  s_waitcnt lgkmcnt(10)
  ds_read_b64_tr_b16 v[128:129], v10 offset:10240
  ds_read_b64_tr_b16 v[130:131], v10 offset:11520
  v_mfma_f32_16x16x32_bf16 v[160:163], v[136:139], v[72:75], v[160:163]
  s_waitcnt lgkmcnt(10)
  ds_read_b64_tr_b16 v[132:133], v10 offset:10272
  ds_read_b64_tr_b16 v[134:135], v10 offset:11552
  v_mfma_f32_16x16x32_bf16 v[144:147], v[140:143], v[76:79], v[144:147]
  s_waitcnt lgkmcnt(10)
  ds_read_b64_tr_b16 v[136:137], v10 offset:10304
  ds_read_b64_tr_b16 v[138:139], v10 offset:11584
  v_mfma_f32_16x16x32_bf16 v[148:151], v[112:115], v[76:79], v[148:151]
  s_waitcnt lgkmcnt(10)
  ds_read_b64_tr_b16 v[140:141], v10 offset:10336
  ds_read_b64_tr_b16 v[142:143], v10 offset:11616
  v_mfma_f32_16x16x32_bf16 v[152:155], v[116:119], v[76:79], v[152:155]
  s_waitcnt lgkmcnt(10)
  ds_read_b64_tr_b16 v[112:113], v10 offset:10368
  ds_read_b64_tr_b16 v[114:115], v10 offset:11648
  v_mfma_f32_16x16x32_bf16 v[156:159], v[120:123], v[76:79], v[156:159]
  s_waitcnt lgkmcnt(10)
  ds_read_b64_tr_b16 v[116:117], v10 offset:15360
  ds_read_b64_tr_b16 v[118:119], v10 offset:16640
  v_mfma_f32_16x16x32_bf16 v[160:163], v[124:127], v[76:79], v[160:163]
  s_waitcnt lgkmcnt(10)
  ds_read_b64_tr_b16 v[120:121], v10 offset:15392
  ds_read_b64_tr_b16 v[122:123], v10 offset:16672
  v_mfma_f32_16x16x32_bf16 v[144:147], v[128:131], v[80:83], v[144:147]
  s_waitcnt lgkmcnt(10)
  ds_read_b64_tr_b16 v[124:125], v10 offset:15424
  ds_read_b64_tr_b16 v[126:127], v10 offset:16704
  v_mfma_f32_16x16x32_bf16 v[148:151], v[132:135], v[80:83], v[148:151]
  s_waitcnt lgkmcnt(10)
  ds_read_b64_tr_b16 v[128:129], v10 offset:15456
  ds_read_b64_tr_b16 v[130:131], v10 offset:16736
  v_mfma_f32_16x16x32_bf16 v[152:155], v[136:139], v[80:83], v[152:155]
  s_waitcnt lgkmcnt(10)
  ds_read_b64_tr_b16 v[132:133], v10 offset:15488
  ds_read_b64_tr_b16 v[134:135], v10 offset:16768
  v_mfma_f32_16x16x32_bf16 v[156:159], v[140:143], v[80:83], v[156:159]
  s_waitcnt lgkmcnt(10)
  ds_read_b64_tr_b16 v[136:137], v10 offset:20480
  ds_read_b64_tr_b16 v[138:139], v10 offset:21760
  v_mfma_f32_16x16x32_bf16 v[160:163], v[112:115], v[80:83], v[160:163]
  s_waitcnt lgkmcnt(10)
  ds_read_b64_tr_b16 v[140:141], v10 offset:20512
  ds_read_b64_tr_b16 v[142:143], v10 offset:21792
  v_mfma_f32_16x16x32_bf16 v[144:147], v[116:119], v[84:87], v[144:147]
  s_waitcnt lgkmcnt(10)
  ds_read_b64_tr_b16 v[112:113], v10 offset:20544
  ds_read_b64_tr_b16 v[114:115], v10 offset:21824
  v_mfma_f32_16x16x32_bf16 v[148:151], v[120:123], v[84:87], v[148:151]
  s_waitcnt lgkmcnt(10)
  ds_read_b64_tr_b16 v[116:117], v10 offset:20576
  ds_read_b64_tr_b16 v[118:119], v10 offset:21856
  v_mfma_f32_16x16x32_bf16 v[152:155], v[124:127], v[84:87], v[152:155]
  s_waitcnt lgkmcnt(10)
  ds_read_b64_tr_b16 v[120:121], v10 offset:20608
  ds_read_b64_tr_b16 v[122:123], v10 offset:21888
  v_mfma_f32_16x16x32_bf16 v[156:159], v[128:131], v[84:87], v[156:159]
  s_waitcnt lgkmcnt(10)
  ds_read_b64_tr_b16 v[124:125], v10 offset:25600
  ds_read_b64_tr_b16 v[126:127], v10 offset:26880
  v_mfma_f32_16x16x32_bf16 v[160:163], v[132:135], v[84:87], v[160:163]
  s_waitcnt lgkmcnt(10)
  ds_read_b64_tr_b16 v[128:129], v10 offset:25632
  ds_read_b64_tr_b16 v[130:131], v10 offset:26912
  v_mfma_f32_16x16x32_bf16 v[144:147], v[136:139], v[88:91], v[144:147]
  s_waitcnt lgkmcnt(10)
  ds_read_b64_tr_b16 v[132:133], v10 offset:25664
  ds_read_b64_tr_b16 v[134:135], v10 offset:26944
  v_mfma_f32_16x16x32_bf16 v[148:151], v[140:143], v[88:91], v[148:151]
  s_waitcnt lgkmcnt(10)
  ds_read_b64_tr_b16 v[136:137], v10 offset:25696
  ds_read_b64_tr_b16 v[138:139], v10 offset:26976
  v_mfma_f32_16x16x32_bf16 v[152:155], v[112:115], v[88:91], v[152:155]
  s_waitcnt lgkmcnt(10)
  ds_read_b64_tr_b16 v[140:141], v10 offset:25728
  ds_read_b64_tr_b16 v[142:143], v10 offset:27008
  v_mfma_f32_16x16x32_bf16 v[156:159], v[116:119], v[88:91], v[156:159]
  s_waitcnt lgkmcnt(10)
  ds_read_b64_tr_b16 v[112:113], v10 offset:30720
  ds_read_b64_tr_b16 v[114:115], v10 offset:32000
  v_mfma_f32_16x16x32_bf16 v[160:163], v[120:123], v[88:91], v[160:163]
  s_waitcnt lgkmcnt(10)
  ds_read_b64_tr_b16 v[116:117], v10 offset:30752
  ds_read_b64_tr_b16 v[118:119], v10 offset:32032
  v_mfma_f32_16x16x32_bf16 v[144:147], v[124:127], v[92:95], v[144:147]
  s_waitcnt lgkmcnt(10)
  ds_read_b64_tr_b16 v[120:121], v10 offset:30784
  ds_read_b64_tr_b16 v[122:123], v10 offset:32064
  v_mfma_f32_16x16x32_bf16 v[148:151], v[128:131], v[92:95], v[148:151]
  s_waitcnt lgkmcnt(10)
  ds_read_b64_tr_b16 v[124:125], v10 offset:30816
  ds_read_b64_tr_b16 v[126:127], v10 offset:32096
  v_mfma_f32_16x16x32_bf16 v[152:155], v[132:135], v[92:95], v[152:155]
  s_waitcnt lgkmcnt(10)
  ds_read_b64_tr_b16 v[128:129], v10 offset:30848
  ds_read_b64_tr_b16 v[130:131], v10 offset:32128
  v_mfma_f32_16x16x32_bf16 v[156:159], v[136:139], v[92:95], v[156:159]
  s_waitcnt lgkmcnt(10)
  ds_read_b64_tr_b16 v[132:133], v10 offset:35840
  ds_read_b64_tr_b16 v[134:135], v10 offset:37120
  v_mfma_f32_16x16x32_bf16 v[160:163], v[140:143], v[92:95], v[160:163]
  ds_read_b64_tr_b16 v[136:137], v10 offset:35872
  ds_read_b64_tr_b16 v[138:139], v10 offset:37152
  s_waitcnt vmcnt(0)
  s_barrier
  s_waitcnt lgkmcnt(12)
  v_mfma_f32_16x16x32_bf16 v[144:147], v[112:115], v[96:99], v[144:147]
  s_waitcnt lgkmcnt(10)
  ds_read_b64_tr_b16 v[140:141], v10 offset:35904
  ds_read_b64_tr_b16 v[142:143], v10 offset:37184
  v_mfma_f32_16x16x32_bf16 v[148:151], v[116:119], v[96:99], v[148:151]
  s_waitcnt lgkmcnt(10)
  ds_read_b64_tr_b16 v[112:113], v10 offset:35936
  ds_read_b64_tr_b16 v[114:115], v10 offset:37216
  v_mfma_f32_16x16x32_bf16 v[152:155], v[120:123], v[96:99], v[152:155]
  s_waitcnt lgkmcnt(10)
  ds_read_b64_tr_b16 v[116:117], v10 offset:35968
  ds_read_b64_tr_b16 v[118:119], v10 offset:37248
  v_mfma_f32_16x16x32_bf16 v[156:159], v[124:127], v[96:99], v[156:159]
  s_waitcnt lgkmcnt(10)
  ds_read_b64_tr_b16 v[120:121], v10 offset:40960
  ds_read_b64_tr_b16 v[122:123], v10 offset:42240
  v_mfma_f32_16x16x32_bf16 v[160:163], v[128:131], v[96:99], v[160:163]
  s_waitcnt lgkmcnt(10)
  ds_read_b64_tr_b16 v[124:125], v10 offset:40992
  ds_read_b64_tr_b16 v[126:127], v10 offset:42272
  v_mfma_f32_16x16x32_bf16 v[144:147], v[132:135], v[100:103], v[144:147]
  s_waitcnt lgkmcnt(10)
  ds_read_b64_tr_b16 v[128:129], v10 offset:41024
  ds_read_b64_tr_b16 v[130:131], v10 offset:42304
  v_mfma_f32_16x16x32_bf16 v[148:151], v[136:139], v[100:103], v[148:151]
  s_waitcnt lgkmcnt(10)
  ds_read_b64_tr_b16 v[132:133], v10 offset:41056
  ds_read_b64_tr_b16 v[134:135], v10 offset:42336
  v_mfma_f32_16x16x32_bf16 v[152:155], v[140:143], v[100:103], v[152:155]
  s_waitcnt lgkmcnt(10)
  ds_read_b64_tr_b16 v[136:137], v10 offset:41088
  ds_read_b64_tr_b16 v[138:139], v10 offset:42368
  v_mfma_f32_16x16x32_bf16 v[156:159], v[112:115], v[100:103], v[156:159]
  s_waitcnt lgkmcnt(10)
  ds_read_b64_tr_b16 v[140:141], v10 offset:46080
  ds_read_b64_tr_b16 v[142:143], v10 offset:47360
  v_mfma_f32_16x16x32_bf16 v[160:163], v[116:119], v[100:103], v[160:163]
  s_waitcnt lgkmcnt(10)
  ds_read_b64_tr_b16 v[112:113], v10 offset:46112
  ds_read_b64_tr_b16 v[114:115], v10 offset:47392
  v_mfma_f32_16x16x32_bf16 v[144:147], v[120:123], v[104:107], v[144:147]
  s_waitcnt lgkmcnt(10)
  ds_read_b64_tr_b16 v[116:117], v10 offset:46144
  ds_read_b64_tr_b16 v[118:119], v10 offset:47424
  v_mfma_f32_16x16x32_bf16 v[148:151], v[124:127], v[104:107], v[148:151]
  s_waitcnt lgkmcnt(10)
  ds_read_b64_tr_b16 v[120:121], v10 offset:46176
  ds_read_b64_tr_b16 v[122:123], v10 offset:47456
  v_mfma_f32_16x16x32_bf16 v[152:155], v[128:131], v[104:107], v[152:155]
  s_waitcnt lgkmcnt(10)
  ds_read_b64_tr_b16 v[124:125], v10 offset:46208
  ds_read_b64_tr_b16 v[126:127], v10 offset:47488
  v_mfma_f32_16x16x32_bf16 v[156:159], v[132:135], v[104:107], v[156:159]
  s_waitcnt lgkmcnt(10)
  v_mfma_f32_16x16x32_bf16 v[160:163], v[136:139], v[104:107], v[160:163]
  s_waitcnt lgkmcnt(8)
  v_mfma_f32_16x16x32_bf16 v[144:147], v[140:143], v[108:111], v[144:147]
  s_waitcnt lgkmcnt(6)
  v_mfma_f32_16x16x32_bf16 v[148:151], v[112:115], v[108:111], v[148:151]
  s_waitcnt lgkmcnt(4)
  v_mfma_f32_16x16x32_bf16 v[152:155], v[116:119], v[108:111], v[152:155]
  s_waitcnt lgkmcnt(2)
  v_mfma_f32_16x16x32_bf16 v[156:159], v[120:123], v[108:111], v[156:159]
  s_waitcnt lgkmcnt(0)
  v_mfma_f32_16x16x32_bf16 v[160:163], v[124:127], v[108:111], v[160:163]
  s_waitcnt vmcnt(0) lgkmcnt(0)
  s_branch L_qdone
L_owner:
  v_mov_b32 v24, 1073741824
  s_lshl_b32 s12, s73, 2
  s_add_u32 s12, s12, s68
  s_mul_i32 s83, s12, 61440
  s_add_u32 s83, s83, 20971520
  s_lshl_b32 s12, s12, 8
  s_add_u32 s12, s12, 19005440
  v_min_u32 v20, 9, v2
  v_lshl_add_u32 v13, v20, 4, s12
  s_lshl_b32 s14, s71, 2
  s_add_u32 s14, s14, s68
  s_mul_i32 s89, s14, 61440
  s_add_u32 s89, s89, 25165824
  s_lshl_b32 s14, s14, 8
  s_add_u32 s27, s14, 19021824
  v_add_u32 v248, s84, v11
  s_xor_b32 s12, s68, 1
  s_mul_i32 s12, s12, 6144
  s_add_u32 s12, s12, 128000
  v_add_u32 v249, s12, v11
  s_lshl_b32 s12, s72, 2
  s_lshl_b32 s14, s79, 1
  s_add_u32 s12, s12, s14
  v_and_b32 v22, 1, v3
  v_add_u32 v22, s12, v22
  v_mul_u32_u24 v22, 20480, v22
  s_mul_i32 s12, s71, 10
  s_mul_i32 s14, s78, 5
  s_add_u32 s12, s12, s14
  v_lshrrev_b32 v21, 5, v1
  v_add_u32 v23, s12, v21
  v_lshl_add_u32 v22, v23, 8, v22
  v_lshl_add_u32 v22, v2, 4, v22
  v_add_u32 v250, 4194304, v22
  v_cmp_lt_u32 vcc, 31, v1
  s_nop 1
  v_cndmask_b32 v251, v24, v250, vcc
  s_lshl_b32 s12, s72, 1
  s_add_u32 s12, s12, s79
  s_lshl_b32 s12, s12, 8
  s_add_u32 s17, s12, 18907136
  s_lshl_b32 s14, s71, 1
  s_add_u32 s14, s14, s78
  s_lshl_b32 s14, s14, 4
  s_add_u32 s12, s17, s14
  v_mov_b32 v253, 1073741824
  v_mov_b32 v20, s12
  v_cmp_eq_u32 vcc, 0, v1
  s_nop 1
  v_cndmask_b32 v253, v253, v20, vcc
  s_lshl_b32 s12, s90, 4
  v_add_u32 v20, s12, v2
  v_mul_u32_u24 v21, 1280, v20
  s_mul_i32 s12, s71, 160
  v_lshl_add_u32 v21, v3, 3, v21
  v_add_u32 v14, s12, v21
  s_mul_i32 s12, s71, 2560
  s_mul_i32 s14, s90, 20480
  s_add_u32 s12, s12, s14
  s_add_u32 s12, s12, 7340032
  v_and_b32 v21, 1, v3
  v_lshrrev_b32 v22, 1, v3
  v_lshl_add_u32 v23, v21, 1, v22
  v_lshlrev_b32 v23, 8, v23
  v_lshl_add_u32 v23, v2, 4, v23
  v_add_u32 v252, s12, v23
  v_mov_b32 v24, 1073741824
  s_cmp_ge_u32 s69, 10
  s_mov_b32 s4, s44
  s_mov_b32 s5, s45
  s_cselect_b32 s6, 0, s46
  s_mov_b32 s7, 0x20000
  s_mov_b32 s8, s48
  s_mov_b32 s9, s49
  s_cselect_b32 s10, 0, s50
  s_mov_b32 s11, 0x20000
  s_cselect_b32 s54, s54, 0
  s_mul_i32 s12, s73, 192
  s_mul_i32 s14, s68, 48
  s_add_u32 s12, s12, s14
  v_add_u32 v20, 0, v1
  v_mul_u32_u24 v22, 0xab, v20
  v_lshrrev_b32 v22, 9, v22
  v_mul_u32_u24 v23, 3, v22
  v_sub_u32 v20, v20, v23
  v_mul_u32_u24 v22, 3072, v22
  v_lshl_add_u32 v20, v20, 4, v22
  v_add_u32 v26, s12, v20
  v_add_u32 v20, 64, v1
  v_mul_u32_u24 v22, 0xab, v20
  v_lshrrev_b32 v22, 9, v22
  v_mul_u32_u24 v23, 3, v22
  v_sub_u32 v20, v20, v23
  v_mul_u32_u24 v22, 3072, v22
  v_lshl_add_u32 v20, v20, 4, v22
  v_add_u32 v27, s12, v20
  v_add_u32 v20, 128, v1
  v_mul_u32_u24 v22, 0xab, v20
  v_lshrrev_b32 v22, 9, v22
  v_mul_u32_u24 v23, 3, v22
  v_sub_u32 v20, v20, v23
  v_mul_u32_u24 v22, 3072, v22
  v_lshl_add_u32 v20, v20, 4, v22
  v_add_u32 v28, s12, v20
  s_mul_i32 s21, s69, 196608
  s_max_u32 s26, s69, 10
  s_sub_u32 s26, s26, 10
  s_lshl_b32 s26, s26, 1
  s_add_u32 s26, s26, s70
  s_mul_i32 s12, s68, 12
  s_add_u32 s26, s26, s12
  s_mul_i32 s26, s26, 40960
  s_lshr_b32 s13, s2, 3
  s_lshl_b32 s13, s13, 2
  s_add_u32 s13, s13, s68
  s_mul_i32 s13, s13, 6400
  v_min_u32 v29, 49, v1
  v_lshlrev_b32 v29, 7, v29
  s_lshl_b32 s12, s69, 10
  s_add_u32 s12, s12, 18878464
  v_lshl_add_u32 v31, v2, 6, s12
  v_lshlrev_b32 v20, 7, v1
  v_add_u32 v16, s17, v20
  s_lshl_b32 s12, s69, 10
  s_add_u32 s12, s12, 18923264
  v_add_u32 v22, s12, v20
  v_cmp_le_u32 vcc, 2, v1
  s_nop 1
  v_cndmask_b32 v16, v16, v22, vcc
  s_lshl_b32 s12, s69, 12
  s_add_u32 s12, s12, 18938624
  v_add_u32 v22, s12, v20
  v_cmp_le_u32 vcc, 10, v1
  s_nop 1
  v_cndmask_b32 v16, v16, v22, vcc
  v_cmp_le_u32 vcc, 42, v1
  s_nop 1
  v_cndmask_b32 v16, v16, v24, vcc
  s_waitcnt vmcnt(19)
  ds_read_b128 v[32:35], v245 offset:0
  s_waitcnt vmcnt(18)
  ds_read_b128 v[36:39], v245 offset:1024
  s_waitcnt vmcnt(17)
  ds_read_b128 v[40:43], v245 offset:2048
  s_waitcnt lgkmcnt(2)
  v_mfma_f32_16x16x32_bf16 v[160:163], v[168:171], v[32:35], 0
  s_waitcnt vmcnt(16)
  ds_read_b128 v[44:47], v245 offset:3072
  v_mfma_f32_16x16x32_bf16 v[164:167], v[32:35], v[32:35], 0
  s_waitcnt lgkmcnt(2)
  v_mfma_f32_16x16x32_bf16 v[160:163], v[168:171], v[36:39], v[160:163]
  s_waitcnt vmcnt(15)
  ds_read_b128 v[48:51], v245 offset:4096
  v_mfma_f32_16x16x32_bf16 v[164:167], v[36:39], v[36:39], v[164:167]
  s_waitcnt lgkmcnt(2)
  v_mfma_f32_16x16x32_bf16 v[160:163], v[168:171], v[40:43], v[160:163]
  s_waitcnt vmcnt(14)
  ds_read_b128 v[52:55], v245 offset:5120
  v_mfma_f32_16x16x32_bf16 v[164:167], v[40:43], v[40:43], v[164:167]
  s_waitcnt lgkmcnt(2)
  v_mfma_f32_16x16x32_bf16 v[160:163], v[168:171], v[44:47], v[160:163]
  s_waitcnt vmcnt(13)
  ds_read_b128 v[56:59], v245 offset:6144
  v_mfma_f32_16x16x32_bf16 v[164:167], v[44:47], v[44:47], v[164:167]
  s_waitcnt lgkmcnt(2)
  v_mfma_f32_16x16x32_bf16 v[160:163], v[168:171], v[48:51], v[160:163]
  s_waitcnt vmcnt(12)
  ds_read_b128 v[60:63], v245 offset:7168
  v_mfma_f32_16x16x32_bf16 v[164:167], v[48:51], v[48:51], v[164:167]
  s_waitcnt lgkmcnt(2)
  v_mfma_f32_16x16x32_bf16 v[160:163], v[168:171], v[52:55], v[160:163]
  s_waitcnt vmcnt(11)
  ds_read_b128 v[64:67], v245 offset:8192
  v_mfma_f32_16x16x32_bf16 v[164:167], v[52:55], v[52:55], v[164:167]
  s_waitcnt lgkmcnt(2)
  v_mfma_f32_16x16x32_bf16 v[160:163], v[168:171], v[56:59], v[160:163]
  s_waitcnt vmcnt(10)
  ds_read_b128 v[68:71], v245 offset:9216
  v_mfma_f32_16x16x32_bf16 v[164:167], v[56:59], v[56:59], v[164:167]
  s_waitcnt lgkmcnt(2)
  v_mfma_f32_16x16x32_bf16 v[160:163], v[168:171], v[60:63], v[160:163]
  s_waitcnt vmcnt(9)
  ds_read_b128 v[72:75], v245 offset:10240
  v_mfma_f32_16x16x32_bf16 v[164:167], v[60:63], v[60:63], v[164:167]
  s_waitcnt lgkmcnt(2)
  v_mfma_f32_16x16x32_bf16 v[160:163], v[168:171], v[64:67], v[160:163]
  s_waitcnt vmcnt(8)
  ds_read_b128 v[76:79], v245 offset:11264
  v_mfma_f32_16x16x32_bf16 v[164:167], v[64:67], v[64:67], v[164:167]
  s_waitcnt lgkmcnt(2)
  v_mfma_f32_16x16x32_bf16 v[160:163], v[168:171], v[68:71], v[160:163]
  s_waitcnt vmcnt(7)
  ds_read_b128 v[80:83], v245 offset:12288
  v_mfma_f32_16x16x32_bf16 v[164:167], v[68:71], v[68:71], v[164:167]
  s_waitcnt lgkmcnt(2)
  v_mfma_f32_16x16x32_bf16 v[160:163], v[168:171], v[72:75], v[160:163]
  s_waitcnt vmcnt(6)
  ds_read_b128 v[84:87], v245 offset:13312
  v_mfma_f32_16x16x32_bf16 v[164:167], v[72:75], v[72:75], v[164:167]
  s_waitcnt lgkmcnt(2)
  v_mfma_f32_16x16x32_bf16 v[160:163], v[168:171], v[76:79], v[160:163]
  s_waitcnt vmcnt(5)
  ds_read_b128 v[88:91], v245 offset:14336
  v_mfma_f32_16x16x32_bf16 v[164:167], v[76:79], v[76:79], v[164:167]
  s_waitcnt lgkmcnt(2)
  v_mfma_f32_16x16x32_bf16 v[160:163], v[168:171], v[80:83], v[160:163]
  s_waitcnt vmcnt(4)
  ds_read_b128 v[92:95], v245 offset:15360
  v_mfma_f32_16x16x32_bf16 v[164:167], v[80:83], v[80:83], v[164:167]
  s_waitcnt lgkmcnt(2)
  v_mfma_f32_16x16x32_bf16 v[160:163], v[168:171], v[84:87], v[160:163]
  s_waitcnt vmcnt(3)
  ds_read_b128 v[96:99], v245 offset:16384
  v_mfma_f32_16x16x32_bf16 v[164:167], v[84:87], v[84:87], v[164:167]
  s_waitcnt lgkmcnt(2)
  v_mfma_f32_16x16x32_bf16 v[160:163], v[168:171], v[88:91], v[160:163]
  s_waitcnt vmcnt(2)
  ds_read_b128 v[100:103], v245 offset:17408
  v_mfma_f32_16x16x32_bf16 v[164:167], v[88:91], v[88:91], v[164:167]
  s_waitcnt lgkmcnt(2)
  v_mfma_f32_16x16x32_bf16 v[160:163], v[168:171], v[92:95], v[160:163]
  s_waitcnt vmcnt(1)
  ds_read_b128 v[104:107], v245 offset:18432
  v_mfma_f32_16x16x32_bf16 v[164:167], v[92:95], v[92:95], v[164:167]
  s_waitcnt lgkmcnt(2)
  v_mfma_f32_16x16x32_bf16 v[160:163], v[168:171], v[96:99], v[160:163]
  s_waitcnt vmcnt(0)
  ds_read_b128 v[108:111], v245 offset:19456
  v_mfma_f32_16x16x32_bf16 v[164:167], v[96:99], v[96:99], v[164:167]
  s_waitcnt lgkmcnt(2)
  v_mfma_f32_16x16x32_bf16 v[160:163], v[168:171], v[100:103], v[160:163]
  v_mfma_f32_16x16x32_bf16 v[164:167], v[100:103], v[100:103], v[164:167]
  s_waitcnt lgkmcnt(1)
  v_mfma_f32_16x16x32_bf16 v[160:163], v[168:171], v[104:107], v[160:163]
  v_mfma_f32_16x16x32_bf16 v[164:167], v[104:107], v[104:107], v[164:167]
  s_waitcnt lgkmcnt(0)
  v_mfma_f32_16x16x32_bf16 v[160:163], v[168:171], v[108:111], v[160:163]
  v_mfma_f32_16x16x32_bf16 v[164:167], v[108:111], v[108:111], v[164:167]
  s_barrier
  s_mov_b32 s94, 0x22222222
  s_mov_b32 s95, 0x22222222
  s_mov_b32 s96, 0x44444444
  s_mov_b32 s97, 0x44444444
  s_mov_b32 s98, 0x88888888
  s_mov_b32 s99, 0x88888888
  s_nop 0
  v_cndmask_b32 v164, v164, v165, s[94:95]
  v_cndmask_b32 v164, v164, v166, s[96:97]
  v_cndmask_b32 v164, v164, v167, s[98:99]
  ds_bpermute_b32 v22, v244, v164
  v_mul_f32 v12, 0x3acccccd, v160
  v_mul_f32 v25, v12, v12
  v_mov_b32 v15, 0x3acccccd
  s_waitcnt lgkmcnt(0)
  v_fma_f32 v25, v22, v15, -v25
  v_max_f32 v25, 0, v25
  v_add_f32 v25, 0x3727c5ac, v25
  v_rsq_f32 v15, v25
  v_sub_f32 v204, 0, v12
  v_sub_f32 v205, 0, v12
  v_sub_f32 v206, 0, v12
  v_sub_f32 v207, 0, v12
  s_waitcnt lgkmcnt(0)
  s_bitcmp1_b32 s71, 0
  s_cbranch_scc1 L_v
  ds_read_b64_tr_b16 v[112:113], v241 offset:0
  ds_read_b64_tr_b16 v[114:115], v241 offset:160
  ds_read_b64_tr_b16 v[116:117], v241 offset:32
  ds_read_b64_tr_b16 v[118:119], v241 offset:192
  ds_read_b64_tr_b16 v[120:121], v241 offset:1280
  ds_read_b64_tr_b16 v[122:123], v241 offset:1440
  ds_read_b64_tr_b16 v[124:125], v241 offset:1312
  ds_read_b64_tr_b16 v[126:127], v241 offset:1472
  v_mfma_f32_16x16x32_bf16 v[172:175], v[196:199], v[32:35], v[204:207]
  v_mfma_f32_16x16x32_bf16 v[176:179], v[200:203], v[32:35], v[204:207]
  v_mfma_f32_16x16x32_bf16 v[180:183], v[196:199], v[36:39], v[204:207]
  v_mfma_f32_16x16x32_bf16 v[184:187], v[200:203], v[36:39], v[204:207]
  v_mfma_f32_16x16x32_bf16 v[188:191], v[196:199], v[40:43], v[204:207]
  v_mfma_f32_16x16x32_bf16 v[192:195], v[200:203], v[40:43], v[204:207]
  s_waitcnt lgkmcnt(6)
  s_nop 1
  v_cvt_pk_bf16_f32 v32, v172, v173
  v_cvt_pk_bf16_f32 v33, v174, v175
  v_cvt_pk_bf16_f32 v34, v176, v177
  v_cvt_pk_bf16_f32 v35, v178, v179
  v_cvt_pk_bf16_f32 v36, v180, v181
  v_cvt_pk_bf16_f32 v37, v182, v183
  v_mfma_f32_16x16x32_bf16 v[212:215], v[112:115], v[32:35], 0
  ds_read_b64_tr_b16 v[128:129], v241 offset:2560
  ds_read_b64_tr_b16 v[130:131], v241 offset:2720
  v_cvt_pk_bf16_f32 v38, v184, v185
  v_cvt_pk_bf16_f32 v39, v186, v187
  v_mfma_f32_16x16x32_bf16 v[172:175], v[196:199], v[44:47], v[204:207]
  s_waitcnt lgkmcnt(6)
  v_mfma_f32_16x16x32_bf16 v[216:219], v[116:119], v[32:35], 0
  ds_read_b64_tr_b16 v[132:133], v241 offset:2592
  ds_read_b64_tr_b16 v[134:135], v241 offset:2752
  v_mfma_f32_16x16x32_bf16 v[176:179], v[200:203], v[44:47], v[204:207]
  s_waitcnt lgkmcnt(6)
  v_cvt_pk_bf16_f32 v40, v188, v189
  v_cvt_pk_bf16_f32 v41, v190, v191
  v_mfma_f32_16x16x32_bf16 v[212:215], v[120:123], v[36:39], v[212:215]
  ds_read_b64_tr_b16 v[136:137], v241 offset:3840
  ds_read_b64_tr_b16 v[138:139], v241 offset:4000
  v_cvt_pk_bf16_f32 v42, v192, v193
  v_cvt_pk_bf16_f32 v43, v194, v195
  v_mfma_f32_16x16x32_bf16 v[180:183], v[196:199], v[48:51], v[204:207]
  s_waitcnt lgkmcnt(6)
  v_mfma_f32_16x16x32_bf16 v[216:219], v[124:127], v[36:39], v[216:219]
  ds_read_b64_tr_b16 v[140:141], v241 offset:3872
  ds_read_b64_tr_b16 v[142:143], v241 offset:4032
  v_mfma_f32_16x16x32_bf16 v[184:187], v[200:203], v[48:51], v[204:207]
  s_waitcnt lgkmcnt(6)
  v_cvt_pk_bf16_f32 v44, v172, v173
  v_cvt_pk_bf16_f32 v45, v174, v175
  v_mfma_f32_16x16x32_bf16 v[212:215], v[128:131], v[40:43], v[212:215]
  ds_read_b64_tr_b16 v[112:113], v241 offset:5120
  ds_read_b64_tr_b16 v[114:115], v241 offset:5280
  v_cvt_pk_bf16_f32 v46, v176, v177
  v_cvt_pk_bf16_f32 v47, v178, v179
  v_mfma_f32_16x16x32_bf16 v[188:191], v[196:199], v[52:55], v[204:207]
  s_waitcnt lgkmcnt(6)
  v_mfma_f32_16x16x32_bf16 v[216:219], v[132:135], v[40:43], v[216:219]
  ds_read_b64_tr_b16 v[116:117], v241 offset:5152
  ds_read_b64_tr_b16 v[118:119], v241 offset:5312
  v_mfma_f32_16x16x32_bf16 v[192:195], v[200:203], v[52:55], v[204:207]
  s_waitcnt lgkmcnt(6)
  v_cvt_pk_bf16_f32 v48, v180, v181
  v_cvt_pk_bf16_f32 v49, v182, v183
  v_mfma_f32_16x16x32_bf16 v[212:215], v[136:139], v[44:47], v[212:215]
  ds_read_b64_tr_b16 v[120:121], v241 offset:6400
  ds_read_b64_tr_b16 v[122:123], v241 offset:6560
  v_cvt_pk_bf16_f32 v50, v184, v185
  v_cvt_pk_bf16_f32 v51, v186, v187
  v_mfma_f32_16x16x32_bf16 v[172:175], v[196:199], v[56:59], v[204:207]
  s_waitcnt lgkmcnt(6)
  v_mfma_f32_16x16x32_bf16 v[216:219], v[140:143], v[44:47], v[216:219]
  ds_read_b64_tr_b16 v[124:125], v241 offset:6432
  ds_read_b64_tr_b16 v[126:127], v241 offset:6592
  v_mfma_f32_16x16x32_bf16 v[176:179], v[200:203], v[56:59], v[204:207]
  s_waitcnt lgkmcnt(6)
  v_cvt_pk_bf16_f32 v52, v188, v189
  v_cvt_pk_bf16_f32 v53, v190, v191
  v_mfma_f32_16x16x32_bf16 v[212:215], v[112:115], v[48:51], v[212:215]
  ds_read_b64_tr_b16 v[128:129], v241 offset:7680
  ds_read_b64_tr_b16 v[130:131], v241 offset:7840
  v_cvt_pk_bf16_f32 v54, v192, v193
  v_cvt_pk_bf16_f32 v55, v194, v195
  v_mfma_f32_16x16x32_bf16 v[180:183], v[196:199], v[60:63], v[204:207]
  s_waitcnt lgkmcnt(6)
  v_mfma_f32_16x16x32_bf16 v[216:219], v[116:119], v[48:51], v[216:219]
  ds_read_b64_tr_b16 v[132:133], v241 offset:7712
  ds_read_b64_tr_b16 v[134:135], v241 offset:7872
  v_mfma_f32_16x16x32_bf16 v[184:187], v[200:203], v[60:63], v[204:207]
  s_waitcnt lgkmcnt(6)
  v_cvt_pk_bf16_f32 v56, v172, v173
  v_cvt_pk_bf16_f32 v57, v174, v175
  v_mfma_f32_16x16x32_bf16 v[212:215], v[120:123], v[52:55], v[212:215]
  ds_read_b64_tr_b16 v[136:137], v241 offset:8960
  ds_read_b64_tr_b16 v[138:139], v241 offset:9120
  v_cvt_pk_bf16_f32 v58, v176, v177
  v_cvt_pk_bf16_f32 v59, v178, v179
  v_mfma_f32_16x16x32_bf16 v[188:191], v[196:199], v[64:67], v[204:207]
  s_waitcnt lgkmcnt(6)
  v_mfma_f32_16x16x32_bf16 v[216:219], v[124:127], v[52:55], v[216:219]
  ds_read_b64_tr_b16 v[140:141], v241 offset:8992
  ds_read_b64_tr_b16 v[142:143], v241 offset:9152
  v_mfma_f32_16x16x32_bf16 v[192:195], v[200:203], v[64:67], v[204:207]
  s_waitcnt lgkmcnt(6)
  v_cvt_pk_bf16_f32 v60, v180, v181
  v_cvt_pk_bf16_f32 v61, v182, v183
  v_mfma_f32_16x16x32_bf16 v[212:215], v[128:131], v[56:59], v[212:215]
  ds_read_b64_tr_b16 v[112:113], v241 offset:10240
  ds_read_b64_tr_b16 v[114:115], v241 offset:10400
  v_cvt_pk_bf16_f32 v62, v184, v185
  v_cvt_pk_bf16_f32 v63, v186, v187
  v_mfma_f32_16x16x32_bf16 v[172:175], v[196:199], v[68:71], v[204:207]
  s_waitcnt lgkmcnt(6)
  v_mfma_f32_16x16x32_bf16 v[216:219], v[132:135], v[56:59], v[216:219]
  ds_read_b64_tr_b16 v[116:117], v241 offset:10272
  ds_read_b64_tr_b16 v[118:119], v241 offset:10432
  v_mfma_f32_16x16x32_bf16 v[176:179], v[200:203], v[68:71], v[204:207]
  s_waitcnt lgkmcnt(6)
  v_cvt_pk_bf16_f32 v64, v188, v189
  v_cvt_pk_bf16_f32 v65, v190, v191
  v_mfma_f32_16x16x32_bf16 v[212:215], v[136:139], v[60:63], v[212:215]
  ds_read_b64_tr_b16 v[120:121], v241 offset:11520
  ds_read_b64_tr_b16 v[122:123], v241 offset:11680
  v_cvt_pk_bf16_f32 v66, v192, v193
  v_cvt_pk_bf16_f32 v67, v194, v195
  v_mfma_f32_16x16x32_bf16 v[180:183], v[196:199], v[72:75], v[204:207]
  s_waitcnt lgkmcnt(6)
  v_mfma_f32_16x16x32_bf16 v[216:219], v[140:143], v[60:63], v[216:219]
  ds_read_b64_tr_b16 v[124:125], v241 offset:11552
  ds_read_b64_tr_b16 v[126:127], v241 offset:11712
  v_mfma_f32_16x16x32_bf16 v[184:187], v[200:203], v[72:75], v[204:207]
  s_waitcnt lgkmcnt(6)
  v_cvt_pk_bf16_f32 v68, v172, v173
  v_cvt_pk_bf16_f32 v69, v174, v175
  v_mfma_f32_16x16x32_bf16 v[212:215], v[112:115], v[64:67], v[212:215]
  ds_read_b64_tr_b16 v[128:129], v241 offset:12800
  ds_read_b64_tr_b16 v[130:131], v241 offset:12960
  v_cvt_pk_bf16_f32 v70, v176, v177
  v_cvt_pk_bf16_f32 v71, v178, v179
  v_mfma_f32_16x16x32_bf16 v[188:191], v[196:199], v[76:79], v[204:207]
  s_waitcnt lgkmcnt(6)
  v_mfma_f32_16x16x32_bf16 v[216:219], v[116:119], v[64:67], v[216:219]
  ds_read_b64_tr_b16 v[132:133], v241 offset:12832
  ds_read_b64_tr_b16 v[134:135], v241 offset:12992
  v_mfma_f32_16x16x32_bf16 v[192:195], v[200:203], v[76:79], v[204:207]
  s_waitcnt lgkmcnt(6)
  v_cvt_pk_bf16_f32 v72, v180, v181
  v_cvt_pk_bf16_f32 v73, v182, v183
  v_mfma_f32_16x16x32_bf16 v[212:215], v[120:123], v[68:71], v[212:215]
  ds_read_b64_tr_b16 v[136:137], v241 offset:14080
  ds_read_b64_tr_b16 v[138:139], v241 offset:14240
  v_cvt_pk_bf16_f32 v74, v184, v185
  v_cvt_pk_bf16_f32 v75, v186, v187
  v_mfma_f32_16x16x32_bf16 v[172:175], v[196:199], v[80:83], v[204:207]
  s_waitcnt lgkmcnt(6)
  v_mfma_f32_16x16x32_bf16 v[216:219], v[124:127], v[68:71], v[216:219]
  ds_read_b64_tr_b16 v[140:141], v241 offset:14112
  ds_read_b64_tr_b16 v[142:143], v241 offset:14272
  v_mfma_f32_16x16x32_bf16 v[176:179], v[200:203], v[80:83], v[204:207]
  s_waitcnt lgkmcnt(6)
  v_cvt_pk_bf16_f32 v76, v188, v189
  v_cvt_pk_bf16_f32 v77, v190, v191
  v_mfma_f32_16x16x32_bf16 v[212:215], v[128:131], v[72:75], v[212:215]
  ds_read_b64_tr_b16 v[112:113], v241 offset:15360
  ds_read_b64_tr_b16 v[114:115], v241 offset:15520
  v_cvt_pk_bf16_f32 v78, v192, v193
  v_cvt_pk_bf16_f32 v79, v194, v195
  v_mfma_f32_16x16x32_bf16 v[180:183], v[196:199], v[84:87], v[204:207]
  s_waitcnt lgkmcnt(6)
  v_mfma_f32_16x16x32_bf16 v[216:219], v[132:135], v[72:75], v[216:219]
  ds_read_b64_tr_b16 v[116:117], v241 offset:15392
  ds_read_b64_tr_b16 v[118:119], v241 offset:15552
  v_mfma_f32_16x16x32_bf16 v[184:187], v[200:203], v[84:87], v[204:207]
  s_waitcnt lgkmcnt(6)
  v_cvt_pk_bf16_f32 v80, v172, v173
  v_cvt_pk_bf16_f32 v81, v174, v175
  v_mfma_f32_16x16x32_bf16 v[212:215], v[136:139], v[76:79], v[212:215]
  ds_read_b64_tr_b16 v[120:121], v241 offset:16640
  ds_read_b64_tr_b16 v[122:123], v241 offset:16800
  v_cvt_pk_bf16_f32 v82, v176, v177
  v_cvt_pk_bf16_f32 v83, v178, v179
  v_mfma_f32_16x16x32_bf16 v[188:191], v[196:199], v[88:91], v[204:207]
  s_waitcnt lgkmcnt(6)
  v_mfma_f32_16x16x32_bf16 v[216:219], v[140:143], v[76:79], v[216:219]
  ds_read_b64_tr_b16 v[124:125], v241 offset:16672
  ds_read_b64_tr_b16 v[126:127], v241 offset:16832
  v_mfma_f32_16x16x32_bf16 v[192:195], v[200:203], v[88:91], v[204:207]
  s_waitcnt lgkmcnt(6)
  v_cvt_pk_bf16_f32 v84, v180, v181
  v_cvt_pk_bf16_f32 v85, v182, v183
  v_mfma_f32_16x16x32_bf16 v[212:215], v[112:115], v[80:83], v[212:215]
  ds_read_b64_tr_b16 v[128:129], v241 offset:17920
  ds_read_b64_tr_b16 v[130:131], v241 offset:18080
  v_cvt_pk_bf16_f32 v86, v184, v185
  v_cvt_pk_bf16_f32 v87, v186, v187
  v_mfma_f32_16x16x32_bf16 v[172:175], v[196:199], v[92:95], v[204:207]
  s_waitcnt lgkmcnt(6)
  v_mfma_f32_16x16x32_bf16 v[216:219], v[116:119], v[80:83], v[216:219]
  ds_read_b64_tr_b16 v[132:133], v241 offset:17952
  ds_read_b64_tr_b16 v[134:135], v241 offset:18112
  v_mfma_f32_16x16x32_bf16 v[176:179], v[200:203], v[92:95], v[204:207]
  s_waitcnt lgkmcnt(6)
  v_cvt_pk_bf16_f32 v88, v188, v189
  v_cvt_pk_bf16_f32 v89, v190, v191
  v_mfma_f32_16x16x32_bf16 v[212:215], v[120:123], v[84:87], v[212:215]
  ds_read_b64_tr_b16 v[136:137], v241 offset:19200
  ds_read_b64_tr_b16 v[138:139], v241 offset:19360
  v_cvt_pk_bf16_f32 v90, v192, v193
  v_cvt_pk_bf16_f32 v91, v194, v195
  v_mfma_f32_16x16x32_bf16 v[180:183], v[196:199], v[96:99], v[204:207]
  s_waitcnt lgkmcnt(6)
  v_mfma_f32_16x16x32_bf16 v[216:219], v[124:127], v[84:87], v[216:219]
  ds_read_b64_tr_b16 v[140:141], v241 offset:19232
  ds_read_b64_tr_b16 v[142:143], v241 offset:19392
  v_mfma_f32_16x16x32_bf16 v[184:187], v[200:203], v[96:99], v[204:207]
  s_waitcnt lgkmcnt(6)
  v_cvt_pk_bf16_f32 v92, v172, v173
  v_cvt_pk_bf16_f32 v93, v174, v175
  v_mfma_f32_16x16x32_bf16 v[212:215], v[128:131], v[88:91], v[212:215]
  ds_read_b64_tr_b16 v[112:113], v241 offset:20480
  ds_read_b64_tr_b16 v[114:115], v241 offset:20640
  v_cvt_pk_bf16_f32 v94, v176, v177
  v_cvt_pk_bf16_f32 v95, v178, v179
  v_mfma_f32_16x16x32_bf16 v[188:191], v[196:199], v[100:103], v[204:207]
  s_waitcnt lgkmcnt(6)
  v_mfma_f32_16x16x32_bf16 v[216:219], v[132:135], v[88:91], v[216:219]
  ds_read_b64_tr_b16 v[116:117], v241 offset:20512
  ds_read_b64_tr_b16 v[118:119], v241 offset:20672
  v_mfma_f32_16x16x32_bf16 v[192:195], v[200:203], v[100:103], v[204:207]
  s_waitcnt lgkmcnt(6)
  v_cvt_pk_bf16_f32 v96, v180, v181
  v_cvt_pk_bf16_f32 v97, v182, v183
  v_mfma_f32_16x16x32_bf16 v[212:215], v[136:139], v[92:95], v[212:215]
  ds_read_b64_tr_b16 v[120:121], v241 offset:21760
  ds_read_b64_tr_b16 v[122:123], v241 offset:21920
  v_cvt_pk_bf16_f32 v98, v184, v185
  v_cvt_pk_bf16_f32 v99, v186, v187
  v_mfma_f32_16x16x32_bf16 v[172:175], v[196:199], v[104:107], v[204:207]
  s_waitcnt lgkmcnt(6)
  v_mfma_f32_16x16x32_bf16 v[216:219], v[140:143], v[92:95], v[216:219]
  ds_read_b64_tr_b16 v[124:125], v241 offset:21792
  ds_read_b64_tr_b16 v[126:127], v241 offset:21952
  v_mfma_f32_16x16x32_bf16 v[176:179], v[200:203], v[104:107], v[204:207]
  s_waitcnt lgkmcnt(6)
  v_cvt_pk_bf16_f32 v100, v188, v189
  v_cvt_pk_bf16_f32 v101, v190, v191
  v_mfma_f32_16x16x32_bf16 v[212:215], v[112:115], v[96:99], v[212:215]
  ds_read_b64_tr_b16 v[128:129], v241 offset:23040
  ds_read_b64_tr_b16 v[130:131], v241 offset:23200
  v_cvt_pk_bf16_f32 v102, v192, v193
  v_cvt_pk_bf16_f32 v103, v194, v195
  v_mfma_f32_16x16x32_bf16 v[180:183], v[196:199], v[108:111], v[204:207]
  s_waitcnt lgkmcnt(6)
  v_mfma_f32_16x16x32_bf16 v[216:219], v[116:119], v[96:99], v[216:219]
  ds_read_b64_tr_b16 v[132:133], v241 offset:23072
  ds_read_b64_tr_b16 v[134:135], v241 offset:23232
  v_mfma_f32_16x16x32_bf16 v[184:187], v[200:203], v[108:111], v[204:207]
  s_waitcnt lgkmcnt(6)
  v_cvt_pk_bf16_f32 v104, v172, v173
  v_cvt_pk_bf16_f32 v105, v174, v175
  v_mfma_f32_16x16x32_bf16 v[212:215], v[120:123], v[100:103], v[212:215]
  s_waitcnt lgkmcnt(4)
  ds_read_b64_tr_b16 v[136:137], v241 offset:24320
  ds_read_b64_tr_b16 v[138:139], v241 offset:24480
  v_cvt_pk_bf16_f32 v106, v176, v177
  v_cvt_pk_bf16_f32 v107, v178, v179
  v_mfma_f32_16x16x32_bf16 v[216:219], v[124:127], v[100:103], v[216:219]
  s_waitcnt lgkmcnt(4)
  ds_read_b64_tr_b16 v[140:141], v241 offset:24352
  ds_read_b64_tr_b16 v[142:143], v241 offset:24512
  v_cvt_pk_bf16_f32 v108, v180, v181
  v_cvt_pk_bf16_f32 v109, v182, v183
  v_mfma_f32_16x16x32_bf16 v[212:215], v[128:131], v[104:107], v[212:215]
  s_waitcnt lgkmcnt(4)
  v_cvt_pk_bf16_f32 v110, v184, v185
  v_cvt_pk_bf16_f32 v111, v186, v187
  v_mfma_f32_16x16x32_bf16 v[216:219], v[132:135], v[104:107], v[216:219]
  s_waitcnt lgkmcnt(2)
  v_mfma_f32_16x16x32_bf16 v[212:215], v[136:139], v[108:111], v[212:215]
  s_waitcnt lgkmcnt(0)
  v_mfma_f32_16x16x32_bf16 v[216:219], v[140:143], v[108:111], v[216:219]
  v_cmp_eq_u32 vcc, 1, v3
  v_mov_b32 v22, s76
  v_mov_b32 v23, s74
  s_nop 2
  v_mul_f32 v212, v212, v15
  v_mul_f32 v213, v213, v15
  v_mul_f32 v214, v214, v15
  v_mul_f32 v215, v215, v15
  v_mul_f32 v216, v216, v15
  v_mul_f32 v217, v217, v15
  v_mul_f32 v218, v218, v15
  v_mul_f32 v219, v219, v15
  v_cvt_pk_bf16_f32 v228, v212, v213
  v_cvt_pk_bf16_f32 v229, v214, v215
  v_cvt_pk_bf16_f32 v230, v216, v217
  v_cvt_pk_bf16_f32 v231, v218, v219
  v_cndmask_b32 v230, v230, v22, vcc
  v_cndmask_b32 v231, v231, v23, vcc
  s_waitcnt lgkmcnt(0)
  s_branch L_kvst
L_v:
  s_nop 7
  v_lshlrev_b32 v20, 4, v3
  ds_bpermute_b32 v222, v20, v15 offset:0
  ds_bpermute_b32 v223, v20, v15 offset:4
  ds_bpermute_b32 v224, v20, v15 offset:8
  ds_bpermute_b32 v225, v20, v15 offset:12
  v_mov_b32 v22, 0
  v_mov_b32 v21, s76
  v_cmp_eq_u32 vcc, 4, v2
  s_nop 1
  v_cndmask_b32 v22, v22, v21, vcc
  ds_read_b64_tr_b16 v[112:113], v241 offset:0
  ds_read_b64_tr_b16 v[114:115], v241 offset:160
  ds_read_b64_tr_b16 v[116:117], v241 offset:32
  ds_read_b64_tr_b16 v[118:119], v241 offset:192
  ds_read_b64_tr_b16 v[120:121], v241 offset:1280
  ds_read_b64_tr_b16 v[122:123], v241 offset:1440
  ds_read_b64_tr_b16 v[124:125], v241 offset:1312
  ds_read_b64_tr_b16 v[126:127], v241 offset:1472
  v_mfma_f32_16x16x32_bf16 v[172:175], v[196:199], v[32:35], v[204:207]
  v_mfma_f32_16x16x32_bf16 v[176:179], v[200:203], v[32:35], v[204:207]
  v_mfma_f32_16x16x32_bf16 v[180:183], v[196:199], v[36:39], v[204:207]
  v_mfma_f32_16x16x32_bf16 v[184:187], v[200:203], v[36:39], v[204:207]
  v_mfma_f32_16x16x32_bf16 v[188:191], v[196:199], v[40:43], v[204:207]
  v_mfma_f32_16x16x32_bf16 v[192:195], v[200:203], v[40:43], v[204:207]
  s_waitcnt lgkmcnt(6)
  s_nop 1
  v_cvt_pk_bf16_f32 v32, v172, v173
  v_cvt_pk_bf16_f32 v33, v174, v175
  v_cvt_pk_bf16_f32 v34, v176, v177
  v_cvt_pk_bf16_f32 v35, v178, v179
  v_cvt_pk_bf16_f32 v36, v180, v181
  v_cvt_pk_bf16_f32 v37, v182, v183
  v_mfma_f32_16x16x32_bf16 v[212:215], v[32:35], v[112:115], 0
  ds_read_b64_tr_b16 v[128:129], v241 offset:2560
  ds_read_b64_tr_b16 v[130:131], v241 offset:2720
  v_cvt_pk_bf16_f32 v38, v184, v185
  v_cvt_pk_bf16_f32 v39, v186, v187
  v_mfma_f32_16x16x32_bf16 v[172:175], v[196:199], v[44:47], v[204:207]
  s_waitcnt lgkmcnt(6)
  v_mfma_f32_16x16x32_bf16 v[216:219], v[32:35], v[116:119], 0
  ds_read_b64_tr_b16 v[132:133], v241 offset:2592
  ds_read_b64_tr_b16 v[134:135], v241 offset:2752
  v_mfma_f32_16x16x32_bf16 v[176:179], v[200:203], v[44:47], v[204:207]
  s_waitcnt lgkmcnt(6)
  v_cvt_pk_bf16_f32 v40, v188, v189
  v_cvt_pk_bf16_f32 v41, v190, v191
  v_mfma_f32_16x16x32_bf16 v[212:215], v[36:39], v[120:123], v[212:215]
  ds_read_b64_tr_b16 v[136:137], v241 offset:3840
  ds_read_b64_tr_b16 v[138:139], v241 offset:4000
  v_cvt_pk_bf16_f32 v42, v192, v193
  v_cvt_pk_bf16_f32 v43, v194, v195
  v_mfma_f32_16x16x32_bf16 v[180:183], v[196:199], v[48:51], v[204:207]
  s_waitcnt lgkmcnt(6)
  v_mfma_f32_16x16x32_bf16 v[216:219], v[36:39], v[124:127], v[216:219]
  ds_read_b64_tr_b16 v[140:141], v241 offset:3872
  ds_read_b64_tr_b16 v[142:143], v241 offset:4032
  v_mfma_f32_16x16x32_bf16 v[184:187], v[200:203], v[48:51], v[204:207]
  s_waitcnt lgkmcnt(6)
  v_cvt_pk_bf16_f32 v44, v172, v173
  v_cvt_pk_bf16_f32 v45, v174, v175
  v_mfma_f32_16x16x32_bf16 v[212:215], v[40:43], v[128:131], v[212:215]
  ds_read_b64_tr_b16 v[112:113], v241 offset:5120
  ds_read_b64_tr_b16 v[114:115], v241 offset:5280
  v_cvt_pk_bf16_f32 v46, v176, v177
  v_cvt_pk_bf16_f32 v47, v178, v179
  v_mfma_f32_16x16x32_bf16 v[188:191], v[196:199], v[52:55], v[204:207]
  s_waitcnt lgkmcnt(6)
  v_mfma_f32_16x16x32_bf16 v[216:219], v[40:43], v[132:135], v[216:219]
  ds_read_b64_tr_b16 v[116:117], v241 offset:5152
  ds_read_b64_tr_b16 v[118:119], v241 offset:5312
  v_mfma_f32_16x16x32_bf16 v[192:195], v[200:203], v[52:55], v[204:207]
  s_waitcnt lgkmcnt(6)
  v_cvt_pk_bf16_f32 v48, v180, v181
  v_cvt_pk_bf16_f32 v49, v182, v183
  v_mfma_f32_16x16x32_bf16 v[212:215], v[44:47], v[136:139], v[212:215]
  ds_read_b64_tr_b16 v[120:121], v241 offset:6400
  ds_read_b64_tr_b16 v[122:123], v241 offset:6560
  v_cvt_pk_bf16_f32 v50, v184, v185
  v_cvt_pk_bf16_f32 v51, v186, v187
  v_mfma_f32_16x16x32_bf16 v[172:175], v[196:199], v[56:59], v[204:207]
  s_waitcnt lgkmcnt(6)
  v_mfma_f32_16x16x32_bf16 v[216:219], v[44:47], v[140:143], v[216:219]
  ds_read_b64_tr_b16 v[124:125], v241 offset:6432
  ds_read_b64_tr_b16 v[126:127], v241 offset:6592
  v_mfma_f32_16x16x32_bf16 v[176:179], v[200:203], v[56:59], v[204:207]
  s_waitcnt lgkmcnt(6)
  v_cvt_pk_bf16_f32 v52, v188, v189
  v_cvt_pk_bf16_f32 v53, v190, v191
  v_mfma_f32_16x16x32_bf16 v[212:215], v[48:51], v[112:115], v[212:215]
  ds_read_b64_tr_b16 v[128:129], v241 offset:7680
  ds_read_b64_tr_b16 v[130:131], v241 offset:7840
  v_cvt_pk_bf16_f32 v54, v192, v193
  v_cvt_pk_bf16_f32 v55, v194, v195
  v_mfma_f32_16x16x32_bf16 v[180:183], v[196:199], v[60:63], v[204:207]
  s_waitcnt lgkmcnt(6)
  v_mfma_f32_16x16x32_bf16 v[216:219], v[48:51], v[116:119], v[216:219]
  ds_read_b64_tr_b16 v[132:133], v241 offset:7712
  ds_read_b64_tr_b16 v[134:135], v241 offset:7872
  v_mfma_f32_16x16x32_bf16 v[184:187], v[200:203], v[60:63], v[204:207]
  s_waitcnt lgkmcnt(6)
  v_cvt_pk_bf16_f32 v56, v172, v173
  v_cvt_pk_bf16_f32 v57, v174, v175
  v_mfma_f32_16x16x32_bf16 v[212:215], v[52:55], v[120:123], v[212:215]
  ds_read_b64_tr_b16 v[136:137], v241 offset:8960
  ds_read_b64_tr_b16 v[138:139], v241 offset:9120
  v_cvt_pk_bf16_f32 v58, v176, v177
  v_cvt_pk_bf16_f32 v59, v178, v179
  v_mfma_f32_16x16x32_bf16 v[188:191], v[196:199], v[64:67], v[204:207]
  s_waitcnt lgkmcnt(6)
  v_mfma_f32_16x16x32_bf16 v[216:219], v[52:55], v[124:127], v[216:219]
  ds_read_b64_tr_b16 v[140:141], v241 offset:8992
  ds_read_b64_tr_b16 v[142:143], v241 offset:9152
  v_mfma_f32_16x16x32_bf16 v[192:195], v[200:203], v[64:67], v[204:207]
  s_waitcnt lgkmcnt(6)
  v_cvt_pk_bf16_f32 v60, v180, v181
  v_cvt_pk_bf16_f32 v61, v182, v183
  v_mfma_f32_16x16x32_bf16 v[212:215], v[56:59], v[128:131], v[212:215]
  ds_read_b64_tr_b16 v[112:113], v241 offset:10240
  ds_read_b64_tr_b16 v[114:115], v241 offset:10400
  v_cvt_pk_bf16_f32 v62, v184, v185
  v_cvt_pk_bf16_f32 v63, v186, v187
  v_mfma_f32_16x16x32_bf16 v[172:175], v[196:199], v[68:71], v[204:207]
  s_waitcnt lgkmcnt(6)
  v_mfma_f32_16x16x32_bf16 v[216:219], v[56:59], v[132:135], v[216:219]
  ds_read_b64_tr_b16 v[116:117], v241 offset:10272
  ds_read_b64_tr_b16 v[118:119], v241 offset:10432
  v_mfma_f32_16x16x32_bf16 v[176:179], v[200:203], v[68:71], v[204:207]
  s_waitcnt lgkmcnt(6)
  v_cvt_pk_bf16_f32 v64, v188, v189
  v_cvt_pk_bf16_f32 v65, v190, v191
  v_mfma_f32_16x16x32_bf16 v[212:215], v[60:63], v[136:139], v[212:215]
  ds_read_b64_tr_b16 v[120:121], v241 offset:11520
  ds_read_b64_tr_b16 v[122:123], v241 offset:11680
  v_cvt_pk_bf16_f32 v66, v192, v193
  v_cvt_pk_bf16_f32 v67, v194, v195
  v_mfma_f32_16x16x32_bf16 v[180:183], v[196:199], v[72:75], v[204:207]
  s_waitcnt lgkmcnt(6)
  v_mfma_f32_16x16x32_bf16 v[216:219], v[60:63], v[140:143], v[216:219]
  ds_read_b64_tr_b16 v[124:125], v241 offset:11552
  ds_read_b64_tr_b16 v[126:127], v241 offset:11712
  v_mfma_f32_16x16x32_bf16 v[184:187], v[200:203], v[72:75], v[204:207]
  s_waitcnt lgkmcnt(6)
  v_cvt_pk_bf16_f32 v68, v172, v173
  v_cvt_pk_bf16_f32 v69, v174, v175
  v_mfma_f32_16x16x32_bf16 v[212:215], v[64:67], v[112:115], v[212:215]
  ds_read_b64_tr_b16 v[128:129], v241 offset:12800
  ds_read_b64_tr_b16 v[130:131], v241 offset:12960
  v_cvt_pk_bf16_f32 v70, v176, v177
  v_cvt_pk_bf16_f32 v71, v178, v179
  v_mfma_f32_16x16x32_bf16 v[188:191], v[196:199], v[76:79], v[204:207]
  s_waitcnt lgkmcnt(6)
  v_mfma_f32_16x16x32_bf16 v[216:219], v[64:67], v[116:119], v[216:219]
  ds_read_b64_tr_b16 v[132:133], v241 offset:12832
  ds_read_b64_tr_b16 v[134:135], v241 offset:12992
  v_mfma_f32_16x16x32_bf16 v[192:195], v[200:203], v[76:79], v[204:207]
  s_waitcnt lgkmcnt(6)
  v_cvt_pk_bf16_f32 v72, v180, v181
  v_cvt_pk_bf16_f32 v73, v182, v183
  v_mfma_f32_16x16x32_bf16 v[212:215], v[68:71], v[120:123], v[212:215]
  ds_read_b64_tr_b16 v[136:137], v241 offset:14080
  ds_read_b64_tr_b16 v[138:139], v241 offset:14240
  v_cvt_pk_bf16_f32 v74, v184, v185
  v_cvt_pk_bf16_f32 v75, v186, v187
  v_mfma_f32_16x16x32_bf16 v[172:175], v[196:199], v[80:83], v[204:207]
  s_waitcnt lgkmcnt(6)
  v_mfma_f32_16x16x32_bf16 v[216:219], v[68:71], v[124:127], v[216:219]
  ds_read_b64_tr_b16 v[140:141], v241 offset:14112
  ds_read_b64_tr_b16 v[142:143], v241 offset:14272
  v_mfma_f32_16x16x32_bf16 v[176:179], v[200:203], v[80:83], v[204:207]
  s_waitcnt lgkmcnt(6)
  v_cvt_pk_bf16_f32 v76, v188, v189
  v_cvt_pk_bf16_f32 v77, v190, v191
  v_mfma_f32_16x16x32_bf16 v[212:215], v[72:75], v[128:131], v[212:215]
  ds_read_b64_tr_b16 v[112:113], v241 offset:15360
  ds_read_b64_tr_b16 v[114:115], v241 offset:15520
  v_cvt_pk_bf16_f32 v78, v192, v193
  v_cvt_pk_bf16_f32 v79, v194, v195
  v_mfma_f32_16x16x32_bf16 v[180:183], v[196:199], v[84:87], v[204:207]
  s_waitcnt lgkmcnt(6)
  v_mfma_f32_16x16x32_bf16 v[216:219], v[72:75], v[132:135], v[216:219]
  ds_read_b64_tr_b16 v[116:117], v241 offset:15392
  ds_read_b64_tr_b16 v[118:119], v241 offset:15552
  v_mfma_f32_16x16x32_bf16 v[184:187], v[200:203], v[84:87], v[204:207]
  s_waitcnt lgkmcnt(6)
  v_cvt_pk_bf16_f32 v80, v172, v173
  v_cvt_pk_bf16_f32 v81, v174, v175
  v_mfma_f32_16x16x32_bf16 v[212:215], v[76:79], v[136:139], v[212:215]
  ds_read_b64_tr_b16 v[120:121], v241 offset:16640
  ds_read_b64_tr_b16 v[122:123], v241 offset:16800
  v_cvt_pk_bf16_f32 v82, v176, v177
  v_cvt_pk_bf16_f32 v83, v178, v179
  v_mfma_f32_16x16x32_bf16 v[188:191], v[196:199], v[88:91], v[204:207]
  s_waitcnt lgkmcnt(6)
  v_mfma_f32_16x16x32_bf16 v[216:219], v[76:79], v[140:143], v[216:219]
  ds_read_b64_tr_b16 v[124:125], v241 offset:16672
  ds_read_b64_tr_b16 v[126:127], v241 offset:16832
  v_mfma_f32_16x16x32_bf16 v[192:195], v[200:203], v[88:91], v[204:207]
  s_waitcnt lgkmcnt(6)
  v_cvt_pk_bf16_f32 v84, v180, v181
  v_cvt_pk_bf16_f32 v85, v182, v183
  v_mfma_f32_16x16x32_bf16 v[212:215], v[80:83], v[112:115], v[212:215]
  ds_read_b64_tr_b16 v[128:129], v241 offset:17920
  ds_read_b64_tr_b16 v[130:131], v241 offset:18080
  v_cvt_pk_bf16_f32 v86, v184, v185
  v_cvt_pk_bf16_f32 v87, v186, v187
  v_mfma_f32_16x16x32_bf16 v[172:175], v[196:199], v[92:95], v[204:207]
  s_waitcnt lgkmcnt(6)
  v_mfma_f32_16x16x32_bf16 v[216:219], v[80:83], v[116:119], v[216:219]
  ds_read_b64_tr_b16 v[132:133], v241 offset:17952
  ds_read_b64_tr_b16 v[134:135], v241 offset:18112
  v_mfma_f32_16x16x32_bf16 v[176:179], v[200:203], v[92:95], v[204:207]
  s_waitcnt lgkmcnt(6)
  v_cvt_pk_bf16_f32 v88, v188, v189
  v_cvt_pk_bf16_f32 v89, v190, v191
  v_mfma_f32_16x16x32_bf16 v[212:215], v[84:87], v[120:123], v[212:215]
  ds_read_b64_tr_b16 v[136:137], v241 offset:19200
  ds_read_b64_tr_b16 v[138:139], v241 offset:19360
  v_cvt_pk_bf16_f32 v90, v192, v193
  v_cvt_pk_bf16_f32 v91, v194, v195
  v_mfma_f32_16x16x32_bf16 v[180:183], v[196:199], v[96:99], v[204:207]
  s_waitcnt lgkmcnt(6)
  v_mfma_f32_16x16x32_bf16 v[216:219], v[84:87], v[124:127], v[216:219]
  ds_read_b64_tr_b16 v[140:141], v241 offset:19232
  ds_read_b64_tr_b16 v[142:143], v241 offset:19392
  v_mfma_f32_16x16x32_bf16 v[184:187], v[200:203], v[96:99], v[204:207]
  s_waitcnt lgkmcnt(6)
  v_cvt_pk_bf16_f32 v92, v172, v173
  v_cvt_pk_bf16_f32 v93, v174, v175
  v_mfma_f32_16x16x32_bf16 v[212:215], v[88:91], v[128:131], v[212:215]
  ds_read_b64_tr_b16 v[112:113], v241 offset:20480
  ds_read_b64_tr_b16 v[114:115], v241 offset:20640
  v_cvt_pk_bf16_f32 v94, v176, v177
  v_cvt_pk_bf16_f32 v95, v178, v179
  v_mfma_f32_16x16x32_bf16 v[188:191], v[196:199], v[100:103], v[204:207]
  s_waitcnt lgkmcnt(6)
  v_mfma_f32_16x16x32_bf16 v[216:219], v[88:91], v[132:135], v[216:219]
  ds_read_b64_tr_b16 v[116:117], v241 offset:20512
  ds_read_b64_tr_b16 v[118:119], v241 offset:20672
  v_mfma_f32_16x16x32_bf16 v[192:195], v[200:203], v[100:103], v[204:207]
  s_waitcnt lgkmcnt(6)
  v_cvt_pk_bf16_f32 v96, v180, v181
  v_cvt_pk_bf16_f32 v97, v182, v183
  v_mfma_f32_16x16x32_bf16 v[212:215], v[92:95], v[136:139], v[212:215]
  ds_read_b64_tr_b16 v[120:121], v241 offset:21760
  ds_read_b64_tr_b16 v[122:123], v241 offset:21920
  v_cvt_pk_bf16_f32 v98, v184, v185
  v_cvt_pk_bf16_f32 v99, v186, v187
  v_mfma_f32_16x16x32_bf16 v[172:175], v[196:199], v[104:107], v[204:207]
  s_waitcnt lgkmcnt(6)
  v_mfma_f32_16x16x32_bf16 v[216:219], v[92:95], v[140:143], v[216:219]
  ds_read_b64_tr_b16 v[124:125], v241 offset:21792
  ds_read_b64_tr_b16 v[126:127], v241 offset:21952
  v_mfma_f32_16x16x32_bf16 v[176:179], v[200:203], v[104:107], v[204:207]
  s_waitcnt lgkmcnt(6)
  v_cvt_pk_bf16_f32 v100, v188, v189
  v_cvt_pk_bf16_f32 v101, v190, v191
  v_mfma_f32_16x16x32_bf16 v[212:215], v[96:99], v[112:115], v[212:215]
  ds_read_b64_tr_b16 v[128:129], v241 offset:23040
  ds_read_b64_tr_b16 v[130:131], v241 offset:23200
  v_cvt_pk_bf16_f32 v102, v192, v193
  v_cvt_pk_bf16_f32 v103, v194, v195
  v_mfma_f32_16x16x32_bf16 v[180:183], v[196:199], v[108:111], v[204:207]
  s_waitcnt lgkmcnt(6)
  v_mfma_f32_16x16x32_bf16 v[216:219], v[96:99], v[116:119], v[216:219]
  ds_read_b64_tr_b16 v[132:133], v241 offset:23072
  ds_read_b64_tr_b16 v[134:135], v241 offset:23232
  v_mfma_f32_16x16x32_bf16 v[184:187], v[200:203], v[108:111], v[204:207]
  s_waitcnt lgkmcnt(6)
  v_cvt_pk_bf16_f32 v104, v172, v173
  v_cvt_pk_bf16_f32 v105, v174, v175
  v_mfma_f32_16x16x32_bf16 v[212:215], v[100:103], v[120:123], v[212:215]
  s_waitcnt lgkmcnt(4)
  ds_read_b64_tr_b16 v[136:137], v241 offset:24320
  ds_read_b64_tr_b16 v[138:139], v241 offset:24480
  v_cvt_pk_bf16_f32 v106, v176, v177
  v_cvt_pk_bf16_f32 v107, v178, v179
  v_mfma_f32_16x16x32_bf16 v[216:219], v[100:103], v[124:127], v[216:219]
  s_waitcnt lgkmcnt(4)
  ds_read_b64_tr_b16 v[140:141], v241 offset:24352
  ds_read_b64_tr_b16 v[142:143], v241 offset:24512
  v_cvt_pk_bf16_f32 v108, v180, v181
  v_cvt_pk_bf16_f32 v109, v182, v183
  v_mfma_f32_16x16x32_bf16 v[212:215], v[104:107], v[128:131], v[212:215]
  s_waitcnt lgkmcnt(4)
  v_cvt_pk_bf16_f32 v110, v184, v185
  v_cvt_pk_bf16_f32 v111, v186, v187
  v_mfma_f32_16x16x32_bf16 v[216:219], v[104:107], v[132:135], v[216:219]
  s_waitcnt lgkmcnt(2)
  v_mfma_f32_16x16x32_bf16 v[212:215], v[108:111], v[136:139], v[212:215]
  s_waitcnt lgkmcnt(0)
  v_mfma_f32_16x16x32_bf16 v[216:219], v[108:111], v[140:143], v[216:219]
  v_cmp_lt_u32 vcc, 3, v2
  s_nop 4
  v_mul_f32 v212, v212, v222
  v_mul_f32 v213, v213, v223
  v_mul_f32 v214, v214, v224
  v_mul_f32 v215, v215, v225
  v_mul_f32 v216, v216, v222
  v_mul_f32 v217, v217, v223
  v_mul_f32 v218, v218, v224
  v_mul_f32 v219, v219, v225
  v_cvt_pk_bf16_f32 v228, v212, v213
  v_cvt_pk_bf16_f32 v229, v214, v215
  v_cvt_pk_bf16_f32 v230, v216, v217
  v_cvt_pk_bf16_f32 v231, v218, v219
  v_cndmask_b32 v230, v230, v22, vcc
  v_cndmask_b32 v231, v231, v22, vcc
  s_waitcnt lgkmcnt(0)
L_kvst:
  s_nop 1
  v_permlane16_swap_b32 v228, v230
  v_permlane16_swap_b32 v229, v231
  buffer_store_dwordx4 v[228:231], v220, s[60:63], 0 offen sc1
  s_barrier
  ds_read_b64_tr_b16 v[112:113], v9 offset:0
  ds_read_b64_tr_b16 v[114:115], v9 offset:1280
  ds_read_b64_tr_b16 v[116:117], v9 offset:32
  ds_read_b64_tr_b16 v[118:119], v9 offset:1312
  ds_read_b64_tr_b16 v[120:121], v9 offset:64
  ds_read_b64_tr_b16 v[122:123], v9 offset:1344
  ds_read_b64_tr_b16 v[124:125], v9 offset:96
  ds_read_b64_tr_b16 v[126:127], v9 offset:1376
  ds_read_b64_tr_b16 v[128:129], v9 offset:128
  ds_read_b64_tr_b16 v[130:131], v9 offset:1408
  ds_read_b64_tr_b16 v[132:133], v9 offset:5120
  ds_read_b64_tr_b16 v[134:135], v9 offset:6400
  ds_read_b64_tr_b16 v[136:137], v9 offset:5152
  ds_read_b64_tr_b16 v[138:139], v9 offset:6432
  s_waitcnt lgkmcnt(12)
  v_mfma_f32_16x16x32_bf16 v[144:147], v[112:115], v[32:35], 0
  s_waitcnt lgkmcnt(10)
  ds_read_b64_tr_b16 v[140:141], v9 offset:5184
  ds_read_b64_tr_b16 v[142:143], v9 offset:6464
  v_mfma_f32_16x16x32_bf16 v[148:151], v[116:119], v[32:35], 0
  s_waitcnt lgkmcnt(10)
  ds_read_b64_tr_b16 v[112:113], v9 offset:5216
  ds_read_b64_tr_b16 v[114:115], v9 offset:6496
  v_mfma_f32_16x16x32_bf16 v[152:155], v[120:123], v[32:35], 0
  s_waitcnt lgkmcnt(10)
  ds_read_b64_tr_b16 v[116:117], v9 offset:5248
  ds_read_b64_tr_b16 v[118:119], v9 offset:6528
  v_mfma_f32_16x16x32_bf16 v[156:159], v[124:127], v[32:35], 0
  s_waitcnt lgkmcnt(10)
  ds_read_b64_tr_b16 v[120:121], v9 offset:10240
  ds_read_b64_tr_b16 v[122:123], v9 offset:11520
  v_mfma_f32_16x16x32_bf16 v[160:163], v[128:131], v[32:35], 0
  s_waitcnt lgkmcnt(10)
  ds_read_b64_tr_b16 v[124:125], v9 offset:10272
  ds_read_b64_tr_b16 v[126:127], v9 offset:11552
  v_mfma_f32_16x16x32_bf16 v[144:147], v[132:135], v[36:39], v[144:147]
  s_waitcnt lgkmcnt(10)
  ds_read_b64_tr_b16 v[128:129], v9 offset:10304
  ds_read_b64_tr_b16 v[130:131], v9 offset:11584
  v_mfma_f32_16x16x32_bf16 v[148:151], v[136:139], v[36:39], v[148:151]
  s_waitcnt lgkmcnt(10)
  ds_read_b64_tr_b16 v[132:133], v9 offset:10336
  ds_read_b64_tr_b16 v[134:135], v9 offset:11616
  v_mfma_f32_16x16x32_bf16 v[152:155], v[140:143], v[36:39], v[152:155]
  s_waitcnt lgkmcnt(10)
  ds_read_b64_tr_b16 v[136:137], v9 offset:10368
  ds_read_b64_tr_b16 v[138:139], v9 offset:11648
  v_mfma_f32_16x16x32_bf16 v[156:159], v[112:115], v[36:39], v[156:159]
  s_waitcnt lgkmcnt(10)
  ds_read_b64_tr_b16 v[140:141], v9 offset:15360
  ds_read_b64_tr_b16 v[142:143], v9 offset:16640
  v_mfma_f32_16x16x32_bf16 v[160:163], v[116:119], v[36:39], v[160:163]
  s_waitcnt lgkmcnt(10)
  ds_read_b64_tr_b16 v[112:113], v9 offset:15392
  ds_read_b64_tr_b16 v[114:115], v9 offset:16672
  v_mfma_f32_16x16x32_bf16 v[144:147], v[120:123], v[40:43], v[144:147]
  s_waitcnt lgkmcnt(10)
  ds_read_b64_tr_b16 v[116:117], v9 offset:15424
  ds_read_b64_tr_b16 v[118:119], v9 offset:16704
  v_mfma_f32_16x16x32_bf16 v[148:151], v[124:127], v[40:43], v[148:151]
  s_waitcnt lgkmcnt(10)
  ds_read_b64_tr_b16 v[120:121], v9 offset:15456
  ds_read_b64_tr_b16 v[122:123], v9 offset:16736
  v_mfma_f32_16x16x32_bf16 v[152:155], v[128:131], v[40:43], v[152:155]
  s_waitcnt lgkmcnt(10)
  ds_read_b64_tr_b16 v[124:125], v9 offset:15488
  ds_read_b64_tr_b16 v[126:127], v9 offset:16768
  v_mfma_f32_16x16x32_bf16 v[156:159], v[132:135], v[40:43], v[156:159]
  s_waitcnt lgkmcnt(10)
  ds_read_b64_tr_b16 v[128:129], v9 offset:20480
  ds_read_b64_tr_b16 v[130:131], v9 offset:21760
  v_mfma_f32_16x16x32_bf16 v[160:163], v[136:139], v[40:43], v[160:163]
  ds_read_b64_tr_b16 v[132:133], v9 offset:20512
  ds_read_b64_tr_b16 v[134:135], v9 offset:21792
  s_waitcnt vmcnt(0)
  buffer_store_dwordx2 v[242:243], v30, s[60:63], 0 offen sc1
  s_waitcnt lgkmcnt(12)
  v_mfma_f32_16x16x32_bf16 v[144:147], v[140:143], v[44:47], v[144:147]
  s_waitcnt lgkmcnt(10)
  ds_read_b64_tr_b16 v[136:137], v9 offset:20544
  ds_read_b64_tr_b16 v[138:139], v9 offset:21824
  v_mfma_f32_16x16x32_bf16 v[148:151], v[112:115], v[44:47], v[148:151]
  s_waitcnt lgkmcnt(10)
  ds_read_b64_tr_b16 v[140:141], v9 offset:20576
  ds_read_b64_tr_b16 v[142:143], v9 offset:21856
  v_mfma_f32_16x16x32_bf16 v[152:155], v[116:119], v[44:47], v[152:155]
  s_waitcnt lgkmcnt(10)
  ds_read_b64_tr_b16 v[112:113], v9 offset:20608
  ds_read_b64_tr_b16 v[114:115], v9 offset:21888
  v_mfma_f32_16x16x32_bf16 v[156:159], v[120:123], v[44:47], v[156:159]
  s_waitcnt lgkmcnt(10)
  ds_read_b64_tr_b16 v[116:117], v9 offset:25600
  ds_read_b64_tr_b16 v[118:119], v9 offset:26880
  v_mfma_f32_16x16x32_bf16 v[160:163], v[124:127], v[44:47], v[160:163]
  ds_read_b64_tr_b16 v[120:121], v9 offset:25632
  ds_read_b64_tr_b16 v[122:123], v9 offset:26912
  s_barrier
  s_waitcnt lgkmcnt(12)
  v_mfma_f32_16x16x32_bf16 v[144:147], v[128:131], v[48:51], v[144:147]
  s_waitcnt lgkmcnt(10)
  ds_read_b64_tr_b16 v[124:125], v9 offset:25664
  ds_read_b64_tr_b16 v[126:127], v9 offset:26944
  v_mfma_f32_16x16x32_bf16 v[148:151], v[132:135], v[48:51], v[148:151]
  s_waitcnt lgkmcnt(10)
  ds_read_b64_tr_b16 v[128:129], v9 offset:25696
  ds_read_b64_tr_b16 v[130:131], v9 offset:26976
  v_mfma_f32_16x16x32_bf16 v[152:155], v[136:139], v[48:51], v[152:155]
  s_waitcnt lgkmcnt(10)
  ds_read_b64_tr_b16 v[132:133], v9 offset:25728
  ds_read_b64_tr_b16 v[134:135], v9 offset:27008
  v_mfma_f32_16x16x32_bf16 v[156:159], v[140:143], v[48:51], v[156:159]
  s_waitcnt lgkmcnt(10)
  ds_read_b64_tr_b16 v[136:137], v9 offset:30720
  ds_read_b64_tr_b16 v[138:139], v9 offset:32000
  v_mfma_f32_16x16x32_bf16 v[160:163], v[112:115], v[48:51], v[160:163]
  s_waitcnt lgkmcnt(10)
  ds_read_b64_tr_b16 v[140:141], v9 offset:30752
  ds_read_b64_tr_b16 v[142:143], v9 offset:32032
  v_mfma_f32_16x16x32_bf16 v[144:147], v[116:119], v[52:55], v[144:147]
  s_waitcnt lgkmcnt(10)
  ds_read_b64_tr_b16 v[112:113], v9 offset:30784
  ds_read_b64_tr_b16 v[114:115], v9 offset:32064
  v_mfma_f32_16x16x32_bf16 v[148:151], v[120:123], v[52:55], v[148:151]
  s_waitcnt lgkmcnt(10)
  ds_read_b64_tr_b16 v[116:117], v9 offset:30816
  ds_read_b64_tr_b16 v[118:119], v9 offset:32096
  v_mfma_f32_16x16x32_bf16 v[152:155], v[124:127], v[52:55], v[152:155]
  s_waitcnt lgkmcnt(10)
  ds_read_b64_tr_b16 v[120:121], v9 offset:30848
  ds_read_b64_tr_b16 v[122:123], v9 offset:32128
  v_mfma_f32_16x16x32_bf16 v[156:159], v[128:131], v[52:55], v[156:159]
  s_waitcnt lgkmcnt(10)
  ds_read_b64_tr_b16 v[124:125], v9 offset:35840
  ds_read_b64_tr_b16 v[126:127], v9 offset:37120
  v_mfma_f32_16x16x32_bf16 v[160:163], v[132:135], v[52:55], v[160:163]
  s_waitcnt lgkmcnt(10)
  ds_read_b64_tr_b16 v[128:129], v9 offset:35872
  ds_read_b64_tr_b16 v[130:131], v9 offset:37152
  v_mfma_f32_16x16x32_bf16 v[144:147], v[136:139], v[56:59], v[144:147]
  s_waitcnt lgkmcnt(10)
  ds_read_b64_tr_b16 v[132:133], v9 offset:35904
  ds_read_b64_tr_b16 v[134:135], v9 offset:37184
  v_mfma_f32_16x16x32_bf16 v[148:151], v[140:143], v[56:59], v[148:151]
  s_waitcnt lgkmcnt(10)
  ds_read_b64_tr_b16 v[136:137], v9 offset:35936
  ds_read_b64_tr_b16 v[138:139], v9 offset:37216
  v_mfma_f32_16x16x32_bf16 v[152:155], v[112:115], v[56:59], v[152:155]
  s_waitcnt lgkmcnt(10)
  ds_read_b64_tr_b16 v[140:141], v9 offset:35968
  ds_read_b64_tr_b16 v[142:143], v9 offset:37248
  v_mfma_f32_16x16x32_bf16 v[156:159], v[116:119], v[56:59], v[156:159]
  s_waitcnt lgkmcnt(10)
  ds_read_b64_tr_b16 v[112:113], v9 offset:40960
  ds_read_b64_tr_b16 v[114:115], v9 offset:42240
  v_mfma_f32_16x16x32_bf16 v[160:163], v[120:123], v[56:59], v[160:163]
  s_waitcnt lgkmcnt(10)
  ds_read_b64_tr_b16 v[116:117], v9 offset:40992
  ds_read_b64_tr_b16 v[118:119], v9 offset:42272
  v_mfma_f32_16x16x32_bf16 v[144:147], v[124:127], v[60:63], v[144:147]
  s_waitcnt lgkmcnt(10)
  ds_read_b64_tr_b16 v[120:121], v9 offset:41024
  ds_read_b64_tr_b16 v[122:123], v9 offset:42304
  v_mfma_f32_16x16x32_bf16 v[148:151], v[128:131], v[60:63], v[148:151]
  s_waitcnt lgkmcnt(10)
  ds_read_b64_tr_b16 v[124:125], v9 offset:41056
  ds_read_b64_tr_b16 v[126:127], v9 offset:42336
  v_mfma_f32_16x16x32_bf16 v[152:155], v[132:135], v[60:63], v[152:155]
  s_waitcnt lgkmcnt(10)
  ds_read_b64_tr_b16 v[128:129], v9 offset:41088
  ds_read_b64_tr_b16 v[130:131], v9 offset:42368
  v_mfma_f32_16x16x32_bf16 v[156:159], v[136:139], v[60:63], v[156:159]
  s_waitcnt lgkmcnt(10)
  ds_read_b64_tr_b16 v[132:133], v9 offset:46080
  ds_read_b64_tr_b16 v[134:135], v9 offset:47360
  v_mfma_f32_16x16x32_bf16 v[160:163], v[140:143], v[60:63], v[160:163]
  s_waitcnt lgkmcnt(10)
  ds_read_b64_tr_b16 v[136:137], v9 offset:46112
  ds_read_b64_tr_b16 v[138:139], v9 offset:47392
  v_mfma_f32_16x16x32_bf16 v[144:147], v[112:115], v[64:67], v[144:147]
  s_waitcnt lgkmcnt(10)
  ds_read_b64_tr_b16 v[140:141], v9 offset:46144
  ds_read_b64_tr_b16 v[142:143], v9 offset:47424
  v_mfma_f32_16x16x32_bf16 v[148:151], v[116:119], v[64:67], v[148:151]
  s_waitcnt lgkmcnt(10)
  ds_read_b64_tr_b16 v[112:113], v9 offset:46176
  ds_read_b64_tr_b16 v[114:115], v9 offset:47456
  v_mfma_f32_16x16x32_bf16 v[152:155], v[120:123], v[64:67], v[152:155]
  s_waitcnt lgkmcnt(10)
  ds_read_b64_tr_b16 v[116:117], v9 offset:46208
  ds_read_b64_tr_b16 v[118:119], v9 offset:47488
  v_mfma_f32_16x16x32_bf16 v[156:159], v[124:127], v[64:67], v[156:159]
  s_waitcnt lgkmcnt(10)
  ds_read_b64_tr_b16 v[120:121], v10 offset:0
  ds_read_b64_tr_b16 v[122:123], v10 offset:1280
  v_mfma_f32_16x16x32_bf16 v[160:163], v[128:131], v[64:67], v[160:163]
  s_waitcnt lgkmcnt(10)
  ds_read_b64_tr_b16 v[124:125], v10 offset:32
  ds_read_b64_tr_b16 v[126:127], v10 offset:1312
  v_mfma_f32_16x16x32_bf16 v[144:147], v[132:135], v[68:71], v[144:147]
  s_waitcnt lgkmcnt(10)
  ds_read_b64_tr_b16 v[128:129], v10 offset:64
  ds_read_b64_tr_b16 v[130:131], v10 offset:1344
  v_mfma_f32_16x16x32_bf16 v[148:151], v[136:139], v[68:71], v[148:151]
  s_waitcnt lgkmcnt(10)
  ds_read_b64_tr_b16 v[132:133], v10 offset:96
  ds_read_b64_tr_b16 v[134:135], v10 offset:1376
  v_mfma_f32_16x16x32_bf16 v[152:155], v[140:143], v[68:71], v[152:155]
  s_waitcnt lgkmcnt(10)
  ds_read_b64_tr_b16 v[136:137], v10 offset:128
  ds_read_b64_tr_b16 v[138:139], v10 offset:1408
  v_mfma_f32_16x16x32_bf16 v[156:159], v[112:115], v[68:71], v[156:159]
  s_waitcnt lgkmcnt(10)
  ds_read_b64_tr_b16 v[140:141], v10 offset:5120
  ds_read_b64_tr_b16 v[142:143], v10 offset:6400
  v_mfma_f32_16x16x32_bf16 v[160:163], v[116:119], v[68:71], v[160:163]
  ds_read_b64_tr_b16 v[112:113], v10 offset:5152
  ds_read_b64_tr_b16 v[114:115], v10 offset:6432
  s_barrier
  s_waitcnt lgkmcnt(12)
  v_mfma_f32_16x16x32_bf16 v[144:147], v[120:123], v[72:75], v[144:147]
  s_waitcnt lgkmcnt(10)
  ds_read_b64_tr_b16 v[116:117], v10 offset:5184
  ds_read_b64_tr_b16 v[118:119], v10 offset:6464
  v_mfma_f32_16x16x32_bf16 v[148:151], v[124:127], v[72:75], v[148:151]
  s_waitcnt lgkmcnt(10)
  ds_read_b64_tr_b16 v[120:121], v10 offset:5216
  ds_read_b64_tr_b16 v[122:123], v10 offset:6496
  v_mfma_f32_16x16x32_bf16 v[152:155], v[128:131], v[72:75], v[152:155]
  s_waitcnt lgkmcnt(10)
  ds_read_b64_tr_b16 v[124:125], v10 offset:5248
  ds_read_b64_tr_b16 v[126:127], v10 offset:6528
  v_mfma_f32_16x16x32_bf16 v[156:159], v[132:135], v[72:75], v[156:159]
  s_waitcnt lgkmcnt(10)
  ds_read_b64_tr_b16 v[128:129], v10 offset:10240
  ds_read_b64_tr_b16 v[130:131], v10 offset:11520
  v_mfma_f32_16x16x32_bf16 v[160:163], v[136:139], v[72:75], v[160:163]
  s_waitcnt lgkmcnt(10)
  ds_read_b64_tr_b16 v[132:133], v10 offset:10272
  ds_read_b64_tr_b16 v[134:135], v10 offset:11552
  v_mfma_f32_16x16x32_bf16 v[144:147], v[140:143], v[76:79], v[144:147]
  s_waitcnt lgkmcnt(10)
  ds_read_b64_tr_b16 v[136:137], v10 offset:10304
  ds_read_b64_tr_b16 v[138:139], v10 offset:11584
  v_mfma_f32_16x16x32_bf16 v[148:151], v[112:115], v[76:79], v[148:151]
  s_waitcnt lgkmcnt(10)
  ds_read_b64_tr_b16 v[140:141], v10 offset:10336
  ds_read_b64_tr_b16 v[142:143], v10 offset:11616
  v_mfma_f32_16x16x32_bf16 v[152:155], v[116:119], v[76:79], v[152:155]
  s_waitcnt lgkmcnt(10)
  ds_read_b64_tr_b16 v[112:113], v10 offset:10368
  ds_read_b64_tr_b16 v[114:115], v10 offset:11648
  v_mfma_f32_16x16x32_bf16 v[156:159], v[120:123], v[76:79], v[156:159]
  s_waitcnt lgkmcnt(10)
  ds_read_b64_tr_b16 v[116:117], v10 offset:15360
  ds_read_b64_tr_b16 v[118:119], v10 offset:16640
  v_mfma_f32_16x16x32_bf16 v[160:163], v[124:127], v[76:79], v[160:163]
  s_waitcnt lgkmcnt(10)
  ds_read_b64_tr_b16 v[120:121], v10 offset:15392
  ds_read_b64_tr_b16 v[122:123], v10 offset:16672
  v_mfma_f32_16x16x32_bf16 v[144:147], v[128:131], v[80:83], v[144:147]
  s_waitcnt lgkmcnt(10)
  ds_read_b64_tr_b16 v[124:125], v10 offset:15424
  ds_read_b64_tr_b16 v[126:127], v10 offset:16704
  v_mfma_f32_16x16x32_bf16 v[148:151], v[132:135], v[80:83], v[148:151]
  s_waitcnt lgkmcnt(10)
  ds_read_b64_tr_b16 v[128:129], v10 offset:15456
  ds_read_b64_tr_b16 v[130:131], v10 offset:16736
  v_mfma_f32_16x16x32_bf16 v[152:155], v[136:139], v[80:83], v[152:155]
  s_waitcnt lgkmcnt(10)
  ds_read_b64_tr_b16 v[132:133], v10 offset:15488
  ds_read_b64_tr_b16 v[134:135], v10 offset:16768
  v_mfma_f32_16x16x32_bf16 v[156:159], v[140:143], v[80:83], v[156:159]
  s_waitcnt lgkmcnt(10)
  ds_read_b64_tr_b16 v[136:137], v10 offset:20480
  ds_read_b64_tr_b16 v[138:139], v10 offset:21760
  v_mfma_f32_16x16x32_bf16 v[160:163], v[112:115], v[80:83], v[160:163]
  s_waitcnt lgkmcnt(10)
  ds_read_b64_tr_b16 v[140:141], v10 offset:20512
  ds_read_b64_tr_b16 v[142:143], v10 offset:21792
  v_mfma_f32_16x16x32_bf16 v[144:147], v[116:119], v[84:87], v[144:147]
  s_waitcnt lgkmcnt(10)
  ds_read_b64_tr_b16 v[112:113], v10 offset:20544
  ds_read_b64_tr_b16 v[114:115], v10 offset:21824
  v_mfma_f32_16x16x32_bf16 v[148:151], v[120:123], v[84:87], v[148:151]
  s_waitcnt lgkmcnt(10)
  ds_read_b64_tr_b16 v[116:117], v10 offset:20576
  ds_read_b64_tr_b16 v[118:119], v10 offset:21856
  v_mfma_f32_16x16x32_bf16 v[152:155], v[124:127], v[84:87], v[152:155]
  s_waitcnt lgkmcnt(10)
  ds_read_b64_tr_b16 v[120:121], v10 offset:20608
  ds_read_b64_tr_b16 v[122:123], v10 offset:21888
  v_mfma_f32_16x16x32_bf16 v[156:159], v[128:131], v[84:87], v[156:159]
  s_waitcnt lgkmcnt(10)
  ds_read_b64_tr_b16 v[124:125], v10 offset:25600
  ds_read_b64_tr_b16 v[126:127], v10 offset:26880
  v_mfma_f32_16x16x32_bf16 v[160:163], v[132:135], v[84:87], v[160:163]
  s_waitcnt lgkmcnt(10)
  ds_read_b64_tr_b16 v[128:129], v10 offset:25632
  ds_read_b64_tr_b16 v[130:131], v10 offset:26912
  v_mfma_f32_16x16x32_bf16 v[144:147], v[136:139], v[88:91], v[144:147]
  s_waitcnt lgkmcnt(10)
  ds_read_b64_tr_b16 v[132:133], v10 offset:25664
  ds_read_b64_tr_b16 v[134:135], v10 offset:26944
  v_mfma_f32_16x16x32_bf16 v[148:151], v[140:143], v[88:91], v[148:151]
  s_waitcnt lgkmcnt(10)
  ds_read_b64_tr_b16 v[136:137], v10 offset:25696
  ds_read_b64_tr_b16 v[138:139], v10 offset:26976
  v_mfma_f32_16x16x32_bf16 v[152:155], v[112:115], v[88:91], v[152:155]
  s_waitcnt lgkmcnt(10)
  ds_read_b64_tr_b16 v[140:141], v10 offset:25728
  ds_read_b64_tr_b16 v[142:143], v10 offset:27008
  v_mfma_f32_16x16x32_bf16 v[156:159], v[116:119], v[88:91], v[156:159]
  s_waitcnt lgkmcnt(10)
  ds_read_b64_tr_b16 v[112:113], v10 offset:30720
  ds_read_b64_tr_b16 v[114:115], v10 offset:32000
  v_mfma_f32_16x16x32_bf16 v[160:163], v[120:123], v[88:91], v[160:163]
  s_waitcnt lgkmcnt(10)
  ds_read_b64_tr_b16 v[116:117], v10 offset:30752
  ds_read_b64_tr_b16 v[118:119], v10 offset:32032
  v_mfma_f32_16x16x32_bf16 v[144:147], v[124:127], v[92:95], v[144:147]
  s_waitcnt lgkmcnt(10)
  ds_read_b64_tr_b16 v[120:121], v10 offset:30784
  ds_read_b64_tr_b16 v[122:123], v10 offset:32064
  v_mfma_f32_16x16x32_bf16 v[148:151], v[128:131], v[92:95], v[148:151]
  s_waitcnt lgkmcnt(10)
  ds_read_b64_tr_b16 v[124:125], v10 offset:30816
  ds_read_b64_tr_b16 v[126:127], v10 offset:32096
  v_mfma_f32_16x16x32_bf16 v[152:155], v[132:135], v[92:95], v[152:155]
  s_waitcnt lgkmcnt(10)
  ds_read_b64_tr_b16 v[128:129], v10 offset:30848
  ds_read_b64_tr_b16 v[130:131], v10 offset:32128
  v_mfma_f32_16x16x32_bf16 v[156:159], v[136:139], v[92:95], v[156:159]
  s_waitcnt lgkmcnt(10)
  ds_read_b64_tr_b16 v[132:133], v10 offset:35840
  ds_read_b64_tr_b16 v[134:135], v10 offset:37120
  v_mfma_f32_16x16x32_bf16 v[160:163], v[140:143], v[92:95], v[160:163]
  ds_read_b64_tr_b16 v[136:137], v10 offset:35872
  ds_read_b64_tr_b16 v[138:139], v10 offset:37152
  s_barrier
  s_waitcnt lgkmcnt(12)
  v_mfma_f32_16x16x32_bf16 v[144:147], v[112:115], v[96:99], v[144:147]
  s_waitcnt lgkmcnt(10)
  ds_read_b64_tr_b16 v[140:141], v10 offset:35904
  ds_read_b64_tr_b16 v[142:143], v10 offset:37184
  v_mfma_f32_16x16x32_bf16 v[148:151], v[116:119], v[96:99], v[148:151]
  s_waitcnt lgkmcnt(10)
  ds_read_b64_tr_b16 v[112:113], v10 offset:35936
  ds_read_b64_tr_b16 v[114:115], v10 offset:37216
  v_mfma_f32_16x16x32_bf16 v[152:155], v[120:123], v[96:99], v[152:155]
  s_waitcnt lgkmcnt(10)
  ds_read_b64_tr_b16 v[116:117], v10 offset:35968
  ds_read_b64_tr_b16 v[118:119], v10 offset:37248
  v_mfma_f32_16x16x32_bf16 v[156:159], v[124:127], v[96:99], v[156:159]
  s_waitcnt lgkmcnt(10)
  ds_read_b64_tr_b16 v[120:121], v10 offset:40960
  ds_read_b64_tr_b16 v[122:123], v10 offset:42240
  v_mfma_f32_16x16x32_bf16 v[160:163], v[128:131], v[96:99], v[160:163]
  s_waitcnt lgkmcnt(10)
  ds_read_b64_tr_b16 v[124:125], v10 offset:40992
  ds_read_b64_tr_b16 v[126:127], v10 offset:42272
  v_mfma_f32_16x16x32_bf16 v[144:147], v[132:135], v[100:103], v[144:147]
  s_waitcnt lgkmcnt(10)
  ds_read_b64_tr_b16 v[128:129], v10 offset:41024
  ds_read_b64_tr_b16 v[130:131], v10 offset:42304
  v_mfma_f32_16x16x32_bf16 v[148:151], v[136:139], v[100:103], v[148:151]
  s_waitcnt lgkmcnt(10)
  ds_read_b64_tr_b16 v[132:133], v10 offset:41056
  ds_read_b64_tr_b16 v[134:135], v10 offset:42336
  v_mfma_f32_16x16x32_bf16 v[152:155], v[140:143], v[100:103], v[152:155]
  s_waitcnt lgkmcnt(10)
  ds_read_b64_tr_b16 v[136:137], v10 offset:41088
  ds_read_b64_tr_b16 v[138:139], v10 offset:42368
  v_mfma_f32_16x16x32_bf16 v[156:159], v[112:115], v[100:103], v[156:159]
  s_waitcnt lgkmcnt(10)
  ds_read_b64_tr_b16 v[140:141], v10 offset:46080
  ds_read_b64_tr_b16 v[142:143], v10 offset:47360
  v_mfma_f32_16x16x32_bf16 v[160:163], v[116:119], v[100:103], v[160:163]
  s_waitcnt lgkmcnt(10)
  ds_read_b64_tr_b16 v[112:113], v10 offset:46112
  ds_read_b64_tr_b16 v[114:115], v10 offset:47392
  v_mfma_f32_16x16x32_bf16 v[144:147], v[120:123], v[104:107], v[144:147]
  s_waitcnt lgkmcnt(10)
  ds_read_b64_tr_b16 v[116:117], v10 offset:46144
  ds_read_b64_tr_b16 v[118:119], v10 offset:47424
  v_mfma_f32_16x16x32_bf16 v[148:151], v[124:127], v[104:107], v[148:151]
  s_waitcnt lgkmcnt(10)
  ds_read_b64_tr_b16 v[120:121], v10 offset:46176
  ds_read_b64_tr_b16 v[122:123], v10 offset:47456
  v_mfma_f32_16x16x32_bf16 v[152:155], v[128:131], v[104:107], v[152:155]
  s_waitcnt lgkmcnt(10)
  ds_read_b64_tr_b16 v[124:125], v10 offset:46208
  ds_read_b64_tr_b16 v[126:127], v10 offset:47488
  v_mfma_f32_16x16x32_bf16 v[156:159], v[132:135], v[104:107], v[156:159]
  s_waitcnt lgkmcnt(10)
  v_mfma_f32_16x16x32_bf16 v[160:163], v[136:139], v[104:107], v[160:163]
  s_waitcnt lgkmcnt(8)
  v_mfma_f32_16x16x32_bf16 v[144:147], v[140:143], v[108:111], v[144:147]
  s_waitcnt lgkmcnt(6)
  v_mfma_f32_16x16x32_bf16 v[148:151], v[112:115], v[108:111], v[148:151]
  s_waitcnt lgkmcnt(4)
  v_mfma_f32_16x16x32_bf16 v[152:155], v[116:119], v[108:111], v[152:155]
  s_waitcnt lgkmcnt(2)
  v_mfma_f32_16x16x32_bf16 v[156:159], v[120:123], v[108:111], v[156:159]
  s_waitcnt lgkmcnt(0)
  v_mfma_f32_16x16x32_bf16 v[160:163], v[124:127], v[108:111], v[160:163]
  s_waitcnt lgkmcnt(0)
L_qdone:
  s_lshl_b32 s12, s78, 13
  s_add_u32 s12, s12, 18878464
  v_lshl_add_u32 v20, v1, 6, s12
  v_add_u32 v21, 4096, v20
  v_min_u32 v24, 23, v1
  v_lshl_add_u32 v24, s3, 2, v24
  v_and_b32 v24, 127, v24
  v_lshl_add_u32 v24, v24, 6, s12
  buffer_load_dword v22, v24, s[60:63], 0 offen sc1
  v_mul_f32 v15, 0x3ea52b5c, v15
  v_mul_f32 v144, v144, v15
  v_mul_f32 v145, v145, v15
  v_mul_f32 v146, v146, v15
  v_mul_f32 v147, v147, v15
  v_cvt_pk_bf16_f32 v112, v144, v145
  v_cvt_pk_bf16_f32 v113, v146, v147
  ds_write_b64 v236, v[112:113] offset:0
  v_mul_f32 v148, v148, v15
  v_mul_f32 v149, v149, v15
  v_mul_f32 v150, v150, v15
  v_mul_f32 v151, v151, v15
  v_cvt_pk_bf16_f32 v114, v148, v149
  v_cvt_pk_bf16_f32 v115, v150, v151
  ds_write_b64 v236, v[114:115] offset:32
  v_mul_f32 v152, v152, v15
  v_mul_f32 v153, v153, v15
  v_mul_f32 v154, v154, v15
  v_mul_f32 v155, v155, v15
  v_cvt_pk_bf16_f32 v116, v152, v153
  v_cvt_pk_bf16_f32 v117, v154, v155
  ds_write_b64 v236, v[116:117] offset:64
  v_mul_f32 v156, v156, v15
  v_mul_f32 v157, v157, v15
  v_mul_f32 v158, v158, v15
  v_mul_f32 v159, v159, v15
  v_cvt_pk_bf16_f32 v118, v156, v157
  v_cvt_pk_bf16_f32 v119, v158, v159
  ds_write_b64 v236, v[118:119] offset:96
  v_mul_f32 v160, v160, v15
  v_mul_f32 v161, v161, v15
  v_mul_f32 v162, v162, v15
  v_mul_f32 v163, v163, v15
  v_cvt_pk_bf16_f32 v120, v160, v161
  v_cvt_pk_bf16_f32 v121, v162, v163
  ds_write_b64 v236, v[120:121] offset:128
  s_waitcnt lgkmcnt(0)
  s_barrier
  ds_read_b64 a[240:241], v232 offset:0
  ds_read_b64 a[242:243], v232 offset:8
  ds_read_b64 v[160:161], v234 offset:32
  ds_read_b64 a[244:245], v232 offset:40
  ds_read_b64 a[246:247], v232 offset:48
  ds_read_b64 a[248:249], v233 offset:0
  ds_read_b64 a[250:251], v233 offset:8
  ds_read_b64 v[162:163], v235 offset:32
  ds_read_b64 a[252:253], v233 offset:40
  ds_read_b64 a[254:255], v233 offset:48
  s_waitcnt vmcnt(0)
  v_cmp_ne_u32 vcc, v22, v19
  s_nop 3
  s_cbranch_vccnz L_kvspin
L_kvspin_back:
  s_mul_i32 s80, s3, 3584
  s_add_u32 s80, s80, s81
  s_add_u32 s22, s60, s80
  s_addc_u32 s23, s61, 0
  global_load_dwordx4 v[164:167], v11, s[22:23]
  s_add_u32 s3, s3, 1
  global_load_dwordx2 v[176:177], v17, s[22:23]
  s_and_b32 s3, s3, 31
  global_load_dwordx4 v[168:171], v0, s[22:23] offset:1536
  global_load_dwordx4 v[172:175], v0, s[22:23] offset:2560
  s_mul_i32 s80, s3, 3584
  s_add_u32 s80, s80, s81
  s_add_u32 s22, s60, s80
  s_addc_u32 s23, s61, 0
  global_load_dwordx4 v[178:181], v11, s[22:23]
  s_add_u32 s3, s3, 1
  global_load_dwordx2 v[190:191], v17, s[22:23]
  s_and_b32 s3, s3, 31
  global_load_dwordx4 v[182:185], v0, s[22:23] offset:1536
  global_load_dwordx4 v[186:189], v0, s[22:23] offset:2560
  s_mul_i32 s80, s3, 3584
  s_add_u32 s80, s80, s81
  s_add_u32 s22, s60, s80
  s_addc_u32 s23, s61, 0
  global_load_dwordx4 v[192:195], v11, s[22:23]
  s_add_u32 s3, s3, 1
  global_load_dwordx2 v[204:205], v17, s[22:23]
  s_and_b32 s3, s3, 31
  global_load_dwordx4 v[196:199], v0, s[22:23] offset:1536
  global_load_dwordx4 v[200:203], v0, s[22:23] offset:2560
  s_mul_i32 s80, s3, 3584
  s_add_u32 s80, s80, s81
  s_add_u32 s22, s60, s80
  s_addc_u32 s23, s61, 0
  global_load_dwordx4 v[206:209], v11, s[22:23]
  s_add_u32 s3, s3, 1
  global_load_dwordx2 v[218:219], v17, s[22:23]
  s_and_b32 s3, s3, 31
  global_load_dwordx4 v[210:213], v0, s[22:23] offset:1536
  global_load_dwordx4 v[214:217], v0, s[22:23] offset:2560
  s_mul_i32 s80, s3, 3584
  s_add_u32 s80, s80, s81
  s_add_u32 s22, s60, s80
  s_addc_u32 s23, s61, 0
  global_load_dwordx4 v[220:223], v11, s[22:23]
  s_add_u32 s3, s3, 1
  global_load_dwordx2 v[232:233], v17, s[22:23]
  s_and_b32 s3, s3, 31
  global_load_dwordx4 v[224:227], v0, s[22:23] offset:1536
  global_load_dwordx4 v[228:231], v0, s[22:23] offset:2560
  v_mov_b64 v[32:33], 0
  v_mov_b64 v[34:35], 0
  v_mov_b64 v[36:37], 0
  v_mov_b64 v[38:39], 0
  v_mov_b64 v[40:41], 0
  v_mov_b64 v[42:43], 0
  v_mov_b64 v[44:45], 0
  v_mov_b64 v[46:47], 0
  v_mov_b64 v[48:49], 0
  v_mov_b64 v[50:51], 0
  v_mov_b64 v[52:53], 0
  v_mov_b64 v[54:55], 0
  v_mov_b64 v[56:57], 0
  v_mov_b64 v[58:59], 0
  v_mov_b64 v[60:61], 0
  v_mov_b64 v[62:63], 0
  v_mov_b64 v[64:65], 0
  v_mov_b64 v[66:67], 0
  v_mov_b64 v[68:69], 0
  v_mov_b64 v[70:71], 0
  v_mov_b64 v[72:73], 0
  v_mov_b64 v[74:75], 0
  v_mov_b64 v[76:77], 0
  v_mov_b64 v[78:79], 0
  v_mov_b64 v[80:81], 0
  v_mov_b64 v[82:83], 0
  v_mov_b64 v[84:85], 0
  v_mov_b64 v[86:87], 0
  v_mov_b64 v[88:89], 0
  v_mov_b64 v[90:91], 0
  v_mov_b64 v[92:93], 0
  v_mov_b64 v[94:95], 0
  s_mov_b32 s82, 0
  s_mov_b32 s20, s83
L_main:
  s_mov_b32 s1, 0
  s_mov_b32 s83, s20
  s_mul_i32 s85, s68, 204800
  s_waitcnt vmcnt(18) lgkmcnt(7)
  v_mfma_f32_32x32x4_2b_bf16 v[96:127], v[176:177], v[160:161], 0 cbsz:1
  s_nop 15
  s_nop 1
  v_mfma_f32_32x32x16_bf16 v[96:111], v[164:167], a[240:243], v[96:111]
  s_waitcnt lgkmcnt(5)
  v_mfma_f32_32x32x16_bf16 v[112:127], v[164:167], a[244:247], v[112:127]
  s_waitcnt lgkmcnt(2)
  s_nop 8
  v_exp_f32 v96, v96
  v_exp_f32 v97, v97
  s_mul_i32 s80, s3, 3584
  s_add_u32 s80, s80, s81
  v_exp_f32 v98, v98
  v_exp_f32 v99, v99
  v_exp_f32 v100, v100
  v_mfma_f32_32x32x4_2b_bf16 v[128:159], v[176:177], v[162:163], 0 cbsz:1
  v_exp_f32 v101, v101
  v_exp_f32 v102, v102
  v_exp_f32 v103, v103
  v_exp_f32 v104, v104
  v_exp_f32 v105, v105
  v_exp_f32 v106, v106
  v_exp_f32 v107, v107
  v_exp_f32 v108, v108
  s_waitcnt vmcnt(17)
  v_smfmac_f32_32x32x32_bf16 v[32:47], v[168:171], v[96:103], v18
  s_add_u32 s22, s60, s80
  s_addc_u32 s23, s61, 0
  global_load_dwordx4 v[234:237], v11, s[22:23]
  v_exp_f32 v109, v109
  v_exp_f32 v110, v110
  v_exp_f32 v111, v111
  v_exp_f32 v112, v112
  v_exp_f32 v113, v113
  v_exp_f32 v114, v114
  v_exp_f32 v115, v115
  v_mfma_f32_32x32x16_bf16 v[128:143], v[164:167], a[248:251], v[128:143]
  s_add_u32 s3, s3, 1
  v_exp_f32 v116, v116
  v_exp_f32 v117, v117
  v_exp_f32 v118, v118
  s_waitcnt vmcnt(17)
  v_smfmac_f32_32x32x32_bf16 v[32:47], v[172:175], v[104:111], v18
  s_waitcnt lgkmcnt(0)
  global_load_dwordx2 v[246:247], v17, s[22:23]
  s_and_b32 s3, s3, 31
  v_exp_f32 v119, v119
  v_exp_f32 v120, v120
  v_exp_f32 v121, v121
  v_mfma_f32_32x32x16_bf16 v[144:159], v[164:167], a[252:255], v[144:159]
  v_exp_f32 v122, v122
  v_exp_f32 v123, v123
  v_exp_f32 v124, v124
  v_smfmac_f32_32x32x32_bf16 v[48:63], v[168:171], v[112:119], v18
  global_load_dwordx4 v[238:241], v0, s[22:23] offset:1536
  v_exp_f32 v125, v125
  v_exp_f32 v126, v126
  v_exp_f32 v127, v127
  v_exp_f32 v128, v128
  v_exp_f32 v129, v129
  v_smfmac_f32_32x32x32_bf16 v[48:63], v[172:175], v[120:127], v18
  s_waitcnt vmcnt(17)
  s_add_u32 m0, s84, 0
  global_load_dwordx4 v[242:245], v0, s[22:23] offset:2560
  v_exp_f32 v130, v130
  v_exp_f32 v131, v131
  v_exp_f32 v132, v132
  v_mfma_f32_32x32x4_2b_bf16 v[96:127], v[190:191], v[160:161], 0 cbsz:1
  v_exp_f32 v133, v133
  v_exp_f32 v134, v134
  v_exp_f32 v135, v135
  v_exp_f32 v136, v136
  v_exp_f32 v137, v137
  v_exp_f32 v138, v138
  v_exp_f32 v139, v139
  v_exp_f32 v140, v140
  v_smfmac_f32_32x32x32_bf16 v[64:79], v[168:171], v[128:135], v18
  s_nop 0
  buffer_load_dwordx4 v26, s[4:7], s21 offen nt lds
  v_exp_f32 v141, v141
  v_exp_f32 v142, v142
  v_exp_f32 v143, v143
  v_exp_f32 v144, v144
  v_exp_f32 v145, v145
  v_exp_f32 v146, v146
  v_exp_f32 v147, v147
  v_mfma_f32_32x32x16_bf16 v[96:111], v[178:181], a[240:243], v[96:111]
  v_exp_f32 v148, v148
  v_exp_f32 v149, v149
  v_exp_f32 v150, v150
  v_smfmac_f32_32x32x32_bf16 v[64:79], v[172:175], v[136:143], v18
  buffer_load_dword v22, v20, s[60:63], 0 offen sc1
  v_exp_f32 v151, v151
  v_exp_f32 v152, v152
  v_exp_f32 v153, v153
  v_mfma_f32_32x32x16_bf16 v[112:127], v[178:181], a[244:247], v[112:127]
  v_exp_f32 v154, v154
  v_exp_f32 v155, v155
  v_exp_f32 v156, v156
  v_smfmac_f32_32x32x32_bf16 v[80:95], v[168:171], v[144:151], v18
  buffer_load_dword v23, v21, s[60:63], 0 offen sc1
  v_exp_f32 v157, v157
  v_exp_f32 v158, v158
  v_exp_f32 v159, v159
  v_exp_f32 v96, v96
  v_exp_f32 v97, v97
  v_smfmac_f32_32x32x32_bf16 v[80:95], v[172:175], v[152:159], v18
  v_exp_f32 v98, v98
  v_exp_f32 v99, v99
  v_exp_f32 v100, v100
  v_mfma_f32_32x32x4_2b_bf16 v[128:159], v[190:191], v[162:163], 0 cbsz:1
  v_exp_f32 v101, v101
  v_exp_f32 v102, v102
  v_exp_f32 v103, v103
  v_exp_f32 v104, v104
  v_exp_f32 v105, v105
  v_exp_f32 v106, v106
  v_exp_f32 v107, v107
  v_exp_f32 v108, v108
  s_waitcnt vmcnt(20)
  v_smfmac_f32_32x32x32_bf16 v[32:47], v[182:185], v[96:103], v18
  s_nop 0
  s_nop 0
  v_exp_f32 v109, v109
  v_exp_f32 v110, v110
  v_exp_f32 v111, v111
  v_exp_f32 v112, v112
  v_exp_f32 v113, v113
  v_exp_f32 v114, v114
  v_exp_f32 v115, v115
  v_mfma_f32_32x32x16_bf16 v[128:143], v[178:181], a[248:251], v[128:143]
  s_waitcnt vmcnt(19)
  v_exp_f32 v116, v116
  v_exp_f32 v117, v117
  v_exp_f32 v118, v118
  v_smfmac_f32_32x32x32_bf16 v[32:47], v[186:189], v[104:111], v18
  v_exp_f32 v119, v119
  v_exp_f32 v120, v120
  v_exp_f32 v121, v121
  v_mfma_f32_32x32x16_bf16 v[144:159], v[178:181], a[252:255], v[144:159]
  v_exp_f32 v122, v122
  v_exp_f32 v123, v123
  v_exp_f32 v124, v124
  v_smfmac_f32_32x32x32_bf16 v[48:63], v[182:185], v[112:119], v18
  v_exp_f32 v125, v125
  v_exp_f32 v126, v126
  v_exp_f32 v127, v127
  v_exp_f32 v128, v128
  v_exp_f32 v129, v129
  v_smfmac_f32_32x32x32_bf16 v[48:63], v[186:189], v[120:127], v18
  s_waitcnt vmcnt(17)
  v_exp_f32 v130, v130
  v_exp_f32 v131, v131
  v_exp_f32 v132, v132
  v_mfma_f32_32x32x4_2b_bf16 v[96:127], v[204:205], v[160:161], 0 cbsz:1
  v_exp_f32 v133, v133
  v_exp_f32 v134, v134
  v_exp_f32 v135, v135
  v_exp_f32 v136, v136
  v_exp_f32 v137, v137
  v_exp_f32 v138, v138
  v_exp_f32 v139, v139
  v_exp_f32 v140, v140
  v_smfmac_f32_32x32x32_bf16 v[64:79], v[182:185], v[128:135], v18
  s_nop 0
  s_nop 0
  v_exp_f32 v141, v141
  v_exp_f32 v142, v142
  v_exp_f32 v143, v143
  v_exp_f32 v144, v144
  v_exp_f32 v145, v145
  v_exp_f32 v146, v146
  v_exp_f32 v147, v147
  v_mfma_f32_32x32x16_bf16 v[96:111], v[192:195], a[240:243], v[96:111]
  s_add_u32 m0, s84, 1024
  v_exp_f32 v148, v148
  v_exp_f32 v149, v149
  v_exp_f32 v150, v150
  v_smfmac_f32_32x32x32_bf16 v[64:79], v[186:189], v[136:143], v18
  buffer_load_dwordx4 v27, s[4:7], s21 offen nt lds
  v_exp_f32 v151, v151
  v_exp_f32 v152, v152
  v_exp_f32 v153, v153
  v_mfma_f32_32x32x16_bf16 v[112:127], v[192:195], a[244:247], v[112:127]
  v_exp_f32 v154, v154
  v_exp_f32 v155, v155
  v_exp_f32 v156, v156
  v_smfmac_f32_32x32x32_bf16 v[80:95], v[182:185], v[144:151], v18
  v_exp_f32 v157, v157
  v_exp_f32 v158, v158
  v_exp_f32 v159, v159
  v_exp_f32 v96, v96
  v_exp_f32 v97, v97
  v_smfmac_f32_32x32x32_bf16 v[80:95], v[186:189], v[152:159], v18
  v_exp_f32 v98, v98
  v_exp_f32 v99, v99
  v_exp_f32 v100, v100
  v_mfma_f32_32x32x4_2b_bf16 v[128:159], v[204:205], v[162:163], 0 cbsz:1
  v_exp_f32 v101, v101
  v_exp_f32 v102, v102
  v_exp_f32 v103, v103
  v_exp_f32 v104, v104
  v_exp_f32 v105, v105
  v_exp_f32 v106, v106
  v_exp_f32 v107, v107
  v_exp_f32 v108, v108
  s_waitcnt vmcnt(17)
  v_smfmac_f32_32x32x32_bf16 v[32:47], v[196:199], v[96:103], v18
  s_nop 0
  s_nop 0
  v_exp_f32 v109, v109
  v_exp_f32 v110, v110
  v_exp_f32 v111, v111
  v_exp_f32 v112, v112
  v_exp_f32 v113, v113
  v_exp_f32 v114, v114
  v_exp_f32 v115, v115
  v_mfma_f32_32x32x16_bf16 v[128:143], v[192:195], a[248:251], v[128:143]
  s_waitcnt vmcnt(16)
  v_exp_f32 v116, v116
  v_exp_f32 v117, v117
  v_exp_f32 v118, v118
  v_smfmac_f32_32x32x32_bf16 v[32:47], v[200:203], v[104:111], v18
  v_exp_f32 v119, v119
  v_exp_f32 v120, v120
  v_exp_f32 v121, v121
  v_mfma_f32_32x32x16_bf16 v[144:159], v[192:195], a[252:255], v[144:159]
  v_exp_f32 v122, v122
  v_exp_f32 v123, v123
  v_exp_f32 v124, v124
  v_smfmac_f32_32x32x32_bf16 v[48:63], v[196:199], v[112:119], v18
  v_exp_f32 v125, v125
  v_exp_f32 v126, v126
  v_exp_f32 v127, v127
  v_exp_f32 v128, v128
  v_exp_f32 v129, v129
  v_smfmac_f32_32x32x32_bf16 v[48:63], v[200:203], v[120:127], v18
  s_waitcnt vmcnt(2)
  v_cmp_ne_u32 vcc, v22, v19
  v_exp_f32 v130, v130
  v_exp_f32 v131, v131
  v_exp_f32 v132, v132
  v_mfma_f32_32x32x4_2b_bf16 v[96:127], v[218:219], v[160:161], 0 cbsz:1
  v_exp_f32 v133, v133
  v_exp_f32 v134, v134
  v_exp_f32 v135, v135
  v_exp_f32 v136, v136
  v_exp_f32 v137, v137
  v_exp_f32 v138, v138
  v_exp_f32 v139, v139
  v_exp_f32 v140, v140
  v_smfmac_f32_32x32x32_bf16 v[64:79], v[196:199], v[128:135], v18
  s_nop 0
  s_waitcnt vmcnt(1)
  v_cmp_ne_u32 s[94:95], v23, v19
  v_exp_f32 v141, v141
  v_exp_f32 v142, v142
  v_exp_f32 v143, v143
  v_exp_f32 v144, v144
  v_exp_f32 v145, v145
  v_exp_f32 v146, v146
  v_exp_f32 v147, v147
  v_mfma_f32_32x32x16_bf16 v[96:111], v[206:209], a[240:243], v[96:111]
  v_exp_f32 v148, v148
  v_exp_f32 v149, v149
  v_exp_f32 v150, v150
  v_smfmac_f32_32x32x32_bf16 v[64:79], v[200:203], v[136:143], v18
  s_or_b64 vcc, vcc, s[94:95]
  s_nop 0
  v_exp_f32 v151, v151
  v_exp_f32 v152, v152
  v_exp_f32 v153, v153
  v_mfma_f32_32x32x16_bf16 v[112:127], v[206:209], a[244:247], v[112:127]
  v_exp_f32 v154, v154
  v_exp_f32 v155, v155
  v_exp_f32 v156, v156
  v_smfmac_f32_32x32x32_bf16 v[80:95], v[196:199], v[144:151], v18
  s_cmp_lg_u64 vcc, 0
  s_cbranch_scc1 L_kvall
L_kvall_back:
  v_exp_f32 v157, v157
  v_exp_f32 v158, v158
  v_exp_f32 v159, v159
  v_exp_f32 v96, v96
  v_exp_f32 v97, v97
  v_smfmac_f32_32x32x32_bf16 v[80:95], v[200:203], v[152:159], v18
  s_add_u32 m0, s84, 2048
  s_mul_i32 s80, s3, 3584
  v_exp_f32 v98, v98
  v_exp_f32 v99, v99
  v_exp_f32 v100, v100
  v_mfma_f32_32x32x4_2b_bf16 v[128:159], v[218:219], v[162:163], 0 cbsz:1
  v_exp_f32 v101, v101
  v_exp_f32 v102, v102
  v_exp_f32 v103, v103
  v_exp_f32 v104, v104
  v_exp_f32 v105, v105
  v_exp_f32 v106, v106
  v_exp_f32 v107, v107
  v_exp_f32 v108, v108
  v_smfmac_f32_32x32x32_bf16 v[32:47], v[210:213], v[96:103], v18
  buffer_load_dwordx4 v28, s[4:7], s21 offen nt lds
  s_add_u32 s80, s80, s81
  v_exp_f32 v109, v109
  v_exp_f32 v110, v110
  v_exp_f32 v111, v111
  v_exp_f32 v112, v112
  v_exp_f32 v113, v113
  v_exp_f32 v114, v114
  v_exp_f32 v115, v115
  v_mfma_f32_32x32x16_bf16 v[128:143], v[206:209], a[248:251], v[128:143]
  v_exp_f32 v116, v116
  v_exp_f32 v117, v117
  v_exp_f32 v118, v118
  v_smfmac_f32_32x32x32_bf16 v[32:47], v[214:217], v[104:111], v18
  s_add_u32 s22, s60, s80
  s_addc_u32 s23, s61, 0
  global_load_dwordx4 v[164:167], v11, s[22:23]
  v_exp_f32 v119, v119
  v_exp_f32 v120, v120
  v_exp_f32 v121, v121
  v_mfma_f32_32x32x16_bf16 v[144:159], v[206:209], a[252:255], v[144:159]
  s_add_u32 s3, s3, 1
  v_exp_f32 v122, v122
  v_exp_f32 v123, v123
  v_exp_f32 v124, v124
  v_smfmac_f32_32x32x32_bf16 v[48:63], v[210:213], v[112:119], v18
  global_load_dwordx2 v[176:177], v17, s[22:23]
  s_and_b32 s3, s3, 31
  v_exp_f32 v125, v125
  v_exp_f32 v126, v126
  v_exp_f32 v127, v127
  v_exp_f32 v128, v128
  v_exp_f32 v129, v129
  v_smfmac_f32_32x32x32_bf16 v[48:63], v[214:217], v[120:127], v18
  global_load_dwordx4 v[168:171], v0, s[22:23] offset:1536
  v_exp_f32 v130, v130
  v_exp_f32 v131, v131
  v_exp_f32 v132, v132
  v_mfma_f32_32x32x4_2b_bf16 v[96:127], v[232:233], v[160:161], 0 cbsz:1
  v_exp_f32 v133, v133
  v_exp_f32 v134, v134
  v_exp_f32 v135, v135
  v_exp_f32 v136, v136
  v_exp_f32 v137, v137
  v_exp_f32 v138, v138
  v_exp_f32 v139, v139
  v_exp_f32 v140, v140
  v_smfmac_f32_32x32x32_bf16 v[64:79], v[210:213], v[128:135], v18
  global_load_dwordx4 v[172:175], v0, s[22:23] offset:2560
  s_mul_i32 s80, s3, 3584
  s_add_u32 s80, s80, s81
  v_exp_f32 v141, v141
  v_exp_f32 v142, v142
  v_exp_f32 v143, v143
  v_exp_f32 v144, v144
  v_exp_f32 v145, v145
  v_exp_f32 v146, v146
  v_exp_f32 v147, v147
  v_mfma_f32_32x32x16_bf16 v[96:111], v[220:223], a[240:243], v[96:111]
  v_exp_f32 v148, v148
  v_exp_f32 v149, v149
  v_exp_f32 v150, v150
  v_smfmac_f32_32x32x32_bf16 v[64:79], v[214:217], v[136:143], v18
  s_add_u32 s22, s60, s80
  s_addc_u32 s23, s61, 0
  global_load_dwordx4 v[178:181], v11, s[22:23]
  v_exp_f32 v151, v151
  v_exp_f32 v152, v152
  v_exp_f32 v153, v153
  v_mfma_f32_32x32x16_bf16 v[112:127], v[220:223], a[244:247], v[112:127]
  s_add_u32 s3, s3, 1
  v_exp_f32 v154, v154
  v_exp_f32 v155, v155
  v_exp_f32 v156, v156
  v_smfmac_f32_32x32x32_bf16 v[80:95], v[210:213], v[144:151], v18
  global_load_dwordx2 v[190:191], v17, s[22:23]
  s_and_b32 s3, s3, 31
  v_exp_f32 v157, v157
  v_exp_f32 v158, v158
  v_exp_f32 v159, v159
  v_exp_f32 v96, v96
  v_exp_f32 v97, v97
  v_smfmac_f32_32x32x32_bf16 v[80:95], v[214:217], v[152:159], v18
  global_load_dwordx4 v[182:185], v0, s[22:23] offset:1536
  v_exp_f32 v98, v98
  v_exp_f32 v99, v99
  v_exp_f32 v100, v100
  v_mfma_f32_32x32x4_2b_bf16 v[128:159], v[232:233], v[162:163], 0 cbsz:1
  v_exp_f32 v101, v101
  v_exp_f32 v102, v102
  v_exp_f32 v103, v103
  v_exp_f32 v104, v104
  v_exp_f32 v105, v105
  v_exp_f32 v106, v106
  v_exp_f32 v107, v107
  v_exp_f32 v108, v108
  v_smfmac_f32_32x32x32_bf16 v[32:47], v[224:227], v[96:103], v18
  global_load_dwordx4 v[186:189], v0, s[22:23] offset:2560
  s_mul_i32 s80, s3, 3584
  s_add_u32 s80, s80, s81
  v_exp_f32 v109, v109
  v_exp_f32 v110, v110
  v_exp_f32 v111, v111
  v_exp_f32 v112, v112
  v_exp_f32 v113, v113
  v_exp_f32 v114, v114
  v_exp_f32 v115, v115
  v_mfma_f32_32x32x16_bf16 v[128:143], v[220:223], a[248:251], v[128:143]
  s_add_u32 m0, s84, 3072
  v_exp_f32 v116, v116
  v_exp_f32 v117, v117
  v_exp_f32 v118, v118
  v_smfmac_f32_32x32x32_bf16 v[32:47], v[228:231], v[104:111], v18
  buffer_load_dwordx4 v26, s[8:11], s21 offen nt lds
  s_add_u32 s22, s60, s80
  s_addc_u32 s23, s61, 0
  v_exp_f32 v119, v119
  v_exp_f32 v120, v120
  v_exp_f32 v121, v121
  v_mfma_f32_32x32x16_bf16 v[144:159], v[220:223], a[252:255], v[144:159]
  v_exp_f32 v122, v122
  v_exp_f32 v123, v123
  v_exp_f32 v124, v124
  v_smfmac_f32_32x32x32_bf16 v[48:63], v[224:227], v[112:119], v18
  global_load_dwordx4 v[192:195], v11, s[22:23]
  s_add_u32 s3, s3, 1
  v_exp_f32 v125, v125
  v_exp_f32 v126, v126
  v_exp_f32 v127, v127
  v_exp_f32 v128, v128
  v_exp_f32 v129, v129
  v_smfmac_f32_32x32x32_bf16 v[48:63], v[228:231], v[120:127], v18
  global_load_dwordx2 v[204:205], v17, s[22:23]
  s_and_b32 s3, s3, 31
  v_exp_f32 v130, v130
  v_exp_f32 v131, v131
  v_exp_f32 v132, v132
  v_mfma_f32_32x32x4_2b_bf16 v[96:127], v[246:247], v[160:161], 0 cbsz:1
  v_exp_f32 v133, v133
  v_exp_f32 v134, v134
  v_exp_f32 v135, v135
  v_exp_f32 v136, v136
  v_exp_f32 v137, v137
  v_exp_f32 v138, v138
  v_exp_f32 v139, v139
  v_exp_f32 v140, v140
  v_smfmac_f32_32x32x32_bf16 v[64:79], v[224:227], v[128:135], v18
  s_nop 0
  global_load_dwordx4 v[196:199], v0, s[22:23] offset:1536
  v_exp_f32 v141, v141
  v_exp_f32 v142, v142
  v_exp_f32 v143, v143
  v_exp_f32 v144, v144
  v_exp_f32 v145, v145
  v_exp_f32 v146, v146
  v_exp_f32 v147, v147
  v_mfma_f32_32x32x16_bf16 v[96:111], v[234:237], a[240:243], v[96:111]
  v_exp_f32 v148, v148
  v_exp_f32 v149, v149
  v_exp_f32 v150, v150
  v_smfmac_f32_32x32x32_bf16 v[64:79], v[228:231], v[136:143], v18
  global_load_dwordx4 v[200:203], v0, s[22:23] offset:2560
  s_mul_i32 s80, s3, 3584
  s_add_u32 s80, s80, s81
  v_exp_f32 v151, v151
  v_exp_f32 v152, v152
  v_exp_f32 v153, v153
  v_mfma_f32_32x32x16_bf16 v[112:127], v[234:237], a[244:247], v[112:127]
  v_exp_f32 v154, v154
  v_exp_f32 v155, v155
  v_exp_f32 v156, v156
  v_smfmac_f32_32x32x32_bf16 v[80:95], v[224:227], v[144:151], v18
  s_add_u32 s22, s60, s80
  s_addc_u32 s23, s61, 0
  global_load_dwordx4 v[206:209], v11, s[22:23]
  v_exp_f32 v157, v157
  v_exp_f32 v158, v158
  v_exp_f32 v159, v159
  v_exp_f32 v96, v96
  v_exp_f32 v97, v97
  v_smfmac_f32_32x32x32_bf16 v[80:95], v[228:231], v[152:159], v18
  s_add_u32 s3, s3, 1
  global_load_dwordx2 v[218:219], v17, s[22:23]
  s_and_b32 s3, s3, 31
  v_exp_f32 v98, v98
  v_exp_f32 v99, v99
  v_exp_f32 v100, v100
  v_mfma_f32_32x32x4_2b_bf16 v[128:159], v[246:247], v[162:163], 0 cbsz:1
  v_exp_f32 v101, v101
  v_exp_f32 v102, v102
  v_exp_f32 v103, v103
  v_exp_f32 v104, v104
  v_exp_f32 v105, v105
  v_exp_f32 v106, v106
  v_exp_f32 v107, v107
  v_exp_f32 v108, v108
  v_smfmac_f32_32x32x32_bf16 v[32:47], v[238:241], v[96:103], v18
  s_nop 0
  global_load_dwordx4 v[210:213], v0, s[22:23] offset:1536
  v_exp_f32 v109, v109
  v_exp_f32 v110, v110
  v_exp_f32 v111, v111
  v_exp_f32 v112, v112
  v_exp_f32 v113, v113
  v_exp_f32 v114, v114
  v_exp_f32 v115, v115
  v_mfma_f32_32x32x16_bf16 v[128:143], v[234:237], a[248:251], v[128:143]
  v_exp_f32 v116, v116
  v_exp_f32 v117, v117
  v_exp_f32 v118, v118
  v_smfmac_f32_32x32x32_bf16 v[32:47], v[242:245], v[104:111], v18
  global_load_dwordx4 v[214:217], v0, s[22:23] offset:2560
  s_mul_i32 s80, s3, 3584
  s_add_u32 s80, s80, s81
  v_exp_f32 v119, v119
  v_exp_f32 v120, v120
  v_exp_f32 v121, v121
  v_mfma_f32_32x32x16_bf16 v[144:159], v[234:237], a[252:255], v[144:159]
  v_exp_f32 v122, v122
  v_exp_f32 v123, v123
  v_exp_f32 v124, v124
  v_smfmac_f32_32x32x32_bf16 v[48:63], v[238:241], v[112:119], v18
  s_add_u32 s22, s60, s80
  s_addc_u32 s23, s61, 0
  global_load_dwordx4 v[220:223], v11, s[22:23]
  v_exp_f32 v125, v125
  v_exp_f32 v126, v126
  v_exp_f32 v127, v127
  v_exp_f32 v128, v128
  v_exp_f32 v129, v129
  v_smfmac_f32_32x32x32_bf16 v[48:63], v[242:245], v[120:127], v18
  s_add_u32 m0, s84, 4096
  s_add_u32 s3, s3, 1
  global_load_dwordx2 v[232:233], v17, s[22:23]
  v_exp_f32 v130, v130
  v_exp_f32 v131, v131
  v_exp_f32 v132, v132
  s_waitcnt vmcnt(17)
  v_mfma_f32_32x32x4_2b_bf16 v[96:127], v[176:177], v[160:161], 0 cbsz:1
  v_exp_f32 v133, v133
  v_exp_f32 v134, v134
  v_exp_f32 v135, v135
  v_exp_f32 v136, v136
  v_exp_f32 v137, v137
  v_exp_f32 v138, v138
  v_exp_f32 v139, v139
  v_exp_f32 v140, v140
  v_smfmac_f32_32x32x32_bf16 v[64:79], v[238:241], v[128:135], v18
  buffer_load_dwordx4 v27, s[8:11], s21 offen nt lds
  s_and_b32 s3, s3, 31
  v_exp_f32 v141, v141
  v_exp_f32 v142, v142
  v_exp_f32 v143, v143
  v_exp_f32 v144, v144
  v_exp_f32 v145, v145
  v_exp_f32 v146, v146
  v_exp_f32 v147, v147
  v_mfma_f32_32x32x16_bf16 v[96:111], v[164:167], a[240:243], v[96:111]
  v_exp_f32 v148, v148
  v_exp_f32 v149, v149
  v_exp_f32 v150, v150
  v_smfmac_f32_32x32x32_bf16 v[64:79], v[242:245], v[136:143], v18
  global_load_dwordx4 v[224:227], v0, s[22:23] offset:1536
  v_exp_f32 v151, v151
  v_exp_f32 v152, v152
  v_exp_f32 v153, v153
  v_mfma_f32_32x32x16_bf16 v[112:127], v[164:167], a[244:247], v[112:127]
  v_exp_f32 v154, v154
  v_exp_f32 v155, v155
  v_exp_f32 v156, v156
  v_smfmac_f32_32x32x32_bf16 v[80:95], v[238:241], v[144:151], v18
  global_load_dwordx4 v[228:231], v0, s[22:23] offset:2560
  v_exp_f32 v157, v157
  v_exp_f32 v158, v158
  v_exp_f32 v159, v159
  v_exp_f32 v96, v96
  v_exp_f32 v97, v97
  v_smfmac_f32_32x32x32_bf16 v[80:95], v[242:245], v[152:159], v18
  v_exp_f32 v98, v98
  v_exp_f32 v99, v99
  v_exp_f32 v100, v100
  v_mfma_f32_32x32x4_2b_bf16 v[128:159], v[176:177], v[162:163], 0 cbsz:1
  v_exp_f32 v101, v101
  v_exp_f32 v102, v102
  v_exp_f32 v103, v103
  v_exp_f32 v104, v104
  v_exp_f32 v105, v105
  v_exp_f32 v106, v106
  v_exp_f32 v107, v107
  v_exp_f32 v108, v108
  s_waitcnt vmcnt(19)
  v_smfmac_f32_32x32x32_bf16 v[32:47], v[168:171], v[96:103], v18
  s_nop 0
  s_nop 0
  v_exp_f32 v109, v109
  v_exp_f32 v110, v110
  v_exp_f32 v111, v111
  v_exp_f32 v112, v112
  v_exp_f32 v113, v113
  v_exp_f32 v114, v114
  v_exp_f32 v115, v115
  v_mfma_f32_32x32x16_bf16 v[128:143], v[164:167], a[248:251], v[128:143]
  s_mul_i32 s80, s3, 3584
  v_exp_f32 v116, v116
  v_exp_f32 v117, v117
  v_exp_f32 v118, v118
  s_waitcnt vmcnt(18)
  v_smfmac_f32_32x32x32_bf16 v[32:47], v[172:175], v[104:111], v18
  s_add_u32 s80, s80, s81
  v_exp_f32 v119, v119
  v_exp_f32 v120, v120
  v_exp_f32 v121, v121
  v_mfma_f32_32x32x16_bf16 v[144:159], v[164:167], a[252:255], v[144:159]
  v_exp_f32 v122, v122
  v_exp_f32 v123, v123
  v_exp_f32 v124, v124
  v_smfmac_f32_32x32x32_bf16 v[48:63], v[168:171], v[112:119], v18
  s_add_u32 s22, s60, s80
  s_addc_u32 s23, s61, 0
  global_load_dwordx4 v[234:237], v11, s[22:23]
  v_exp_f32 v125, v125
  v_exp_f32 v126, v126
  v_exp_f32 v127, v127
  v_exp_f32 v128, v128
  v_exp_f32 v129, v129
  v_smfmac_f32_32x32x32_bf16 v[48:63], v[172:175], v[120:127], v18
  s_waitcnt vmcnt(17)
  s_add_u32 s3, s3, 1
  global_load_dwordx2 v[246:247], v17, s[22:23]
  s_and_b32 s3, s3, 31
  v_exp_f32 v130, v130
  v_exp_f32 v131, v131
  v_exp_f32 v132, v132
  v_mfma_f32_32x32x4_2b_bf16 v[96:127], v[190:191], v[160:161], 0 cbsz:1
  v_exp_f32 v133, v133
  v_exp_f32 v134, v134
  v_exp_f32 v135, v135
  v_exp_f32 v136, v136
  v_exp_f32 v137, v137
  v_exp_f32 v138, v138
  v_exp_f32 v139, v139
  v_exp_f32 v140, v140
  v_smfmac_f32_32x32x32_bf16 v[64:79], v[168:171], v[128:135], v18
  s_nop 0
  global_load_dwordx4 v[238:241], v0, s[22:23] offset:1536
  v_exp_f32 v141, v141
  v_exp_f32 v142, v142
  v_exp_f32 v143, v143
  v_exp_f32 v144, v144
  v_exp_f32 v145, v145
  v_exp_f32 v146, v146
  v_exp_f32 v147, v147
  v_mfma_f32_32x32x16_bf16 v[96:111], v[178:181], a[240:243], v[96:111]
  s_add_u32 m0, s84, 5120
  v_exp_f32 v148, v148
  v_exp_f32 v149, v149
  v_exp_f32 v150, v150
  v_smfmac_f32_32x32x32_bf16 v[64:79], v[172:175], v[136:143], v18
  buffer_load_dwordx4 v28, s[8:11], s21 offen nt lds
  v_exp_f32 v151, v151
  v_exp_f32 v152, v152
  v_exp_f32 v153, v153
  v_mfma_f32_32x32x16_bf16 v[112:127], v[178:181], a[244:247], v[112:127]
  v_exp_f32 v154, v154
  v_exp_f32 v155, v155
  v_exp_f32 v156, v156
  v_smfmac_f32_32x32x32_bf16 v[80:95], v[168:171], v[144:151], v18
  global_load_dwordx4 v[242:245], v0, s[22:23] offset:2560
  v_exp_f32 v157, v157
  v_exp_f32 v158, v158
  v_exp_f32 v159, v159
  v_exp_f32 v96, v96
  v_exp_f32 v97, v97
  v_smfmac_f32_32x32x32_bf16 v[80:95], v[172:175], v[152:159], v18
  v_exp_f32 v98, v98
  v_exp_f32 v99, v99
  v_exp_f32 v100, v100
  v_mfma_f32_32x32x4_2b_bf16 v[128:159], v[190:191], v[162:163], 0 cbsz:1
  v_exp_f32 v101, v101
  v_exp_f32 v102, v102
  v_exp_f32 v103, v103
  v_exp_f32 v104, v104
  v_exp_f32 v105, v105
  v_exp_f32 v106, v106
  v_exp_f32 v107, v107
  v_exp_f32 v108, v108
  s_waitcnt vmcnt(20)
  v_smfmac_f32_32x32x32_bf16 v[32:47], v[182:185], v[96:103], v18
  s_nop 0
  s_nop 0
  v_exp_f32 v109, v109
  v_exp_f32 v110, v110
  v_exp_f32 v111, v111
  v_exp_f32 v112, v112
  v_exp_f32 v113, v113
  v_exp_f32 v114, v114
  v_exp_f32 v115, v115
  v_mfma_f32_32x32x16_bf16 v[128:143], v[178:181], a[248:251], v[128:143]
  s_mul_i32 s80, s3, 3584
  v_exp_f32 v116, v116
  v_exp_f32 v117, v117
  v_exp_f32 v118, v118
  s_waitcnt vmcnt(19)
  v_smfmac_f32_32x32x32_bf16 v[32:47], v[186:189], v[104:111], v18
  s_add_u32 s80, s80, s81
  v_exp_f32 v119, v119
  v_exp_f32 v120, v120
  v_exp_f32 v121, v121
  v_mfma_f32_32x32x16_bf16 v[144:159], v[178:181], a[252:255], v[144:159]
  v_exp_f32 v122, v122
  v_exp_f32 v123, v123
  v_exp_f32 v124, v124
  v_smfmac_f32_32x32x32_bf16 v[48:63], v[182:185], v[112:119], v18
  s_add_u32 s22, s60, s80
  s_addc_u32 s23, s61, 0
  global_load_dwordx4 v[164:167], v11, s[22:23]
  v_exp_f32 v125, v125
  v_exp_f32 v126, v126
  v_exp_f32 v127, v127
  v_exp_f32 v128, v128
  v_exp_f32 v129, v129
  v_smfmac_f32_32x32x32_bf16 v[48:63], v[186:189], v[120:127], v18
  s_waitcnt vmcnt(17)
  s_add_u32 s3, s3, 1
  global_load_dwordx2 v[176:177], v17, s[22:23]
  s_and_b32 s3, s3, 31
  v_exp_f32 v130, v130
  v_exp_f32 v131, v131
  v_exp_f32 v132, v132
  v_mfma_f32_32x32x4_2b_bf16 v[96:127], v[204:205], v[160:161], 0 cbsz:1
  v_exp_f32 v133, v133
  v_exp_f32 v134, v134
  v_exp_f32 v135, v135
  v_exp_f32 v136, v136
  v_exp_f32 v137, v137
  v_exp_f32 v138, v138
  v_exp_f32 v139, v139
  v_exp_f32 v140, v140
  v_smfmac_f32_32x32x32_bf16 v[64:79], v[182:185], v[128:135], v18
  s_nop 0
  global_load_dwordx4 v[168:171], v0, s[22:23] offset:1536
  v_exp_f32 v141, v141
  v_exp_f32 v142, v142
  v_exp_f32 v143, v143
  v_exp_f32 v144, v144
  v_exp_f32 v145, v145
  v_exp_f32 v146, v146
  v_exp_f32 v147, v147
  v_mfma_f32_32x32x16_bf16 v[96:111], v[192:195], a[240:243], v[96:111]
  v_exp_f32 v148, v148
  v_exp_f32 v149, v149
  v_exp_f32 v150, v150
  v_smfmac_f32_32x32x32_bf16 v[64:79], v[186:189], v[136:143], v18
  global_load_dwordx4 v[172:175], v0, s[22:23] offset:2560
  v_exp_f32 v151, v151
  v_exp_f32 v152, v152
  v_exp_f32 v153, v153
  v_mfma_f32_32x32x16_bf16 v[112:127], v[192:195], a[244:247], v[112:127]
  v_exp_f32 v154, v154
  v_exp_f32 v155, v155
  v_exp_f32 v156, v156
  v_smfmac_f32_32x32x32_bf16 v[80:95], v[182:185], v[144:151], v18
  buffer_load_dword v30, v29, s[40:43], s13 offen
  v_exp_f32 v157, v157
  v_exp_f32 v158, v158
  v_exp_f32 v159, v159
  v_exp_f32 v96, v96
  v_exp_f32 v97, v97
  v_smfmac_f32_32x32x32_bf16 v[80:95], v[186:189], v[152:159], v18
  v_exp_f32 v98, v98
  v_exp_f32 v99, v99
  v_exp_f32 v100, v100
  v_mfma_f32_32x32x4_2b_bf16 v[128:159], v[204:205], v[162:163], 0 cbsz:1
  v_exp_f32 v101, v101
  v_exp_f32 v102, v102
  v_exp_f32 v103, v103
  v_exp_f32 v104, v104
  v_exp_f32 v105, v105
  v_exp_f32 v106, v106
  v_exp_f32 v107, v107
  v_exp_f32 v108, v108
  s_waitcnt vmcnt(20)
  v_smfmac_f32_32x32x32_bf16 v[32:47], v[196:199], v[96:103], v18
  s_nop 0
  s_nop 0
  v_exp_f32 v109, v109
  v_exp_f32 v110, v110
  v_exp_f32 v111, v111
  v_exp_f32 v112, v112
  v_exp_f32 v113, v113
  v_exp_f32 v114, v114
  v_exp_f32 v115, v115
  v_mfma_f32_32x32x16_bf16 v[128:143], v[192:195], a[248:251], v[128:143]
  s_mul_i32 s80, s3, 3584
  v_exp_f32 v116, v116
  v_exp_f32 v117, v117
  v_exp_f32 v118, v118
  s_waitcnt vmcnt(19)
  v_smfmac_f32_32x32x32_bf16 v[32:47], v[200:203], v[104:111], v18
  s_add_u32 s80, s80, s81
  v_exp_f32 v119, v119
  v_exp_f32 v120, v120
  v_exp_f32 v121, v121
  v_mfma_f32_32x32x16_bf16 v[144:159], v[192:195], a[252:255], v[144:159]
  v_exp_f32 v122, v122
  v_exp_f32 v123, v123
  v_exp_f32 v124, v124
  v_smfmac_f32_32x32x32_bf16 v[48:63], v[196:199], v[112:119], v18
  s_add_u32 s22, s60, s80
  s_addc_u32 s23, s61, 0
  global_load_dwordx4 v[178:181], v11, s[22:23]
  v_exp_f32 v125, v125
  v_exp_f32 v126, v126
  v_exp_f32 v127, v127
  v_exp_f32 v128, v128
  v_exp_f32 v129, v129
  v_smfmac_f32_32x32x32_bf16 v[48:63], v[200:203], v[120:127], v18
  s_waitcnt vmcnt(18)
  s_add_u32 s3, s3, 1
  global_load_dwordx2 v[190:191], v17, s[22:23]
  s_and_b32 s3, s3, 31
  v_exp_f32 v130, v130
  v_exp_f32 v131, v131
  v_exp_f32 v132, v132
  v_mfma_f32_32x32x4_2b_bf16 v[96:127], v[218:219], v[160:161], 0 cbsz:1
  v_exp_f32 v133, v133
  v_exp_f32 v134, v134
  v_exp_f32 v135, v135
  v_exp_f32 v136, v136
  v_exp_f32 v137, v137
  v_exp_f32 v138, v138
  v_exp_f32 v139, v139
  v_exp_f32 v140, v140
  v_smfmac_f32_32x32x32_bf16 v[64:79], v[196:199], v[128:135], v18
  s_nop 0
  global_load_dwordx4 v[182:185], v0, s[22:23] offset:1536
  v_exp_f32 v141, v141
  v_exp_f32 v142, v142
  v_exp_f32 v143, v143
  v_exp_f32 v144, v144
  v_exp_f32 v145, v145
  v_exp_f32 v146, v146
  v_exp_f32 v147, v147
  v_mfma_f32_32x32x16_bf16 v[96:111], v[206:209], a[240:243], v[96:111]
  v_exp_f32 v148, v148
  v_exp_f32 v149, v149
  v_exp_f32 v150, v150
  v_smfmac_f32_32x32x32_bf16 v[64:79], v[200:203], v[136:143], v18
  global_load_dwordx4 v[186:189], v0, s[22:23] offset:2560
  v_exp_f32 v151, v151
  v_exp_f32 v152, v152
  v_exp_f32 v153, v153
  v_mfma_f32_32x32x16_bf16 v[112:127], v[206:209], a[244:247], v[112:127]
  v_exp_f32 v154, v154
  v_exp_f32 v155, v155
  v_exp_f32 v156, v156
  v_smfmac_f32_32x32x32_bf16 v[80:95], v[196:199], v[144:151], v18
  v_exp_f32 v157, v157
  v_exp_f32 v158, v158
  v_exp_f32 v159, v159
  v_exp_f32 v96, v96
  v_exp_f32 v97, v97
  v_smfmac_f32_32x32x32_bf16 v[80:95], v[200:203], v[152:159], v18
  v_exp_f32 v98, v98
  v_exp_f32 v99, v99
  v_exp_f32 v100, v100
  v_mfma_f32_32x32x4_2b_bf16 v[128:159], v[218:219], v[162:163], 0 cbsz:1
  v_exp_f32 v101, v101
  v_exp_f32 v102, v102
  v_exp_f32 v103, v103
  v_exp_f32 v104, v104
  v_exp_f32 v105, v105
  v_exp_f32 v106, v106
  v_exp_f32 v107, v107
  v_exp_f32 v108, v108
  s_waitcnt vmcnt(20)
  v_smfmac_f32_32x32x32_bf16 v[32:47], v[210:213], v[96:103], v18
  s_nop 0
  s_nop 0
  v_exp_f32 v109, v109
  v_exp_f32 v110, v110
  v_exp_f32 v111, v111
  v_exp_f32 v112, v112
  v_exp_f32 v113, v113
  v_exp_f32 v114, v114
  v_exp_f32 v115, v115
  v_mfma_f32_32x32x16_bf16 v[128:143], v[206:209], a[248:251], v[128:143]
  s_mul_i32 s80, s3, 3584
  v_exp_f32 v116, v116
  v_exp_f32 v117, v117
  v_exp_f32 v118, v118
  s_waitcnt vmcnt(19)
  v_smfmac_f32_32x32x32_bf16 v[32:47], v[214:217], v[104:111], v18
  s_add_u32 s80, s80, s81
  v_exp_f32 v119, v119
  v_exp_f32 v120, v120
  v_exp_f32 v121, v121
  v_mfma_f32_32x32x16_bf16 v[144:159], v[206:209], a[252:255], v[144:159]
  v_exp_f32 v122, v122
  v_exp_f32 v123, v123
  v_exp_f32 v124, v124
  v_smfmac_f32_32x32x32_bf16 v[48:63], v[210:213], v[112:119], v18
  s_add_u32 s22, s60, s80
  s_addc_u32 s23, s61, 0
  global_load_dwordx4 v[192:195], v11, s[22:23]
  v_exp_f32 v125, v125
  v_exp_f32 v126, v126
  v_exp_f32 v127, v127
  s_waitcnt vmcnt(11)
  v_mov_b32 v12, 1073741824
  s_cmp_ge_u32 s69, 10
  s_cbranch_scc1 L_rtrA
  v_lshrrev_b32 v20, 2, v2
  v_lshl_add_u32 v20, v3, 3, v20
  v_mul_u32_u24 v20, 48, v20
  v_add_u32 v20, s84, v20
  v_and_b32 v22, 3, v2
  v_lshl_add_u32 v24, v22, 3, v20
  v_and_b32 v23, 1, v2
  v_lshl_add_u32 v20, v23, 3, v20
  v_lshrrev_b32 v22, 1, v22
  v_mul_u32_u24 v22, 3072, v22
  v_add3_u32 v25, v20, v22, 32
  ds_read_b64_tr_b16 a[0:1], v24 offset:0
  ds_read_b64_tr_b16 a[2:3], v24 offset:192
  ds_read_b64_tr_b16 a[4:5], v24 offset:3072
  ds_read_b64_tr_b16 a[6:7], v24 offset:3264
  ds_read_b64_tr_b16 a[8:9], v25 offset:0
  ds_read_b64_tr_b16 a[10:11], v25 offset:192
  ds_read_b64_tr_b16 a[12:13], v24 offset:1536
  ds_read_b64_tr_b16 a[14:15], v24 offset:1728
  ds_read_b64_tr_b16 a[16:17], v24 offset:4608
  ds_read_b64_tr_b16 a[18:19], v24 offset:4800
  ds_read_b64_tr_b16 a[20:21], v25 offset:1536
  ds_read_b64_tr_b16 a[22:23], v25 offset:1728
  s_lshl_b32 s12, s73, 2
  s_add_u32 s12, s12, s68
  s_mul_i32 s13, s12, 61440
  s_mul_i32 s14, s69, 6144
  s_add_u32 s13, s13, s14
  s_add_u32 s13, s13, 20971520
  s_add_u32 s14, s13, 4096
  s_lshl_b32 s12, s12, 8
  s_lshl_b32 s15, s69, 4
  s_add_u32 s12, s12, s15
  s_add_u32 s16, s12, 19005440
  s_waitcnt lgkmcnt(10)
  buffer_store_dwordx4 a[0:3], v11, s[60:63], s13 offen offset:0 sc1
  s_waitcnt lgkmcnt(8)
  buffer_store_dwordx4 a[4:7], v11, s[60:63], s13 offen offset:1024 sc1
  s_waitcnt lgkmcnt(6)
  buffer_store_dwordx4 a[8:11], v11, s[60:63], s13 offen offset:2048 sc1
  s_waitcnt lgkmcnt(4)
  buffer_store_dwordx4 a[12:15], v11, s[60:63], s13 offen offset:3072 sc1
  s_waitcnt lgkmcnt(2)
  buffer_store_dwordx4 a[16:19], v11, s[60:63], s14 offen offset:0 sc1
  s_waitcnt lgkmcnt(0)
  buffer_store_dwordx4 a[20:23], v11, s[60:63], s14 offen offset:1024 sc1
  v_mov_b32 v12, 1073741824
  v_mov_b32 v20, s16
  v_cmp_eq_u32 vcc, 0, v1
  s_nop 1
  v_cndmask_b32 v12, v12, v20, vcc
L_rtrA:
  v_exp_f32 v128, v128
  v_exp_f32 v129, v129
  v_smfmac_f32_32x32x32_bf16 v[48:63], v[214:217], v[120:127], v18
  s_add_u32 s3, s3, 1
  global_load_dwordx2 v[204:205], v17, s[22:23]
  s_and_b32 s3, s3, 31
  v_exp_f32 v130, v130
  v_exp_f32 v131, v131
  v_exp_f32 v132, v132
  v_mfma_f32_32x32x4_2b_bf16 v[96:127], v[232:233], v[160:161], 0 cbsz:1
  v_exp_f32 v133, v133
  v_exp_f32 v134, v134
  v_exp_f32 v135, v135
  v_exp_f32 v136, v136
  v_exp_f32 v137, v137
  v_exp_f32 v138, v138
  v_exp_f32 v139, v139
  v_exp_f32 v140, v140
  v_smfmac_f32_32x32x32_bf16 v[64:79], v[210:213], v[128:135], v18
  s_nop 0
  global_load_dwordx4 v[196:199], v0, s[22:23] offset:1536
  v_exp_f32 v141, v141
  v_exp_f32 v142, v142
  v_exp_f32 v143, v143
  v_exp_f32 v144, v144
  v_exp_f32 v145, v145
  v_exp_f32 v146, v146
  v_exp_f32 v147, v147
  v_mfma_f32_32x32x16_bf16 v[96:111], v[220:223], a[240:243], v[96:111]
  v_exp_f32 v148, v148
  v_exp_f32 v149, v149
  v_exp_f32 v150, v150
  v_smfmac_f32_32x32x32_bf16 v[64:79], v[214:217], v[136:143], v18
  global_load_dwordx4 v[200:203], v0, s[22:23] offset:2560
  v_exp_f32 v151, v151
  v_exp_f32 v152, v152
  v_exp_f32 v153, v153
  v_mfma_f32_32x32x16_bf16 v[112:127], v[220:223], a[244:247], v[112:127]
  v_exp_f32 v154, v154
  v_exp_f32 v155, v155
  v_exp_f32 v156, v156
  v_smfmac_f32_32x32x32_bf16 v[80:95], v[210:213], v[144:151], v18
  v_exp_f32 v157, v157
  v_exp_f32 v158, v158
  v_exp_f32 v159, v159
  v_exp_f32 v96, v96
  v_exp_f32 v97, v97
  v_smfmac_f32_32x32x32_bf16 v[80:95], v[214:217], v[152:159], v18
  s_add_u32 m0, s86, 0
  v_exp_f32 v98, v98
  v_exp_f32 v99, v99
  v_exp_f32 v100, v100
  v_mfma_f32_32x32x4_2b_bf16 v[128:159], v[232:233], v[162:163], 0 cbsz:1
  v_exp_f32 v101, v101
  v_exp_f32 v102, v102
  v_exp_f32 v103, v103
  v_exp_f32 v104, v104
  v_exp_f32 v105, v105
  v_exp_f32 v106, v106
  v_exp_f32 v107, v107
  v_exp_f32 v108, v108
  v_smfmac_f32_32x32x32_bf16 v[32:47], v[224:227], v[96:103], v18
  s_nop 0
  buffer_load_dwordx4 v4, s[40:43], s85 offen offset:0 nt lds
  v_exp_f32 v109, v109
  v_exp_f32 v110, v110
  v_exp_f32 v111, v111
  v_exp_f32 v112, v112
  v_exp_f32 v113, v113
  v_exp_f32 v114, v114
  v_exp_f32 v115, v115
  v_mfma_f32_32x32x16_bf16 v[128:143], v[220:223], a[248:251], v[128:143]
  s_mul_i32 s80, s3, 3584
  v_exp_f32 v116, v116
  v_exp_f32 v117, v117
  v_exp_f32 v118, v118
  v_smfmac_f32_32x32x32_bf16 v[32:47], v[228:231], v[104:111], v18
  s_add_u32 s80, s80, s81
  v_exp_f32 v119, v119
  v_exp_f32 v120, v120
  v_exp_f32 v121, v121
  v_mfma_f32_32x32x16_bf16 v[144:159], v[220:223], a[252:255], v[144:159]
  v_exp_f32 v122, v122
  v_exp_f32 v123, v123
  v_exp_f32 v124, v124
  v_smfmac_f32_32x32x32_bf16 v[48:63], v[224:227], v[112:119], v18
  s_add_u32 s22, s60, s80
  s_addc_u32 s23, s61, 0
  global_load_dwordx4 v[206:209], v11, s[22:23]
  v_exp_f32 v125, v125
  v_exp_f32 v126, v126
  v_exp_f32 v127, v127
  v_exp_f32 v128, v128
  v_exp_f32 v129, v129
  v_smfmac_f32_32x32x32_bf16 v[48:63], v[228:231], v[120:127], v18
  buffer_load_dwordx4 v5, s[40:43], s85 offen offset:1024 nt lds
  s_add_u32 s3, s3, 1
  v_exp_f32 v130, v130
  v_exp_f32 v131, v131
  v_exp_f32 v132, v132
  v_mfma_f32_32x32x4_2b_bf16 v[96:127], v[246:247], v[160:161], 0 cbsz:1
  v_exp_f32 v133, v133
  v_exp_f32 v134, v134
  v_exp_f32 v135, v135
  v_exp_f32 v136, v136
  v_exp_f32 v137, v137
  v_exp_f32 v138, v138
  v_exp_f32 v139, v139
  v_exp_f32 v140, v140
  v_smfmac_f32_32x32x32_bf16 v[64:79], v[224:227], v[128:135], v18
  global_load_dwordx2 v[218:219], v17, s[22:23]
  s_and_b32 s3, s3, 31
  v_exp_f32 v141, v141
  v_exp_f32 v142, v142
  v_exp_f32 v143, v143
  v_exp_f32 v144, v144
  v_exp_f32 v145, v145
  v_exp_f32 v146, v146
  v_exp_f32 v147, v147
  v_mfma_f32_32x32x16_bf16 v[96:111], v[234:237], a[240:243], v[96:111]
  v_exp_f32 v148, v148
  v_exp_f32 v149, v149
  v_exp_f32 v150, v150
  v_smfmac_f32_32x32x32_bf16 v[64:79], v[228:231], v[136:143], v18
  buffer_load_dwordx4 v6, s[40:43], s85 offen offset:2048 nt lds
  v_exp_f32 v151, v151
  v_exp_f32 v152, v152
  v_exp_f32 v153, v153
  v_mfma_f32_32x32x16_bf16 v[112:127], v[234:237], a[244:247], v[112:127]
  v_exp_f32 v154, v154
  v_exp_f32 v155, v155
  v_exp_f32 v156, v156
  v_smfmac_f32_32x32x32_bf16 v[80:95], v[224:227], v[144:151], v18
  global_load_dwordx4 v[210:213], v0, s[22:23] offset:1536
  v_exp_f32 v157, v157
  v_exp_f32 v158, v158
  v_exp_f32 v159, v159
  v_exp_f32 v96, v96
  v_exp_f32 v97, v97
  v_smfmac_f32_32x32x32_bf16 v[80:95], v[228:231], v[152:159], v18
  buffer_load_dwordx4 v7, s[40:43], s85 offen offset:3072 nt lds
  v_exp_f32 v98, v98
  v_exp_f32 v99, v99
  v_exp_f32 v100, v100
  v_mfma_f32_32x32x4_2b_bf16 v[128:159], v[246:247], v[162:163], 0 cbsz:1
  v_exp_f32 v101, v101
  v_exp_f32 v102, v102
  v_exp_f32 v103, v103
  v_exp_f32 v104, v104
  v_exp_f32 v105, v105
  v_exp_f32 v106, v106
  v_exp_f32 v107, v107
  v_exp_f32 v108, v108
  v_smfmac_f32_32x32x32_bf16 v[32:47], v[238:241], v[96:103], v18
  s_nop 0
  global_load_dwordx4 v[214:217], v0, s[22:23] offset:2560
  v_exp_f32 v109, v109
  v_exp_f32 v110, v110
  v_exp_f32 v111, v111
  v_exp_f32 v112, v112
  v_exp_f32 v113, v113
  v_exp_f32 v114, v114
  v_exp_f32 v115, v115
  v_mfma_f32_32x32x16_bf16 v[128:143], v[234:237], a[248:251], v[128:143]
  s_mul_i32 s80, s3, 3584
  v_exp_f32 v116, v116
  v_exp_f32 v117, v117
  v_exp_f32 v118, v118
  s_waitcnt vmcnt(21)
  v_smfmac_f32_32x32x32_bf16 v[32:47], v[242:245], v[104:111], v18
  s_add_u32 s80, s80, s81
  s_add_u32 m0, s86, 4096
  v_exp_f32 v119, v119
  v_exp_f32 v120, v120
  v_exp_f32 v121, v121
  v_mfma_f32_32x32x16_bf16 v[144:159], v[234:237], a[252:255], v[144:159]
  v_exp_f32 v122, v122
  v_exp_f32 v123, v123
  v_exp_f32 v124, v124
  v_smfmac_f32_32x32x32_bf16 v[48:63], v[238:241], v[112:119], v18
  buffer_load_dwordx4 v8, s[40:43], s85 offen offset:0 nt lds
  s_add_u32 s22, s60, s80
  s_addc_u32 s23, s61, 0
  v_exp_f32 v125, v125
  v_exp_f32 v126, v126
  v_exp_f32 v127, v127
  v_exp_f32 v128, v128
  v_exp_f32 v129, v129
  v_smfmac_f32_32x32x32_bf16 v[48:63], v[242:245], v[120:127], v18
  s_waitcnt vmcnt(20)
  global_load_dwordx4 v[220:223], v11, s[22:23]
  s_add_u32 s3, s3, 1
  s_add_u32 s85, s85, 40960
  v_exp_f32 v130, v130
  v_exp_f32 v131, v131
  v_exp_f32 v132, v132
  v_mfma_f32_32x32x4_2b_bf16 v[96:127], v[176:177], v[160:161], 0 cbsz:1
  v_exp_f32 v133, v133
  v_exp_f32 v134, v134
  v_exp_f32 v135, v135
  v_exp_f32 v136, v136
  v_exp_f32 v137, v137
  v_exp_f32 v138, v138
  v_exp_f32 v139, v139
  v_exp_f32 v140, v140
  v_smfmac_f32_32x32x32_bf16 v[64:79], v[238:241], v[128:135], v18
  global_load_dwordx2 v[232:233], v17, s[22:23]
  s_and_b32 s3, s3, 31
  s_add_u32 m0, s86, 5120
  v_exp_f32 v141, v141
  v_exp_f32 v142, v142
  v_exp_f32 v143, v143
  v_exp_f32 v144, v144
  v_exp_f32 v145, v145
  v_exp_f32 v146, v146
  v_exp_f32 v147, v147
  v_mfma_f32_32x32x16_bf16 v[96:111], v[164:167], a[240:243], v[96:111]
  v_exp_f32 v148, v148
  v_exp_f32 v149, v149
  v_exp_f32 v150, v150
  v_smfmac_f32_32x32x32_bf16 v[64:79], v[242:245], v[136:143], v18
  buffer_load_dwordx4 v4, s[40:43], s85 offen offset:0 nt lds
  v_exp_f32 v151, v151
  v_exp_f32 v152, v152
  v_exp_f32 v153, v153
  v_mfma_f32_32x32x16_bf16 v[112:127], v[164:167], a[244:247], v[112:127]
  v_exp_f32 v154, v154
  v_exp_f32 v155, v155
  v_exp_f32 v156, v156
  v_smfmac_f32_32x32x32_bf16 v[80:95], v[238:241], v[144:151], v18
  buffer_load_dwordx4 v5, s[40:43], s85 offen offset:1024 nt lds
  v_exp_f32 v157, v157
  v_exp_f32 v158, v158
  v_exp_f32 v159, v159
  v_exp_f32 v96, v96
  v_exp_f32 v97, v97
  v_smfmac_f32_32x32x32_bf16 v[80:95], v[242:245], v[152:159], v18
  buffer_load_dwordx4 v6, s[40:43], s85 offen offset:2048 nt lds
  v_exp_f32 v98, v98
  v_exp_f32 v99, v99
  v_exp_f32 v100, v100
  v_mfma_f32_32x32x4_2b_bf16 v[128:159], v[176:177], v[162:163], 0 cbsz:1
  v_exp_f32 v101, v101
  v_exp_f32 v102, v102
  v_exp_f32 v103, v103
  v_exp_f32 v104, v104
  v_exp_f32 v105, v105
  v_exp_f32 v106, v106
  v_exp_f32 v107, v107
  v_exp_f32 v108, v108
  s_waitcnt vmcnt(24)
  v_smfmac_f32_32x32x32_bf16 v[32:47], v[168:171], v[96:103], v18
  s_nop 0
  global_load_dwordx4 v[224:227], v0, s[22:23] offset:1536
  v_exp_f32 v109, v109
  v_exp_f32 v110, v110
  v_exp_f32 v111, v111
  v_exp_f32 v112, v112
  v_exp_f32 v113, v113
  v_exp_f32 v114, v114
  v_exp_f32 v115, v115
  v_mfma_f32_32x32x16_bf16 v[128:143], v[164:167], a[248:251], v[128:143]
  s_waitcnt vmcnt(24)
  v_exp_f32 v116, v116
  v_exp_f32 v117, v117
  v_exp_f32 v118, v118
  v_smfmac_f32_32x32x32_bf16 v[32:47], v[172:175], v[104:111], v18
  buffer_load_dwordx4 v7, s[40:43], s85 offen offset:3072 nt lds
  v_exp_f32 v119, v119
  v_exp_f32 v120, v120
  v_exp_f32 v121, v121
  v_mfma_f32_32x32x16_bf16 v[144:159], v[164:167], a[252:255], v[144:159]
  v_exp_f32 v122, v122
  v_exp_f32 v123, v123
  v_exp_f32 v124, v124
  v_smfmac_f32_32x32x32_bf16 v[48:63], v[168:171], v[112:119], v18
  global_load_dwordx4 v[228:231], v0, s[22:23] offset:2560
  s_mul_i32 s80, s3, 3584
  s_add_u32 s80, s80, s81
  v_exp_f32 v125, v125
  v_exp_f32 v126, v126
  v_exp_f32 v127, v127
  v_exp_f32 v128, v128
  v_exp_f32 v129, v129
  v_smfmac_f32_32x32x32_bf16 v[48:63], v[172:175], v[120:127], v18
  s_waitcnt vmcnt(20)
  buffer_store_dword v19, v12, s[60:63], 0 offen offset:0 sc1
  s_add_u32 s22, s60, s80
  s_addc_u32 s23, s61, 0
  v_exp_f32 v130, v130
  v_exp_f32 v131, v131
  v_exp_f32 v132, v132
  v_mfma_f32_32x32x4_2b_bf16 v[96:127], v[190:191], v[160:161], 0 cbsz:1
  v_exp_f32 v133, v133
  v_exp_f32 v134, v134
  v_exp_f32 v135, v135
  v_exp_f32 v136, v136
  v_exp_f32 v137, v137
  v_exp_f32 v138, v138
  v_exp_f32 v139, v139
  v_exp_f32 v140, v140
  v_smfmac_f32_32x32x32_bf16 v[64:79], v[168:171], v[128:135], v18
  global_load_dwordx4 v[234:237], v11, s[22:23]
  s_add_u32 s3, s3, 1
  s_add_u32 m0, s86, 9216
  v_exp_f32 v141, v141
  v_exp_f32 v142, v142
  v_exp_f32 v143, v143
  v_exp_f32 v144, v144
  v_exp_f32 v145, v145
  v_exp_f32 v146, v146
  v_exp_f32 v147, v147
  v_mfma_f32_32x32x16_bf16 v[96:111], v[178:181], a[240:243], v[96:111]
  v_exp_f32 v148, v148
  v_exp_f32 v149, v149
  v_exp_f32 v150, v150
  v_smfmac_f32_32x32x32_bf16 v[64:79], v[172:175], v[136:143], v18
  buffer_load_dwordx4 v8, s[40:43], s85 offen offset:0 nt lds
  s_add_u32 s85, s85, 40960
  s_add_u32 m0, s86, 10240
  v_exp_f32 v151, v151
  v_exp_f32 v152, v152
  v_exp_f32 v153, v153
  v_mfma_f32_32x32x16_bf16 v[112:127], v[178:181], a[244:247], v[112:127]
  v_exp_f32 v154, v154
  v_exp_f32 v155, v155
  v_exp_f32 v156, v156
  v_smfmac_f32_32x32x32_bf16 v[80:95], v[168:171], v[144:151], v18
  buffer_load_dwordx4 v4, s[40:43], s85 offen offset:0 nt lds
  v_exp_f32 v157, v157
  v_exp_f32 v158, v158
  v_exp_f32 v159, v159
  v_exp_f32 v96, v96
  v_exp_f32 v97, v97
  v_smfmac_f32_32x32x32_bf16 v[80:95], v[172:175], v[152:159], v18
  global_load_dwordx2 v[246:247], v17, s[22:23]
  s_and_b32 s3, s3, 31
  v_exp_f32 v98, v98
  v_exp_f32 v99, v99
  v_exp_f32 v100, v100
  v_mfma_f32_32x32x4_2b_bf16 v[128:159], v[190:191], v[162:163], 0 cbsz:1
  v_exp_f32 v101, v101
  v_exp_f32 v102, v102
  v_exp_f32 v103, v103
  v_exp_f32 v104, v104
  v_exp_f32 v105, v105
  v_exp_f32 v106, v106
  v_exp_f32 v107, v107
  v_exp_f32 v108, v108
  v_smfmac_f32_32x32x32_bf16 v[32:47], v[182:185], v[96:103], v18
  s_nop 0
  global_load_dwordx4 v[238:241], v0, s[22:23] offset:1536
  v_exp_f32 v109, v109
  v_exp_f32 v110, v110
  v_exp_f32 v111, v111
  v_exp_f32 v112, v112
  v_exp_f32 v113, v113
  v_exp_f32 v114, v114
  v_exp_f32 v115, v115
  v_mfma_f32_32x32x16_bf16 v[128:143], v[178:181], a[248:251], v[128:143]
  v_exp_f32 v116, v116
  v_exp_f32 v117, v117
  v_exp_f32 v118, v118
  v_smfmac_f32_32x32x32_bf16 v[32:47], v[186:189], v[104:111], v18
  buffer_load_dwordx4 v5, s[40:43], s85 offen offset:1024 nt lds
  v_exp_f32 v119, v119
  v_exp_f32 v120, v120
  v_exp_f32 v121, v121
  v_mfma_f32_32x32x16_bf16 v[144:159], v[178:181], a[252:255], v[144:159]
  v_exp_f32 v122, v122
  v_exp_f32 v123, v123
  v_exp_f32 v124, v124
  v_smfmac_f32_32x32x32_bf16 v[48:63], v[182:185], v[112:119], v18
  global_load_dwordx4 v[242:245], v0, s[22:23] offset:2560
  s_mul_i32 s80, s3, 3584
  s_add_u32 s80, s80, s81
  v_exp_f32 v125, v125
  v_exp_f32 v126, v126
  v_exp_f32 v127, v127
  v_exp_f32 v128, v128
  v_exp_f32 v129, v129
  v_smfmac_f32_32x32x32_bf16 v[48:63], v[186:189], v[120:127], v18
  s_waitcnt vmcnt(27)
  buffer_load_dwordx4 v6, s[40:43], s85 offen offset:2048 nt lds
  s_add_u32 s22, s60, s80
  s_addc_u32 s23, s61, 0
  v_exp_f32 v130, v130
  v_exp_f32 v131, v131
  v_exp_f32 v132, v132
  v_mfma_f32_32x32x4_2b_bf16 v[96:127], v[204:205], v[160:161], 0 cbsz:1
  v_exp_f32 v133, v133
  v_exp_f32 v134, v134
  v_exp_f32 v135, v135
  v_exp_f32 v136, v136
  v_exp_f32 v137, v137
  v_exp_f32 v138, v138
  v_exp_f32 v139, v139
  v_exp_f32 v140, v140
  v_smfmac_f32_32x32x32_bf16 v[64:79], v[182:185], v[128:135], v18
  global_load_dwordx4 v[164:167], v11, s[22:23]
  s_add_u32 s3, s3, 1
  v_exp_f32 v141, v141
  v_exp_f32 v142, v142
  v_exp_f32 v143, v143
  v_exp_f32 v144, v144
  v_exp_f32 v145, v145
  v_exp_f32 v146, v146
  v_exp_f32 v147, v147
  v_mfma_f32_32x32x16_bf16 v[96:111], v[192:195], a[240:243], v[96:111]
  v_exp_f32 v148, v148
  v_exp_f32 v149, v149
  v_exp_f32 v150, v150
  v_smfmac_f32_32x32x32_bf16 v[64:79], v[186:189], v[136:143], v18
  buffer_load_dwordx4 v7, s[40:43], s85 offen offset:3072 nt lds
  v_exp_f32 v151, v151
  v_exp_f32 v152, v152
  v_exp_f32 v153, v153
  v_mfma_f32_32x32x16_bf16 v[112:127], v[192:195], a[244:247], v[112:127]
  v_exp_f32 v154, v154
  v_exp_f32 v155, v155
  v_exp_f32 v156, v156
  v_smfmac_f32_32x32x32_bf16 v[80:95], v[182:185], v[144:151], v18
  global_load_dwordx2 v[176:177], v17, s[22:23]
  s_and_b32 s3, s3, 31
  v_exp_f32 v157, v157
  v_exp_f32 v158, v158
  v_exp_f32 v159, v159
  v_exp_f32 v96, v96
  v_exp_f32 v97, v97
  v_smfmac_f32_32x32x32_bf16 v[80:95], v[186:189], v[152:159], v18
  global_load_dwordx4 v[168:171], v0, s[22:23] offset:1536
  s_add_u32 m0, s86, 14336
  v_exp_f32 v98, v98
  v_exp_f32 v99, v99
  v_exp_f32 v100, v100
  v_mfma_f32_32x32x4_2b_bf16 v[128:159], v[204:205], v[162:163], 0 cbsz:1
  v_exp_f32 v101, v101
  v_exp_f32 v102, v102
  v_exp_f32 v103, v103
  v_exp_f32 v104, v104
  v_exp_f32 v105, v105
  v_exp_f32 v106, v106
  v_exp_f32 v107, v107
  v_exp_f32 v108, v108
  s_waitcnt vmcnt(31)
  v_smfmac_f32_32x32x32_bf16 v[32:47], v[196:199], v[96:103], v18
  s_nop 0
  buffer_load_dwordx4 v8, s[40:43], s85 offen offset:0 nt lds
  v_exp_f32 v109, v109
  v_exp_f32 v110, v110
  v_exp_f32 v111, v111
  v_exp_f32 v112, v112
  v_exp_f32 v113, v113
  v_exp_f32 v114, v114
  v_exp_f32 v115, v115
  v_mfma_f32_32x32x16_bf16 v[128:143], v[192:195], a[248:251], v[128:143]
  s_add_u32 s85, s85, 40960
  v_exp_f32 v116, v116
  v_exp_f32 v117, v117
  v_exp_f32 v118, v118
  s_waitcnt vmcnt(31)
  v_smfmac_f32_32x32x32_bf16 v[32:47], v[200:203], v[104:111], v18
  global_load_dwordx4 v[172:175], v0, s[22:23] offset:2560
  s_mul_i32 s80, s3, 3584
  s_add_u32 s80, s80, s81
  v_exp_f32 v119, v119
  v_exp_f32 v120, v120
  v_exp_f32 v121, v121
  v_mfma_f32_32x32x16_bf16 v[144:159], v[192:195], a[252:255], v[144:159]
  s_add_u32 m0, s86, 15360
  v_exp_f32 v122, v122
  v_exp_f32 v123, v123
  v_exp_f32 v124, v124
  v_smfmac_f32_32x32x32_bf16 v[48:63], v[196:199], v[112:119], v18
  buffer_load_dwordx4 v4, s[40:43], s85 offen offset:0 nt lds
  s_add_u32 s22, s60, s80
  s_addc_u32 s23, s61, 0
  v_exp_f32 v125, v125
  v_exp_f32 v126, v126
  v_exp_f32 v127, v127
  v_exp_f32 v128, v128
  v_exp_f32 v129, v129
  v_smfmac_f32_32x32x32_bf16 v[48:63], v[200:203], v[120:127], v18
  s_waitcnt vmcnt(29)
  buffer_load_dwordx4 v5, s[40:43], s85 offen offset:1024 nt lds
  v_exp_f32 v130, v130
  v_exp_f32 v131, v131
  v_exp_f32 v132, v132
  v_mfma_f32_32x32x4_2b_bf16 v[96:127], v[218:219], v[160:161], 0 cbsz:1
  v_exp_f32 v133, v133
  v_exp_f32 v134, v134
  v_exp_f32 v135, v135
  v_exp_f32 v136, v136
  v_exp_f32 v137, v137
  v_exp_f32 v138, v138
  v_exp_f32 v139, v139
  v_exp_f32 v140, v140
  v_smfmac_f32_32x32x32_bf16 v[64:79], v[196:199], v[128:135], v18
  global_load_dwordx4 v[178:181], v11, s[22:23]
  s_add_u32 s3, s3, 1
  v_exp_f32 v141, v141
  v_exp_f32 v142, v142
  v_exp_f32 v143, v143
  v_exp_f32 v144, v144
  v_exp_f32 v145, v145
  v_exp_f32 v146, v146
  v_exp_f32 v147, v147
  v_mfma_f32_32x32x16_bf16 v[96:111], v[206:209], a[240:243], v[96:111]
  v_exp_f32 v148, v148
  v_exp_f32 v149, v149
  v_exp_f32 v150, v150
  v_smfmac_f32_32x32x32_bf16 v[64:79], v[200:203], v[136:143], v18
  buffer_load_dwordx4 v6, s[40:43], s85 offen offset:2048 nt lds
  v_exp_f32 v151, v151
  v_exp_f32 v152, v152
  v_exp_f32 v153, v153
  v_mfma_f32_32x32x16_bf16 v[112:127], v[206:209], a[244:247], v[112:127]
  v_exp_f32 v154, v154
  v_exp_f32 v155, v155
  v_exp_f32 v156, v156
  v_smfmac_f32_32x32x32_bf16 v[80:95], v[196:199], v[144:151], v18
  global_load_dwordx2 v[190:191], v17, s[22:23]
  s_and_b32 s3, s3, 31
  v_exp_f32 v157, v157
  v_exp_f32 v158, v158
  v_exp_f32 v159, v159
  v_exp_f32 v96, v96
  v_exp_f32 v97, v97
  v_smfmac_f32_32x32x32_bf16 v[80:95], v[200:203], v[152:159], v18
  buffer_load_dwordx4 v7, s[40:43], s85 offen offset:3072 nt lds
  v_exp_f32 v98, v98
  v_exp_f32 v99, v99
  v_exp_f32 v100, v100
  v_mfma_f32_32x32x4_2b_bf16 v[128:159], v[218:219], v[162:163], 0 cbsz:1
  v_exp_f32 v101, v101
  v_exp_f32 v102, v102
  v_exp_f32 v103, v103
  v_exp_f32 v104, v104
  v_exp_f32 v105, v105
  v_exp_f32 v106, v106
  v_exp_f32 v107, v107
  v_exp_f32 v108, v108
  s_waitcnt vmcnt(32)
  v_smfmac_f32_32x32x32_bf16 v[32:47], v[210:213], v[96:103], v18
  s_nop 0
  global_load_dwordx4 v[182:185], v0, s[22:23] offset:1536
  v_exp_f32 v109, v109
  v_exp_f32 v110, v110
  v_exp_f32 v111, v111
  v_exp_f32 v112, v112
  v_exp_f32 v113, v113
  v_exp_f32 v114, v114
  v_exp_f32 v115, v115
  v_mfma_f32_32x32x16_bf16 v[128:143], v[206:209], a[248:251], v[128:143]
  s_add_u32 m0, s86, 19456
  v_exp_f32 v116, v116
  v_exp_f32 v117, v117
  v_exp_f32 v118, v118
  s_waitcnt vmcnt(31)
  v_smfmac_f32_32x32x32_bf16 v[32:47], v[214:217], v[104:111], v18
  buffer_load_dwordx4 v8, s[40:43], s85 offen offset:0 nt lds
  v_exp_f32 v119, v119
  v_exp_f32 v120, v120
  v_exp_f32 v121, v121
  v_mfma_f32_32x32x16_bf16 v[144:159], v[206:209], a[252:255], v[144:159]
  v_exp_f32 v122, v122
  v_exp_f32 v123, v123
  v_exp_f32 v124, v124
  v_smfmac_f32_32x32x32_bf16 v[48:63], v[210:213], v[112:119], v18
  global_load_dwordx4 v[186:189], v0, s[22:23] offset:2560
  s_mul_i32 s80, s3, 3584
  s_add_u32 s80, s80, s81
  v_exp_f32 v125, v125
  v_exp_f32 v126, v126
  v_exp_f32 v127, v127
  v_exp_f32 v128, v128
  v_exp_f32 v129, v129
  v_smfmac_f32_32x32x32_bf16 v[48:63], v[214:217], v[120:127], v18
  s_add_u32 m0, s84, 0
  s_add_u32 s85, s85, 40960
  v_exp_f32 v130, v130
  v_exp_f32 v131, v131
  v_exp_f32 v132, v132
  s_waitcnt vmcnt(30)
  v_mfma_f32_32x32x4_2b_bf16 v[96:127], v[232:233], v[160:161], 0 cbsz:1
  v_exp_f32 v133, v133
  v_exp_f32 v134, v134
  v_exp_f32 v135, v135
  v_exp_f32 v136, v136
  v_exp_f32 v137, v137
  v_exp_f32 v138, v138
  v_exp_f32 v139, v139
  v_exp_f32 v140, v140
  v_smfmac_f32_32x32x32_bf16 v[64:79], v[210:213], v[128:135], v18
  buffer_load_dwordx4 v4, s[52:55], s26 offen offset:0 nt lds
  s_add_u32 s22, s60, s80
  s_addc_u32 s23, s61, 0
  v_exp_f32 v141, v141
  v_exp_f32 v142, v142
  v_exp_f32 v143, v143
  v_exp_f32 v144, v144
  v_exp_f32 v145, v145
  v_exp_f32 v146, v146
  v_exp_f32 v147, v147
  v_mfma_f32_32x32x16_bf16 v[96:111], v[220:223], a[240:243], v[96:111]
  v_exp_f32 v148, v148
  v_exp_f32 v149, v149
  v_exp_f32 v150, v150
  v_smfmac_f32_32x32x32_bf16 v[64:79], v[214:217], v[136:143], v18
  global_load_dwordx4 v[192:195], v11, s[22:23]
  s_add_u32 s3, s3, 1
  v_exp_f32 v151, v151
  v_exp_f32 v152, v152
  v_exp_f32 v153, v153
  v_mfma_f32_32x32x16_bf16 v[112:127], v[220:223], a[244:247], v[112:127]
  v_exp_f32 v154, v154
  v_exp_f32 v155, v155
  v_exp_f32 v156, v156
  v_smfmac_f32_32x32x32_bf16 v[80:95], v[210:213], v[144:151], v18
  global_load_dwordx2 v[204:205], v17, s[22:23]
  s_and_b32 s3, s3, 31
  v_exp_f32 v157, v157
  v_exp_f32 v158, v158
  v_exp_f32 v159, v159
  v_exp_f32 v96, v96
  v_exp_f32 v97, v97
  v_smfmac_f32_32x32x32_bf16 v[80:95], v[214:217], v[152:159], v18
  buffer_load_dwordx2 v[20:21], v31, s[60:63], 0 offen sc1
  v_exp_f32 v98, v98
  v_exp_f32 v99, v99
  v_exp_f32 v100, v100
  v_mfma_f32_32x32x4_2b_bf16 v[128:159], v[232:233], v[162:163], 0 cbsz:1
  v_exp_f32 v101, v101
  v_exp_f32 v102, v102
  v_exp_f32 v103, v103
  v_exp_f32 v104, v104
  v_exp_f32 v105, v105
  v_exp_f32 v106, v106
  v_exp_f32 v107, v107
  v_exp_f32 v108, v108
  s_waitcnt vmcnt(30)
  v_smfmac_f32_32x32x32_bf16 v[32:47], v[224:227], v[96:103], v18
  s_nop 0
  global_load_dwordx4 v[196:199], v0, s[22:23] offset:1536
  v_exp_f32 v109, v109
  v_exp_f32 v110, v110
  v_exp_f32 v111, v111
  v_exp_f32 v112, v112
  v_exp_f32 v113, v113
  v_exp_f32 v114, v114
  v_exp_f32 v115, v115
  v_mfma_f32_32x32x16_bf16 v[128:143], v[220:223], a[248:251], v[128:143]
  s_waitcnt vmcnt(29)
  v_exp_f32 v116, v116
  v_exp_f32 v117, v117
  v_exp_f32 v118, v118
  v_smfmac_f32_32x32x32_bf16 v[32:47], v[228:231], v[104:111], v18
  global_load_dwordx4 v[200:203], v0, s[22:23] offset:2560
  s_mul_i32 s80, s3, 3584
  s_add_u32 s80, s80, s81
  v_exp_f32 v119, v119
  v_exp_f32 v120, v120
  v_exp_f32 v121, v121
  v_mfma_f32_32x32x16_bf16 v[144:159], v[220:223], a[252:255], v[144:159]
  v_exp_f32 v122, v122
  v_exp_f32 v123, v123
  v_exp_f32 v124, v124
  v_smfmac_f32_32x32x32_bf16 v[48:63], v[224:227], v[112:119], v18
  s_add_u32 s22, s60, s80
  s_addc_u32 s23, s61, 0
  global_load_dwordx4 v[206:209], v11, s[22:23]
  v_exp_f32 v125, v125
  v_exp_f32 v126, v126
  v_exp_f32 v127, v127
  v_exp_f32 v128, v128
  v_exp_f32 v129, v129
  v_smfmac_f32_32x32x32_bf16 v[48:63], v[228:231], v[120:127], v18
  s_waitcnt vmcnt(26)
  buffer_load_dword v15, v13, s[60:63], 0 offen sc1
  s_add_u32 s3, s3, 1
  v_exp_f32 v130, v130
  v_exp_f32 v131, v131
  v_exp_f32 v132, v132
  v_mfma_f32_32x32x4_2b_bf16 v[96:127], v[246:247], v[160:161], 0 cbsz:1
  v_exp_f32 v133, v133
  v_exp_f32 v134, v134
  v_exp_f32 v135, v135
  v_exp_f32 v136, v136
  v_exp_f32 v137, v137
  v_exp_f32 v138, v138
  v_exp_f32 v139, v139
  v_exp_f32 v140, v140
  v_smfmac_f32_32x32x32_bf16 v[64:79], v[224:227], v[128:135], v18
  s_nop 0
  buffer_load_dword v30, v16, s[60:63], 0 offen sc1
  v_exp_f32 v141, v141
  v_exp_f32 v142, v142
  v_exp_f32 v143, v143
  v_exp_f32 v144, v144
  v_exp_f32 v145, v145
  v_exp_f32 v146, v146
  v_exp_f32 v147, v147
  v_mfma_f32_32x32x16_bf16 v[96:111], v[234:237], a[240:243], v[96:111]
  v_exp_f32 v148, v148
  v_exp_f32 v149, v149
  v_exp_f32 v150, v150
  v_smfmac_f32_32x32x32_bf16 v[64:79], v[228:231], v[136:143], v18
  global_load_dwordx2 v[218:219], v17, s[22:23]
  s_and_b32 s3, s3, 31
  v_exp_f32 v151, v151
  v_exp_f32 v152, v152
  v_exp_f32 v153, v153
  v_mfma_f32_32x32x16_bf16 v[112:127], v[234:237], a[244:247], v[112:127]
  v_exp_f32 v154, v154
  v_exp_f32 v155, v155
  v_exp_f32 v156, v156
  v_smfmac_f32_32x32x32_bf16 v[80:95], v[224:227], v[144:151], v18
  global_load_dwordx4 v[210:213], v0, s[22:23] offset:1536
  v_exp_f32 v157, v157
  v_exp_f32 v158, v158
  v_exp_f32 v159, v159
  v_exp_f32 v96, v96
  v_exp_f32 v97, v97
  v_smfmac_f32_32x32x32_bf16 v[80:95], v[228:231], v[152:159], v18
  buffer_load_dwordx4 v5, s[52:55], s26 offen offset:1024 nt lds
  v_exp_f32 v98, v98
  v_exp_f32 v99, v99
  v_exp_f32 v100, v100
  v_mfma_f32_32x32x4_2b_bf16 v[128:159], v[246:247], v[162:163], 0 cbsz:1
  v_exp_f32 v101, v101
  v_exp_f32 v102, v102
  v_exp_f32 v103, v103
  v_exp_f32 v104, v104
  v_exp_f32 v105, v105
  v_exp_f32 v106, v106
  v_exp_f32 v107, v107
  v_exp_f32 v108, v108
  s_waitcnt vmcnt(30)
  v_smfmac_f32_32x32x32_bf16 v[32:47], v[238:241], v[96:103], v18
  s_nop 0
  global_load_dwordx4 v[214:217], v0, s[22:23] offset:2560
  v_exp_f32 v109, v109
  v_exp_f32 v110, v110
  v_exp_f32 v111, v111
  v_exp_f32 v112, v112
  v_exp_f32 v113, v113
  v_exp_f32 v114, v114
  v_exp_f32 v115, v115
  v_mfma_f32_32x32x16_bf16 v[128:143], v[234:237], a[248:251], v[128:143]
  s_mul_i32 s80, s3, 3584
  v_exp_f32 v116, v116
  v_exp_f32 v117, v117
  v_exp_f32 v118, v118
  s_waitcnt vmcnt(29)
  v_smfmac_f32_32x32x32_bf16 v[32:47], v[242:245], v[104:111], v18
  s_add_u32 s80, s80, s81
  v_exp_f32 v119, v119
  v_exp_f32 v120, v120
  v_exp_f32 v121, v121
  v_mfma_f32_32x32x16_bf16 v[144:159], v[234:237], a[252:255], v[144:159]
  v_exp_f32 v122, v122
  v_exp_f32 v123, v123
  v_exp_f32 v124, v124
  v_smfmac_f32_32x32x32_bf16 v[48:63], v[238:241], v[112:119], v18
  s_add_u32 s22, s60, s80
  s_addc_u32 s23, s61, 0
  global_load_dwordx4 v[220:223], v11, s[22:23]
  v_exp_f32 v125, v125
  v_exp_f32 v126, v126
  v_exp_f32 v127, v127
  v_exp_f32 v128, v128
  v_exp_f32 v129, v129
  v_smfmac_f32_32x32x32_bf16 v[48:63], v[242:245], v[120:127], v18
  s_waitcnt vmcnt(26)
  s_add_u32 s3, s3, 1
  global_load_dwordx2 v[232:233], v17, s[22:23]
  s_and_b32 s3, s3, 31
  v_exp_f32 v130, v130
  v_exp_f32 v131, v131
  v_exp_f32 v132, v132
  v_mfma_f32_32x32x4_2b_bf16 v[96:127], v[176:177], v[160:161], 0 cbsz:1
  v_exp_f32 v133, v133
  v_exp_f32 v134, v134
  v_exp_f32 v135, v135
  v_exp_f32 v136, v136
  v_exp_f32 v137, v137
  v_exp_f32 v138, v138
  v_exp_f32 v139, v139
  v_exp_f32 v140, v140
  v_smfmac_f32_32x32x32_bf16 v[64:79], v[238:241], v[128:135], v18
  s_nop 0
  global_load_dwordx4 v[224:227], v0, s[22:23] offset:1536
  v_exp_f32 v141, v141
  v_exp_f32 v142, v142
  v_exp_f32 v143, v143
  v_exp_f32 v144, v144
  v_exp_f32 v145, v145
  v_exp_f32 v146, v146
  v_exp_f32 v147, v147
  v_mfma_f32_32x32x16_bf16 v[96:111], v[164:167], a[240:243], v[96:111]
  v_exp_f32 v148, v148
  v_exp_f32 v149, v149
  v_exp_f32 v150, v150
  v_smfmac_f32_32x32x32_bf16 v[64:79], v[242:245], v[136:143], v18
  global_load_dwordx4 v[228:231], v0, s[22:23] offset:2560
  v_exp_f32 v151, v151
  v_exp_f32 v152, v152
  v_exp_f32 v153, v153
  v_mfma_f32_32x32x16_bf16 v[112:127], v[164:167], a[244:247], v[112:127]
  v_exp_f32 v154, v154
  v_exp_f32 v155, v155
  v_exp_f32 v156, v156
  v_smfmac_f32_32x32x32_bf16 v[80:95], v[238:241], v[144:151], v18
  v_exp_f32 v157, v157
  v_exp_f32 v158, v158
  v_exp_f32 v159, v159
  v_exp_f32 v96, v96
  v_exp_f32 v97, v97
  v_smfmac_f32_32x32x32_bf16 v[80:95], v[242:245], v[152:159], v18
  s_waitcnt vmcnt(9)
  v_cmp_ne_u32 vcc, v15, v19
  v_exp_f32 v98, v98
  v_exp_f32 v99, v99
  v_exp_f32 v100, v100
  v_mfma_f32_32x32x4_2b_bf16 v[128:159], v[176:177], v[162:163], 0 cbsz:1
  v_exp_f32 v101, v101
  v_exp_f32 v102, v102
  v_exp_f32 v103, v103
  v_exp_f32 v104, v104
  v_exp_f32 v105, v105
  v_exp_f32 v106, v106
  v_exp_f32 v107, v107
  v_exp_f32 v108, v108
  v_smfmac_f32_32x32x32_bf16 v[32:47], v[168:171], v[96:103], v18
  s_nop 0
  s_nop 0
  v_exp_f32 v109, v109
  v_exp_f32 v110, v110
  v_exp_f32 v111, v111
  v_exp_f32 v112, v112
  v_exp_f32 v113, v113
  v_exp_f32 v114, v114
  v_exp_f32 v115, v115
  v_mfma_f32_32x32x16_bf16 v[128:143], v[164:167], a[248:251], v[128:143]
  s_cbranch_vccnz L_rspin
L_rback:
  v_exp_f32 v116, v116
  v_exp_f32 v117, v117
  v_exp_f32 v118, v118
  v_smfmac_f32_32x32x32_bf16 v[32:47], v[172:175], v[104:111], v18
  s_mul_i32 s80, s3, 3584
  s_add_u32 s80, s80, s81
  v_exp_f32 v119, v119
  v_exp_f32 v120, v120
  v_exp_f32 v121, v121
  v_mfma_f32_32x32x16_bf16 v[144:159], v[164:167], a[252:255], v[144:159]
  v_exp_f32 v122, v122
  v_exp_f32 v123, v123
  v_exp_f32 v124, v124
  v_smfmac_f32_32x32x32_bf16 v[48:63], v[168:171], v[112:119], v18
  s_add_u32 s22, s60, s80
  s_addc_u32 s23, s61, 0
  global_load_dwordx4 v[234:237], v11, s[22:23]
  v_exp_f32 v125, v125
  v_exp_f32 v126, v126
  v_exp_f32 v127, v127
  v_exp_f32 v128, v128
  v_exp_f32 v129, v129
  v_smfmac_f32_32x32x32_bf16 v[48:63], v[172:175], v[120:127], v18
  buffer_load_dwordx4 v6, s[52:55], s26 offen offset:2048 nt lds
  s_add_u32 s3, s3, 1
  v_exp_f32 v130, v130
  v_exp_f32 v131, v131
  v_exp_f32 v132, v132
  v_mfma_f32_32x32x4_2b_bf16 v[96:127], v[190:191], v[160:161], 0 cbsz:1
  v_exp_f32 v133, v133
  v_exp_f32 v134, v134
  v_exp_f32 v135, v135
  v_exp_f32 v136, v136
  v_exp_f32 v137, v137
  v_exp_f32 v138, v138
  v_exp_f32 v139, v139
  v_exp_f32 v140, v140
  v_smfmac_f32_32x32x32_bf16 v[64:79], v[168:171], v[128:135], v18
  s_nop 0
  v_cmp_eq_u32 vcc, v20, v19
  v_exp_f32 v141, v141
  v_exp_f32 v142, v142
  v_exp_f32 v143, v143
  v_exp_f32 v144, v144
  v_exp_f32 v145, v145
  v_exp_f32 v146, v146
  v_exp_f32 v147, v147
  v_mfma_f32_32x32x16_bf16 v[96:111], v[178:181], a[240:243], v[96:111]
  v_cmp_eq_u32 s[94:95], s0, v21
  v_exp_f32 v148, v148
  v_exp_f32 v149, v149
  v_exp_f32 v150, v150
  v_smfmac_f32_32x32x32_bf16 v[64:79], v[172:175], v[136:143], v18
  s_and_b64 vcc, vcc, s[94:95]
  s_nop 0
  global_load_dwordx2 v[246:247], v17, s[22:23]
  v_exp_f32 v151, v151
  v_exp_f32 v152, v152
  v_exp_f32 v153, v153
  v_mfma_f32_32x32x16_bf16 v[112:127], v[178:181], a[244:247], v[112:127]
  s_and_b32 s3, s3, 31
  v_exp_f32 v154, v154
  v_exp_f32 v155, v155
  v_exp_f32 v156, v156
  v_smfmac_f32_32x32x32_bf16 v[80:95], v[168:171], v[144:151], v18
  s_cmp_eq_u64 vcc, -1
  s_cselect_b32 s1, 1, 0
  global_load_dwordx4 v[238:241], v0, s[22:23] offset:1536
  v_exp_f32 v157, v157
  v_exp_f32 v158, v158
  v_exp_f32 v159, v159
  v_exp_f32 v96, v96
  v_exp_f32 v97, v97
  v_smfmac_f32_32x32x32_bf16 v[80:95], v[172:175], v[152:159], v18
  s_add_u32 s24, s60, s83
  s_addc_u32 s25, s61, 0
  global_load_dwordx4 a[0:3], v11, s[24:25] offset:0 sc1
  v_exp_f32 v98, v98
  v_exp_f32 v99, v99
  v_exp_f32 v100, v100
  v_mfma_f32_32x32x4_2b_bf16 v[128:159], v[190:191], v[162:163], 0 cbsz:1
  v_exp_f32 v101, v101
  v_exp_f32 v102, v102
  v_exp_f32 v103, v103
  v_exp_f32 v104, v104
  v_exp_f32 v105, v105
  v_exp_f32 v106, v106
  v_exp_f32 v107, v107
  v_exp_f32 v108, v108
  v_smfmac_f32_32x32x32_bf16 v[32:47], v[182:185], v[96:103], v18
  s_nop 0
  global_load_dwordx4 a[4:7], v11, s[24:25] offset:1024 sc1
  v_exp_f32 v109, v109
  v_exp_f32 v110, v110
  v_exp_f32 v111, v111
  v_exp_f32 v112, v112
  v_exp_f32 v113, v113
  v_exp_f32 v114, v114
  v_exp_f32 v115, v115
  v_mfma_f32_32x32x16_bf16 v[128:143], v[178:181], a[248:251], v[128:143]
  v_exp_f32 v116, v116
  v_exp_f32 v117, v117
  v_exp_f32 v118, v118
  v_smfmac_f32_32x32x32_bf16 v[32:47], v[186:189], v[104:111], v18
  global_load_dwordx4 a[8:11], v11, s[24:25] offset:2048 sc1
  v_exp_f32 v119, v119
  v_exp_f32 v120, v120
  v_exp_f32 v121, v121
  v_mfma_f32_32x32x16_bf16 v[144:159], v[178:181], a[252:255], v[144:159]
  v_exp_f32 v122, v122
  v_exp_f32 v123, v123
  v_exp_f32 v124, v124
  v_smfmac_f32_32x32x32_bf16 v[48:63], v[182:185], v[112:119], v18
  global_load_dwordx4 a[12:15], v11, s[24:25] offset:3072 sc1
  v_exp_f32 v125, v125
  v_exp_f32 v126, v126
  v_exp_f32 v127, v127
  v_exp_f32 v128, v128
  v_exp_f32 v129, v129
  v_smfmac_f32_32x32x32_bf16 v[48:63], v[186:189], v[120:127], v18
  s_add_u32 s83, s83, 4096
  global_load_dwordx4 v[242:245], v0, s[22:23] offset:2560
  s_mul_i32 s80, s3, 3584
  v_exp_f32 v130, v130
  v_exp_f32 v131, v131
  v_exp_f32 v132, v132
  v_mfma_f32_32x32x4_2b_bf16 v[96:127], v[204:205], v[160:161], 0 cbsz:1
  v_exp_f32 v133, v133
  v_exp_f32 v134, v134
  v_exp_f32 v135, v135
  v_exp_f32 v136, v136
  v_exp_f32 v137, v137
  v_exp_f32 v138, v138
  v_exp_f32 v139, v139
  v_exp_f32 v140, v140
  v_smfmac_f32_32x32x32_bf16 v[64:79], v[182:185], v[128:135], v18
  s_add_u32 s24, s60, s83
  s_addc_u32 s25, s61, 0
  global_load_dwordx4 a[16:19], v11, s[24:25] offset:0 sc1
  v_exp_f32 v141, v141
  v_exp_f32 v142, v142
  v_exp_f32 v143, v143
  v_exp_f32 v144, v144
  v_exp_f32 v145, v145
  v_exp_f32 v146, v146
  v_exp_f32 v147, v147
  v_mfma_f32_32x32x16_bf16 v[96:111], v[192:195], a[240:243], v[96:111]
  s_add_u32 s80, s80, s81
  v_exp_f32 v148, v148
  v_exp_f32 v149, v149
  v_exp_f32 v150, v150
  v_smfmac_f32_32x32x32_bf16 v[64:79], v[186:189], v[136:143], v18
  global_load_dwordx4 a[20:23], v11, s[24:25] offset:1024 sc1
  s_add_u32 s22, s60, s80
  s_addc_u32 s23, s61, 0
  v_exp_f32 v151, v151
  v_exp_f32 v152, v152
  v_exp_f32 v153, v153
  v_mfma_f32_32x32x16_bf16 v[112:127], v[192:195], a[244:247], v[112:127]
  v_exp_f32 v154, v154
  v_exp_f32 v155, v155
  v_exp_f32 v156, v156
  v_smfmac_f32_32x32x32_bf16 v[80:95], v[182:185], v[144:151], v18
  global_load_dwordx4 v[164:167], v11, s[22:23]
  s_add_u32 s3, s3, 1
  v_exp_f32 v157, v157
  v_exp_f32 v158, v158
  v_exp_f32 v159, v159
  v_exp_f32 v96, v96
  v_exp_f32 v97, v97
  v_smfmac_f32_32x32x32_bf16 v[80:95], v[186:189], v[152:159], v18
  buffer_load_dwordx4 v7, s[52:55], s26 offen offset:3072 nt lds
  s_add_u32 m0, s86, 20480
  v_exp_f32 v98, v98
  v_exp_f32 v99, v99
  v_exp_f32 v100, v100
  v_mfma_f32_32x32x4_2b_bf16 v[128:159], v[204:205], v[162:163], 0 cbsz:1
  v_exp_f32 v101, v101
  v_exp_f32 v102, v102
  v_exp_f32 v103, v103
  v_exp_f32 v104, v104
  v_exp_f32 v105, v105
  v_exp_f32 v106, v106
  v_exp_f32 v107, v107
  v_exp_f32 v108, v108
  v_smfmac_f32_32x32x32_bf16 v[32:47], v[196:199], v[96:103], v18
  s_nop 0
  buffer_load_dwordx4 v4, s[40:43], s85 offen offset:0 nt lds
  v_exp_f32 v109, v109
  v_exp_f32 v110, v110
  v_exp_f32 v111, v111
  v_exp_f32 v112, v112
  v_exp_f32 v113, v113
  v_exp_f32 v114, v114
  v_exp_f32 v115, v115
  v_mfma_f32_32x32x16_bf16 v[128:143], v[192:195], a[248:251], v[128:143]
  v_exp_f32 v116, v116
  v_exp_f32 v117, v117
  v_exp_f32 v118, v118
  v_smfmac_f32_32x32x32_bf16 v[32:47], v[200:203], v[104:111], v18
  buffer_load_dwordx4 v5, s[40:43], s85 offen offset:1024 nt lds
  v_exp_f32 v119, v119
  v_exp_f32 v120, v120
  v_exp_f32 v121, v121
  v_mfma_f32_32x32x16_bf16 v[144:159], v[192:195], a[252:255], v[144:159]
  v_exp_f32 v122, v122
  v_exp_f32 v123, v123
  v_exp_f32 v124, v124
  v_smfmac_f32_32x32x32_bf16 v[48:63], v[196:199], v[112:119], v18
  buffer_load_dwordx4 v6, s[40:43], s85 offen offset:2048 nt lds
  v_exp_f32 v125, v125
  v_exp_f32 v126, v126
  v_exp_f32 v127, v127
  v_exp_f32 v128, v128
  v_exp_f32 v129, v129
  v_smfmac_f32_32x32x32_bf16 v[48:63], v[200:203], v[120:127], v18
  s_waitcnt vmcnt(23)
  buffer_load_dwordx4 v7, s[40:43], s85 offen offset:3072 nt lds
  s_add_u32 m0, s86, 24576
  v_exp_f32 v130, v130
  v_exp_f32 v131, v131
  v_exp_f32 v132, v132
  v_mfma_f32_32x32x4_2b_bf16 v[96:127], v[218:219], v[160:161], 0 cbsz:1
  v_exp_f32 v133, v133
  v_exp_f32 v134, v134
  v_exp_f32 v135, v135
  v_exp_f32 v136, v136
  v_exp_f32 v137, v137
  v_exp_f32 v138, v138
  v_exp_f32 v139, v139
  v_exp_f32 v140, v140
  v_smfmac_f32_32x32x32_bf16 v[64:79], v[196:199], v[128:135], v18
  s_nop 0
  buffer_load_dwordx4 v8, s[40:43], s85 offen offset:0 nt lds
  v_exp_f32 v141, v141
  v_exp_f32 v142, v142
  v_exp_f32 v143, v143
  v_exp_f32 v144, v144
  v_exp_f32 v145, v145
  v_exp_f32 v146, v146
  v_exp_f32 v147, v147
  v_mfma_f32_32x32x16_bf16 v[96:111], v[206:209], a[240:243], v[96:111]
  v_exp_f32 v148, v148
  v_exp_f32 v149, v149
  v_exp_f32 v150, v150
  v_smfmac_f32_32x32x32_bf16 v[64:79], v[200:203], v[136:143], v18
  global_load_dwordx4 a[24:27], v11, s[24:25] offset:2048 sc1
  v_exp_f32 v151, v151
  v_exp_f32 v152, v152
  v_exp_f32 v153, v153
  v_mfma_f32_32x32x16_bf16 v[112:127], v[206:209], a[244:247], v[112:127]
  v_exp_f32 v154, v154
  v_exp_f32 v155, v155
  v_exp_f32 v156, v156
  v_smfmac_f32_32x32x32_bf16 v[80:95], v[196:199], v[144:151], v18
  global_load_dwordx4 a[28:31], v11, s[24:25] offset:3072 sc1
  s_add_u32 s83, s83, 4096
  v_exp_f32 v157, v157
  v_exp_f32 v158, v158
  v_exp_f32 v159, v159
  v_exp_f32 v96, v96
  v_exp_f32 v97, v97
  v_smfmac_f32_32x32x32_bf16 v[80:95], v[200:203], v[152:159], v18
  s_add_u32 s24, s60, s83
  s_addc_u32 s25, s61, 0
  global_load_dwordx4 a[32:35], v11, s[24:25] offset:0 sc1
  v_exp_f32 v98, v98
  v_exp_f32 v99, v99
  v_exp_f32 v100, v100
  v_mfma_f32_32x32x4_2b_bf16 v[128:159], v[218:219], v[162:163], 0 cbsz:1
  v_exp_f32 v101, v101
  v_exp_f32 v102, v102
  v_exp_f32 v103, v103
  v_exp_f32 v104, v104
  v_exp_f32 v105, v105
  v_exp_f32 v106, v106
  v_exp_f32 v107, v107
  v_exp_f32 v108, v108
  s_waitcnt vmcnt(27)
  v_smfmac_f32_32x32x32_bf16 v[32:47], v[210:213], v[96:103], v18
  s_nop 0
  global_load_dwordx4 a[36:39], v11, s[24:25] offset:1024 sc1
  v_exp_f32 v109, v109
  v_exp_f32 v110, v110
  v_exp_f32 v111, v111
  v_exp_f32 v112, v112
  v_exp_f32 v113, v113
  v_exp_f32 v114, v114
  v_exp_f32 v115, v115
  v_mfma_f32_32x32x16_bf16 v[128:143], v[206:209], a[248:251], v[128:143]
  s_waitcnt vmcnt(26)
  v_exp_f32 v116, v116
  v_exp_f32 v117, v117
  v_exp_f32 v118, v118
  v_smfmac_f32_32x32x32_bf16 v[32:47], v[214:217], v[104:111], v18
  global_load_dwordx4 a[40:43], v11, s[24:25] offset:2048 sc1
  v_exp_f32 v119, v119
  v_exp_f32 v120, v120
  v_exp_f32 v121, v121
  v_mfma_f32_32x32x16_bf16 v[144:159], v[206:209], a[252:255], v[144:159]
  v_exp_f32 v122, v122
  v_exp_f32 v123, v123
  v_exp_f32 v124, v124
  v_smfmac_f32_32x32x32_bf16 v[48:63], v[210:213], v[112:119], v18
  global_load_dwordx4 a[44:47], v11, s[24:25] offset:3072 sc1
  v_exp_f32 v125, v125
  v_exp_f32 v126, v126
  v_exp_f32 v127, v127
  v_exp_f32 v128, v128
  v_exp_f32 v129, v129
  v_smfmac_f32_32x32x32_bf16 v[48:63], v[214:217], v[120:127], v18
  s_add_u32 m0, s84, 4096
  s_add_u32 s83, s83, 4096
  global_load_dwordx2 v[176:177], v17, s[22:23]
  v_exp_f32 v130, v130
  v_exp_f32 v131, v131
  v_exp_f32 v132, v132
  s_waitcnt vmcnt(27)
  v_mfma_f32_32x32x4_2b_bf16 v[96:127], v[232:233], v[160:161], 0 cbsz:1
  v_exp_f32 v133, v133
  v_exp_f32 v134, v134
  v_exp_f32 v135, v135
  v_exp_f32 v136, v136
  v_exp_f32 v137, v137
  v_exp_f32 v138, v138
  v_exp_f32 v139, v139
  v_exp_f32 v140, v140
  v_smfmac_f32_32x32x32_bf16 v[64:79], v[210:213], v[128:135], v18
  buffer_load_dwordx4 v8, s[52:55], s26 offen offset:0 nt lds
  s_add_u32 s24, s60, s83
  s_addc_u32 s25, s61, 0
  v_exp_f32 v141, v141
  v_exp_f32 v142, v142
  v_exp_f32 v143, v143
  v_exp_f32 v144, v144
  v_exp_f32 v145, v145
  v_exp_f32 v146, v146
  v_exp_f32 v147, v147
  v_mfma_f32_32x32x16_bf16 v[96:111], v[220:223], a[240:243], v[96:111]
  s_and_b32 s3, s3, 31
  v_exp_f32 v148, v148
  v_exp_f32 v149, v149
  v_exp_f32 v150, v150
  v_smfmac_f32_32x32x32_bf16 v[64:79], v[214:217], v[136:143], v18
  global_load_dwordx4 a[48:51], v11, s[24:25] offset:0 sc1
  v_exp_f32 v151, v151
  v_exp_f32 v152, v152
  v_exp_f32 v153, v153
  v_mfma_f32_32x32x16_bf16 v[112:127], v[220:223], a[244:247], v[112:127]
  v_exp_f32 v154, v154
  v_exp_f32 v155, v155
  v_exp_f32 v156, v156
  v_smfmac_f32_32x32x32_bf16 v[80:95], v[210:213], v[144:151], v18
  global_load_dwordx4 a[52:55], v11, s[24:25] offset:1024 sc1
  v_exp_f32 v157, v157
  v_exp_f32 v158, v158
  v_exp_f32 v159, v159
  v_exp_f32 v96, v96
  v_exp_f32 v97, v97
  v_smfmac_f32_32x32x32_bf16 v[80:95], v[214:217], v[152:159], v18
  global_load_dwordx4 a[56:59], v11, s[24:25] offset:2048 sc1
  v_exp_f32 v98, v98
  v_exp_f32 v99, v99
  v_exp_f32 v100, v100
  v_mfma_f32_32x32x4_2b_bf16 v[128:159], v[232:233], v[162:163], 0 cbsz:1
  v_exp_f32 v101, v101
  v_exp_f32 v102, v102
  v_exp_f32 v103, v103
  v_exp_f32 v104, v104
  v_exp_f32 v105, v105
  v_exp_f32 v106, v106
  v_exp_f32 v107, v107
  v_exp_f32 v108, v108
  s_waitcnt vmcnt(30)
  v_smfmac_f32_32x32x32_bf16 v[32:47], v[224:227], v[96:103], v18
  s_nop 0
  global_load_dwordx4 v[168:171], v0, s[22:23] offset:1536
  v_exp_f32 v109, v109
  v_exp_f32 v110, v110
  v_exp_f32 v111, v111
  v_exp_f32 v112, v112
  v_exp_f32 v113, v113
  v_exp_f32 v114, v114
  v_exp_f32 v115, v115
  v_mfma_f32_32x32x16_bf16 v[128:143], v[220:223], a[248:251], v[128:143]
  s_waitcnt vmcnt(30)
  v_exp_f32 v116, v116
  v_exp_f32 v117, v117
  v_exp_f32 v118, v118
  v_smfmac_f32_32x32x32_bf16 v[32:47], v[228:231], v[104:111], v18
  global_load_dwordx4 a[60:63], v11, s[24:25] offset:3072 sc1
  v_exp_f32 v119, v119
  v_exp_f32 v120, v120
  v_exp_f32 v121, v121
  v_mfma_f32_32x32x16_bf16 v[144:159], v[220:223], a[252:255], v[144:159]
  v_exp_f32 v122, v122
  v_exp_f32 v123, v123
  v_exp_f32 v124, v124
  v_smfmac_f32_32x32x32_bf16 v[48:63], v[224:227], v[112:119], v18
  global_load_dwordx4 v[172:175], v0, s[22:23] offset:2560
  s_mul_i32 s80, s3, 3584
  s_add_u32 s80, s80, s81
  v_exp_f32 v125, v125
  v_exp_f32 v126, v126
  v_exp_f32 v127, v127
  v_exp_f32 v128, v128
  v_exp_f32 v129, v129
  v_smfmac_f32_32x32x32_bf16 v[48:63], v[228:231], v[120:127], v18
  s_waitcnt vmcnt(29)
  s_add_u32 s83, s83, 4096
  v_exp_f32 v130, v130
  v_exp_f32 v131, v131
  v_exp_f32 v132, v132
  v_mfma_f32_32x32x4_2b_bf16 v[96:127], v[246:247], v[160:161], 0 cbsz:1
  v_exp_f32 v133, v133
  v_exp_f32 v134, v134
  v_exp_f32 v135, v135
  v_exp_f32 v136, v136
  v_exp_f32 v137, v137
  v_exp_f32 v138, v138
  v_exp_f32 v139, v139
  v_exp_f32 v140, v140
  v_smfmac_f32_32x32x32_bf16 v[64:79], v[224:227], v[128:135], v18
  s_add_u32 s24, s60, s83
  s_addc_u32 s25, s61, 0
  global_load_dwordx4 a[64:67], v11, s[24:25] offset:0 sc1
  v_exp_f32 v141, v141
  v_exp_f32 v142, v142
  v_exp_f32 v143, v143
  v_exp_f32 v144, v144
  v_exp_f32 v145, v145
  v_exp_f32 v146, v146
  v_exp_f32 v147, v147
  v_mfma_f32_32x32x16_bf16 v[96:111], v[234:237], a[240:243], v[96:111]
  v_exp_f32 v148, v148
  v_exp_f32 v149, v149
  v_exp_f32 v150, v150
  v_smfmac_f32_32x32x32_bf16 v[64:79], v[228:231], v[136:143], v18
  global_load_dwordx4 a[68:71], v11, s[24:25] offset:1024 sc1
  s_add_u32 s22, s60, s80
  s_addc_u32 s23, s61, 0
  v_exp_f32 v151, v151
  v_exp_f32 v152, v152
  v_exp_f32 v153, v153
  v_mfma_f32_32x32x16_bf16 v[112:127], v[234:237], a[244:247], v[112:127]
  v_exp_f32 v154, v154
  v_exp_f32 v155, v155
  v_exp_f32 v156, v156
  v_smfmac_f32_32x32x32_bf16 v[80:95], v[224:227], v[144:151], v18
  global_load_dwordx4 v[178:181], v11, s[22:23]
  s_add_u32 s3, s3, 1
  v_exp_f32 v157, v157
  v_exp_f32 v158, v158
  v_exp_f32 v159, v159
  v_exp_f32 v96, v96
  v_exp_f32 v97, v97
  v_smfmac_f32_32x32x32_bf16 v[80:95], v[228:231], v[152:159], v18
  global_load_dwordx4 a[72:75], v11, s[24:25] offset:2048 sc1
  v_exp_f32 v98, v98
  v_exp_f32 v99, v99
  v_exp_f32 v100, v100
  v_mfma_f32_32x32x4_2b_bf16 v[128:159], v[246:247], v[162:163], 0 cbsz:1
  v_exp_f32 v101, v101
  v_exp_f32 v102, v102
  v_exp_f32 v103, v103
  v_exp_f32 v104, v104
  v_exp_f32 v105, v105
  v_exp_f32 v106, v106
  v_exp_f32 v107, v107
  v_exp_f32 v108, v108
  s_waitcnt vmcnt(32)
  v_smfmac_f32_32x32x32_bf16 v[32:47], v[238:241], v[96:103], v18
  global_load_dwordx2 v[190:191], v17, s[22:23]
  s_and_b32 s3, s3, 31
  v_exp_f32 v109, v109
  v_exp_f32 v110, v110
  v_exp_f32 v111, v111
  v_exp_f32 v112, v112
  v_exp_f32 v113, v113
  v_exp_f32 v114, v114
  v_exp_f32 v115, v115
  v_mfma_f32_32x32x16_bf16 v[128:143], v[234:237], a[248:251], v[128:143]
  s_waitcnt vmcnt(28)
  v_exp_f32 v116, v116
  v_exp_f32 v117, v117
  v_exp_f32 v118, v118
  v_smfmac_f32_32x32x32_bf16 v[32:47], v[242:245], v[104:111], v18
  global_load_dwordx4 a[76:79], v11, s[24:25] offset:3072 sc1
  v_exp_f32 v119, v119
  v_exp_f32 v120, v120
  v_exp_f32 v121, v121
  v_mfma_f32_32x32x16_bf16 v[144:159], v[234:237], a[252:255], v[144:159]
  v_exp_f32 v122, v122
  v_exp_f32 v123, v123
  v_exp_f32 v124, v124
  v_smfmac_f32_32x32x32_bf16 v[48:63], v[238:241], v[112:119], v18
  global_load_dwordx4 v[182:185], v0, s[22:23] offset:1536
  v_exp_f32 v125, v125
  v_exp_f32 v126, v126
  v_exp_f32 v127, v127
  v_exp_f32 v128, v128
  v_exp_f32 v129, v129
  v_smfmac_f32_32x32x32_bf16 v[48:63], v[242:245], v[120:127], v18
  s_waitcnt vmcnt(14)
  s_add_u32 s83, s83, 4096
  global_load_dwordx4 v[186:189], v0, s[22:23] offset:2560
  s_mul_i32 s80, s3, 3584
  v_exp_f32 v130, v130
  v_exp_f32 v131, v131
  v_exp_f32 v132, v132
  v_mfma_f32_32x32x4_2b_bf16 v[96:127], v[176:177], v[160:161], 0 cbsz:1
  v_exp_f32 v133, v133
  v_exp_f32 v134, v134
  v_exp_f32 v135, v135
  v_exp_f32 v136, v136
  v_exp_f32 v137, v137
  v_exp_f32 v138, v138
  v_exp_f32 v139, v139
  v_exp_f32 v140, v140
  v_smfmac_f32_32x32x32_bf16 v[64:79], v[238:241], v[128:135], v18
  s_add_u32 s24, s60, s83
  s_addc_u32 s25, s61, 0
  global_load_dwordx4 a[80:83], v11, s[24:25] offset:0 sc1
  v_exp_f32 v141, v141
  v_exp_f32 v142, v142
  v_exp_f32 v143, v143
  v_exp_f32 v144, v144
  v_exp_f32 v145, v145
  v_exp_f32 v146, v146
  v_exp_f32 v147, v147
  v_mfma_f32_32x32x16_bf16 v[96:111], v[164:167], a[240:243], v[96:111]
  s_add_u32 s80, s80, s81
  v_exp_f32 v148, v148
  v_exp_f32 v149, v149
  v_exp_f32 v150, v150
  v_smfmac_f32_32x32x32_bf16 v[64:79], v[242:245], v[136:143], v18
  global_load_dwordx4 a[84:87], v11, s[24:25] offset:1024 sc1
  s_add_u32 s22, s60, s80
  s_addc_u32 s23, s61, 0
  v_exp_f32 v151, v151
  v_exp_f32 v152, v152
  v_exp_f32 v153, v153
  v_mfma_f32_32x32x16_bf16 v[112:127], v[164:167], a[244:247], v[112:127]
  v_exp_f32 v154, v154
  v_exp_f32 v155, v155
  v_exp_f32 v156, v156
  v_smfmac_f32_32x32x32_bf16 v[80:95], v[238:241], v[144:151], v18
  global_load_dwordx4 v[192:195], v11, s[22:23]
  s_add_u32 s3, s3, 1
  v_exp_f32 v157, v157
  v_exp_f32 v158, v158
  v_exp_f32 v159, v159
  v_exp_f32 v96, v96
  v_exp_f32 v97, v97
  v_smfmac_f32_32x32x32_bf16 v[80:95], v[242:245], v[152:159], v18
  global_load_dwordx4 a[88:91], v11, s[24:25] offset:2048 sc1
  v_exp_f32 v98, v98
  v_exp_f32 v99, v99
  v_exp_f32 v100, v100
  v_mfma_f32_32x32x4_2b_bf16 v[128:159], v[176:177], v[162:163], 0 cbsz:1
  v_exp_f32 v101, v101
  v_exp_f32 v102, v102
  v_exp_f32 v103, v103
  v_exp_f32 v104, v104
  v_exp_f32 v105, v105
  v_exp_f32 v106, v106
  v_exp_f32 v107, v107
  v_exp_f32 v108, v108
  s_waitcnt vmcnt(14)
  v_smfmac_f32_32x32x32_bf16 v[32:47], v[168:171], v[96:103], v18
  global_load_dwordx2 v[204:205], v17, s[22:23]
  s_and_b32 s3, s3, 31
  v_exp_f32 v109, v109
  v_exp_f32 v110, v110
  v_exp_f32 v111, v111
  v_exp_f32 v112, v112
  v_exp_f32 v113, v113
  v_exp_f32 v114, v114
  v_exp_f32 v115, v115
  v_mfma_f32_32x32x16_bf16 v[128:143], v[164:167], a[248:251], v[128:143]
  s_waitcnt vmcnt(13)
  v_exp_f32 v116, v116
  v_exp_f32 v117, v117
  v_exp_f32 v118, v118
  v_smfmac_f32_32x32x32_bf16 v[32:47], v[172:175], v[104:111], v18
  global_load_dwordx4 a[92:95], v11, s[24:25] offset:3072 sc1
  v_exp_f32 v119, v119
  v_exp_f32 v120, v120
  v_exp_f32 v121, v121
  v_mfma_f32_32x32x16_bf16 v[144:159], v[164:167], a[252:255], v[144:159]
  v_exp_f32 v122, v122
  v_exp_f32 v123, v123
  v_exp_f32 v124, v124
  v_smfmac_f32_32x32x32_bf16 v[48:63], v[168:171], v[112:119], v18
  global_load_dwordx4 v[196:199], v0, s[22:23] offset:1536
  v_exp_f32 v125, v125
  v_exp_f32 v126, v126
  v_exp_f32 v127, v127
  v_exp_f32 v128, v128
  v_exp_f32 v129, v129
  v_smfmac_f32_32x32x32_bf16 v[48:63], v[172:175], v[120:127], v18
  s_waitcnt vmcnt(10)
  s_add_u32 s83, s83, 4096
  global_load_dwordx4 v[200:203], v0, s[22:23] offset:2560
  s_mul_i32 s80, s3, 3584
  v_exp_f32 v130, v130
  v_exp_f32 v131, v131
  v_exp_f32 v132, v132
  v_mfma_f32_32x32x4_2b_bf16 v[96:127], v[190:191], v[160:161], 0 cbsz:1
  v_exp_f32 v133, v133
  v_exp_f32 v134, v134
  v_exp_f32 v135, v135
  v_exp_f32 v136, v136
  v_exp_f32 v137, v137
  v_exp_f32 v138, v138
  v_exp_f32 v139, v139
  v_exp_f32 v140, v140
  v_smfmac_f32_32x32x32_bf16 v[64:79], v[168:171], v[128:135], v18
  s_add_u32 s24, s60, s83
  s_addc_u32 s25, s61, 0
  global_load_dwordx4 a[96:99], v11, s[24:25] offset:0 sc1
  v_exp_f32 v141, v141
  v_exp_f32 v142, v142
  v_exp_f32 v143, v143
  v_exp_f32 v144, v144
  v_exp_f32 v145, v145
  v_exp_f32 v146, v146
  v_exp_f32 v147, v147
  v_mfma_f32_32x32x16_bf16 v[96:111], v[178:181], a[240:243], v[96:111]
  s_add_u32 s80, s80, s81
  v_exp_f32 v148, v148
  v_exp_f32 v149, v149
  v_exp_f32 v150, v150
  v_smfmac_f32_32x32x32_bf16 v[64:79], v[172:175], v[136:143], v18
  global_load_dwordx4 a[100:103], v11, s[24:25] offset:1024 sc1
  s_add_u32 s22, s60, s80
  s_addc_u32 s23, s61, 0
  v_exp_f32 v151, v151
  v_exp_f32 v152, v152
  v_exp_f32 v153, v153
  v_mfma_f32_32x32x16_bf16 v[112:127], v[178:181], a[244:247], v[112:127]
  v_exp_f32 v154, v154
  v_exp_f32 v155, v155
  v_exp_f32 v156, v156
  v_smfmac_f32_32x32x32_bf16 v[80:95], v[168:171], v[144:151], v18
  global_load_dwordx4 v[206:209], v11, s[22:23]
  s_add_u32 s3, s3, 1
  v_exp_f32 v157, v157
  v_exp_f32 v158, v158
  v_exp_f32 v159, v159
  v_exp_f32 v96, v96
  v_exp_f32 v97, v97
  v_smfmac_f32_32x32x32_bf16 v[80:95], v[172:175], v[152:159], v18
  global_load_dwordx4 a[104:107], v11, s[24:25] offset:2048 sc1
  v_exp_f32 v98, v98
  v_exp_f32 v99, v99
  v_exp_f32 v100, v100
  v_mfma_f32_32x32x4_2b_bf16 v[128:159], v[190:191], v[162:163], 0 cbsz:1
  v_exp_f32 v101, v101
  v_exp_f32 v102, v102
  v_exp_f32 v103, v103
  v_exp_f32 v104, v104
  v_exp_f32 v105, v105
  v_exp_f32 v106, v106
  v_exp_f32 v107, v107
  v_exp_f32 v108, v108
  s_waitcnt vmcnt(13)
  v_smfmac_f32_32x32x32_bf16 v[32:47], v[182:185], v[96:103], v18
  global_load_dwordx2 v[218:219], v17, s[22:23]
  s_and_b32 s3, s3, 31
  v_exp_f32 v109, v109
  v_exp_f32 v110, v110
  v_exp_f32 v111, v111
  v_exp_f32 v112, v112
  v_exp_f32 v113, v113
  v_exp_f32 v114, v114
  v_exp_f32 v115, v115
  v_mfma_f32_32x32x16_bf16 v[128:143], v[178:181], a[248:251], v[128:143]
  s_waitcnt vmcnt(13)
  v_exp_f32 v116, v116
  v_exp_f32 v117, v117
  v_exp_f32 v118, v118
  v_smfmac_f32_32x32x32_bf16 v[32:47], v[186:189], v[104:111], v18
  global_load_dwordx4 a[108:111], v11, s[24:25] offset:3072 sc1
  v_exp_f32 v119, v119
  v_exp_f32 v120, v120
  v_exp_f32 v121, v121
  v_mfma_f32_32x32x16_bf16 v[144:159], v[178:181], a[252:255], v[144:159]
  v_exp_f32 v122, v122
  v_exp_f32 v123, v123
  v_exp_f32 v124, v124
  v_smfmac_f32_32x32x32_bf16 v[48:63], v[182:185], v[112:119], v18
  global_load_dwordx4 v[210:213], v0, s[22:23] offset:1536
  v_exp_f32 v125, v125
  v_exp_f32 v126, v126
  v_exp_f32 v127, v127
  v_exp_f32 v128, v128
  v_exp_f32 v129, v129
  v_smfmac_f32_32x32x32_bf16 v[48:63], v[186:189], v[120:127], v18
  s_waitcnt vmcnt(10)
  s_add_u32 s83, s83, 4096
  global_load_dwordx4 v[214:217], v0, s[22:23] offset:2560
  s_mul_i32 s80, s3, 3584
  v_exp_f32 v130, v130
  v_exp_f32 v131, v131
  v_exp_f32 v132, v132
  v_mfma_f32_32x32x4_2b_bf16 v[96:127], v[204:205], v[160:161], 0 cbsz:1
  v_exp_f32 v133, v133
  v_exp_f32 v134, v134
  v_exp_f32 v135, v135
  v_exp_f32 v136, v136
  v_exp_f32 v137, v137
  v_exp_f32 v138, v138
  v_exp_f32 v139, v139
  v_exp_f32 v140, v140
  v_smfmac_f32_32x32x32_bf16 v[64:79], v[182:185], v[128:135], v18
  s_add_u32 s24, s60, s83
  s_addc_u32 s25, s61, 0
  global_load_dwordx4 a[112:115], v11, s[24:25] offset:0 sc1
  v_exp_f32 v141, v141
  v_exp_f32 v142, v142
  v_exp_f32 v143, v143
  v_exp_f32 v144, v144
  v_exp_f32 v145, v145
  v_exp_f32 v146, v146
  v_exp_f32 v147, v147
  v_mfma_f32_32x32x16_bf16 v[96:111], v[192:195], a[240:243], v[96:111]
  s_add_u32 s80, s80, s81
  v_exp_f32 v148, v148
  v_exp_f32 v149, v149
  v_exp_f32 v150, v150
  v_smfmac_f32_32x32x32_bf16 v[64:79], v[186:189], v[136:143], v18
  global_load_dwordx4 a[116:119], v11, s[24:25] offset:1024 sc1
  s_add_u32 s22, s60, s80
  s_addc_u32 s23, s61, 0
  v_exp_f32 v151, v151
  v_exp_f32 v152, v152
  v_exp_f32 v153, v153
  v_mfma_f32_32x32x16_bf16 v[112:127], v[192:195], a[244:247], v[112:127]
  v_exp_f32 v154, v154
  v_exp_f32 v155, v155
  v_exp_f32 v156, v156
  v_smfmac_f32_32x32x32_bf16 v[80:95], v[182:185], v[144:151], v18
  global_load_dwordx4 v[220:223], v11, s[22:23]
  s_add_u32 s3, s3, 1
  v_exp_f32 v157, v157
  v_exp_f32 v158, v158
  v_exp_f32 v159, v159
  v_exp_f32 v96, v96
  v_exp_f32 v97, v97
  v_smfmac_f32_32x32x32_bf16 v[80:95], v[186:189], v[152:159], v18
  global_load_dwordx4 a[120:123], v11, s[24:25] offset:2048 sc1
  v_exp_f32 v98, v98
  v_exp_f32 v99, v99
  v_exp_f32 v100, v100
  v_mfma_f32_32x32x4_2b_bf16 v[128:159], v[204:205], v[162:163], 0 cbsz:1
  v_exp_f32 v101, v101
  v_exp_f32 v102, v102
  v_exp_f32 v103, v103
  v_exp_f32 v104, v104
  v_exp_f32 v105, v105
  v_exp_f32 v106, v106
  v_exp_f32 v107, v107
  v_exp_f32 v108, v108
  s_waitcnt vmcnt(13)
  v_smfmac_f32_32x32x32_bf16 v[32:47], v[196:199], v[96:103], v18
  global_load_dwordx2 v[232:233], v17, s[22:23]
  s_and_b32 s3, s3, 31
  v_exp_f32 v109, v109
  v_exp_f32 v110, v110
  v_exp_f32 v111, v111
  v_exp_f32 v112, v112
  v_exp_f32 v113, v113
  v_exp_f32 v114, v114
  v_exp_f32 v115, v115
  v_mfma_f32_32x32x16_bf16 v[128:143], v[192:195], a[248:251], v[128:143]
  s_waitcnt vmcnt(13)
  v_exp_f32 v116, v116
  v_exp_f32 v117, v117
  v_exp_f32 v118, v118
  v_smfmac_f32_32x32x32_bf16 v[32:47], v[200:203], v[104:111], v18
  global_load_dwordx4 a[124:127], v11, s[24:25] offset:3072 sc1
  v_exp_f32 v119, v119
  v_exp_f32 v120, v120
  v_exp_f32 v121, v121
  v_mfma_f32_32x32x16_bf16 v[144:159], v[192:195], a[252:255], v[144:159]
  v_exp_f32 v122, v122
  v_exp_f32 v123, v123
  v_exp_f32 v124, v124
  v_smfmac_f32_32x32x32_bf16 v[48:63], v[196:199], v[112:119], v18
  global_load_dwordx4 v[224:227], v0, s[22:23] offset:1536
  v_exp_f32 v125, v125
  v_exp_f32 v126, v126
  v_exp_f32 v127, v127
  v_mov_b32 v12, 1073741824
  s_cmp_ge_u32 s69, 10
  s_cbranch_scc0 L_rtrB
  v_add_u32 v24, s84, v9
  ds_read_b64_tr_b16 a[216:217], v24 offset:0
  ds_read_b64_tr_b16 a[218:219], v24 offset:1280
  ds_read_b64_tr_b16 a[220:221], v24 offset:32
  ds_read_b64_tr_b16 a[222:223], v24 offset:1312
  ds_read_b64_tr_b16 a[224:225], v24 offset:64
  ds_read_b64_tr_b16 a[226:227], v24 offset:1344
  ds_read_b64_tr_b16 a[228:229], v24 offset:96
  ds_read_b64_tr_b16 a[230:231], v24 offset:1376
  ds_read_b64_tr_b16 a[232:233], v24 offset:128
  ds_read_b64_tr_b16 a[234:235], v24 offset:1408
  s_sub_u32 s15, s69, 10
  s_lshl_b32 s15, s15, 1
  s_add_u32 s15, s15, s70
  s_lshl_b32 s12, s71, 2
  s_add_u32 s12, s12, s68
  s_mul_i32 s13, s12, 61440
  s_mul_i32 s14, s15, 5120
  s_add_u32 s13, s13, s14
  s_add_u32 s13, s13, 25165824
  s_add_u32 s14, s13, 4096
  s_lshl_b32 s12, s12, 8
  s_lshl_b32 s15, s15, 4
  s_add_u32 s12, s12, s15
  s_add_u32 s16, s12, 19021824
  s_waitcnt lgkmcnt(8)
  buffer_store_dwordx4 a[216:219], v11, s[60:63], s13 offen offset:0 sc1
  s_waitcnt lgkmcnt(6)
  buffer_store_dwordx4 a[220:223], v11, s[60:63], s13 offen offset:1024 sc1
  s_waitcnt lgkmcnt(4)
  buffer_store_dwordx4 a[224:227], v11, s[60:63], s13 offen offset:2048 sc1
  s_waitcnt lgkmcnt(2)
  buffer_store_dwordx4 a[228:231], v11, s[60:63], s13 offen offset:3072 sc1
  s_waitcnt lgkmcnt(0)
  buffer_store_dwordx4 a[232:235], v11, s[60:63], s14 offen offset:0 sc1
  v_mov_b32 v12, 1073741824
  v_mov_b32 v20, s16
  v_cmp_eq_u32 vcc, 0, v1
  s_nop 1
  v_cndmask_b32 v12, v12, v20, vcc
L_rtrB:
  v_exp_f32 v128, v128
  v_exp_f32 v129, v129
  v_smfmac_f32_32x32x32_bf16 v[48:63], v[200:203], v[120:127], v18
  s_waitcnt vmcnt(10)
  s_add_u32 s83, s83, 4096
  global_load_dwordx4 v[228:231], v0, s[22:23] offset:2560
  s_mul_i32 s80, s3, 3584
  v_exp_f32 v130, v130
  v_exp_f32 v131, v131
  v_exp_f32 v132, v132
  v_mfma_f32_32x32x4_2b_bf16 v[96:127], v[218:219], v[160:161], 0 cbsz:1
  v_exp_f32 v133, v133
  v_exp_f32 v134, v134
  v_exp_f32 v135, v135
  v_exp_f32 v136, v136
  v_exp_f32 v137, v137
  v_exp_f32 v138, v138
  v_exp_f32 v139, v139
  v_exp_f32 v140, v140
  v_smfmac_f32_32x32x32_bf16 v[64:79], v[196:199], v[128:135], v18
  s_add_u32 s24, s60, s83
  s_addc_u32 s25, s61, 0
  global_load_dwordx4 a[128:131], v11, s[24:25] offset:0 sc1
  v_exp_f32 v141, v141
  v_exp_f32 v142, v142
  v_exp_f32 v143, v143
  v_exp_f32 v144, v144
  v_exp_f32 v145, v145
  v_exp_f32 v146, v146
  v_exp_f32 v147, v147
  v_mfma_f32_32x32x16_bf16 v[96:111], v[206:209], a[240:243], v[96:111]
  s_add_u32 s80, s80, s81
  v_exp_f32 v148, v148
  v_exp_f32 v149, v149
  v_exp_f32 v150, v150
  v_smfmac_f32_32x32x32_bf16 v[64:79], v[200:203], v[136:143], v18
  global_load_dwordx4 a[132:135], v11, s[24:25] offset:1024 sc1
  s_add_u32 s22, s60, s80
  s_addc_u32 s23, s61, 0
  v_exp_f32 v151, v151
  v_exp_f32 v152, v152
  v_exp_f32 v153, v153
  v_mfma_f32_32x32x16_bf16 v[112:127], v[206:209], a[244:247], v[112:127]
  v_exp_f32 v154, v154
  v_exp_f32 v155, v155
  v_exp_f32 v156, v156
  v_smfmac_f32_32x32x32_bf16 v[80:95], v[196:199], v[144:151], v18
  global_load_dwordx4 v[234:237], v11, s[22:23]
  s_add_u32 s3, s3, 1
  v_exp_f32 v157, v157
  v_exp_f32 v158, v158
  v_exp_f32 v159, v159
  v_exp_f32 v96, v96
  v_exp_f32 v97, v97
  v_smfmac_f32_32x32x32_bf16 v[80:95], v[200:203], v[152:159], v18
  global_load_dwordx4 a[136:139], v11, s[24:25] offset:2048 sc1
  v_exp_f32 v98, v98
  v_exp_f32 v99, v99
  v_exp_f32 v100, v100
  v_mfma_f32_32x32x4_2b_bf16 v[128:159], v[218:219], v[162:163], 0 cbsz:1
  v_exp_f32 v101, v101
  v_exp_f32 v102, v102
  v_exp_f32 v103, v103
  v_exp_f32 v104, v104
  v_exp_f32 v105, v105
  v_exp_f32 v106, v106
  v_exp_f32 v107, v107
  v_exp_f32 v108, v108
  s_waitcnt vmcnt(13)
  v_smfmac_f32_32x32x32_bf16 v[32:47], v[210:213], v[96:103], v18
  global_load_dwordx2 v[246:247], v17, s[22:23]
  s_and_b32 s3, s3, 31
  v_exp_f32 v109, v109
  v_exp_f32 v110, v110
  v_exp_f32 v111, v111
  v_exp_f32 v112, v112
  v_exp_f32 v113, v113
  v_exp_f32 v114, v114
  v_exp_f32 v115, v115
  v_mfma_f32_32x32x16_bf16 v[128:143], v[206:209], a[248:251], v[128:143]
  s_waitcnt vmcnt(13)
  v_exp_f32 v116, v116
  v_exp_f32 v117, v117
  v_exp_f32 v118, v118
  v_smfmac_f32_32x32x32_bf16 v[32:47], v[214:217], v[104:111], v18
  global_load_dwordx4 a[140:143], v11, s[24:25] offset:3072 sc1
  v_exp_f32 v119, v119
  v_exp_f32 v120, v120
  v_exp_f32 v121, v121
  v_mfma_f32_32x32x16_bf16 v[144:159], v[206:209], a[252:255], v[144:159]
  v_exp_f32 v122, v122
  v_exp_f32 v123, v123
  v_exp_f32 v124, v124
  v_smfmac_f32_32x32x32_bf16 v[48:63], v[210:213], v[112:119], v18
  global_load_dwordx4 v[238:241], v0, s[22:23] offset:1536
  v_exp_f32 v125, v125
  v_exp_f32 v126, v126
  v_exp_f32 v127, v127
  v_exp_f32 v128, v128
  v_exp_f32 v129, v129
  v_smfmac_f32_32x32x32_bf16 v[48:63], v[214:217], v[120:127], v18
  s_waitcnt vmcnt(10)
  s_add_u32 s83, s83, 4096
  global_load_dwordx4 v[242:245], v0, s[22:23] offset:2560
  s_mul_i32 s80, s3, 3584
  v_exp_f32 v130, v130
  v_exp_f32 v131, v131
  v_exp_f32 v132, v132
  v_mfma_f32_32x32x4_2b_bf16 v[96:127], v[232:233], v[160:161], 0 cbsz:1
  v_exp_f32 v133, v133
  v_exp_f32 v134, v134
  v_exp_f32 v135, v135
  v_exp_f32 v136, v136
  v_exp_f32 v137, v137
  v_exp_f32 v138, v138
  v_exp_f32 v139, v139
  v_exp_f32 v140, v140
  v_smfmac_f32_32x32x32_bf16 v[64:79], v[210:213], v[128:135], v18
  s_add_u32 s24, s60, s83
  s_addc_u32 s25, s61, 0
  global_load_dwordx4 a[144:147], v11, s[24:25] offset:0 sc1
  v_exp_f32 v141, v141
  v_exp_f32 v142, v142
  v_exp_f32 v143, v143
  v_exp_f32 v144, v144
  v_exp_f32 v145, v145
  v_exp_f32 v146, v146
  v_exp_f32 v147, v147
  v_mfma_f32_32x32x16_bf16 v[96:111], v[220:223], a[240:243], v[96:111]
  s_add_u32 s80, s80, s81
  v_exp_f32 v148, v148
  v_exp_f32 v149, v149
  v_exp_f32 v150, v150
  v_smfmac_f32_32x32x32_bf16 v[64:79], v[214:217], v[136:143], v18
  global_load_dwordx4 a[148:151], v11, s[24:25] offset:1024 sc1
  s_add_u32 s22, s60, s80
  s_addc_u32 s23, s61, 0
  v_exp_f32 v151, v151
  v_exp_f32 v152, v152
  v_exp_f32 v153, v153
  v_mfma_f32_32x32x16_bf16 v[112:127], v[220:223], a[244:247], v[112:127]
  v_exp_f32 v154, v154
  v_exp_f32 v155, v155
  v_exp_f32 v156, v156
  v_smfmac_f32_32x32x32_bf16 v[80:95], v[210:213], v[144:151], v18
  global_load_dwordx4 v[164:167], v11, s[22:23]
  s_add_u32 s3, s3, 1
  v_exp_f32 v157, v157
  v_exp_f32 v158, v158
  v_exp_f32 v159, v159
  v_exp_f32 v96, v96
  v_exp_f32 v97, v97
  v_smfmac_f32_32x32x32_bf16 v[80:95], v[214:217], v[152:159], v18
  global_load_dwordx4 a[152:155], v11, s[24:25] offset:2048 sc1
  v_exp_f32 v98, v98
  v_exp_f32 v99, v99
  v_exp_f32 v100, v100
  v_mfma_f32_32x32x4_2b_bf16 v[128:159], v[232:233], v[162:163], 0 cbsz:1
  v_exp_f32 v101, v101
  v_exp_f32 v102, v102
  v_exp_f32 v103, v103
  v_exp_f32 v104, v104
  v_exp_f32 v105, v105
  v_exp_f32 v106, v106
  v_exp_f32 v107, v107
  v_exp_f32 v108, v108
  s_waitcnt vmcnt(13)
  v_smfmac_f32_32x32x32_bf16 v[32:47], v[224:227], v[96:103], v18
  global_load_dwordx2 v[176:177], v17, s[22:23]
  s_and_b32 s3, s3, 31
  v_exp_f32 v109, v109
  v_exp_f32 v110, v110
  v_exp_f32 v111, v111
  v_exp_f32 v112, v112
  v_exp_f32 v113, v113
  v_exp_f32 v114, v114
  v_exp_f32 v115, v115
  v_mfma_f32_32x32x16_bf16 v[128:143], v[220:223], a[248:251], v[128:143]
  s_waitcnt vmcnt(13)
  v_exp_f32 v116, v116
  v_exp_f32 v117, v117
  v_exp_f32 v118, v118
  v_smfmac_f32_32x32x32_bf16 v[32:47], v[228:231], v[104:111], v18
  global_load_dwordx4 a[156:159], v11, s[24:25] offset:3072 sc1
  v_exp_f32 v119, v119
  v_exp_f32 v120, v120
  v_exp_f32 v121, v121
  v_mfma_f32_32x32x16_bf16 v[144:159], v[220:223], a[252:255], v[144:159]
  v_exp_f32 v122, v122
  v_exp_f32 v123, v123
  v_exp_f32 v124, v124
  v_smfmac_f32_32x32x32_bf16 v[48:63], v[224:227], v[112:119], v18
  global_load_dwordx4 v[168:171], v0, s[22:23] offset:1536
  v_exp_f32 v125, v125
  v_exp_f32 v126, v126
  v_exp_f32 v127, v127
  v_exp_f32 v128, v128
  v_exp_f32 v129, v129
  v_smfmac_f32_32x32x32_bf16 v[48:63], v[228:231], v[120:127], v18
  s_waitcnt vmcnt(10)
  s_add_u32 s83, s83, 4096
  global_load_dwordx4 v[172:175], v0, s[22:23] offset:2560
  s_mul_i32 s80, s3, 3584
  v_exp_f32 v130, v130
  v_exp_f32 v131, v131
  v_exp_f32 v132, v132
  v_mfma_f32_32x32x4_2b_bf16 v[96:127], v[246:247], v[160:161], 0 cbsz:1
  v_exp_f32 v133, v133
  v_exp_f32 v134, v134
  v_exp_f32 v135, v135
  v_exp_f32 v136, v136
  v_exp_f32 v137, v137
  v_exp_f32 v138, v138
  v_exp_f32 v139, v139
  v_exp_f32 v140, v140
  v_smfmac_f32_32x32x32_bf16 v[64:79], v[224:227], v[128:135], v18
  s_add_u32 s24, s60, s83
  s_addc_u32 s25, s61, 0
  global_load_dwordx4 a[160:163], v11, s[24:25] offset:0 sc1
  v_exp_f32 v141, v141
  v_exp_f32 v142, v142
  v_exp_f32 v143, v143
  v_exp_f32 v144, v144
  v_exp_f32 v145, v145
  v_exp_f32 v146, v146
  v_exp_f32 v147, v147
  v_mfma_f32_32x32x16_bf16 v[96:111], v[234:237], a[240:243], v[96:111]
  s_add_u32 s80, s80, s81
  v_exp_f32 v148, v148
  v_exp_f32 v149, v149
  v_exp_f32 v150, v150
  v_smfmac_f32_32x32x32_bf16 v[64:79], v[228:231], v[136:143], v18
  global_load_dwordx4 a[164:167], v11, s[24:25] offset:1024 sc1
  s_add_u32 s22, s60, s80
  s_addc_u32 s23, s61, 0
  v_exp_f32 v151, v151
  v_exp_f32 v152, v152
  v_exp_f32 v153, v153
  v_mfma_f32_32x32x16_bf16 v[112:127], v[234:237], a[244:247], v[112:127]
  v_exp_f32 v154, v154
  v_exp_f32 v155, v155
  v_exp_f32 v156, v156
  v_smfmac_f32_32x32x32_bf16 v[80:95], v[224:227], v[144:151], v18
  global_load_dwordx4 v[178:181], v11, s[22:23]
  s_add_u32 s3, s3, 1
  v_exp_f32 v157, v157
  v_exp_f32 v158, v158
  v_exp_f32 v159, v159
  v_exp_f32 v96, v96
  v_exp_f32 v97, v97
  v_smfmac_f32_32x32x32_bf16 v[80:95], v[228:231], v[152:159], v18
  global_load_dwordx4 a[168:171], v11, s[24:25] offset:2048 sc1
  v_exp_f32 v98, v98
  v_exp_f32 v99, v99
  v_exp_f32 v100, v100
  v_mfma_f32_32x32x4_2b_bf16 v[128:159], v[246:247], v[162:163], 0 cbsz:1
  v_exp_f32 v101, v101
  v_exp_f32 v102, v102
  v_exp_f32 v103, v103
  v_exp_f32 v104, v104
  v_exp_f32 v105, v105
  v_exp_f32 v106, v106
  v_exp_f32 v107, v107
  v_exp_f32 v108, v108
  s_waitcnt vmcnt(13)
  v_smfmac_f32_32x32x32_bf16 v[32:47], v[238:241], v[96:103], v18
  global_load_dwordx2 v[190:191], v17, s[22:23]
  s_and_b32 s3, s3, 31
  v_exp_f32 v109, v109
  v_exp_f32 v110, v110
  v_exp_f32 v111, v111
  v_exp_f32 v112, v112
  v_exp_f32 v113, v113
  v_exp_f32 v114, v114
  v_exp_f32 v115, v115
  v_mfma_f32_32x32x16_bf16 v[128:143], v[234:237], a[248:251], v[128:143]
  s_waitcnt vmcnt(13)
  v_exp_f32 v116, v116
  v_exp_f32 v117, v117
  v_exp_f32 v118, v118
  v_smfmac_f32_32x32x32_bf16 v[32:47], v[242:245], v[104:111], v18
  global_load_dwordx4 a[172:175], v11, s[24:25] offset:3072 sc1
  v_exp_f32 v119, v119
  v_exp_f32 v120, v120
  v_exp_f32 v121, v121
  v_mfma_f32_32x32x16_bf16 v[144:159], v[234:237], a[252:255], v[144:159]
  v_exp_f32 v122, v122
  v_exp_f32 v123, v123
  v_exp_f32 v124, v124
  v_smfmac_f32_32x32x32_bf16 v[48:63], v[238:241], v[112:119], v18
  global_load_dwordx4 v[182:185], v0, s[22:23] offset:1536
  v_exp_f32 v125, v125
  v_exp_f32 v126, v126
  v_exp_f32 v127, v127
  v_exp_f32 v128, v128
  v_exp_f32 v129, v129
  v_smfmac_f32_32x32x32_bf16 v[48:63], v[242:245], v[120:127], v18
  s_waitcnt vmcnt(10)
  s_add_u32 s83, s83, 4096
  global_load_dwordx4 v[186:189], v0, s[22:23] offset:2560
  v_exp_f32 v130, v130
  v_exp_f32 v131, v131
  v_exp_f32 v132, v132
  v_mfma_f32_32x32x4_2b_bf16 v[96:127], v[176:177], v[160:161], 0 cbsz:1
  v_exp_f32 v133, v133
  v_exp_f32 v134, v134
  v_exp_f32 v135, v135
  v_exp_f32 v136, v136
  v_exp_f32 v137, v137
  v_exp_f32 v138, v138
  v_exp_f32 v139, v139
  v_exp_f32 v140, v140
  v_smfmac_f32_32x32x32_bf16 v[64:79], v[238:241], v[128:135], v18
  s_add_u32 s24, s60, s83
  s_addc_u32 s25, s61, 0
  global_load_dwordx4 a[176:179], v11, s[24:25] offset:0 sc1
  v_exp_f32 v141, v141
  v_exp_f32 v142, v142
  v_exp_f32 v143, v143
  v_exp_f32 v144, v144
  v_exp_f32 v145, v145
  v_exp_f32 v146, v146
  v_exp_f32 v147, v147
  v_mfma_f32_32x32x16_bf16 v[96:111], v[164:167], a[240:243], v[96:111]
  v_exp_f32 v148, v148
  v_exp_f32 v149, v149
  v_exp_f32 v150, v150
  v_smfmac_f32_32x32x32_bf16 v[64:79], v[242:245], v[136:143], v18
  global_load_dwordx4 a[180:183], v11, s[24:25] offset:1024 sc1
  v_exp_f32 v151, v151
  v_exp_f32 v152, v152
  v_exp_f32 v153, v153
  v_mfma_f32_32x32x16_bf16 v[112:127], v[164:167], a[244:247], v[112:127]
  v_exp_f32 v154, v154
  v_exp_f32 v155, v155
  v_exp_f32 v156, v156
  v_smfmac_f32_32x32x32_bf16 v[80:95], v[238:241], v[144:151], v18
  buffer_store_dword v19, v12, s[60:63], 0 offen offset:0 sc1
  v_exp_f32 v157, v157
  v_exp_f32 v158, v158
  v_exp_f32 v159, v159
  v_exp_f32 v96, v96
  v_exp_f32 v97, v97
  v_smfmac_f32_32x32x32_bf16 v[80:95], v[242:245], v[152:159], v18
  global_load_dwordx4 a[184:187], v11, s[24:25] offset:2048 sc1
  v_exp_f32 v98, v98
  v_exp_f32 v99, v99
  v_exp_f32 v100, v100
  v_mfma_f32_32x32x4_2b_bf16 v[128:159], v[176:177], v[162:163], 0 cbsz:1
  v_exp_f32 v101, v101
  v_exp_f32 v102, v102
  v_exp_f32 v103, v103
  v_exp_f32 v104, v104
  v_exp_f32 v105, v105
  v_exp_f32 v106, v106
  v_exp_f32 v107, v107
  v_exp_f32 v108, v108
  s_waitcnt vmcnt(13)
  v_smfmac_f32_32x32x32_bf16 v[32:47], v[168:171], v[96:103], v18
  s_nop 0
  buffer_load_dwordx2 a[192:193], v14, s[28:31], 0 offen offset:0
  v_exp_f32 v109, v109
  v_exp_f32 v110, v110
  v_exp_f32 v111, v111
  v_exp_f32 v112, v112
  v_exp_f32 v113, v113
  v_exp_f32 v114, v114
  v_exp_f32 v115, v115
  v_mfma_f32_32x32x16_bf16 v[128:143], v[164:167], a[248:251], v[128:143]
  s_waitcnt vmcnt(13)
  v_exp_f32 v116, v116
  v_exp_f32 v117, v117
  v_exp_f32 v118, v118
  v_smfmac_f32_32x32x32_bf16 v[32:47], v[172:175], v[104:111], v18
  global_load_dwordx4 a[188:191], v11, s[24:25] offset:3072 sc1
  v_exp_f32 v119, v119
  v_exp_f32 v120, v120
  v_exp_f32 v121, v121
  v_mfma_f32_32x32x16_bf16 v[144:159], v[164:167], a[252:255], v[144:159]
  v_exp_f32 v122, v122
  v_exp_f32 v123, v123
  v_exp_f32 v124, v124
  v_smfmac_f32_32x32x32_bf16 v[48:63], v[168:171], v[112:119], v18
  buffer_load_dwordx2 a[194:195], v14, s[28:31], 0 offen offset:32
  v_exp_f32 v125, v125
  v_exp_f32 v126, v126
  v_exp_f32 v127, v127
  v_exp_f32 v128, v128
  v_exp_f32 v129, v129
  v_smfmac_f32_32x32x32_bf16 v[48:63], v[172:175], v[120:127], v18
  s_waitcnt vmcnt(10)
  s_add_u32 s83, s83, 4096
  buffer_load_dwordx2 a[196:197], v14, s[28:31], 0 offen offset:64
  v_exp_f32 v130, v130
  v_exp_f32 v131, v131
  v_exp_f32 v132, v132
  v_mfma_f32_32x32x4_2b_bf16 v[96:127], v[190:191], v[162:163], 0 cbsz:1
  v_exp_f32 v133, v133
  v_exp_f32 v134, v134
  v_exp_f32 v135, v135
  v_exp_f32 v136, v136
  v_exp_f32 v137, v137
  v_exp_f32 v138, v138
  v_exp_f32 v139, v139
  v_exp_f32 v140, v140
  v_smfmac_f32_32x32x32_bf16 v[64:79], v[168:171], v[128:135], v18
  s_nop 0
  buffer_load_dwordx2 a[198:199], v14, s[28:31], 0 offen offset:96
  v_exp_f32 v141, v141
  v_exp_f32 v142, v142
  v_exp_f32 v143, v143
  v_exp_f32 v144, v144
  v_exp_f32 v145, v145
  v_exp_f32 v146, v146
  v_exp_f32 v147, v147
  v_mfma_f32_32x32x16_bf16 v[96:111], v[178:181], a[248:251], v[96:111]
  v_exp_f32 v148, v148
  v_exp_f32 v149, v149
  v_exp_f32 v150, v150
  v_smfmac_f32_32x32x32_bf16 v[64:79], v[172:175], v[136:143], v18
  buffer_load_dwordx2 a[200:201], v14, s[28:31], 0 offen offset:128
  v_exp_f32 v151, v151
  v_exp_f32 v152, v152
  v_exp_f32 v153, v153
  v_mfma_f32_32x32x16_bf16 v[112:127], v[178:181], a[252:255], v[112:127]
  v_exp_f32 v154, v154
  v_exp_f32 v155, v155
  v_exp_f32 v156, v156
  v_smfmac_f32_32x32x32_bf16 v[80:95], v[168:171], v[144:151], v18
  v_exp_f32 v157, v157
  v_exp_f32 v158, v158
  v_exp_f32 v159, v159
  v_exp_f32 v96, v96
  v_exp_f32 v97, v97
  v_smfmac_f32_32x32x32_bf16 v[80:95], v[172:175], v[152:159], v18
  v_exp_f32 v98, v98
  v_exp_f32 v99, v99
  v_exp_f32 v100, v100
  v_mfma_f32_32x32x4_2b_bf16 v[128:159], v[190:191], v[160:161], 0 cbsz:1
  v_exp_f32 v101, v101
  v_exp_f32 v102, v102
  v_exp_f32 v103, v103
  v_exp_f32 v104, v104
  v_exp_f32 v105, v105
  v_exp_f32 v106, v106
  v_exp_f32 v107, v107
  v_exp_f32 v108, v108
  s_waitcnt vmcnt(11)
  v_smfmac_f32_32x32x32_bf16 v[64:79], v[182:185], v[96:103], v18
  s_nop 0
  s_nop 0
  v_exp_f32 v109, v109
  v_exp_f32 v110, v110
  v_exp_f32 v111, v111
  v_exp_f32 v112, v112
  v_exp_f32 v113, v113
  v_exp_f32 v114, v114
  v_exp_f32 v115, v115
  v_mfma_f32_32x32x16_bf16 v[128:143], v[178:181], a[240:243], v[128:143]
  s_waitcnt vmcnt(10)
  v_exp_f32 v116, v116
  v_exp_f32 v117, v117
  v_exp_f32 v118, v118
  v_smfmac_f32_32x32x32_bf16 v[64:79], v[186:189], v[104:111], v18
  v_exp_f32 v119, v119
  v_exp_f32 v120, v120
  v_exp_f32 v121, v121
  v_mfma_f32_32x32x16_bf16 v[144:159], v[178:181], a[244:247], v[144:159]
  v_exp_f32 v122, v122
  v_exp_f32 v123, v123
  v_exp_f32 v124, v124
  v_smfmac_f32_32x32x32_bf16 v[80:95], v[182:185], v[112:119], v18
  v_exp_f32 v125, v125
  v_exp_f32 v126, v126
  v_exp_f32 v127, v127
  v_exp_f32 v128, v128
  v_exp_f32 v129, v129
  v_smfmac_f32_32x32x32_bf16 v[80:95], v[186:189], v[120:127], v18
  ds_write_b128 v248, v[64:67] offset:0
  ds_write_b128 v248, v[68:71] offset:1024
  v_exp_f32 v130, v130
  v_exp_f32 v131, v131
  v_exp_f32 v132, v132
  v_exp_f32 v133, v133
  v_exp_f32 v134, v134
  v_exp_f32 v135, v135
  v_exp_f32 v136, v136
  v_exp_f32 v137, v137
  v_exp_f32 v138, v138
  v_exp_f32 v139, v139
  v_exp_f32 v140, v140
  v_smfmac_f32_32x32x32_bf16 v[32:47], v[182:185], v[128:135], v18
  ds_write_b128 v248, v[72:75] offset:2048
  ds_write_b128 v248, v[80:83] offset:3072
  v_exp_f32 v141, v141
  v_exp_f32 v142, v142
  v_exp_f32 v143, v143
  v_exp_f32 v144, v144
  v_exp_f32 v145, v145
  v_exp_f32 v146, v146
  v_exp_f32 v147, v147
  v_exp_f32 v148, v148
  v_exp_f32 v149, v149
  v_exp_f32 v150, v150
  v_smfmac_f32_32x32x32_bf16 v[32:47], v[186:189], v[136:143], v18
  ds_write_b128 v248, v[84:87] offset:4096
  ds_write_b128 v248, v[88:91] offset:5120
  v_exp_f32 v151, v151
  v_exp_f32 v152, v152
  v_exp_f32 v153, v153
  v_exp_f32 v154, v154
  v_exp_f32 v155, v155
  v_exp_f32 v156, v156
  v_smfmac_f32_32x32x32_bf16 v[48:63], v[182:185], v[144:151], v18
  v_exp_f32 v157, v157
  v_exp_f32 v158, v158
  v_exp_f32 v159, v159
  s_nop 1
  v_smfmac_f32_32x32x32_bf16 v[48:63], v[186:189], v[152:159], v18
L_guard:
  s_mov_b32 s4, 0x21800000
  s_mov_b32 s5, 0x5d800000
  s_lshl_b32 s6, s68, 2
  v_mov_b32 v26, s6
  v_add_u32 v26, 163584, v26
  v_min3_f32 v20, v72, v88, v40
  v_max3_f32 v21, v72, v88, v40
  v_add_f32 v22, v72, v88
  v_add_f32 v22, v22, v40
  s_nop 2
  v_min_f32 v20, v20, v56
  v_max_f32 v21, v21, v56
  v_add_f32 v22, v22, v56
  v_cmp_ge_f32 vcc, v20, s4
  v_cmp_le_f32 s[94:95], v21, s5
  v_cmp_o_f32 s[96:97], v22, v22
  s_nop 2
  s_and_b32 s95, s95, vcc_hi
  s_and_b32 s95, s95, s97
  s_cmp_eq_u32 s95, -1
  s_cselect_b32 s4, 0, 1
  v_mov_b32 v25, s4
  ds_write_b32 v26, v25
  v_mov_b32 v26, 163584
  s_waitcnt lgkmcnt(0)
  s_barrier
  ds_read_b128 v[120:123], v26
  ds_read_b128 v[96:99], v249 offset:0
  ds_read_b128 v[100:103], v249 offset:1024
  ds_read_b128 v[104:107], v249 offset:2048
  ds_read_b128 v[108:111], v249 offset:3072
  ds_read_b128 v[112:115], v249 offset:4096
  ds_read_b128 v[116:119], v249 offset:5120
  s_waitcnt lgkmcnt(6)
  v_or3_b32 v25, v120, v121, v122
  v_or_b32 v25, v25, v123
  s_nop 0
  v_readfirstlane_b32 s4, v25
  s_xor_b32 s5, s82, 1
  s_waitcnt lgkmcnt(3)
  v_add_f32 v22, v40, v104
  v_mov_b32 v20, v22
  s_waitcnt lgkmcnt(0)
  v_add_f32 v23, v56, v116
  v_mov_b32 v21, v23
  s_and_b32 s4, s4, s5
  s_cmp_lg_u32 s4, 0
  s_cbranch_scc1 L_slow
  v_permlane32_swap_b32 v20, v22
  v_permlane32_swap_b32 v21, v23
  v_rcp_f32 v22, v22
  v_rcp_f32 v23, v23
  v_pk_add_f32 v[32:33], v[32:33], v[96:97]
  v_pk_add_f32 v[34:35], v[34:35], v[98:99]
  v_pk_add_f32 v[36:37], v[36:37], v[100:101]
  v_pk_add_f32 v[38:39], v[38:39], v[102:103]
  v_pk_add_f32 v[40:41], v[40:41], v[104:105]
  v_pk_add_f32 v[42:43], v[42:43], v[106:107]
  v_pk_add_f32 v[48:49], v[48:49], v[108:109]
  v_pk_add_f32 v[50:51], v[50:51], v[110:111]
  v_pk_add_f32 v[52:53], v[52:53], v[112:113]
  v_pk_add_f32 v[54:55], v[54:55], v[114:115]
  v_pk_add_f32 v[56:57], v[56:57], v[116:117]
  v_pk_add_f32 v[58:59], v[58:59], v[118:119]
  v_pk_mul_f32 v[32:33], v[32:33], v[22:23] op_sel:[0,0] op_sel_hi:[1,0]
  v_pk_mul_f32 v[34:35], v[34:35], v[22:23] op_sel:[0,0] op_sel_hi:[1,0]
  v_pk_mul_f32 v[36:37], v[36:37], v[22:23] op_sel:[0,0] op_sel_hi:[1,0]
  v_pk_mul_f32 v[38:39], v[38:39], v[22:23] op_sel:[0,0] op_sel_hi:[1,0]
  v_pk_mul_f32 v[40:41], v[40:41], v[22:23] op_sel:[0,0] op_sel_hi:[1,0]
  v_pk_mul_f32 v[42:43], v[42:43], v[22:23] op_sel:[0,0] op_sel_hi:[1,0]
  v_pk_mul_f32 v[48:49], v[48:49], v[22:23] op_sel:[0,1] op_sel_hi:[1,1]
  v_pk_mul_f32 v[50:51], v[50:51], v[22:23] op_sel:[0,1] op_sel_hi:[1,1]
  v_pk_mul_f32 v[52:53], v[52:53], v[22:23] op_sel:[0,1] op_sel_hi:[1,1]
  v_pk_mul_f32 v[54:55], v[54:55], v[22:23] op_sel:[0,1] op_sel_hi:[1,1]
  v_pk_mul_f32 v[56:57], v[56:57], v[22:23] op_sel:[0,1] op_sel_hi:[1,1]
  v_pk_mul_f32 v[58:59], v[58:59], v[22:23] op_sel:[0,1] op_sel_hi:[1,1]
  v_cvt_pk_bf16_f32 v124, v32, v33
  v_cvt_pk_bf16_f32 v125, v34, v35
  v_cvt_pk_bf16_f32 v126, v36, v37
  v_cvt_pk_bf16_f32 v127, v38, v39
  v_cvt_pk_bf16_f32 v128, v40, v41
  v_cvt_pk_bf16_f32 v129, v42, v43
  v_cvt_pk_bf16_f32 v130, v48, v49
  v_cvt_pk_bf16_f32 v131, v50, v51
  v_cvt_pk_bf16_f32 v132, v52, v53
  v_cvt_pk_bf16_f32 v133, v54, v55
  v_cvt_pk_bf16_f32 v136, v56, v57
  v_cvt_pk_bf16_f32 v137, v58, v59
  v_permlane32_swap_b32 v124, v126
  v_permlane32_swap_b32 v125, v127
  v_permlane32_swap_b32 v130, v132
  v_permlane32_swap_b32 v131, v133
  s_nop 0
  v_permlane32_swap_b32 v128, v132
  v_permlane32_swap_b32 v129, v133
  v_permlane32_swap_b32 v134, v136
  v_permlane32_swap_b32 v135, v137
  s_cmp_eq_u32 s1, 0
  s_cbranch_scc1 L_tailG
  buffer_store_dwordx4 v[124:127], v250, s[60:63], 0 offen sc1
  buffer_store_dwordx4 v[128:131], v250, s[60:63], 0 offen offset:512 sc1
  buffer_store_dwordx4 v[132:135], v251, s[60:63], 0 offen offset:768 sc1
  v_mov_b32 v232, s76
  v_mov_b32 v233, s76
  v_mov_b32 v234, s76
  v_mov_b32 v235, s76
  v_mov_b32 v24, 1073741824
  v_and_b32 v21, 1, v3
  v_cmp_eq_u32 vcc, 1, v21
  s_nop 1
  v_cndmask_b32 v246, v252, v24, vcc
  s_lshl_b32 s4, s90, 10
  s_lshl_b32 s5, s71, 3
  s_add_u32 s4, s4, s5
  s_add_u32 s4, s4, 10485760
  v_lshl_add_u32 v20, v2, 6, s4
  v_cmp_eq_u32 vcc, 0, v3
  s_nop 1
  v_cndmask_b32 v247, v24, v20, vcc
  s_or_b32 s4, s2, s68
  s_cmp_eq_u32 s4, 0
  s_mov_b32 s5, 1073741824
  s_cselect_b32 s4, 18874368, s5
  v_mov_b32 v26, 1073741824
  v_mov_b32 v20, s4
  v_cmp_eq_u32 vcc, 0, v1
  s_nop 1
  v_cndmask_b32 v26, v26, v20, vcc
  s_lshl_b32 s4, s90, 7
  s_lshl_b32 s5, s71, 4
  s_add_u32 s4, s4, s5
  s_add_u32 s4, s4, 18923520
  v_lshl_add_u32 v20, v2, 4, s17
  v_mov_b32 v27, v20
  v_mov_b32 v28, 1073741824
  v_mov_b32 v20, s4
  v_cmp_eq_u32 vcc, 0, v1
  s_nop 1
  v_cndmask_b32 v28, v28, v20, vcc
  s_mul_i32 s6, s90, 20480
  s_add_u32 s6, s6, 4194304
  v_add_u32 v12, 61440, v11
  s_mul_i32 s88, s68, 5120
  s_lshl_b32 s91, s69, 3
  s_mul_i32 s87, s91, 20480
  s_add_u32 s87, s87, s88
  s_add_u32 s87, s87, 7340032
  s_lshl_b32 s4, s91, 7
  s_add_u32 s4, s4, 18923520
  v_add_u32 v30, s4, v11
  s_lshl_b32 s10, s91, 10
  s_lshl_b32 s11, s68, 11
  s_add_u32 s10, s10, s11
  s_add_u32 s10, s10, 10485760
  v_lshlrev_b32 v31, 6, v2
  v_add_u32 v31, 65536, v31
  v_lshrrev_b32 v20, 2, v1
  v_and_b32 v21, 1, v1
  v_lshlrev_b32 v20, 6, v20
  v_lshl_add_u32 v20, v21, 3, v20
  s_lshl_b32 s11, s68, 4
  s_add_u32 s11, s11, 65536
  v_add_u32 v25, s11, v20
  v_min_u32 v20, 11, v2
  v_lshl_add_u32 v29, v20, 4, s27
  s_lshl_b32 s4, s73, 2
  s_add_u32 s4, s4, s68
  s_lshl_b32 s7, s4, 4
  s_mul_i32 s4, s4, 768
  s_mul_i32 s5, s91, 49152
  s_add_u32 s4, s4, s5
  s_add_u32 s4, s4, 11534336
  v_and_b32 v20, 1, v3
  v_lshrrev_b32 v21, 1, v3
  v_mul_u32_u24 v22, 49152, v20
  v_lshl_add_u32 v22, v21, 8, v22
  v_lshl_add_u32 v22, v2, 4, v22
  v_add_u32 v13, s4, v22
  v_mul_u32_u24 v21, 49152, v21
  v_lshl_add_u32 v21, v20, 3, v21
  v_lshl_add_u32 v20, v2, 4, v21
  v_add_u32 v14, s4, v20
  v_add_u32 v14, 512, v14
  s_lshl_b32 s4, s69, 12
  s_add_u32 s4, s4, s7
  s_add_u32 s4, s4, 18939904
  v_mov_b32 v15, 1073741824
  v_mov_b32 v20, s4
  v_cmp_eq_u32 vcc, 0, v1
  s_nop 1
  v_cndmask_b32 v15, v15, v20, vcc
  v_mov_b32 v16, 0xbfb8aa3b
  v_mov_b32 v20, 0xbf317218
  v_cmp_lt_u32 vcc, 31, v1
  s_nop 1
  v_cndmask_b32 v16, v16, v20, vcc
  s_mov_b32 s19, 0xbfb8aa3b
  s_mov_b32 s18, 0xbf317218
  v_and_b32 v20, 3, v1
  v_lshrrev_b32 v21, 2, v1
  v_min_u32 v21, 9, v21
  s_lshl_b32 s4, s68, 2
  v_add_u32 v20, s4, v20
  v_mul_u32_u24 v22, 576, v21
  v_lshl_add_u32 v18, v20, 4, v22
  v_add_u32 v18, 102400, v18
  v_mul_u32_u24 v22, 288, v3
  v_lshl_add_u32 v22, v2, 4, v22
  s_mul_i32 s4, s68, 5760
  s_add_u32 s4, s4, 102400
  v_add_u32 v17, s4, v22
  s_add_u32 s8, s91, s70
  s_lshl_b32 s4, s8, 4
  v_add_u32 v22, s4, v20
  v_mul_u32_u24 v22, 1280, v22
  v_lshl_add_u32 v22, v21, 4, v22
  s_mul_i32 s4, s71, 160
  v_add_u32 v22, s4, v22
  v_mov_b32 v23, 1073741824
  v_cmp_gt_u32 vcc, 40, v1
  s_nop 1
  v_cndmask_b32 v22, v23, v22, vcc
  v_accvgpr_write_b32 a252, v22
  s_mul_i32 s4, s8, 20480
  s_mul_i32 s5, s71, 2560
  s_add_u32 s4, s4, s5
  s_add_u32 s4, s4, 7340032
  v_lshlrev_b32 v22, 8, v21
  v_lshl_add_u32 v22, v20, 4, v22
  v_add_u32 v22, s4, v22
  v_cndmask_b32 v22, v23, v22, vcc
  v_accvgpr_write_b32 a253, v22
  s_mul_i32 s9, s8, 49152
  s_mul_i32 s5, s68, 12288
  s_add_u32 s9, s9, s5
  s_add_u32 s9, s9, 11534336
  v_mov_b32 v214, 0
  v_mov_b32 v215, 0
  v_mov_b32 v216, 0
  v_mov_b32 v217, 0
  s_waitcnt vmcnt(8)
  v_accvgpr_read_b32 v236, a192
  v_accvgpr_read_b32 v237, a193
  s_waitcnt vmcnt(6)
  v_accvgpr_read_b32 v238, a194
  v_accvgpr_read_b32 v239, a195
  s_waitcnt vmcnt(5)
  v_accvgpr_read_b32 v240, a196
  v_accvgpr_read_b32 v241, a197
  s_waitcnt vmcnt(4)
  v_accvgpr_read_b32 v242, a198
  v_accvgpr_read_b32 v243, a199
  s_waitcnt vmcnt(3)
  v_accvgpr_read_b32 v244, a200
  v_accvgpr_read_b32 v245, a201
  v_dot2_f32_bf16 v172, v236, s74, 0
  v_dot2_f32_bf16 v173, v236, s75, 0
  v_dot2_f32_bf16 v174, v237, s74, 0
  v_dot2_f32_bf16 v175, v237, s75, 0
  v_dot2_f32_bf16 v176, v238, s74, 0
  v_dot2_f32_bf16 v177, v238, s75, 0
  v_dot2_f32_bf16 v178, v239, s74, 0
  v_dot2_f32_bf16 v179, v239, s75, 0
  v_dot2_f32_bf16 v180, v240, s74, 0
  v_dot2_f32_bf16 v181, v240, s75, 0
  v_dot2_f32_bf16 v182, v241, s74, 0
  v_dot2_f32_bf16 v183, v241, s75, 0
  v_dot2_f32_bf16 v184, v242, s74, 0
  v_dot2_f32_bf16 v185, v242, s75, 0
  v_dot2_f32_bf16 v186, v243, s74, 0
  v_dot2_f32_bf16 v187, v243, s75, 0
  v_dot2_f32_bf16 v188, v244, s74, 0
  v_dot2_f32_bf16 v189, v244, s75, 0
  v_dot2_f32_bf16 v190, v245, s74, 0
  v_dot2_f32_bf16 v191, v245, s75, 0
  s_waitcnt vmcnt(0)
  buffer_store_dword v19, v253, s[60:63], 0 offen offset:0
  buffer_store_dword v19, v26, s[60:63], 0 offen sc1
  ds_read_b64_tr_b16 v[112:113], v9 offset:0
  ds_read_b64_tr_b16 v[114:115], v9 offset:1280
  ds_read_b64_tr_b16 v[116:117], v9 offset:32
  ds_read_b64_tr_b16 v[118:119], v9 offset:1312
  ds_read_b64_tr_b16 v[120:121], v9 offset:64
  ds_read_b64_tr_b16 v[122:123], v9 offset:1344
  ds_read_b64_tr_b16 v[124:125], v9 offset:96
  ds_read_b64_tr_b16 v[126:127], v9 offset:1376
  ds_read_b64_tr_b16 v[128:129], v9 offset:128
  ds_read_b64_tr_b16 v[130:131], v9 offset:1408
  ds_read_b64_tr_b16 v[132:133], v9 offset:5120
  ds_read_b64_tr_b16 v[134:135], v9 offset:6400
  ds_read_b64_tr_b16 v[136:137], v9 offset:5152
  ds_read_b64_tr_b16 v[138:139], v9 offset:6432
  s_mov_b32 s93, 0x40000
L_polloL:
  buffer_load_dword v20, v27, s[60:63], 0 offen offset:0 sc1
  s_waitcnt vmcnt(0)
  v_cmp_ne_u32 vcc, v20, v19
  s_nop 3
  s_cmp_eq_u64 vcc, 0
  s_cbranch_scc1 L_polloL_ok
  s_sub_u32 s93, s93, 1
  s_cbranch_scc0 L_polloL
L_polloL_ok:
  buffer_load_dwordx4 v[32:35], v11, s[60:63], s6 offen offset:0 sc1
  buffer_load_dwordx4 v[36:39], v11, s[60:63], s6 offen offset:1024 sc1
  buffer_load_dwordx4 v[40:43], v11, s[60:63], s6 offen offset:2048 sc1
  buffer_load_dwordx4 v[44:47], v11, s[60:63], s6 offen offset:3072 sc1
  s_add_u32 s6, s6, 4096
  buffer_load_dwordx4 v[48:51], v11, s[60:63], s6 offen offset:0 sc1
  buffer_load_dwordx4 v[52:55], v11, s[60:63], s6 offen offset:1024 sc1
  buffer_load_dwordx4 v[56:59], v11, s[60:63], s6 offen offset:2048 sc1
  buffer_load_dwordx4 v[60:63], v11, s[60:63], s6 offen offset:3072 sc1
  s_add_u32 s6, s6, 4096
  buffer_load_dwordx4 v[64:67], v11, s[60:63], s6 offen offset:0 sc1
  buffer_load_dwordx4 v[68:71], v11, s[60:63], s6 offen offset:1024 sc1
  buffer_load_dwordx4 v[72:75], v11, s[60:63], s6 offen offset:2048 sc1
  buffer_load_dwordx4 v[76:79], v11, s[60:63], s6 offen offset:3072 sc1
  s_add_u32 s6, s6, 4096
  buffer_load_dwordx4 v[80:83], v11, s[60:63], s6 offen offset:0 sc1
  buffer_load_dwordx4 v[84:87], v11, s[60:63], s6 offen offset:1024 sc1
  buffer_load_dwordx4 v[88:91], v11, s[60:63], s6 offen offset:2048 sc1
  buffer_load_dwordx4 v[92:95], v11, s[60:63], s6 offen offset:3072 sc1
  s_add_u32 s6, s6, 4096
  buffer_load_dwordx4 v[96:99], v11, s[60:63], s6 offen offset:0 sc1
  buffer_load_dwordx4 v[100:103], v11, s[60:63], s6 offen offset:1024 sc1
  buffer_load_dwordx4 v[104:107], v11, s[60:63], s6 offen offset:2048 sc1
  buffer_load_dwordx4 v[108:111], v11, s[60:63], s6 offen offset:3072 sc1
  s_waitcnt vmcnt(19) lgkmcnt(12)
  v_mfma_f32_16x16x32_bf16 v[172:175], v[112:115], v[32:35], v[172:175]
  s_waitcnt lgkmcnt(10)
  ds_read_b64_tr_b16 v[140:141], v9 offset:5184
  ds_read_b64_tr_b16 v[142:143], v9 offset:6464
  v_mfma_f32_16x16x32_bf16 v[176:179], v[116:119], v[32:35], v[176:179]
  s_waitcnt lgkmcnt(10)
  ds_read_b64_tr_b16 v[112:113], v9 offset:5216
  ds_read_b64_tr_b16 v[114:115], v9 offset:6496
  v_mfma_f32_16x16x32_bf16 v[180:183], v[120:123], v[32:35], v[180:183]
  s_waitcnt lgkmcnt(10)
  ds_read_b64_tr_b16 v[116:117], v9 offset:5248
  ds_read_b64_tr_b16 v[118:119], v9 offset:6528
  v_mfma_f32_16x16x32_bf16 v[184:187], v[124:127], v[32:35], v[184:187]
  s_waitcnt lgkmcnt(10)
  ds_read_b64_tr_b16 v[120:121], v9 offset:10240
  ds_read_b64_tr_b16 v[122:123], v9 offset:11520
  v_mfma_f32_16x16x32_bf16 v[188:191], v[128:131], v[32:35], v[188:191]
  s_waitcnt vmcnt(18) lgkmcnt(10)
  ds_read_b64_tr_b16 v[124:125], v9 offset:10272
  ds_read_b64_tr_b16 v[126:127], v9 offset:11552
  v_mfma_f32_16x16x32_bf16 v[172:175], v[132:135], v[36:39], v[172:175]
  s_waitcnt lgkmcnt(10)
  ds_read_b64_tr_b16 v[128:129], v9 offset:10304
  ds_read_b64_tr_b16 v[130:131], v9 offset:11584
  v_mfma_f32_16x16x32_bf16 v[176:179], v[136:139], v[36:39], v[176:179]
  s_waitcnt lgkmcnt(10)
  ds_read_b64_tr_b16 v[132:133], v9 offset:10336
  ds_read_b64_tr_b16 v[134:135], v9 offset:11616
  v_mfma_f32_16x16x32_bf16 v[180:183], v[140:143], v[36:39], v[180:183]
  s_waitcnt lgkmcnt(10)
  ds_read_b64_tr_b16 v[136:137], v9 offset:10368
  ds_read_b64_tr_b16 v[138:139], v9 offset:11648
  v_mfma_f32_16x16x32_bf16 v[184:187], v[112:115], v[36:39], v[184:187]
  s_waitcnt lgkmcnt(10)
  ds_read_b64_tr_b16 v[140:141], v9 offset:15360
  ds_read_b64_tr_b16 v[142:143], v9 offset:16640
  v_mfma_f32_16x16x32_bf16 v[188:191], v[116:119], v[36:39], v[188:191]
  s_waitcnt vmcnt(17) lgkmcnt(10)
  ds_read_b64_tr_b16 v[112:113], v9 offset:15392
  ds_read_b64_tr_b16 v[114:115], v9 offset:16672
  s_add_u32 s24, s60, s83
  s_addc_u32 s25, s61, 0
  global_load_dwordx4 a[192:195], v11, s[24:25] offset:0 sc1
  v_mfma_f32_16x16x32_bf16 v[172:175], v[120:123], v[40:43], v[172:175]
  s_waitcnt lgkmcnt(10)
  ds_read_b64_tr_b16 v[116:117], v9 offset:15424
  ds_read_b64_tr_b16 v[118:119], v9 offset:16704
  v_mfma_f32_16x16x32_bf16 v[176:179], v[124:127], v[40:43], v[176:179]
  s_waitcnt lgkmcnt(10)
  ds_read_b64_tr_b16 v[120:121], v9 offset:15456
  ds_read_b64_tr_b16 v[122:123], v9 offset:16736
  v_mfma_f32_16x16x32_bf16 v[180:183], v[128:131], v[40:43], v[180:183]
  s_waitcnt lgkmcnt(10)
  ds_read_b64_tr_b16 v[124:125], v9 offset:15488
  ds_read_b64_tr_b16 v[126:127], v9 offset:16768
  v_mfma_f32_16x16x32_bf16 v[184:187], v[132:135], v[40:43], v[184:187]
  s_waitcnt lgkmcnt(10)
  ds_read_b64_tr_b16 v[128:129], v9 offset:20480
  ds_read_b64_tr_b16 v[130:131], v9 offset:21760
  v_mfma_f32_16x16x32_bf16 v[188:191], v[136:139], v[40:43], v[188:191]
  s_waitcnt vmcnt(17) lgkmcnt(10)
  ds_read_b64_tr_b16 v[132:133], v9 offset:20512
  ds_read_b64_tr_b16 v[134:135], v9 offset:21792
  global_load_dwordx4 a[196:199], v11, s[24:25] offset:1024 sc1
  v_mfma_f32_16x16x32_bf16 v[172:175], v[140:143], v[44:47], v[172:175]
  s_waitcnt lgkmcnt(10)
  ds_read_b64_tr_b16 v[136:137], v9 offset:20544
  ds_read_b64_tr_b16 v[138:139], v9 offset:21824
  v_mfma_f32_16x16x32_bf16 v[176:179], v[112:115], v[44:47], v[176:179]
  s_waitcnt lgkmcnt(10)
  ds_read_b64_tr_b16 v[140:141], v9 offset:20576
  ds_read_b64_tr_b16 v[142:143], v9 offset:21856
  v_mfma_f32_16x16x32_bf16 v[180:183], v[116:119], v[44:47], v[180:183]
  s_waitcnt lgkmcnt(10)
  ds_read_b64_tr_b16 v[112:113], v9 offset:20608
  ds_read_b64_tr_b16 v[114:115], v9 offset:21888
  v_mfma_f32_16x16x32_bf16 v[184:187], v[120:123], v[44:47], v[184:187]
  s_waitcnt lgkmcnt(10)
  ds_read_b64_tr_b16 v[116:117], v9 offset:25600
  ds_read_b64_tr_b16 v[118:119], v9 offset:26880
  v_mfma_f32_16x16x32_bf16 v[188:191], v[124:127], v[44:47], v[188:191]
  s_waitcnt vmcnt(17) lgkmcnt(10)
  ds_read_b64_tr_b16 v[120:121], v9 offset:25632
  ds_read_b64_tr_b16 v[122:123], v9 offset:26912
  global_load_dwordx4 a[200:203], v11, s[24:25] offset:2048 sc1
  v_mfma_f32_16x16x32_bf16 v[172:175], v[128:131], v[48:51], v[172:175]
  s_waitcnt lgkmcnt(10)
  ds_read_b64_tr_b16 v[124:125], v9 offset:25664
  ds_read_b64_tr_b16 v[126:127], v9 offset:26944
  v_mfma_f32_16x16x32_bf16 v[176:179], v[132:135], v[48:51], v[176:179]
  s_waitcnt lgkmcnt(10)
  ds_read_b64_tr_b16 v[128:129], v9 offset:25696
  ds_read_b64_tr_b16 v[130:131], v9 offset:26976
  v_mfma_f32_16x16x32_bf16 v[180:183], v[136:139], v[48:51], v[180:183]
  s_waitcnt lgkmcnt(10)
  ds_read_b64_tr_b16 v[132:133], v9 offset:25728
  ds_read_b64_tr_b16 v[134:135], v9 offset:27008
  v_mfma_f32_16x16x32_bf16 v[184:187], v[140:143], v[48:51], v[184:187]
  s_waitcnt lgkmcnt(10)
  ds_read_b64_tr_b16 v[136:137], v9 offset:30720
  ds_read_b64_tr_b16 v[138:139], v9 offset:32000
  v_mfma_f32_16x16x32_bf16 v[188:191], v[112:115], v[48:51], v[188:191]
  s_waitcnt vmcnt(17) lgkmcnt(10)
  ds_read_b64_tr_b16 v[140:141], v9 offset:30752
  ds_read_b64_tr_b16 v[142:143], v9 offset:32032
  v_mfma_f32_16x16x32_bf16 v[172:175], v[116:119], v[52:55], v[172:175]
  s_waitcnt lgkmcnt(10)
  ds_read_b64_tr_b16 v[112:113], v9 offset:30784
  ds_read_b64_tr_b16 v[114:115], v9 offset:32064
  v_mfma_f32_16x16x32_bf16 v[176:179], v[120:123], v[52:55], v[176:179]
  s_waitcnt lgkmcnt(10)
  ds_read_b64_tr_b16 v[116:117], v9 offset:30816
  ds_read_b64_tr_b16 v[118:119], v9 offset:32096
  v_mfma_f32_16x16x32_bf16 v[180:183], v[124:127], v[52:55], v[180:183]
  s_waitcnt lgkmcnt(10)
  ds_read_b64_tr_b16 v[120:121], v9 offset:30848
  ds_read_b64_tr_b16 v[122:123], v9 offset:32128
  v_mfma_f32_16x16x32_bf16 v[184:187], v[128:131], v[52:55], v[184:187]
  s_waitcnt lgkmcnt(10)
  ds_read_b64_tr_b16 v[124:125], v9 offset:35840
  ds_read_b64_tr_b16 v[126:127], v9 offset:37120
  v_mfma_f32_16x16x32_bf16 v[188:191], v[132:135], v[52:55], v[188:191]
  s_waitcnt vmcnt(16) lgkmcnt(10)
  ds_read_b64_tr_b16 v[128:129], v9 offset:35872
  ds_read_b64_tr_b16 v[130:131], v9 offset:37152
  global_load_dwordx4 a[204:207], v11, s[24:25] offset:3072 sc1
  v_mfma_f32_16x16x32_bf16 v[172:175], v[136:139], v[56:59], v[172:175]
  s_waitcnt lgkmcnt(10)
  ds_read_b64_tr_b16 v[132:133], v9 offset:35904
  ds_read_b64_tr_b16 v[134:135], v9 offset:37184
  v_mfma_f32_16x16x32_bf16 v[176:179], v[140:143], v[56:59], v[176:179]
  s_waitcnt lgkmcnt(10)
  ds_read_b64_tr_b16 v[136:137], v9 offset:35936
  ds_read_b64_tr_b16 v[138:139], v9 offset:37216
  v_mfma_f32_16x16x32_bf16 v[180:183], v[112:115], v[56:59], v[180:183]
  s_waitcnt lgkmcnt(10)
  ds_read_b64_tr_b16 v[140:141], v9 offset:35968
  ds_read_b64_tr_b16 v[142:143], v9 offset:37248
  v_mfma_f32_16x16x32_bf16 v[184:187], v[116:119], v[56:59], v[184:187]
  s_waitcnt lgkmcnt(10)
  ds_read_b64_tr_b16 v[112:113], v9 offset:40960
  ds_read_b64_tr_b16 v[114:115], v9 offset:42240
  v_mfma_f32_16x16x32_bf16 v[188:191], v[120:123], v[56:59], v[188:191]
  s_waitcnt vmcnt(16) lgkmcnt(10)
  ds_read_b64_tr_b16 v[116:117], v9 offset:40992
  ds_read_b64_tr_b16 v[118:119], v9 offset:42272
  s_add_u32 s83, s83, 4096
  s_add_u32 s24, s60, s83
  s_addc_u32 s25, s61, 0
  global_load_dwordx4 a[208:211], v11, s[24:25] offset:0 sc1
  v_mfma_f32_16x16x32_bf16 v[172:175], v[124:127], v[60:63], v[172:175]
  s_waitcnt lgkmcnt(10)
  ds_read_b64_tr_b16 v[120:121], v9 offset:41024
  ds_read_b64_tr_b16 v[122:123], v9 offset:42304
  v_mfma_f32_16x16x32_bf16 v[176:179], v[128:131], v[60:63], v[176:179]
  s_waitcnt lgkmcnt(10)
  ds_read_b64_tr_b16 v[124:125], v9 offset:41056
  ds_read_b64_tr_b16 v[126:127], v9 offset:42336
  v_mfma_f32_16x16x32_bf16 v[180:183], v[132:135], v[60:63], v[180:183]
  s_waitcnt lgkmcnt(10)
  ds_read_b64_tr_b16 v[128:129], v9 offset:41088
  ds_read_b64_tr_b16 v[130:131], v9 offset:42368
  v_mfma_f32_16x16x32_bf16 v[184:187], v[136:139], v[60:63], v[184:187]
  s_waitcnt lgkmcnt(10)
  ds_read_b64_tr_b16 v[132:133], v9 offset:46080
  ds_read_b64_tr_b16 v[134:135], v9 offset:47360
  v_mfma_f32_16x16x32_bf16 v[188:191], v[140:143], v[60:63], v[188:191]
  s_waitcnt vmcnt(16) lgkmcnt(10)
  ds_read_b64_tr_b16 v[136:137], v9 offset:46112
  ds_read_b64_tr_b16 v[138:139], v9 offset:47392
  v_mfma_f32_16x16x32_bf16 v[172:175], v[112:115], v[64:67], v[172:175]
  s_waitcnt lgkmcnt(10)
  ds_read_b64_tr_b16 v[140:141], v9 offset:46144
  ds_read_b64_tr_b16 v[142:143], v9 offset:47424
  v_mfma_f32_16x16x32_bf16 v[176:179], v[116:119], v[64:67], v[176:179]
  s_waitcnt lgkmcnt(10)
  ds_read_b64_tr_b16 v[112:113], v9 offset:46176
  ds_read_b64_tr_b16 v[114:115], v9 offset:47456
  v_mfma_f32_16x16x32_bf16 v[180:183], v[120:123], v[64:67], v[180:183]
  s_waitcnt lgkmcnt(10)
  ds_read_b64_tr_b16 v[116:117], v9 offset:46208
  ds_read_b64_tr_b16 v[118:119], v9 offset:47488
  v_mfma_f32_16x16x32_bf16 v[184:187], v[124:127], v[64:67], v[184:187]
  s_waitcnt lgkmcnt(10)
  ds_read_b64_tr_b16 v[120:121], v10 offset:0
  ds_read_b64_tr_b16 v[122:123], v10 offset:1280
  v_mfma_f32_16x16x32_bf16 v[188:191], v[128:131], v[64:67], v[188:191]
  s_waitcnt vmcnt(15) lgkmcnt(10)
  ds_read_b64_tr_b16 v[124:125], v10 offset:32
  ds_read_b64_tr_b16 v[126:127], v10 offset:1312
  global_load_dwordx4 a[212:215], v11, s[24:25] offset:1024 sc1
  v_mfma_f32_16x16x32_bf16 v[172:175], v[132:135], v[68:71], v[172:175]
  s_waitcnt lgkmcnt(10)
  ds_read_b64_tr_b16 v[128:129], v10 offset:64
  ds_read_b64_tr_b16 v[130:131], v10 offset:1344
  v_mfma_f32_16x16x32_bf16 v[176:179], v[136:139], v[68:71], v[176:179]
  s_waitcnt lgkmcnt(10)
  ds_read_b64_tr_b16 v[132:133], v10 offset:96
  ds_read_b64_tr_b16 v[134:135], v10 offset:1376
  v_mfma_f32_16x16x32_bf16 v[180:183], v[140:143], v[68:71], v[180:183]
  s_waitcnt lgkmcnt(10)
  ds_read_b64_tr_b16 v[136:137], v10 offset:128
  ds_read_b64_tr_b16 v[138:139], v10 offset:1408
  v_mfma_f32_16x16x32_bf16 v[184:187], v[112:115], v[68:71], v[184:187]
  s_waitcnt lgkmcnt(10)
  ds_read_b64_tr_b16 v[140:141], v10 offset:5120
  ds_read_b64_tr_b16 v[142:143], v10 offset:6400
  v_mfma_f32_16x16x32_bf16 v[188:191], v[116:119], v[68:71], v[188:191]
  s_waitcnt vmcnt(15) lgkmcnt(10)
  ds_read_b64_tr_b16 v[112:113], v10 offset:5152
  ds_read_b64_tr_b16 v[114:115], v10 offset:6432
  global_load_dwordx4 a[216:219], v11, s[24:25] offset:2048 sc1
  v_mfma_f32_16x16x32_bf16 v[172:175], v[120:123], v[72:75], v[172:175]
  s_waitcnt lgkmcnt(10)
  ds_read_b64_tr_b16 v[116:117], v10 offset:5184
  ds_read_b64_tr_b16 v[118:119], v10 offset:6464
  v_mfma_f32_16x16x32_bf16 v[176:179], v[124:127], v[72:75], v[176:179]
  s_waitcnt lgkmcnt(10)
  ds_read_b64_tr_b16 v[120:121], v10 offset:5216
  ds_read_b64_tr_b16 v[122:123], v10 offset:6496
  v_mfma_f32_16x16x32_bf16 v[180:183], v[128:131], v[72:75], v[180:183]
  s_waitcnt lgkmcnt(10)
  ds_read_b64_tr_b16 v[124:125], v10 offset:5248
  ds_read_b64_tr_b16 v[126:127], v10 offset:6528
  v_mfma_f32_16x16x32_bf16 v[184:187], v[132:135], v[72:75], v[184:187]
  s_waitcnt lgkmcnt(10)
  ds_read_b64_tr_b16 v[128:129], v10 offset:10240
  ds_read_b64_tr_b16 v[130:131], v10 offset:11520
  v_mfma_f32_16x16x32_bf16 v[188:191], v[136:139], v[72:75], v[188:191]
  s_waitcnt vmcnt(15) lgkmcnt(10)
  ds_read_b64_tr_b16 v[132:133], v10 offset:10272
  ds_read_b64_tr_b16 v[134:135], v10 offset:11552
  global_load_dwordx4 a[220:223], v11, s[24:25] offset:3072 sc1
  v_mfma_f32_16x16x32_bf16 v[172:175], v[140:143], v[76:79], v[172:175]
  s_waitcnt lgkmcnt(10)
  ds_read_b64_tr_b16 v[136:137], v10 offset:10304
  ds_read_b64_tr_b16 v[138:139], v10 offset:11584
  v_mfma_f32_16x16x32_bf16 v[176:179], v[112:115], v[76:79], v[176:179]
  s_waitcnt lgkmcnt(10)
  ds_read_b64_tr_b16 v[140:141], v10 offset:10336
  ds_read_b64_tr_b16 v[142:143], v10 offset:11616
  v_mfma_f32_16x16x32_bf16 v[180:183], v[116:119], v[76:79], v[180:183]
  s_waitcnt lgkmcnt(10)
  ds_read_b64_tr_b16 v[112:113], v10 offset:10368
  ds_read_b64_tr_b16 v[114:115], v10 offset:11648
  v_mfma_f32_16x16x32_bf16 v[184:187], v[120:123], v[76:79], v[184:187]
  s_waitcnt lgkmcnt(10)
  ds_read_b64_tr_b16 v[116:117], v10 offset:15360
  ds_read_b64_tr_b16 v[118:119], v10 offset:16640
  v_mfma_f32_16x16x32_bf16 v[188:191], v[124:127], v[76:79], v[188:191]
  s_waitcnt vmcnt(15) lgkmcnt(10)
  ds_read_b64_tr_b16 v[120:121], v10 offset:15392
  ds_read_b64_tr_b16 v[122:123], v10 offset:16672
  v_mfma_f32_16x16x32_bf16 v[172:175], v[128:131], v[80:83], v[172:175]
  s_waitcnt lgkmcnt(10)
  ds_read_b64_tr_b16 v[124:125], v10 offset:15424
  ds_read_b64_tr_b16 v[126:127], v10 offset:16704
  v_mfma_f32_16x16x32_bf16 v[176:179], v[132:135], v[80:83], v[176:179]
  s_waitcnt lgkmcnt(10)
  ds_read_b64_tr_b16 v[128:129], v10 offset:15456
  ds_read_b64_tr_b16 v[130:131], v10 offset:16736
  v_mfma_f32_16x16x32_bf16 v[180:183], v[136:139], v[80:83], v[180:183]
  s_waitcnt lgkmcnt(10)
  ds_read_b64_tr_b16 v[132:133], v10 offset:15488
  ds_read_b64_tr_b16 v[134:135], v10 offset:16768
  v_mfma_f32_16x16x32_bf16 v[184:187], v[140:143], v[80:83], v[184:187]
  s_waitcnt lgkmcnt(10)
  ds_read_b64_tr_b16 v[136:137], v10 offset:20480
  ds_read_b64_tr_b16 v[138:139], v10 offset:21760
  v_mfma_f32_16x16x32_bf16 v[188:191], v[112:115], v[80:83], v[188:191]
  s_waitcnt vmcnt(14) lgkmcnt(10)
  ds_read_b64_tr_b16 v[140:141], v10 offset:20512
  ds_read_b64_tr_b16 v[142:143], v10 offset:21792
  s_add_u32 s83, s83, 4096
  s_add_u32 s24, s60, s83
  s_addc_u32 s25, s61, 0
  global_load_dwordx4 a[224:227], v11, s[24:25] offset:0 sc1
  v_mfma_f32_16x16x32_bf16 v[172:175], v[116:119], v[84:87], v[172:175]
  s_waitcnt lgkmcnt(10)
  ds_read_b64_tr_b16 v[112:113], v10 offset:20544
  ds_read_b64_tr_b16 v[114:115], v10 offset:21824
  v_mfma_f32_16x16x32_bf16 v[176:179], v[120:123], v[84:87], v[176:179]
  s_waitcnt lgkmcnt(10)
  ds_read_b64_tr_b16 v[116:117], v10 offset:20576
  ds_read_b64_tr_b16 v[118:119], v10 offset:21856
  v_mfma_f32_16x16x32_bf16 v[180:183], v[124:127], v[84:87], v[180:183]
  s_waitcnt lgkmcnt(10)
  ds_read_b64_tr_b16 v[120:121], v10 offset:20608
  ds_read_b64_tr_b16 v[122:123], v10 offset:21888
  v_mfma_f32_16x16x32_bf16 v[184:187], v[128:131], v[84:87], v[184:187]
  s_waitcnt lgkmcnt(10)
  ds_read_b64_tr_b16 v[124:125], v10 offset:25600
  ds_read_b64_tr_b16 v[126:127], v10 offset:26880
  v_mfma_f32_16x16x32_bf16 v[188:191], v[132:135], v[84:87], v[188:191]
  s_waitcnt vmcnt(14) lgkmcnt(10)
  ds_read_b64_tr_b16 v[128:129], v10 offset:25632
  ds_read_b64_tr_b16 v[130:131], v10 offset:26912
  global_load_dwordx4 a[228:231], v11, s[24:25] offset:1024 sc1
  v_mfma_f32_16x16x32_bf16 v[172:175], v[136:139], v[88:91], v[172:175]
  s_waitcnt lgkmcnt(10)
  ds_read_b64_tr_b16 v[132:133], v10 offset:25664
  ds_read_b64_tr_b16 v[134:135], v10 offset:26944
  v_mfma_f32_16x16x32_bf16 v[176:179], v[140:143], v[88:91], v[176:179]
  s_waitcnt lgkmcnt(10)
  ds_read_b64_tr_b16 v[136:137], v10 offset:25696
  ds_read_b64_tr_b16 v[138:139], v10 offset:26976
  v_mfma_f32_16x16x32_bf16 v[180:183], v[112:115], v[88:91], v[180:183]
  s_waitcnt lgkmcnt(10)
  ds_read_b64_tr_b16 v[140:141], v10 offset:25728
  ds_read_b64_tr_b16 v[142:143], v10 offset:27008
  v_mfma_f32_16x16x32_bf16 v[184:187], v[116:119], v[88:91], v[184:187]
  s_waitcnt lgkmcnt(10)
  ds_read_b64_tr_b16 v[112:113], v10 offset:30720
  ds_read_b64_tr_b16 v[114:115], v10 offset:32000
  v_mfma_f32_16x16x32_bf16 v[188:191], v[120:123], v[88:91], v[188:191]
  s_waitcnt vmcnt(14) lgkmcnt(10)
  ds_read_b64_tr_b16 v[116:117], v10 offset:30752
  ds_read_b64_tr_b16 v[118:119], v10 offset:32032
  v_mfma_f32_16x16x32_bf16 v[172:175], v[124:127], v[92:95], v[172:175]
  s_waitcnt lgkmcnt(10)
  ds_read_b64_tr_b16 v[120:121], v10 offset:30784
  ds_read_b64_tr_b16 v[122:123], v10 offset:32064
  v_mfma_f32_16x16x32_bf16 v[176:179], v[128:131], v[92:95], v[176:179]
  s_waitcnt lgkmcnt(10)
  ds_read_b64_tr_b16 v[124:125], v10 offset:30816
  ds_read_b64_tr_b16 v[126:127], v10 offset:32096
  v_mfma_f32_16x16x32_bf16 v[180:183], v[132:135], v[92:95], v[180:183]
  s_waitcnt lgkmcnt(10)
  ds_read_b64_tr_b16 v[128:129], v10 offset:30848
  ds_read_b64_tr_b16 v[130:131], v10 offset:32128
  v_mfma_f32_16x16x32_bf16 v[184:187], v[136:139], v[92:95], v[184:187]
  s_waitcnt lgkmcnt(10)
  ds_read_b64_tr_b16 v[132:133], v10 offset:35840
  ds_read_b64_tr_b16 v[134:135], v10 offset:37120
  v_mfma_f32_16x16x32_bf16 v[188:191], v[140:143], v[92:95], v[188:191]
  s_waitcnt vmcnt(13) lgkmcnt(10)
  ds_read_b64_tr_b16 v[136:137], v10 offset:35872
  ds_read_b64_tr_b16 v[138:139], v10 offset:37152
  global_load_dwordx4 a[232:235], v11, s[24:25] offset:2048 sc1
  v_mfma_f32_16x16x32_bf16 v[172:175], v[112:115], v[96:99], v[172:175]
  s_waitcnt lgkmcnt(10)
  ds_read_b64_tr_b16 v[140:141], v10 offset:35904
  ds_read_b64_tr_b16 v[142:143], v10 offset:37184
  v_mfma_f32_16x16x32_bf16 v[176:179], v[116:119], v[96:99], v[176:179]
  s_waitcnt lgkmcnt(10)
  ds_read_b64_tr_b16 v[112:113], v10 offset:35936
  ds_read_b64_tr_b16 v[114:115], v10 offset:37216
  v_mfma_f32_16x16x32_bf16 v[180:183], v[120:123], v[96:99], v[180:183]
  s_waitcnt lgkmcnt(10)
  ds_read_b64_tr_b16 v[116:117], v10 offset:35968
  ds_read_b64_tr_b16 v[118:119], v10 offset:37248
  v_mfma_f32_16x16x32_bf16 v[184:187], v[124:127], v[96:99], v[184:187]
  s_waitcnt lgkmcnt(10)
  ds_read_b64_tr_b16 v[120:121], v10 offset:40960
  ds_read_b64_tr_b16 v[122:123], v10 offset:42240
  v_mfma_f32_16x16x32_bf16 v[188:191], v[128:131], v[96:99], v[188:191]
  s_waitcnt vmcnt(13) lgkmcnt(10)
  ds_read_b64_tr_b16 v[124:125], v10 offset:40992
  ds_read_b64_tr_b16 v[126:127], v10 offset:42272
  global_load_dwordx4 a[236:239], v11, s[24:25] offset:3072 sc1
  v_mfma_f32_16x16x32_bf16 v[172:175], v[132:135], v[100:103], v[172:175]
  s_waitcnt lgkmcnt(10)
  ds_read_b64_tr_b16 v[128:129], v10 offset:41024
  ds_read_b64_tr_b16 v[130:131], v10 offset:42304
  v_mfma_f32_16x16x32_bf16 v[176:179], v[136:139], v[100:103], v[176:179]
  s_waitcnt lgkmcnt(10)
  ds_read_b64_tr_b16 v[132:133], v10 offset:41056
  ds_read_b64_tr_b16 v[134:135], v10 offset:42336
  v_mfma_f32_16x16x32_bf16 v[180:183], v[140:143], v[100:103], v[180:183]
  s_waitcnt lgkmcnt(10)
  ds_read_b64_tr_b16 v[136:137], v10 offset:41088
  ds_read_b64_tr_b16 v[138:139], v10 offset:42368
  v_mfma_f32_16x16x32_bf16 v[184:187], v[112:115], v[100:103], v[184:187]
  s_waitcnt lgkmcnt(10)
  ds_read_b64_tr_b16 v[140:141], v10 offset:46080
  ds_read_b64_tr_b16 v[142:143], v10 offset:47360
  v_mfma_f32_16x16x32_bf16 v[188:191], v[116:119], v[100:103], v[188:191]
  s_waitcnt vmcnt(13) lgkmcnt(10)
  ds_read_b64_tr_b16 v[112:113], v10 offset:46112
  ds_read_b64_tr_b16 v[114:115], v10 offset:47392
  v_mfma_f32_16x16x32_bf16 v[172:175], v[120:123], v[104:107], v[172:175]
  s_waitcnt lgkmcnt(10)
  ds_read_b64_tr_b16 v[116:117], v10 offset:46144
  ds_read_b64_tr_b16 v[118:119], v10 offset:47424
  v_mfma_f32_16x16x32_bf16 v[176:179], v[124:127], v[104:107], v[176:179]
  s_waitcnt lgkmcnt(10)
  ds_read_b64_tr_b16 v[120:121], v10 offset:46176
  ds_read_b64_tr_b16 v[122:123], v10 offset:47456
  v_mfma_f32_16x16x32_bf16 v[180:183], v[128:131], v[104:107], v[180:183]
  s_waitcnt lgkmcnt(10)
  ds_read_b64_tr_b16 v[124:125], v10 offset:46208
  ds_read_b64_tr_b16 v[126:127], v10 offset:47488
  v_mfma_f32_16x16x32_bf16 v[184:187], v[132:135], v[104:107], v[184:187]
  s_waitcnt lgkmcnt(10)
  v_mfma_f32_16x16x32_bf16 v[188:191], v[136:139], v[104:107], v[188:191]
  s_add_u32 s83, s83, 4096
  s_waitcnt vmcnt(12) lgkmcnt(8)
  v_mfma_f32_16x16x32_bf16 v[172:175], v[140:143], v[108:111], v[172:175]
  s_waitcnt lgkmcnt(6)
  v_mfma_f32_16x16x32_bf16 v[176:179], v[112:115], v[108:111], v[176:179]
  s_waitcnt lgkmcnt(4)
  v_mfma_f32_16x16x32_bf16 v[180:183], v[116:119], v[108:111], v[180:183]
  s_waitcnt lgkmcnt(2)
  v_mfma_f32_16x16x32_bf16 v[184:187], v[120:123], v[108:111], v[184:187]
  s_waitcnt lgkmcnt(0)
  v_mfma_f32_16x16x32_bf16 v[188:191], v[124:127], v[108:111], v[188:191]
  v_cvt_pk_bf16_f32 v204, v172, v173
  v_cvt_pk_bf16_f32 v205, v174, v175
  v_cvt_pk_bf16_f32 v206, v176, v177
  v_cvt_pk_bf16_f32 v207, v178, v179
  v_cvt_pk_bf16_f32 v208, v180, v181
  v_cvt_pk_bf16_f32 v209, v182, v183
  v_cvt_pk_bf16_f32 v210, v184, v185
  v_cvt_pk_bf16_f32 v211, v186, v187
  v_cvt_pk_bf16_f32 v212, v188, v189
  v_cvt_pk_bf16_f32 v213, v190, v191
  v_permlane16_swap_b32 v204, v206
  v_permlane16_swap_b32 v205, v207
  v_permlane16_swap_b32 v208, v210
  v_permlane16_swap_b32 v209, v211
  v_permlane16_swap_b32 v212, v214
  v_permlane16_swap_b32 v213, v215
  buffer_store_dwordx4 v[204:207], v252, s[60:63], 0 offen sc1
  buffer_store_dwordx4 v[208:211], v252, s[60:63], 0 offen offset:1024 sc1
  buffer_store_dwordx4 v[212:215], v246, s[60:63], 0 offen offset:2048 sc1
  v_dot2_f32_bf16 v216, v204, s76, v216
  v_dot2_f32_bf16 v217, v204, v204, v217
  v_dot2_f32_bf16 v216, v205, s76, v216
  v_dot2_f32_bf16 v217, v205, v205, v217
  v_dot2_f32_bf16 v216, v206, s76, v216
  v_dot2_f32_bf16 v217, v206, v206, v217
  v_dot2_f32_bf16 v216, v207, s76, v216
  v_dot2_f32_bf16 v217, v207, v207, v217
  v_dot2_f32_bf16 v216, v208, s76, v216
  v_dot2_f32_bf16 v217, v208, v208, v217
  v_dot2_f32_bf16 v216, v209, s76, v216
  v_dot2_f32_bf16 v217, v209, v209, v217
  v_dot2_f32_bf16 v216, v210, s76, v216
  v_dot2_f32_bf16 v217, v210, v210, v217
  v_dot2_f32_bf16 v216, v211, s76, v216
  v_dot2_f32_bf16 v217, v211, v211, v217
  v_dot2_f32_bf16 v216, v212, s76, v216
  v_dot2_f32_bf16 v217, v212, v212, v217
  v_dot2_f32_bf16 v216, v213, s76, v216
  v_dot2_f32_bf16 v217, v213, v213, v217
  v_dot2_f32_bf16 v216, v214, s76, v216
  v_dot2_f32_bf16 v217, v214, v214, v217
  v_dot2_f32_bf16 v216, v215, s76, v216
  v_dot2_f32_bf16 v217, v215, v215, v217
  s_nop 1
  v_mov_b32 v20, v216
  v_mov_b32 v21, v217
  s_nop 0
  v_permlane32_swap_b32 v20, v216
  v_permlane32_swap_b32 v21, v217
  v_add_f32 v216, v216, v20
  v_add_f32 v217, v217, v21
  v_mov_b32 v20, v216
  v_mov_b32 v21, v217
  s_nop 0
  v_permlane16_swap_b32 v20, v216
  v_permlane16_swap_b32 v21, v217
  v_add_f32 v216, v216, v20
  v_add_f32 v217, v217, v21
  buffer_store_dwordx2 v[216:217], v247, s[60:63], 0 offen sc1
  v_accvgpr_read_b32 v128, a252
  v_accvgpr_read_b32 v129, a253
  v_mfma_f32_16x16x32_bf16 a[240:243], a[0:3], v[232:235], 0
  v_mfma_f32_16x16x32_bf16 a[244:247], a[4:7], v[232:235], 0
  v_mfma_f32_16x16x32_bf16 a[248:251], a[8:11], v[232:235], 0
  v_mfma_f32_16x16x32_bf16 a[240:243], a[12:15], v[232:235], a[240:243]
  v_mfma_f32_16x16x32_bf16 a[244:247], a[16:19], v[232:235], a[244:247]
  v_mfma_f32_16x16x32_bf16 a[248:251], a[20:23], v[232:235], a[248:251]
  v_mfma_f32_16x16x32_bf16 a[240:243], a[24:27], v[232:235], a[240:243]
  v_mfma_f32_16x16x32_bf16 a[244:247], a[28:31], v[232:235], a[244:247]
  v_mfma_f32_16x16x32_bf16 a[248:251], a[32:35], v[232:235], a[248:251]
  v_mfma_f32_16x16x32_bf16 a[240:243], a[36:39], v[232:235], a[240:243]
  v_mfma_f32_16x16x32_bf16 a[244:247], a[40:43], v[232:235], a[244:247]
  v_mfma_f32_16x16x32_bf16 a[248:251], a[44:47], v[232:235], a[248:251]
  v_mfma_f32_16x16x32_bf16 a[240:243], a[48:51], v[232:235], a[240:243]
  v_mfma_f32_16x16x32_bf16 a[244:247], a[52:55], v[232:235], a[244:247]
  v_mfma_f32_16x16x32_bf16 a[248:251], a[56:59], v[232:235], a[248:251]
  v_mfma_f32_16x16x32_bf16 a[240:243], a[60:63], v[232:235], a[240:243]
  v_mfma_f32_16x16x32_bf16 a[244:247], a[64:67], v[232:235], a[244:247]
  v_mfma_f32_16x16x32_bf16 a[248:251], a[68:71], v[232:235], a[248:251]
  v_mfma_f32_16x16x32_bf16 a[240:243], a[72:75], v[232:235], a[240:243]
  v_mfma_f32_16x16x32_bf16 a[244:247], a[76:79], v[232:235], a[244:247]
  v_mfma_f32_16x16x32_bf16 a[248:251], a[80:83], v[232:235], a[248:251]
  v_mfma_f32_16x16x32_bf16 a[240:243], a[84:87], v[232:235], a[240:243]
  v_mfma_f32_16x16x32_bf16 a[244:247], a[88:91], v[232:235], a[244:247]
  v_mfma_f32_16x16x32_bf16 a[248:251], a[92:95], v[232:235], a[248:251]
  v_mfma_f32_16x16x32_bf16 a[240:243], a[96:99], v[232:235], a[240:243]
  v_mfma_f32_16x16x32_bf16 a[244:247], a[100:103], v[232:235], a[244:247]
  v_mfma_f32_16x16x32_bf16 a[248:251], a[104:107], v[232:235], a[248:251]
  v_mfma_f32_16x16x32_bf16 a[240:243], a[108:111], v[232:235], a[240:243]
  v_mfma_f32_16x16x32_bf16 a[244:247], a[112:115], v[232:235], a[244:247]
  v_mfma_f32_16x16x32_bf16 a[248:251], a[116:119], v[232:235], a[248:251]
  v_mfma_f32_16x16x32_bf16 a[240:243], a[120:123], v[232:235], a[240:243]
  v_mfma_f32_16x16x32_bf16 a[244:247], a[124:127], v[232:235], a[244:247]
  v_mfma_f32_16x16x32_bf16 a[248:251], a[128:131], v[232:235], a[248:251]
  v_mfma_f32_16x16x32_bf16 a[240:243], a[132:135], v[232:235], a[240:243]
  v_mfma_f32_16x16x32_bf16 a[244:247], a[136:139], v[232:235], a[244:247]
  v_mfma_f32_16x16x32_bf16 a[248:251], a[140:143], v[232:235], a[248:251]
  s_waitcnt vmcnt(0)
  buffer_store_dword v19, v28, s[60:63], 0 offen offset:0
  s_mov_b32 s93, 0x40000
L_pollhL:
  buffer_load_dword v20, v30, s[60:63], 0 offen offset:0 sc1
  buffer_load_dword v21, v29, s[60:63], 0 offen offset:0 sc1
  s_waitcnt vmcnt(0)
  v_cmp_ne_u32 vcc, v20, v19
  v_cmp_ne_u32 s[94:95], v21, v19
  s_nop 3
  s_or_b64 vcc, vcc, s[94:95]
  s_cmp_eq_u64 vcc, 0
  s_cbranch_scc1 L_pollhL_ok
  s_sub_u32 s93, s93, 1
  s_cbranch_scc0 L_pollhL
L_pollhL_ok:
  buffer_load_dwordx4 v[200:203], v11, s[60:63], s10 offen offset:0 sc1
  buffer_load_dwordx4 v[204:207], v11, s[60:63], s10 offen offset:1024 sc1
  s_add_u32 m0, s88, 0
  s_nop 0
  buffer_load_dwordx4 v11, s[60:63], s87 offen offset:0 sc1 lds
  buffer_load_dwordx4 v11, s[60:63], s87 offen offset:1024 sc1 lds
  buffer_load_dwordx4 v11, s[60:63], s87 offen offset:2048 sc1 lds
  buffer_load_dwordx4 v11, s[60:63], s87 offen offset:3072 sc1 lds
  s_add_u32 s87, s87, 4096
  s_add_u32 m0, s88, 4096
  s_nop 0
  buffer_load_dwordx4 v11, s[60:63], s87 offen offset:0 sc1 lds
  s_add_u32 s87, s87, 16384
  s_add_u32 m0, s88, 20480
  s_nop 0
  buffer_load_dwordx4 v11, s[60:63], s87 offen offset:0 sc1 lds
  buffer_load_dwordx4 v11, s[60:63], s87 offen offset:1024 sc1 lds
  buffer_load_dwordx4 v11, s[60:63], s87 offen offset:2048 sc1 lds
  buffer_load_dwordx4 v11, s[60:63], s87 offen offset:3072 sc1 lds
  s_add_u32 s87, s87, 4096
  s_add_u32 m0, s88, 24576
  s_nop 0
  buffer_load_dwordx4 v11, s[60:63], s87 offen offset:0 sc1 lds
  s_add_u32 s87, s87, 16384
  v_mfma_f32_16x16x32_bf16 a[240:243], a[144:147], v[232:235], a[240:243]
  v_mfma_f32_16x16x32_bf16 a[244:247], a[148:151], v[232:235], a[244:247]
  v_mfma_f32_16x16x32_bf16 a[248:251], a[152:155], v[232:235], a[248:251]
  v_mfma_f32_16x16x32_bf16 a[240:243], a[156:159], v[232:235], a[240:243]
  v_mfma_f32_16x16x32_bf16 a[244:247], a[160:163], v[232:235], a[244:247]
  v_mfma_f32_16x16x32_bf16 a[248:251], a[164:167], v[232:235], a[248:251]
  v_mfma_f32_16x16x32_bf16 a[240:243], a[168:171], v[232:235], a[240:243]
  v_mfma_f32_16x16x32_bf16 a[244:247], a[172:175], v[232:235], a[244:247]
  v_mfma_f32_16x16x32_bf16 a[248:251], a[176:179], v[232:235], a[248:251]
  v_mfma_f32_16x16x32_bf16 a[240:243], a[180:183], v[232:235], a[240:243]
  v_mfma_f32_16x16x32_bf16 a[244:247], a[184:187], v[232:235], a[244:247]
  v_mfma_f32_16x16x32_bf16 a[248:251], a[188:191], v[232:235], a[248:251]
  v_mfma_f32_16x16x32_bf16 a[240:243], a[192:195], v[232:235], a[240:243]
  v_mfma_f32_16x16x32_bf16 a[244:247], a[196:199], v[232:235], a[244:247]
  v_mfma_f32_16x16x32_bf16 a[248:251], a[200:203], v[232:235], a[248:251]
  v_mfma_f32_16x16x32_bf16 a[240:243], a[204:207], v[232:235], a[240:243]
  v_mfma_f32_16x16x32_bf16 a[244:247], a[208:211], v[232:235], a[244:247]
  v_mfma_f32_16x16x32_bf16 a[248:251], a[212:215], v[232:235], a[248:251]
  v_mfma_f32_16x16x32_bf16 a[240:243], a[216:219], v[232:235], a[240:243]
  v_mfma_f32_16x16x32_bf16 a[244:247], a[220:223], v[232:235], a[244:247]
  v_mfma_f32_16x16x32_bf16 a[248:251], a[224:227], v[232:235], a[248:251]
  v_mfma_f32_16x16x32_bf16 a[240:243], a[228:231], v[232:235], a[240:243]
  v_mfma_f32_16x16x32_bf16 a[244:247], a[232:235], v[232:235], a[244:247]
  v_mfma_f32_16x16x32_bf16 a[248:251], a[236:239], v[232:235], a[248:251]
  s_mov_b32 s94, 0xaaaaaaaa
  s_mov_b32 s95, 0xaaaaaaaa
  s_waitcnt vmcnt(11)
  v_add_f32 v200, v200, v202
  v_add_f32 v201, v201, v203
  s_waitcnt vmcnt(10)
  v_add_f32 v204, v204, v206
  v_add_f32 v205, v205, v207
  v_add_f32_dpp v200, v200, v200 quad_perm:[1,0,3,2] row_mask:0xf bank_mask:0xf
  v_add_f32_dpp v201, v201, v201 quad_perm:[1,0,3,2] row_mask:0xf bank_mask:0xf
  v_add_f32_dpp v204, v204, v204 quad_perm:[1,0,3,2] row_mask:0xf bank_mask:0xf
  v_add_f32_dpp v205, v205, v205 quad_perm:[1,0,3,2] row_mask:0xf bank_mask:0xf
  v_add_f32_dpp v200, v200, v200 quad_perm:[2,3,0,1] row_mask:0xf bank_mask:0xf
  v_add_f32_dpp v201, v201, v201 quad_perm:[2,3,0,1] row_mask:0xf bank_mask:0xf
  v_add_f32_dpp v204, v204, v204 quad_perm:[2,3,0,1] row_mask:0xf bank_mask:0xf
  v_add_f32_dpp v205, v205, v205 quad_perm:[2,3,0,1] row_mask:0xf bank_mask:0xf
  v_cndmask_b32 v200, v200, v204, s[94:95]
  v_cndmask_b32 v201, v201, v205, s[94:95]
  v_mul_f32 v205, 0x3acccccd, v200
  v_mul_f32 v202, v205, v205
  v_mov_b32 v204, 0x3acccccd
  v_fma_f32 v202, v201, v204, -v202
  v_max_f32 v202, 0, v202
  v_add_f32 v202, 0x3727c5ac, v202
  v_rsq_f32 v204, v202
  ds_write_b64 v25, v[204:205] offset:36864
  v_accvgpr_read_b32 v72, a240
  v_accvgpr_read_b32 v73, a241
  v_accvgpr_read_b32 v74, a242
  v_accvgpr_read_b32 v75, a243
  v_accvgpr_read_b32 v76, a244
  v_accvgpr_read_b32 v77, a245
  v_accvgpr_read_b32 v78, a246
  v_accvgpr_read_b32 v79, a247
  v_accvgpr_read_b32 v80, a248
  v_accvgpr_read_b32 v81, a249
  v_accvgpr_read_b32 v82, a250
  v_accvgpr_read_b32 v83, a251
  s_lshl_b32 s4, s69, 12
  s_lshl_b32 s5, s68, 8
  s_add_u32 s4, s4, s5
  s_add_u32 s4, s4, 18939904
  v_lshl_add_u32 v28, v2, 4, s4
  v_lshrrev_b32 v20, 5, v1
  v_lshl_add_u32 v27, v20, 10, v28
  s_mul_i32 s12, s68, 15360
  s_add_u32 s12, s12, 102400
  s_mul_i32 s13, s68, 10240
  s_add_u32 s13, s13, 61440
  s_add_u32 s14, s89, 30720
  v_add_u32 v4, s12, v11
  v_add_u32 v5, s13, v11
  v_add_u32 v6, s88, v11
  s_waitcnt vmcnt(5)
  s_waitcnt lgkmcnt(0)
  s_barrier
  ds_read_b128 v[56:59], v11 offset:0
  ds_read_b128 v[60:63], v11 offset:1024
  ds_read_b128 v[64:67], v11 offset:2048
  s_waitcnt lgkmcnt(2)
  v_mfma_f32_16x16x32_bf16 v[32:35], a[0:3], v[56:59], 0
  s_add_u32 m0, s88, 40960
  ds_read_b128 v[68:71], v11 offset:3072
  v_mfma_f32_16x16x32_bf16 v[36:39], a[4:7], v[56:59], 0
  buffer_load_dwordx4 v11, s[60:63], s87 offen offset:0 sc1 lds
  v_mfma_f32_16x16x32_bf16 v[40:43], a[8:11], v[56:59], 0
  s_waitcnt lgkmcnt(2)
  ds_read_b128 v[84:87], v31 offset:36864
  ds_read_b128 v[88:91], v31 offset:36880
  v_mfma_f32_16x16x32_bf16 v[32:35], a[12:15], v[60:63], v[32:35]
  ds_read_b128 v[56:59], v11 offset:4096
  ds_read_b128 v[92:95], v31 offset:36896
  v_mfma_f32_16x16x32_bf16 v[36:39], a[16:19], v[60:63], v[36:39]
  ds_read_b128 v[96:99], v31 offset:36912
  v_mfma_f32_16x16x32_bf16 v[40:43], a[20:23], v[60:63], v[40:43]
  s_waitcnt lgkmcnt(6)
  buffer_load_dwordx4 v11, s[60:63], s87 offen offset:1024 sc1 lds
  v_mfma_f32_16x16x32_bf16 v[32:35], a[24:27], v[64:67], v[32:35]
  ds_read_b128 v[60:63], v11 offset:5120
  v_mfma_f32_16x16x32_bf16 v[36:39], a[28:31], v[64:67], v[36:39]
  v_mfma_f32_16x16x32_bf16 v[40:43], a[32:35], v[64:67], v[40:43]
  s_waitcnt lgkmcnt(6)
  v_mfma_f32_16x16x32_bf16 v[32:35], a[36:39], v[68:71], v[32:35]
  ds_read_b128 v[64:67], v11 offset:6144
  v_mfma_f32_16x16x32_bf16 v[36:39], a[40:43], v[68:71], v[36:39]
  buffer_load_dwordx4 v11, s[60:63], s87 offen offset:2048 sc1 lds
  v_mfma_f32_16x16x32_bf16 v[40:43], a[44:47], v[68:71], v[40:43]
  s_waitcnt lgkmcnt(4)
  v_mfma_f32_16x16x32_bf16 v[32:35], a[48:51], v[56:59], v[32:35]
  ds_read_b128 v[68:71], v11 offset:7168
  v_mfma_f32_16x16x32_bf16 v[36:39], a[52:55], v[56:59], v[36:39]
  v_mfma_f32_16x16x32_bf16 v[40:43], a[56:59], v[56:59], v[40:43]
  s_waitcnt lgkmcnt(2)
  buffer_load_dwordx4 v11, s[60:63], s87 offen offset:3072 sc1 lds
  v_mfma_f32_16x16x32_bf16 v[32:35], a[60:63], v[60:63], v[32:35]
  s_add_u32 s87, s87, 4096
  ds_read_b128 v[56:59], v11 offset:8192
  v_mfma_f32_16x16x32_bf16 v[36:39], a[64:67], v[60:63], v[36:39]
  s_add_u32 m0, s88, 45056
  v_mfma_f32_16x16x32_bf16 v[40:43], a[68:71], v[60:63], v[40:43]
  s_waitcnt lgkmcnt(2)
  v_mfma_f32_16x16x32_bf16 v[32:35], a[72:75], v[64:67], v[32:35]
  ds_read_b128 v[60:63], v11 offset:9216
  v_mfma_f32_16x16x32_bf16 v[36:39], a[76:79], v[64:67], v[36:39]
  buffer_load_dwordx4 v11, s[60:63], s87 offen offset:0 sc1 lds
  v_mfma_f32_16x16x32_bf16 v[40:43], a[80:83], v[64:67], v[40:43]
  s_waitcnt lgkmcnt(2)
  v_mfma_f32_16x16x32_bf16 v[32:35], a[84:87], v[68:71], v[32:35]
  s_add_u32 s87, s87, 16384
  ds_read_b128 v[64:67], v11 offset:10240
  v_mfma_f32_16x16x32_bf16 v[36:39], a[88:91], v[68:71], v[36:39]
  s_add_u32 m0, s88, 61440
  v_mfma_f32_16x16x32_bf16 v[40:43], a[92:95], v[68:71], v[40:43]
  s_waitcnt lgkmcnt(2)
  buffer_load_dwordx4 v11, s[60:63], s87 offen offset:0 sc1 lds
  v_mfma_f32_16x16x32_bf16 v[32:35], a[96:99], v[56:59], v[32:35]
  s_add_u32 s24, s60, s89
  s_addc_u32 s25, s61, 0
  ds_read_b128 v[68:71], v11 offset:11264
  v_mfma_f32_16x16x32_bf16 v[36:39], a[100:103], v[56:59], v[36:39]
  v_mfma_f32_16x16x32_bf16 v[40:43], a[104:107], v[56:59], v[40:43]
  s_waitcnt lgkmcnt(2)
  v_mfma_f32_16x16x32_bf16 v[32:35], a[108:111], v[60:63], v[32:35]
  ds_read_b128 v[56:59], v11 offset:12288
  v_mfma_f32_16x16x32_bf16 v[36:39], a[112:115], v[60:63], v[36:39]
  buffer_load_dwordx4 v11, s[60:63], s87 offen offset:1024 sc1 lds
  v_mfma_f32_16x16x32_bf16 v[40:43], a[116:119], v[60:63], v[40:43]
  s_waitcnt lgkmcnt(2)
  v_mfma_f32_16x16x32_bf16 v[32:35], a[120:123], v[64:67], v[32:35]
  ds_read_b128 v[60:63], v11 offset:13312
  v_mfma_f32_16x16x32_bf16 v[36:39], a[124:127], v[64:67], v[36:39]
  v_mfma_f32_16x16x32_bf16 v[40:43], a[128:131], v[64:67], v[40:43]
  s_waitcnt lgkmcnt(2)
  buffer_load_dwordx4 v11, s[60:63], s87 offen offset:2048 sc1 lds
  v_mfma_f32_16x16x32_bf16 v[32:35], a[132:135], v[68:71], v[32:35]
  ds_read_b128 v[64:67], v11 offset:14336
  v_mfma_f32_16x16x32_bf16 v[36:39], a[136:139], v[68:71], v[36:39]
  v_mfma_f32_16x16x32_bf16 v[40:43], a[140:143], v[68:71], v[40:43]
  s_waitcnt lgkmcnt(2)
  v_mfma_f32_16x16x32_bf16 v[32:35], a[144:147], v[56:59], v[32:35]
  ds_read_b128 v[68:71], v11 offset:15360
  v_mfma_f32_16x16x32_bf16 v[36:39], a[148:151], v[56:59], v[36:39]
  buffer_load_dwordx4 v11, s[60:63], s87 offen offset:3072 sc1 lds
  v_mfma_f32_16x16x32_bf16 v[40:43], a[152:155], v[56:59], v[40:43]
  s_waitcnt lgkmcnt(2)
  v_mfma_f32_16x16x32_bf16 v[32:35], a[156:159], v[60:63], v[32:35]
  s_add_u32 s87, s87, 4096
  ds_read_b128 v[56:59], v11 offset:16384
  v_mfma_f32_16x16x32_bf16 v[36:39], a[160:163], v[60:63], v[36:39]
  s_add_u32 m0, s88, 65536
  v_mfma_f32_16x16x32_bf16 v[40:43], a[164:167], v[60:63], v[40:43]
  s_waitcnt lgkmcnt(2)
  buffer_load_dwordx4 v11, s[60:63], s87 offen offset:0 sc1 lds
  v_mfma_f32_16x16x32_bf16 v[32:35], a[168:171], v[64:67], v[32:35]
  s_add_u32 s87, s87, 16384
  ds_read_b128 v[60:63], v11 offset:17408
  v_mfma_f32_16x16x32_bf16 v[36:39], a[172:175], v[64:67], v[36:39]
  s_add_u32 m0, s88, 81920
  v_mfma_f32_16x16x32_bf16 v[40:43], a[176:179], v[64:67], v[40:43]
  s_waitcnt lgkmcnt(2)
  v_mfma_f32_16x16x32_bf16 v[32:35], a[180:183], v[68:71], v[32:35]
  ds_read_b128 v[64:67], v11 offset:18432
  v_mfma_f32_16x16x32_bf16 v[36:39], a[184:187], v[68:71], v[36:39]
  buffer_load_dwordx4 v11, s[60:63], s87 offen offset:0 sc1 lds
  v_mfma_f32_16x16x32_bf16 v[40:43], a[188:191], v[68:71], v[40:43]
  s_waitcnt vmcnt(11)
  s_barrier
  s_waitcnt lgkmcnt(2)
  v_mfma_f32_16x16x32_bf16 v[32:35], a[192:195], v[56:59], v[32:35]
  ds_read_b128 v[68:71], v11 offset:19456
  v_mfma_f32_16x16x32_bf16 v[36:39], a[196:199], v[56:59], v[36:39]
  v_mfma_f32_16x16x32_bf16 v[40:43], a[200:203], v[56:59], v[40:43]
  s_waitcnt lgkmcnt(2)
  buffer_load_dwordx4 v11, s[60:63], s87 offen offset:1024 sc1 lds
  v_mfma_f32_16x16x32_bf16 v[32:35], a[204:207], v[60:63], v[32:35]
  ds_read_b128 v[56:59], v11 offset:20480
  v_mfma_f32_16x16x32_bf16 v[36:39], a[208:211], v[60:63], v[36:39]
  v_mfma_f32_16x16x32_bf16 v[40:43], a[212:215], v[60:63], v[40:43]
  s_waitcnt lgkmcnt(2)
  v_mfma_f32_16x16x32_bf16 v[32:35], a[216:219], v[64:67], v[32:35]
  ds_read_b128 v[60:63], v11 offset:21504
  v_mfma_f32_16x16x32_bf16 v[36:39], a[220:223], v[64:67], v[36:39]
  buffer_load_dwordx4 v11, s[60:63], s87 offen offset:2048 sc1 lds
  v_mfma_f32_16x16x32_bf16 v[40:43], a[224:227], v[64:67], v[40:43]
  s_waitcnt lgkmcnt(2)
  v_mfma_f32_16x16x32_bf16 v[32:35], a[228:231], v[68:71], v[32:35]
  ds_read_b128 v[64:67], v11 offset:22528
  v_mfma_f32_16x16x32_bf16 v[36:39], a[232:235], v[68:71], v[36:39]
  v_mfma_f32_16x16x32_bf16 v[40:43], a[236:239], v[68:71], v[40:43]
  s_waitcnt lgkmcnt(2)
  buffer_load_dwordx4 v11, s[60:63], s87 offen offset:3072 sc1 lds
  v_mfma_f32_16x16x32_bf16 v[44:47], a[0:3], v[56:59], 0
  s_add_u32 s87, s87, 4096
  ds_read_b128 v[68:71], v11 offset:23552
  v_mfma_f32_16x16x32_bf16 v[48:51], a[4:7], v[56:59], 0
  s_add_u32 m0, s88, 86016
  v_mfma_f32_16x16x32_bf16 v[52:55], a[8:11], v[56:59], 0
  s_waitcnt lgkmcnt(2)
  v_mul_f32 v124, s19, v84
  v_mul_f32 v125, s18, v84
  v_mfma_f32_16x16x32_bf16 v[44:47], a[12:15], v[60:63], v[44:47]
  ds_read_b128 v[56:59], v11 offset:24576
  v_mul_f32 v126, v16, v84
  v_mfma_f32_16x16x32_bf16 v[48:51], a[16:19], v[60:63], v[48:51]
  buffer_load_dwordx4 v11, s[60:63], s87 offen offset:0 sc1 lds
  v_mfma_f32_16x16x32_bf16 v[52:55], a[20:23], v[60:63], v[52:55]
  s_waitcnt lgkmcnt(2)
  v_fma_f32 v32, -v85, v72, v32
  v_fma_f32 v33, -v85, v73, v33
  v_mfma_f32_16x16x32_bf16 v[44:47], a[24:27], v[64:67], v[44:47]
  s_add_u32 s87, s87, 16384
  ds_read_b128 v[60:63], v11 offset:25600
  v_fma_f32 v34, -v85, v74, v34
  v_mfma_f32_16x16x32_bf16 v[48:51], a[28:31], v[64:67], v[48:51]
  s_add_u32 m0, s12, 0
  v_fma_f32 v35, -v85, v75, v35
  v_fma_f32 v36, -v85, v76, v36
  v_mfma_f32_16x16x32_bf16 v[52:55], a[32:35], v[64:67], v[52:55]
  s_waitcnt lgkmcnt(2)
  buffer_load_dwordx4 v11, s[60:63], s14 offen offset:0 sc1 lds
  v_mfma_f32_16x16x32_bf16 v[44:47], a[36:39], v[68:71], v[44:47]
  ds_read_b128 v[64:67], v11 offset:26624
  v_fma_f32 v37, -v85, v77, v37
  v_mfma_f32_16x16x32_bf16 v[48:51], a[40:43], v[68:71], v[48:51]
  v_fma_f32 v38, -v85, v78, v38
  v_fma_f32 v39, -v85, v79, v39
  v_mfma_f32_16x16x32_bf16 v[52:55], a[44:47], v[68:71], v[52:55]
  s_waitcnt lgkmcnt(2)
  v_fma_f32 v40, -v85, v80, v40
  v_fma_f32 v41, -v85, v81, v41
  v_mfma_f32_16x16x32_bf16 v[44:47], a[48:51], v[56:59], v[44:47]
  ds_read_b128 v[68:71], v11 offset:27648
  v_fma_f32 v42, -v85, v82, v42
  v_mfma_f32_16x16x32_bf16 v[48:51], a[52:55], v[56:59], v[48:51]
  buffer_load_dwordx4 v11, s[60:63], s14 offen offset:1024 sc1 lds
  v_mfma_f32_16x16x32_bf16 v[52:55], a[56:59], v[56:59], v[52:55]
  s_waitcnt lgkmcnt(2)
  v_fma_f32 v43, -v85, v83, v43
  v_mul_f32 v116, v32, v124
  v_mfma_f32_16x16x32_bf16 v[44:47], a[60:63], v[60:63], v[44:47]
  ds_read_b128 v[56:59], v11 offset:28672
  v_mul_f32 v117, v33, v124
  v_mfma_f32_16x16x32_bf16 v[48:51], a[64:67], v[60:63], v[48:51]
  v_mul_f32 v118, v34, v124
  v_mul_f32 v119, v35, v124
  v_mfma_f32_16x16x32_bf16 v[52:55], a[68:71], v[60:63], v[52:55]
  s_waitcnt lgkmcnt(2)
  global_load_dwordx4 v[130:133], v11, s[24:25] offset:0 sc1
  v_mfma_f32_16x16x32_bf16 v[44:47], a[72:75], v[64:67], v[44:47]
  ds_read_b128 v[60:63], v11 offset:29696
  v_mul_f32 v120, v36, v125
  v_mfma_f32_16x16x32_bf16 v[48:51], a[76:79], v[64:67], v[48:51]
  v_mul_f32 v121, v37, v125
  v_mul_f32 v122, v38, v125
  v_mfma_f32_16x16x32_bf16 v[52:55], a[80:83], v[64:67], v[52:55]
  s_waitcnt lgkmcnt(2)
  v_mul_f32 v123, v39, v125
  v_mul_f32 v100, v40, v126
  v_mfma_f32_16x16x32_bf16 v[44:47], a[84:87], v[68:71], v[44:47]
  ds_read_b128 v[64:67], v11 offset:30720
  v_mul_f32 v101, v41, v126
  v_mfma_f32_16x16x32_bf16 v[48:51], a[88:91], v[68:71], v[48:51]
  buffer_load_dwordx4 v11, s[60:63], s14 offen offset:2048 sc1 lds
  v_mfma_f32_16x16x32_bf16 v[52:55], a[92:95], v[68:71], v[52:55]
  s_waitcnt lgkmcnt(2)
  v_mul_f32 v102, v42, v126
  v_mul_f32 v103, v43, v126
  v_mfma_f32_16x16x32_bf16 v[44:47], a[96:99], v[56:59], v[44:47]
  ds_read_b128 v[68:71], v11 offset:31744
  v_mfma_f32_16x16x32_bf16 v[48:51], a[100:103], v[56:59], v[48:51]
  v_exp_f32 v124, v116
  v_mfma_f32_16x16x32_bf16 v[52:55], a[104:107], v[56:59], v[52:55]
  s_waitcnt lgkmcnt(2)
  buffer_load_dwordx4 v11, s[60:63], s14 offen offset:3072 sc1 lds
  v_mfma_f32_16x16x32_bf16 v[44:47], a[108:111], v[60:63], v[44:47]
  s_add_u32 s14, s14, 4096
  ds_read_b128 v[56:59], v11 offset:32768
  v_mfma_f32_16x16x32_bf16 v[48:51], a[112:115], v[60:63], v[48:51]
  v_exp_f32 v125, v117
  v_mfma_f32_16x16x32_bf16 v[52:55], a[116:119], v[60:63], v[52:55]
  s_waitcnt lgkmcnt(2)
  v_exp_f32 v126, v118
  v_mfma_f32_16x16x32_bf16 v[44:47], a[120:123], v[64:67], v[44:47]
  ds_read_b128 v[60:63], v11 offset:33792
  v_mfma_f32_16x16x32_bf16 v[48:51], a[124:127], v[64:67], v[48:51]
  global_load_dwordx4 v[134:137], v11, s[24:25] offset:1024 sc1
  v_mfma_f32_16x16x32_bf16 v[52:55], a[128:131], v[64:67], v[52:55]
  s_waitcnt lgkmcnt(2)
  v_exp_f32 v127, v119
  v_mfma_f32_16x16x32_bf16 v[44:47], a[132:135], v[68:71], v[44:47]
  ds_read_b128 v[64:67], v11 offset:34816
  v_mul_f32 v116, v116, v120
  v_mfma_f32_16x16x32_bf16 v[48:51], a[136:139], v[68:71], v[48:51]
  s_add_u32 m0, s12, 4096
  v_mul_f32 v117, v117, v121
  v_mul_f32 v118, v118, v122
  v_mfma_f32_16x16x32_bf16 v[52:55], a[140:143], v[68:71], v[52:55]
  s_waitcnt lgkmcnt(2)
  buffer_load_dwordx4 v11, s[60:63], s14 offen offset:0 sc1 lds
  v_mfma_f32_16x16x32_bf16 v[44:47], a[144:147], v[56:59], v[44:47]
  ds_read_b128 v[68:71], v11 offset:35840
  v_mul_f32 v119, v119, v123
  v_mfma_f32_16x16x32_bf16 v[48:51], a[148:151], v[56:59], v[48:51]
  v_add_f32 v124, 1.0, v124
  v_add_f32 v125, 1.0, v125
  v_mfma_f32_16x16x32_bf16 v[52:55], a[152:155], v[56:59], v[52:55]
  s_waitcnt lgkmcnt(2)
  v_add_f32 v126, 1.0, v126
  v_add_f32 v127, 1.0, v127
  v_mfma_f32_16x16x32_bf16 v[44:47], a[156:159], v[60:63], v[44:47]
  ds_read_b128 v[56:59], v11 offset:36864
  v_mfma_f32_16x16x32_bf16 v[48:51], a[160:163], v[60:63], v[48:51]
  global_load_dwordx4 v[138:141], v11, s[24:25] offset:2048 sc1
  v_mfma_f32_16x16x32_bf16 v[52:55], a[164:167], v[60:63], v[52:55]
  s_waitcnt lgkmcnt(2)
  v_rcp_f32 v124, v124
  v_mfma_f32_16x16x32_bf16 v[44:47], a[168:171], v[64:67], v[44:47]
  ds_read_b128 v[60:63], v11 offset:37888
  v_mfma_f32_16x16x32_bf16 v[48:51], a[172:175], v[64:67], v[48:51]
  v_rcp_f32 v125, v125
  v_mfma_f32_16x16x32_bf16 v[52:55], a[176:179], v[64:67], v[52:55]
  s_waitcnt lgkmcnt(2)
  buffer_load_dwordx4 v11, s[60:63], s14 offen offset:1024 sc1 lds
  v_mfma_f32_16x16x32_bf16 v[44:47], a[180:183], v[68:71], v[44:47]
  ds_read_b128 v[64:67], v11 offset:38912
  v_mfma_f32_16x16x32_bf16 v[48:51], a[184:187], v[68:71], v[48:51]
  v_rcp_f32 v126, v126
  v_mfma_f32_16x16x32_bf16 v[52:55], a[188:191], v[68:71], v[52:55]
  v_rcp_f32 v127, v127
  s_waitcnt vmcnt(19)
  s_barrier
  s_waitcnt lgkmcnt(2)
  v_mfma_f32_16x16x32_bf16 v[44:47], a[192:195], v[56:59], v[44:47]
  ds_read_b128 v[68:71], v11 offset:39936
  v_mul_f32 v116, v116, v124
  v_mfma_f32_16x16x32_bf16 v[48:51], a[196:199], v[56:59], v[48:51]
  global_load_dwordx4 v[142:145], v11, s[24:25] offset:3072 sc1
  v_mfma_f32_16x16x32_bf16 v[52:55], a[200:203], v[56:59], v[52:55]
  s_waitcnt lgkmcnt(2)
  v_mul_f32 v117, v117, v125
  v_mul_f32 v118, v118, v126
  v_mfma_f32_16x16x32_bf16 v[44:47], a[204:207], v[60:63], v[44:47]
  s_add_u32 s89, s89, 4096
  ds_read_b128 v[56:59], v11 offset:40960
  v_mul_f32 v119, v119, v127
  v_mfma_f32_16x16x32_bf16 v[48:51], a[208:211], v[60:63], v[48:51]
  s_add_u32 s24, s60, s89
  s_addc_u32 s25, s61, 0
  v_cvt_pk_bf16_f32 v108, v116, v117
  v_cvt_pk_bf16_f32 v109, v118, v119
  v_mfma_f32_16x16x32_bf16 v[52:55], a[212:215], v[60:63], v[52:55]
  s_waitcnt lgkmcnt(2)
  buffer_load_dwordx4 v11, s[60:63], s14 offen offset:2048 sc1 lds
  v_mfma_f32_16x16x32_bf16 v[44:47], a[216:219], v[64:67], v[44:47]
  ds_read_b128 v[60:63], v11 offset:41984
  v_mfma_f32_16x16x32_bf16 v[48:51], a[220:223], v[64:67], v[48:51]
  v_mfma_f32_16x16x32_bf16 v[52:55], a[224:227], v[64:67], v[52:55]
  s_waitcnt lgkmcnt(2)
  v_mfma_f32_16x16x32_bf16 v[44:47], a[228:231], v[68:71], v[44:47]
  ds_read_b128 v[64:67], v11 offset:43008
  v_mfma_f32_16x16x32_bf16 v[48:51], a[232:235], v[68:71], v[48:51]
  buffer_load_dwordx4 v11, s[60:63], s14 offen offset:3072 sc1 lds
  v_mfma_f32_16x16x32_bf16 v[52:55], a[236:239], v[68:71], v[52:55]
  s_waitcnt lgkmcnt(2)
  v_mfma_f32_16x16x32_bf16 v[32:35], a[0:3], v[56:59], 0
  s_add_u32 m0, s88, 0
  ds_read_b128 v[68:71], v11 offset:44032
  v_mfma_f32_16x16x32_bf16 v[36:39], a[4:7], v[56:59], 0
  s_add_u32 s14, s14, 4096
  v_mfma_f32_16x16x32_bf16 v[40:43], a[8:11], v[56:59], 0
  s_waitcnt lgkmcnt(2)
  buffer_load_dwordx4 v11, s[60:63], s87 offen offset:0 sc1 lds
  v_mfma_f32_16x16x32_bf16 v[32:35], a[12:15], v[60:63], v[32:35]
  ds_read_b128 v[56:59], v11 offset:45056
  v_mul_f32 v124, s19, v86
  v_mfma_f32_16x16x32_bf16 v[36:39], a[16:19], v[60:63], v[36:39]
  v_mul_f32 v125, s18, v86
  v_mul_f32 v126, v16, v86
  v_mfma_f32_16x16x32_bf16 v[40:43], a[20:23], v[60:63], v[40:43]
  s_waitcnt lgkmcnt(2)
  v_fma_f32 v44, -v87, v72, v44
  v_fma_f32 v45, -v87, v73, v45
  v_mfma_f32_16x16x32_bf16 v[32:35], a[24:27], v[64:67], v[32:35]
  ds_read_b128 v[60:63], v11 offset:46080
  v_fma_f32 v46, -v87, v74, v46
  v_mfma_f32_16x16x32_bf16 v[36:39], a[28:31], v[64:67], v[36:39]
  buffer_load_dwordx4 v11, s[60:63], s87 offen offset:1024 sc1 lds
  v_mfma_f32_16x16x32_bf16 v[40:43], a[32:35], v[64:67], v[40:43]
  s_waitcnt lgkmcnt(2)
  v_fma_f32 v47, -v87, v75, v47
  v_fma_f32 v48, -v87, v76, v48
  v_mfma_f32_16x16x32_bf16 v[32:35], a[36:39], v[68:71], v[32:35]
  ds_read_b128 v[64:67], v11 offset:47104
  v_fma_f32 v49, -v87, v77, v49
  v_mfma_f32_16x16x32_bf16 v[36:39], a[40:43], v[68:71], v[36:39]
  v_fma_f32 v50, -v87, v78, v50
  v_fma_f32 v51, -v87, v79, v51
  v_mfma_f32_16x16x32_bf16 v[40:43], a[44:47], v[68:71], v[40:43]
  s_waitcnt lgkmcnt(2)
  buffer_load_dwordx4 v11, s[60:63], s87 offen offset:2048 sc1 lds
  v_mfma_f32_16x16x32_bf16 v[32:35], a[48:51], v[56:59], v[32:35]
  ds_read_b128 v[68:71], v11 offset:48128
  v_fma_f32 v52, -v87, v80, v52
  v_mfma_f32_16x16x32_bf16 v[36:39], a[52:55], v[56:59], v[36:39]
  v_fma_f32 v53, -v87, v81, v53
  v_fma_f32 v54, -v87, v82, v54
  v_mfma_f32_16x16x32_bf16 v[40:43], a[56:59], v[56:59], v[40:43]
  s_waitcnt lgkmcnt(2)
  v_fma_f32 v55, -v87, v83, v55
  v_mul_f32 v116, v44, v124
  v_mfma_f32_16x16x32_bf16 v[32:35], a[60:63], v[60:63], v[32:35]
  ds_read_b128 v[56:59], v11 offset:49152
  v_mul_f32 v117, v45, v124
  v_mfma_f32_16x16x32_bf16 v[36:39], a[64:67], v[60:63], v[36:39]
  buffer_load_dwordx4 v11, s[60:63], s87 offen offset:3072 sc1 lds
  v_mfma_f32_16x16x32_bf16 v[40:43], a[68:71], v[60:63], v[40:43]
  s_waitcnt lgkmcnt(2)
  v_mul_f32 v118, v46, v124
  v_mul_f32 v119, v47, v124
  v_mfma_f32_16x16x32_bf16 v[32:35], a[72:75], v[64:67], v[32:35]
  s_add_u32 s87, s87, 4096
  ds_read_b128 v[60:63], v11 offset:50176
  v_mul_f32 v120, v48, v125
  v_mfma_f32_16x16x32_bf16 v[36:39], a[76:79], v[64:67], v[36:39]
  s_add_u32 m0, s88, 4096
  v_mul_f32 v121, v49, v125
  v_mul_f32 v122, v50, v125
  v_mfma_f32_16x16x32_bf16 v[40:43], a[80:83], v[64:67], v[40:43]
  s_waitcnt lgkmcnt(2)
  buffer_load_dwordx4 v11, s[60:63], s87 offen offset:0 sc1 lds
  v_mfma_f32_16x16x32_bf16 v[32:35], a[84:87], v[68:71], v[32:35]
  s_add_u32 s87, s87, 16384
  ds_read_b128 v[64:67], v11 offset:51200
  v_mul_f32 v123, v51, v125
  v_mfma_f32_16x16x32_bf16 v[36:39], a[88:91], v[68:71], v[36:39]
  s_add_u32 m0, s12, 8192
  v_mul_f32 v104, v52, v126
  v_mul_f32 v105, v53, v126
  v_mfma_f32_16x16x32_bf16 v[40:43], a[92:95], v[68:71], v[40:43]
  s_waitcnt lgkmcnt(2)
  v_mul_f32 v106, v54, v126
  v_mul_f32 v107, v55, v126
  v_mfma_f32_16x16x32_bf16 v[32:35], a[96:99], v[56:59], v[32:35]
  ds_read_b128 v[68:71], v11 offset:52224
  v_mfma_f32_16x16x32_bf16 v[36:39], a[100:103], v[56:59], v[36:39]
  buffer_load_dwordx4 v11, s[60:63], s14 offen offset:0 sc1 lds
  v_mfma_f32_16x16x32_bf16 v[40:43], a[104:107], v[56:59], v[40:43]
  s_waitcnt lgkmcnt(2)
  v_exp_f32 v124, v116
  v_mfma_f32_16x16x32_bf16 v[32:35], a[108:111], v[60:63], v[32:35]
  ds_read_b128 v[56:59], v11 offset:53248
  v_mfma_f32_16x16x32_bf16 v[36:39], a[112:115], v[60:63], v[36:39]
  v_exp_f32 v125, v117
  v_mfma_f32_16x16x32_bf16 v[40:43], a[116:119], v[60:63], v[40:43]
  s_waitcnt lgkmcnt(2)
  buffer_load_dwordx4 v11, s[60:63], s14 offen offset:1024 sc1 lds
  v_mfma_f32_16x16x32_bf16 v[32:35], a[120:123], v[64:67], v[32:35]
  ds_read_b128 v[60:63], v11 offset:54272
  v_mfma_f32_16x16x32_bf16 v[36:39], a[124:127], v[64:67], v[36:39]
  v_exp_f32 v126, v118
  v_mfma_f32_16x16x32_bf16 v[40:43], a[128:131], v[64:67], v[40:43]
  s_waitcnt lgkmcnt(2)
  v_exp_f32 v127, v119
  v_mfma_f32_16x16x32_bf16 v[32:35], a[132:135], v[68:71], v[32:35]
  ds_read_b128 v[64:67], v11 offset:55296
  v_mul_f32 v116, v116, v120
  v_mfma_f32_16x16x32_bf16 v[36:39], a[136:139], v[68:71], v[36:39]
  buffer_load_dwordx4 v11, s[60:63], s14 offen offset:2048 sc1 lds
  v_mfma_f32_16x16x32_bf16 v[40:43], a[140:143], v[68:71], v[40:43]
  s_waitcnt lgkmcnt(2)
  v_mul_f32 v117, v117, v121
  v_mul_f32 v118, v118, v122
  v_mfma_f32_16x16x32_bf16 v[32:35], a[144:147], v[56:59], v[32:35]
  ds_read_b128 v[68:71], v11 offset:56320
  v_mul_f32 v119, v119, v123
  v_mfma_f32_16x16x32_bf16 v[36:39], a[148:151], v[56:59], v[36:39]
  v_add_f32 v124, 1.0, v124
  v_add_f32 v125, 1.0, v125
  v_mfma_f32_16x16x32_bf16 v[40:43], a[152:155], v[56:59], v[40:43]
  s_waitcnt lgkmcnt(2)
  buffer_load_dwordx4 v11, s[60:63], s14 offen offset:3072 sc1 lds
  v_mfma_f32_16x16x32_bf16 v[32:35], a[156:159], v[60:63], v[32:35]
  s_add_u32 s14, s14, 4096
  ds_read_b128 v[56:59], v11 offset:57344
  v_add_f32 v126, 1.0, v126
  v_mfma_f32_16x16x32_bf16 v[36:39], a[160:163], v[60:63], v[36:39]
  s_add_u32 m0, s12, 12288
  v_add_f32 v127, 1.0, v127
  v_mfma_f32_16x16x32_bf16 v[40:43], a[164:167], v[60:63], v[40:43]
  s_waitcnt lgkmcnt(2)
  v_rcp_f32 v124, v124
  v_mfma_f32_16x16x32_bf16 v[32:35], a[168:171], v[64:67], v[32:35]
  ds_read_b128 v[60:63], v11 offset:58368
  v_mfma_f32_16x16x32_bf16 v[36:39], a[172:175], v[64:67], v[36:39]
  buffer_load_dwordx4 v11, s[60:63], s14 offen offset:0 sc1 lds
  v_mfma_f32_16x16x32_bf16 v[40:43], a[176:179], v[64:67], v[40:43]
  s_waitcnt lgkmcnt(2)
  v_rcp_f32 v125, v125
  v_mfma_f32_16x16x32_bf16 v[32:35], a[180:183], v[68:71], v[32:35]
  ds_read_b128 v[64:67], v11 offset:59392
  v_mfma_f32_16x16x32_bf16 v[36:39], a[184:187], v[68:71], v[36:39]
  v_rcp_f32 v126, v126
  v_mfma_f32_16x16x32_bf16 v[40:43], a[188:191], v[68:71], v[40:43]
  buffer_load_dwordx4 v11, s[60:63], s14 offen offset:1024 sc1 lds
  s_waitcnt vmcnt(28)
  s_barrier
  s_waitcnt lgkmcnt(2)
  v_mfma_f32_16x16x32_bf16 v[32:35], a[192:195], v[56:59], v[32:35]
  ds_read_b128 v[68:71], v11 offset:60416
  v_mfma_f32_16x16x32_bf16 v[36:39], a[196:199], v[56:59], v[36:39]
  v_rcp_f32 v127, v127
  v_mfma_f32_16x16x32_bf16 v[40:43], a[200:203], v[56:59], v[40:43]
  s_waitcnt lgkmcnt(2)
  v_mul_f32 v116, v116, v124
  v_mul_f32 v117, v117, v125
  v_mfma_f32_16x16x32_bf16 v[32:35], a[204:207], v[60:63], v[32:35]
  ds_read_b128 v[56:59], v12 offset:0
  v_mul_f32 v118, v118, v126
  v_mfma_f32_16x16x32_bf16 v[36:39], a[208:211], v[60:63], v[36:39]
  global_load_dwordx4 v[146:149], v11, s[24:25] offset:0 sc1
  v_mfma_f32_16x16x32_bf16 v[40:43], a[212:215], v[60:63], v[40:43]
  s_waitcnt lgkmcnt(2)
  v_mul_f32 v119, v119, v127
  v_cvt_pk_bf16_f32 v110, v116, v117
  v_mfma_f32_16x16x32_bf16 v[32:35], a[216:219], v[64:67], v[32:35]
  ds_read_b128 v[60:63], v12 offset:1024
  v_cvt_pk_bf16_f32 v111, v118, v119
  v_mfma_f32_16x16x32_bf16 v[36:39], a[220:223], v[64:67], v[36:39]
  v_permlane32_swap_b32 v100, v104
  v_mfma_f32_16x16x32_bf16 v[40:43], a[224:227], v[64:67], v[40:43]
  s_waitcnt lgkmcnt(2)
  buffer_load_dwordx4 v11, s[60:63], s14 offen offset:2048 sc1 lds
  v_mfma_f32_16x16x32_bf16 v[32:35], a[228:231], v[68:71], v[32:35]
  s_add_u32 m0, s88, 20480
  ds_read_b128 v[64:67], v12 offset:2048
  v_mfma_f32_16x16x32_bf16 v[36:39], a[232:235], v[68:71], v[36:39]
  s_add_u32 s14, s14, 3072
  v_permlane32_swap_b32 v101, v105
  v_mfma_f32_16x16x32_bf16 v[40:43], a[236:239], v[68:71], v[40:43]
  s_waitcnt lgkmcnt(2)
  v_permlane32_swap_b32 v102, v106
  v_mfma_f32_16x16x32_bf16 v[44:47], a[0:3], v[56:59], 0
  ds_read_b128 v[68:71], v12 offset:3072
  v_mfma_f32_16x16x32_bf16 v[48:51], a[4:7], v[56:59], 0
  buffer_load_dwordx4 v11, s[60:63], s87 offen offset:0 sc1 lds
  v_mfma_f32_16x16x32_bf16 v[52:55], a[8:11], v[56:59], 0
  s_waitcnt lgkmcnt(2)
  v_permlane32_swap_b32 v103, v107
  v_mfma_f32_16x16x32_bf16 v[44:47], a[12:15], v[60:63], v[44:47]
  ds_read_b128 v[56:59], v12 offset:4096
  v_mfma_f32_16x16x32_bf16 v[48:51], a[16:19], v[60:63], v[48:51]
  v_permlane16_swap_b32 v108, v110
  v_mfma_f32_16x16x32_bf16 v[52:55], a[20:23], v[60:63], v[52:55]
  s_waitcnt lgkmcnt(2)
  buffer_load_dwordx4 v11, s[60:63], s87 offen offset:1024 sc1 lds
  v_mfma_f32_16x16x32_bf16 v[44:47], a[24:27], v[64:67], v[44:47]
  ds_read_b128 v[60:63], v12 offset:5120
  v_mfma_f32_16x16x32_bf16 v[48:51], a[28:31], v[64:67], v[48:51]
  v_permlane16_swap_b32 v109, v111
  v_mfma_f32_16x16x32_bf16 v[52:55], a[32:35], v[64:67], v[52:55]
  s_waitcnt lgkmcnt(2)
  v_mfma_f32_16x16x32_bf16 v[44:47], a[36:39], v[68:71], v[44:47]
  s_mov_b32 s92, 0
  ds_read_b128 v[64:67], v12 offset:6144
  v_mfma_f32_16x16x32_bf16 v[48:51], a[40:43], v[68:71], v[48:51]
  buffer_load_dwordx4 v11, s[60:63], s87 offen offset:2048 sc1 lds
  v_mfma_f32_16x16x32_bf16 v[52:55], a[44:47], v[68:71], v[52:55]
  s_waitcnt lgkmcnt(2)
  buffer_store_dwordx4 v[108:111], v13, s[60:63], s92 offen sc1
  v_mfma_f32_16x16x32_bf16 v[44:47], a[48:51], v[56:59], v[44:47]
  ds_read_b128 v[68:71], v12 offset:7168
  v_mfma_f32_16x16x32_bf16 v[48:51], a[52:55], v[56:59], v[48:51]
  v_exp_f32 v124, v100
  v_mfma_f32_16x16x32_bf16 v[52:55], a[56:59], v[56:59], v[52:55]
  s_waitcnt lgkmcnt(2)
  v_exp_f32 v125, v101
  v_mfma_f32_16x16x32_bf16 v[44:47], a[60:63], v[60:63], v[44:47]
  ds_read_b128 v[56:59], v12 offset:8192
  v_mfma_f32_16x16x32_bf16 v[48:51], a[64:67], v[60:63], v[48:51]
  buffer_load_dwordx4 v11, s[60:63], s87 offen offset:3072 sc1 lds
  v_mfma_f32_16x16x32_bf16 v[52:55], a[68:71], v[60:63], v[52:55]
  s_waitcnt lgkmcnt(2)
  v_exp_f32 v126, v102
  v_mfma_f32_16x16x32_bf16 v[44:47], a[72:75], v[64:67], v[44:47]
  s_add_u32 s87, s87, 4096
  ds_read_b128 v[60:63], v12 offset:9216
  v_mfma_f32_16x16x32_bf16 v[48:51], a[76:79], v[64:67], v[48:51]
  s_add_u32 m0, s88, 24576
  v_exp_f32 v127, v103
  v_mfma_f32_16x16x32_bf16 v[52:55], a[80:83], v[64:67], v[52:55]
  s_waitcnt lgkmcnt(2)
  buffer_load_dwordx4 v11, s[60:63], s87 offen offset:0 sc1 lds
  v_mfma_f32_16x16x32_bf16 v[44:47], a[84:87], v[68:71], v[44:47]
  s_add_u32 s87, s87, 16384
  ds_read_b128 v[64:67], v12 offset:10240
  v_mul_f32 v100, v100, v104
  v_mfma_f32_16x16x32_bf16 v[48:51], a[88:91], v[68:71], v[48:51]
  v_mul_f32 v101, v101, v105
  v_mul_f32 v102, v102, v106
  v_mfma_f32_16x16x32_bf16 v[52:55], a[92:95], v[68:71], v[52:55]
  s_waitcnt lgkmcnt(2)
  v_mul_f32 v103, v103, v107
  v_add_f32 v124, 1.0, v124
  v_mfma_f32_16x16x32_bf16 v[44:47], a[96:99], v[56:59], v[44:47]
  ds_read_b128 v[68:71], v12 offset:11264
  v_add_f32 v125, 1.0, v125
  v_mfma_f32_16x16x32_bf16 v[48:51], a[100:103], v[56:59], v[48:51]
  global_load_dwordx4 v[150:153], v11, s[24:25] offset:1024 sc1
  v_mfma_f32_16x16x32_bf16 v[52:55], a[104:107], v[56:59], v[52:55]
  s_waitcnt lgkmcnt(2)
  v_add_f32 v126, 1.0, v126
  v_add_f32 v127, 1.0, v127
  v_mfma_f32_16x16x32_bf16 v[44:47], a[108:111], v[60:63], v[44:47]
  ds_read_b128 v[56:59], v12 offset:12288
  v_mfma_f32_16x16x32_bf16 v[48:51], a[112:115], v[60:63], v[48:51]
  v_rcp_f32 v124, v124
  v_mfma_f32_16x16x32_bf16 v[52:55], a[116:119], v[60:63], v[52:55]
  s_waitcnt lgkmcnt(2)
  global_load_dwordx4 v[154:157], v11, s[24:25] offset:2048 sc1
  v_mfma_f32_16x16x32_bf16 v[44:47], a[120:123], v[64:67], v[44:47]
  ds_read_b128 v[60:63], v12 offset:13312
  v_mfma_f32_16x16x32_bf16 v[48:51], a[124:127], v[64:67], v[48:51]
  v_rcp_f32 v125, v125
  v_mfma_f32_16x16x32_bf16 v[52:55], a[128:131], v[64:67], v[52:55]
  s_waitcnt lgkmcnt(2)
  v_rcp_f32 v126, v126
  v_mfma_f32_16x16x32_bf16 v[44:47], a[132:135], v[68:71], v[44:47]
  ds_read_b128 v[64:67], v12 offset:14336
  v_mfma_f32_16x16x32_bf16 v[48:51], a[136:139], v[68:71], v[48:51]
  global_load_dwordx4 v[158:161], v11, s[24:25] offset:3072 sc1
  v_mfma_f32_16x16x32_bf16 v[52:55], a[140:143], v[68:71], v[52:55]
  s_waitcnt lgkmcnt(2)
  v_rcp_f32 v127, v127
  v_mfma_f32_16x16x32_bf16 v[44:47], a[144:147], v[56:59], v[44:47]
  s_add_u32 s89, s89, 4096
  ds_read_b128 v[68:71], v12 offset:15360
  v_mul_f32 v100, v100, v124
  v_mfma_f32_16x16x32_bf16 v[48:51], a[148:151], v[56:59], v[48:51]
  s_add_u32 s24, s60, s89
  s_addc_u32 s25, s61, 0
  v_mul_f32 v101, v101, v125
  v_mul_f32 v102, v102, v126
  v_mfma_f32_16x16x32_bf16 v[52:55], a[152:155], v[56:59], v[52:55]
  s_waitcnt lgkmcnt(2)
  global_load_dwordx4 v[162:165], v11, s[24:25] offset:0 sc1
  v_mfma_f32_16x16x32_bf16 v[44:47], a[156:159], v[60:63], v[44:47]
  ds_read_b128 v[56:59], v12 offset:16384
  v_mul_f32 v103, v103, v127
  v_mfma_f32_16x16x32_bf16 v[48:51], a[160:163], v[60:63], v[48:51]
  v_cvt_pk_bf16_f32 v112, v100, v101
  v_cvt_pk_bf16_f32 v113, v102, v103
  v_mfma_f32_16x16x32_bf16 v[52:55], a[164:167], v[60:63], v[52:55]
  s_waitcnt lgkmcnt(2)
  buffer_store_dwordx2 v[112:113], v14, s[60:63], s92 offen sc1
  v_mfma_f32_16x16x32_bf16 v[44:47], a[168:171], v[64:67], v[44:47]
  ds_read_b128 v[60:63], v12 offset:17408
  v_mul_f32 v124, s19, v88
  v_mfma_f32_16x16x32_bf16 v[48:51], a[172:175], v[64:67], v[48:51]
  v_mul_f32 v125, s18, v88
  v_mul_f32 v126, v16, v88
  v_mfma_f32_16x16x32_bf16 v[52:55], a[176:179], v[64:67], v[52:55]
  s_waitcnt lgkmcnt(2)
  v_fma_f32 v32, -v89, v72, v32
  v_fma_f32 v33, -v89, v73, v33
  v_mfma_f32_16x16x32_bf16 v[44:47], a[180:183], v[68:71], v[44:47]
  ds_read_b128 v[64:67], v12 offset:18432
  v_fma_f32 v34, -v89, v74, v34
  v_mfma_f32_16x16x32_bf16 v[48:51], a[184:187], v[68:71], v[48:51]
  global_load_dwordx4 v[166:169], v11, s[24:25] offset:1024 sc1
  v_mfma_f32_16x16x32_bf16 v[52:55], a[188:191], v[68:71], v[52:55]
  v_fma_f32 v35, -v89, v75, v35
  v_fma_f32 v36, -v89, v76, v36
  s_waitcnt vmcnt(37)
  s_barrier
  s_waitcnt lgkmcnt(2)
  v_mfma_f32_16x16x32_bf16 v[44:47], a[192:195], v[56:59], v[44:47]
  ds_read_b128 v[68:71], v12 offset:19456
  v_fma_f32 v37, -v89, v77, v37
  v_mfma_f32_16x16x32_bf16 v[48:51], a[196:199], v[56:59], v[48:51]
  s_add_u32 m0, s88, 40960
  v_fma_f32 v38, -v89, v78, v38
  v_fma_f32 v39, -v89, v79, v39
  v_mfma_f32_16x16x32_bf16 v[52:55], a[200:203], v[56:59], v[52:55]
  s_waitcnt lgkmcnt(2)
  buffer_load_dwordx4 v11, s[60:63], s87 offen offset:0 sc1 lds
  v_mfma_f32_16x16x32_bf16 v[44:47], a[204:207], v[60:63], v[44:47]
  ds_read_b128 v[56:59], v12 offset:20480
  v_fma_f32 v40, -v89, v80, v40
  v_mfma_f32_16x16x32_bf16 v[48:51], a[208:211], v[60:63], v[48:51]
  v_fma_f32 v41, -v89, v81, v41
  v_fma_f32 v42, -v89, v82, v42
  v_mfma_f32_16x16x32_bf16 v[52:55], a[212:215], v[60:63], v[52:55]
  s_waitcnt lgkmcnt(2)
  v_fma_f32 v43, -v89, v83, v43
  v_mul_f32 v116, v32, v124
  v_mfma_f32_16x16x32_bf16 v[44:47], a[216:219], v[64:67], v[44:47]
  ds_read_b128 v[60:63], v12 offset:21504
  v_mul_f32 v117, v33, v124
  v_mfma_f32_16x16x32_bf16 v[48:51], a[220:223], v[64:67], v[48:51]
  buffer_load_dwordx4 v11, s[60:63], s87 offen offset:1024 sc1 lds
  v_mfma_f32_16x16x32_bf16 v[52:55], a[224:227], v[64:67], v[52:55]
  s_waitcnt lgkmcnt(2)
  v_mul_f32 v118, v34, v124
  v_mul_f32 v119, v35, v124
  v_mfma_f32_16x16x32_bf16 v[44:47], a[228:231], v[68:71], v[44:47]
  ds_read_b128 v[64:67], v12 offset:22528
  v_mul_f32 v120, v36, v125
  v_mfma_f32_16x16x32_bf16 v[48:51], a[232:235], v[68:71], v[48:51]
  v_mul_f32 v121, v37, v125
  v_mul_f32 v122, v38, v125
  v_mfma_f32_16x16x32_bf16 v[52:55], a[236:239], v[68:71], v[52:55]
  s_waitcnt lgkmcnt(2)
  buffer_load_dwordx4 v11, s[60:63], s87 offen offset:2048 sc1 lds
  v_mul_f32 v123, v39, v125
  v_mul_f32 v100, v40, v126
  v_mul_f32 v101, v41, v126
  v_mul_f32 v102, v42, v126
  v_mul_f32 v103, v43, v126
  v_mfma_f32_16x16x32_bf16 v[32:35], a[0:3], v[56:59], 0
  ds_read_b128 v[68:71], v12 offset:23552
  v_mfma_f32_16x16x32_bf16 v[36:39], a[4:7], v[56:59], 0
  v_exp_f32 v124, v116
  v_mfma_f32_16x16x32_bf16 v[40:43], a[8:11], v[56:59], 0
  s_waitcnt lgkmcnt(2)
  v_exp_f32 v125, v117
  v_mfma_f32_16x16x32_bf16 v[32:35], a[12:15], v[60:63], v[32:35]
  ds_read_b128 v[56:59], v12 offset:24576
  v_mfma_f32_16x16x32_bf16 v[36:39], a[16:19], v[60:63], v[36:39]
  buffer_load_dwordx4 v11, s[60:63], s87 offen offset:3072 sc1 lds
  v_mfma_f32_16x16x32_bf16 v[40:43], a[20:23], v[60:63], v[40:43]
  s_waitcnt lgkmcnt(2)
  v_exp_f32 v126, v118
  v_mfma_f32_16x16x32_bf16 v[32:35], a[24:27], v[64:67], v[32:35]
  s_add_u32 s87, s87, 4096
  ds_read_b128 v[60:63], v12 offset:25600
  v_mfma_f32_16x16x32_bf16 v[36:39], a[28:31], v[64:67], v[36:39]
  s_add_u32 m0, s88, 45056
  v_exp_f32 v127, v119
  v_mfma_f32_16x16x32_bf16 v[40:43], a[32:35], v[64:67], v[40:43]
  s_waitcnt lgkmcnt(2)
  buffer_load_dwordx4 v11, s[60:63], s87 offen offset:0 sc1 lds
  v_mfma_f32_16x16x32_bf16 v[32:35], a[36:39], v[68:71], v[32:35]
  s_add_u32 s87, s87, 16384
  ds_read_b128 v[64:67], v12 offset:26624
  v_mul_f32 v116, v116, v120
  v_mfma_f32_16x16x32_bf16 v[36:39], a[40:43], v[68:71], v[36:39]
  v_mul_f32 v117, v117, v121
  v_mul_f32 v118, v118, v122
  v_mfma_f32_16x16x32_bf16 v[40:43], a[44:47], v[68:71], v[40:43]
  s_waitcnt lgkmcnt(2)
  v_mul_f32 v119, v119, v123
  v_add_f32 v124, 1.0, v124
  v_mfma_f32_16x16x32_bf16 v[32:35], a[48:51], v[56:59], v[32:35]
  ds_read_b128 v[68:71], v12 offset:27648
  v_add_f32 v125, 1.0, v125
  v_mfma_f32_16x16x32_bf16 v[36:39], a[52:55], v[56:59], v[36:39]
  global_load_dwordx4 v[170:173], v11, s[24:25] offset:2048 sc1
  v_mfma_f32_16x16x32_bf16 v[40:43], a[56:59], v[56:59], v[40:43]
  s_waitcnt lgkmcnt(2)
  v_add_f32 v126, 1.0, v126
  v_add_f32 v127, 1.0, v127
  v_mfma_f32_16x16x32_bf16 v[32:35], a[60:63], v[60:63], v[32:35]
  ds_read_b128 v[56:59], v12 offset:28672
  v_mfma_f32_16x16x32_bf16 v[36:39], a[64:67], v[60:63], v[36:39]
  v_rcp_f32 v124, v124
  v_mfma_f32_16x16x32_bf16 v[40:43], a[68:71], v[60:63], v[40:43]
  s_waitcnt lgkmcnt(2)
  global_load_dwordx4 v[174:177], v11, s[24:25] offset:3072 sc1
  v_mfma_f32_16x16x32_bf16 v[32:35], a[72:75], v[64:67], v[32:35]
  s_add_u32 s89, s89, 4096
  ds_read_b128 v[60:63], v12 offset:29696
  v_mfma_f32_16x16x32_bf16 v[36:39], a[76:79], v[64:67], v[36:39]
  s_add_u32 s24, s60, s89
  s_addc_u32 s25, s61, 0
  v_rcp_f32 v125, v125
  v_mfma_f32_16x16x32_bf16 v[40:43], a[80:83], v[64:67], v[40:43]
  s_waitcnt lgkmcnt(2)
  v_rcp_f32 v126, v126
  v_mfma_f32_16x16x32_bf16 v[32:35], a[84:87], v[68:71], v[32:35]
  ds_read_b128 v[64:67], v12 offset:30720
  v_mfma_f32_16x16x32_bf16 v[36:39], a[88:91], v[68:71], v[36:39]
  global_load_dwordx4 v[178:181], v11, s[24:25] offset:0 sc1
  v_mfma_f32_16x16x32_bf16 v[40:43], a[92:95], v[68:71], v[40:43]
  s_waitcnt lgkmcnt(2)
  v_rcp_f32 v127, v127
  v_mfma_f32_16x16x32_bf16 v[32:35], a[96:99], v[56:59], v[32:35]
  ds_read_b128 v[68:71], v12 offset:31744
  v_mul_f32 v116, v116, v124
  v_mfma_f32_16x16x32_bf16 v[36:39], a[100:103], v[56:59], v[36:39]
  v_mul_f32 v117, v117, v125
  v_mul_f32 v118, v118, v126
  v_mfma_f32_16x16x32_bf16 v[40:43], a[104:107], v[56:59], v[40:43]
  s_waitcnt lgkmcnt(2)
  global_load_dwordx4 v[182:185], v11, s[24:25] offset:1024 sc1
  v_mfma_f32_16x16x32_bf16 v[32:35], a[108:111], v[60:63], v[32:35]
  ds_read_b128 v[56:59], v12 offset:32768
  v_mul_f32 v119, v119, v127
  v_mfma_f32_16x16x32_bf16 v[36:39], a[112:115], v[60:63], v[36:39]
  s_waitcnt vmcnt(10)
  v_cvt_pk_bf16_f32 v108, v116, v117
  v_cvt_pk_bf16_f32 v109, v118, v119
  v_mfma_f32_16x16x32_bf16 v[40:43], a[116:119], v[60:63], v[40:43]
  s_waitcnt lgkmcnt(2)
  buffer_store_dword v19, v15, s[60:63], 0 offen offset:0
  v_mfma_f32_16x16x32_bf16 v[32:35], a[120:123], v[64:67], v[32:35]
  ds_read_b128 v[60:63], v12 offset:33792
  v_mul_f32 v124, s19, v90
  v_mfma_f32_16x16x32_bf16 v[36:39], a[124:127], v[64:67], v[36:39]
  v_mul_f32 v125, s18, v90
  v_mul_f32 v126, v16, v90
  v_mfma_f32_16x16x32_bf16 v[40:43], a[128:131], v[64:67], v[40:43]
  s_waitcnt lgkmcnt(2)
  v_fma_f32 v44, -v91, v72, v44
  v_fma_f32 v45, -v91, v73, v45
  v_mfma_f32_16x16x32_bf16 v[32:35], a[132:135], v[68:71], v[32:35]
  ds_read_b128 v[64:67], v12 offset:34816
  v_fma_f32 v46, -v91, v74, v46
  v_mfma_f32_16x16x32_bf16 v[36:39], a[136:139], v[68:71], v[36:39]
  global_load_dwordx4 v[186:189], v11, s[24:25] offset:2048 sc1
  v_mfma_f32_16x16x32_bf16 v[40:43], a[140:143], v[68:71], v[40:43]
  s_waitcnt lgkmcnt(2)
  v_fma_f32 v47, -v91, v75, v47
  v_fma_f32 v48, -v91, v76, v48
  v_mfma_f32_16x16x32_bf16 v[32:35], a[144:147], v[56:59], v[32:35]
  ds_read_b128 v[68:71], v12 offset:35840
  v_fma_f32 v49, -v91, v77, v49
  v_mfma_f32_16x16x32_bf16 v[36:39], a[148:151], v[56:59], v[36:39]
  v_fma_f32 v50, -v91, v78, v50
  v_fma_f32 v51, -v91, v79, v51
  v_mfma_f32_16x16x32_bf16 v[40:43], a[152:155], v[56:59], v[40:43]
  s_waitcnt lgkmcnt(2)
  global_load_dwordx4 v[190:193], v11, s[24:25] offset:3072 sc1
  v_mfma_f32_16x16x32_bf16 v[32:35], a[156:159], v[60:63], v[32:35]
  s_add_u32 s89, s89, 4096
  ds_read_b128 v[56:59], v12 offset:36864
  v_fma_f32 v52, -v91, v80, v52
  v_mfma_f32_16x16x32_bf16 v[36:39], a[160:163], v[60:63], v[36:39]
  s_add_u32 s24, s60, s89
  s_addc_u32 s25, s61, 0
  v_fma_f32 v53, -v91, v81, v53
  v_fma_f32 v54, -v91, v82, v54
  v_mfma_f32_16x16x32_bf16 v[40:43], a[164:167], v[60:63], v[40:43]
  s_waitcnt lgkmcnt(2)
  v_fma_f32 v55, -v91, v83, v55
  v_mul_f32 v116, v44, v124
  v_mfma_f32_16x16x32_bf16 v[32:35], a[168:171], v[64:67], v[32:35]
  ds_read_b128 v[60:63], v12 offset:37888
  v_mul_f32 v117, v45, v124
  v_mfma_f32_16x16x32_bf16 v[36:39], a[172:175], v[64:67], v[36:39]
  global_load_dwordx4 v[194:197], v11, s[24:25] offset:0 sc1
  v_mfma_f32_16x16x32_bf16 v[40:43], a[176:179], v[64:67], v[40:43]
  s_waitcnt lgkmcnt(2)
  v_mul_f32 v118, v46, v124
  v_mul_f32 v119, v47, v124
  v_mfma_f32_16x16x32_bf16 v[32:35], a[180:183], v[68:71], v[32:35]
  ds_read_b128 v[64:67], v12 offset:38912
  v_mul_f32 v120, v48, v125
  v_mfma_f32_16x16x32_bf16 v[36:39], a[184:187], v[68:71], v[36:39]
  v_mul_f32 v121, v49, v125
  v_mul_f32 v122, v50, v125
  v_mfma_f32_16x16x32_bf16 v[40:43], a[188:191], v[68:71], v[40:43]
  global_load_dwordx4 v[198:201], v11, s[24:25] offset:1024 sc1
  s_barrier
  s_waitcnt lgkmcnt(2)
  v_mfma_f32_16x16x32_bf16 v[32:35], a[192:195], v[56:59], v[32:35]
  ds_read_b128 v[68:71], v12 offset:39936
  v_mul_f32 v123, v51, v125
  v_mfma_f32_16x16x32_bf16 v[36:39], a[196:199], v[56:59], v[36:39]
  s_add_u32 m0, s13, 0
  v_mul_f32 v104, v52, v126
  v_mul_f32 v105, v53, v126
  v_mfma_f32_16x16x32_bf16 v[40:43], a[200:203], v[56:59], v[40:43]
  s_waitcnt lgkmcnt(2)
  v_mul_f32 v106, v54, v126
  v_mul_f32 v107, v55, v126
  v_mfma_f32_16x16x32_bf16 v[32:35], a[204:207], v[60:63], v[32:35]
  ds_read_b128 v[56:59], v11 offset:0
  v_mfma_f32_16x16x32_bf16 v[36:39], a[208:211], v[60:63], v[36:39]
  buffer_load_dwordx4 v11, s[60:63], s14 offen offset:0 sc1 lds
  v_mfma_f32_16x16x32_bf16 v[40:43], a[212:215], v[60:63], v[40:43]
  s_waitcnt lgkmcnt(2)
  v_exp_f32 v124, v116
  v_mfma_f32_16x16x32_bf16 v[32:35], a[216:219], v[64:67], v[32:35]
  ds_read_b128 v[60:63], v11 offset:1024
  v_mfma_f32_16x16x32_bf16 v[36:39], a[220:223], v[64:67], v[36:39]
  v_exp_f32 v125, v117
  v_mfma_f32_16x16x32_bf16 v[40:43], a[224:227], v[64:67], v[40:43]
  s_waitcnt lgkmcnt(2)
  buffer_load_dwordx4 v11, s[60:63], s14 offen offset:1024 sc1 lds
  v_mfma_f32_16x16x32_bf16 v[32:35], a[228:231], v[68:71], v[32:35]
  ds_read_b128 v[64:67], v11 offset:2048
  v_mfma_f32_16x16x32_bf16 v[36:39], a[232:235], v[68:71], v[36:39]
  v_exp_f32 v126, v118
  v_mfma_f32_16x16x32_bf16 v[40:43], a[236:239], v[68:71], v[40:43]
  s_waitcnt lgkmcnt(2)
  v_exp_f32 v127, v119
  v_mfma_f32_16x16x32_bf16 v[44:47], a[0:3], v[56:59], 0
  ds_read_b128 v[68:71], v11 offset:3072
  v_mul_f32 v116, v116, v120
  v_mfma_f32_16x16x32_bf16 v[48:51], a[4:7], v[56:59], 0
  buffer_load_dwordx4 v11, s[60:63], s14 offen offset:2048 sc1 lds
  v_mfma_f32_16x16x32_bf16 v[52:55], a[8:11], v[56:59], 0
  s_waitcnt lgkmcnt(2)
  v_mul_f32 v117, v117, v121
  v_mul_f32 v118, v118, v122
  v_mfma_f32_16x16x32_bf16 v[44:47], a[12:15], v[60:63], v[44:47]
  ds_read_b128 v[56:59], v11 offset:4096
  v_mul_f32 v119, v119, v123
  v_mfma_f32_16x16x32_bf16 v[48:51], a[16:19], v[60:63], v[48:51]
  v_add_f32 v124, 1.0, v124
  v_add_f32 v125, 1.0, v125
  v_mfma_f32_16x16x32_bf16 v[52:55], a[20:23], v[60:63], v[52:55]
  s_waitcnt lgkmcnt(2)
  buffer_load_dwordx4 v11, s[60:63], s14 offen offset:3072 sc1 lds
  v_mfma_f32_16x16x32_bf16 v[44:47], a[24:27], v[64:67], v[44:47]
  s_add_u32 s14, s14, 4096
  ds_read_b128 v[60:63], v11 offset:5120
  v_add_f32 v126, 1.0, v126
  v_mfma_f32_16x16x32_bf16 v[48:51], a[28:31], v[64:67], v[48:51]
  s_add_u32 m0, s13, 4096
  v_add_f32 v127, 1.0, v127
  v_mfma_f32_16x16x32_bf16 v[52:55], a[32:35], v[64:67], v[52:55]
  s_waitcnt lgkmcnt(2)
  v_rcp_f32 v124, v124
  v_mfma_f32_16x16x32_bf16 v[44:47], a[36:39], v[68:71], v[44:47]
  ds_read_b128 v[64:67], v11 offset:6144
  v_mfma_f32_16x16x32_bf16 v[48:51], a[40:43], v[68:71], v[48:51]
  buffer_load_dwordx4 v11, s[60:63], s14 offen offset:0 sc1 lds
  v_mfma_f32_16x16x32_bf16 v[52:55], a[44:47], v[68:71], v[52:55]
  s_waitcnt lgkmcnt(2)
  v_rcp_f32 v125, v125
  v_mfma_f32_16x16x32_bf16 v[44:47], a[48:51], v[56:59], v[44:47]
  s_add_u32 s14, s14, 1024
  ds_read_b128 v[68:71], v11 offset:7168
  v_mfma_f32_16x16x32_bf16 v[48:51], a[52:55], v[56:59], v[48:51]
  v_rcp_f32 v126, v126
  v_mfma_f32_16x16x32_bf16 v[52:55], a[56:59], v[56:59], v[52:55]
  s_waitcnt lgkmcnt(2)
  global_load_dwordx4 v[202:205], v11, s[24:25] offset:2048 sc1
  v_mfma_f32_16x16x32_bf16 v[44:47], a[60:63], v[60:63], v[44:47]
  ds_read_b128 v[56:59], v11 offset:8192
  v_mfma_f32_16x16x32_bf16 v[48:51], a[64:67], v[60:63], v[48:51]
  v_rcp_f32 v127, v127
  v_mfma_f32_16x16x32_bf16 v[52:55], a[68:71], v[60:63], v[52:55]
  s_waitcnt lgkmcnt(2)
  v_mul_f32 v116, v116, v124
  v_mul_f32 v117, v117, v125
  v_mfma_f32_16x16x32_bf16 v[44:47], a[72:75], v[64:67], v[44:47]
  ds_read_b128 v[60:63], v11 offset:9216
  v_mul_f32 v118, v118, v126
  v_mfma_f32_16x16x32_bf16 v[48:51], a[76:79], v[64:67], v[48:51]
  global_load_dwordx4 v[206:209], v11, s[24:25] offset:3072 sc1
  v_mfma_f32_16x16x32_bf16 v[52:55], a[80:83], v[64:67], v[52:55]
  s_waitcnt lgkmcnt(2)
  v_mul_f32 v119, v119, v127
  v_cvt_pk_bf16_f32 v110, v116, v117
  v_mfma_f32_16x16x32_bf16 v[44:47], a[84:87], v[68:71], v[44:47]
  s_add_u32 s89, s89, 4096
  ds_read_b128 v[64:67], v11 offset:10240
  v_cvt_pk_bf16_f32 v111, v118, v119
  v_mfma_f32_16x16x32_bf16 v[48:51], a[88:91], v[68:71], v[48:51]
  s_add_u32 s24, s60, s89
  s_addc_u32 s25, s61, 0
  v_permlane32_swap_b32 v100, v104
  v_mfma_f32_16x16x32_bf16 v[52:55], a[92:95], v[68:71], v[52:55]
  s_waitcnt lgkmcnt(2)
  global_load_dwordx4 v[210:213], v11, s[24:25] offset:0 sc1
  v_mfma_f32_16x16x32_bf16 v[44:47], a[96:99], v[56:59], v[44:47]
  ds_read_b128 v[68:71], v11 offset:11264
  v_mfma_f32_16x16x32_bf16 v[48:51], a[100:103], v[56:59], v[48:51]
  v_permlane32_swap_b32 v101, v105
  v_mfma_f32_16x16x32_bf16 v[52:55], a[104:107], v[56:59], v[52:55]
  s_waitcnt lgkmcnt(2)
  v_permlane32_swap_b32 v102, v106
  v_mfma_f32_16x16x32_bf16 v[44:47], a[108:111], v[60:63], v[44:47]
  ds_read_b128 v[56:59], v11 offset:12288
  v_mfma_f32_16x16x32_bf16 v[48:51], a[112:115], v[60:63], v[48:51]
  global_load_dwordx4 v[214:217], v11, s[24:25] offset:1024 sc1
  v_mfma_f32_16x16x32_bf16 v[52:55], a[116:119], v[60:63], v[52:55]
  s_waitcnt lgkmcnt(2)
  v_permlane32_swap_b32 v103, v107
  v_mfma_f32_16x16x32_bf16 v[44:47], a[120:123], v[64:67], v[44:47]
  ds_read_b128 v[60:63], v11 offset:13312
  v_mfma_f32_16x16x32_bf16 v[48:51], a[124:127], v[64:67], v[48:51]
  v_permlane16_swap_b32 v108, v110
  v_mfma_f32_16x16x32_bf16 v[52:55], a[128:131], v[64:67], v[52:55]
  s_waitcnt lgkmcnt(2)
  global_load_dwordx4 v[218:221], v11, s[24:25] offset:2048 sc1
  v_mfma_f32_16x16x32_bf16 v[44:47], a[132:135], v[68:71], v[44:47]
  ds_read_b128 v[64:67], v11 offset:14336
  v_mfma_f32_16x16x32_bf16 v[48:51], a[136:139], v[68:71], v[48:51]
  v_permlane16_swap_b32 v109, v111
  v_mfma_f32_16x16x32_bf16 v[52:55], a[140:143], v[68:71], v[52:55]
  s_waitcnt lgkmcnt(2)
  v_mfma_f32_16x16x32_bf16 v[44:47], a[144:147], v[56:59], v[44:47]
  s_mov_b32 s92, 98304
  ds_read_b128 v[68:71], v11 offset:15360
  v_mfma_f32_16x16x32_bf16 v[48:51], a[148:151], v[56:59], v[48:51]
  global_load_dwordx4 v[222:225], v11, s[24:25] offset:3072 sc1
  v_mfma_f32_16x16x32_bf16 v[52:55], a[152:155], v[56:59], v[52:55]
  s_waitcnt lgkmcnt(2)
  buffer_store_dwordx4 v[108:111], v13, s[60:63], s92 offen sc1
  v_mfma_f32_16x16x32_bf16 v[44:47], a[156:159], v[60:63], v[44:47]
  s_add_u32 s89, s89, 4096
  ds_read_b128 v[56:59], v11 offset:16384
  v_mfma_f32_16x16x32_bf16 v[48:51], a[160:163], v[60:63], v[48:51]
  s_add_u32 s24, s60, s89
  s_addc_u32 s25, s61, 0
  v_exp_f32 v124, v100
  v_mfma_f32_16x16x32_bf16 v[52:55], a[164:167], v[60:63], v[52:55]
  s_waitcnt lgkmcnt(2)
  v_exp_f32 v125, v101
  v_mfma_f32_16x16x32_bf16 v[44:47], a[168:171], v[64:67], v[44:47]
  ds_read_b128 v[60:63], v11 offset:17408
  v_mfma_f32_16x16x32_bf16 v[48:51], a[172:175], v[64:67], v[48:51]
  global_load_dwordx4 v[226:229], v11, s[24:25] offset:0 sc1
  v_mfma_f32_16x16x32_bf16 v[52:55], a[176:179], v[64:67], v[52:55]
  s_waitcnt lgkmcnt(2)
  v_exp_f32 v126, v102
  v_mfma_f32_16x16x32_bf16 v[44:47], a[180:183], v[68:71], v[44:47]
  ds_read_b128 v[64:67], v11 offset:18432
  v_mfma_f32_16x16x32_bf16 v[48:51], a[184:187], v[68:71], v[48:51]
  v_exp_f32 v127, v103
  v_mfma_f32_16x16x32_bf16 v[52:55], a[188:191], v[68:71], v[52:55]
  global_load_dwordx4 v[230:233], v11, s[24:25] offset:1024 sc1
  s_barrier
  s_waitcnt lgkmcnt(2)
  v_mfma_f32_16x16x32_bf16 v[44:47], a[192:195], v[56:59], v[44:47]
  ds_read_b128 v[68:71], v11 offset:19456
  v_mul_f32 v100, v100, v104
  v_mfma_f32_16x16x32_bf16 v[48:51], a[196:199], v[56:59], v[48:51]
  s_add_u32 m0, s13, 5120
  v_mul_f32 v101, v101, v105
  v_mul_f32 v102, v102, v106
  v_mfma_f32_16x16x32_bf16 v[52:55], a[200:203], v[56:59], v[52:55]
  s_waitcnt lgkmcnt(2)
  v_mul_f32 v103, v103, v107
  v_add_f32 v124, 1.0, v124
  v_mfma_f32_16x16x32_bf16 v[44:47], a[204:207], v[60:63], v[44:47]
  ds_read_b128 v[56:59], v11 offset:20480
  v_add_f32 v125, 1.0, v125
  v_mfma_f32_16x16x32_bf16 v[48:51], a[208:211], v[60:63], v[48:51]
  buffer_load_dwordx4 v11, s[60:63], s14 offen offset:0 sc1 lds
  v_mfma_f32_16x16x32_bf16 v[52:55], a[212:215], v[60:63], v[52:55]
  s_waitcnt lgkmcnt(2)
  v_add_f32 v126, 1.0, v126
  v_add_f32 v127, 1.0, v127
  v_mfma_f32_16x16x32_bf16 v[44:47], a[216:219], v[64:67], v[44:47]
  ds_read_b128 v[60:63], v11 offset:21504
  v_mfma_f32_16x16x32_bf16 v[48:51], a[220:223], v[64:67], v[48:51]
  v_rcp_f32 v124, v124
  v_mfma_f32_16x16x32_bf16 v[52:55], a[224:227], v[64:67], v[52:55]
  s_waitcnt lgkmcnt(2)
  buffer_load_dwordx4 v11, s[60:63], s14 offen offset:1024 sc1 lds
  v_mfma_f32_16x16x32_bf16 v[44:47], a[228:231], v[68:71], v[44:47]
  ds_read_b128 v[64:67], v11 offset:22528
  v_mfma_f32_16x16x32_bf16 v[48:51], a[232:235], v[68:71], v[48:51]
  v_rcp_f32 v125, v125
  v_mfma_f32_16x16x32_bf16 v[52:55], a[236:239], v[68:71], v[52:55]
  v_rcp_f32 v126, v126
  v_rcp_f32 v127, v127
  v_mul_f32 v100, v100, v124
  v_mul_f32 v101, v101, v125
  v_mul_f32 v102, v102, v126
  v_mul_f32 v103, v103, v127
  v_cvt_pk_bf16_f32 v112, v100, v101
  v_cvt_pk_bf16_f32 v113, v102, v103
  buffer_store_dwordx2 v[112:113], v14, s[60:63], s92 offen sc1
  v_mul_f32 v124, s19, v92
  v_mul_f32 v125, s18, v92
  v_mul_f32 v126, v16, v92
  v_fma_f32 v32, -v93, v72, v32
  v_fma_f32 v33, -v93, v73, v33
  v_fma_f32 v34, -v93, v74, v34
  v_fma_f32 v35, -v93, v75, v35
  v_fma_f32 v36, -v93, v76, v36
  v_fma_f32 v37, -v93, v77, v37
  v_fma_f32 v38, -v93, v78, v38
  v_fma_f32 v39, -v93, v79, v39
  v_fma_f32 v40, -v93, v80, v40
  v_fma_f32 v41, -v93, v81, v41
  v_fma_f32 v42, -v93, v82, v42
  v_fma_f32 v43, -v93, v83, v43
  v_mul_f32 v116, v32, v124
  v_mul_f32 v117, v33, v124
  v_mul_f32 v118, v34, v124
  v_mul_f32 v119, v35, v124
  v_mul_f32 v120, v36, v125
  v_mul_f32 v121, v37, v125
  v_mul_f32 v122, v38, v125
  v_mul_f32 v123, v39, v125
  v_mul_f32 v100, v40, v126
  v_mul_f32 v101, v41, v126
  v_mul_f32 v102, v42, v126
  v_mul_f32 v103, v43, v126
  s_waitcnt lgkmcnt(2)
  v_mfma_f32_16x16x32_bf16 v[32:35], a[0:3], v[56:59], 0
  ds_read_b128 v[68:71], v11 offset:23552
  v_mfma_f32_16x16x32_bf16 v[36:39], a[4:7], v[56:59], 0
  buffer_load_dwordx4 v11, s[60:63], s14 offen offset:2048 sc1 lds
  v_mfma_f32_16x16x32_bf16 v[40:43], a[8:11], v[56:59], 0
  s_waitcnt lgkmcnt(2)
  v_exp_f32 v124, v116
  v_mfma_f32_16x16x32_bf16 v[32:35], a[12:15], v[60:63], v[32:35]
  ds_read_b128 v[56:59], v11 offset:24576
  v_mfma_f32_16x16x32_bf16 v[36:39], a[16:19], v[60:63], v[36:39]
  v_exp_f32 v125, v117
  v_mfma_f32_16x16x32_bf16 v[40:43], a[20:23], v[60:63], v[40:43]
  s_waitcnt lgkmcnt(2)
  buffer_load_dwordx4 v11, s[60:63], s14 offen offset:3072 sc1 lds
  v_mfma_f32_16x16x32_bf16 v[32:35], a[24:27], v[64:67], v[32:35]
  s_add_u32 s14, s14, 4096
  ds_read_b128 v[60:63], v11 offset:25600
  v_mfma_f32_16x16x32_bf16 v[36:39], a[28:31], v[64:67], v[36:39]
  s_add_u32 m0, s13, 9216
  v_exp_f32 v126, v118
  v_mfma_f32_16x16x32_bf16 v[40:43], a[32:35], v[64:67], v[40:43]
  s_waitcnt lgkmcnt(2)
  v_exp_f32 v127, v119
  v_mfma_f32_16x16x32_bf16 v[32:35], a[36:39], v[68:71], v[32:35]
  ds_read_b128 v[64:67], v11 offset:26624
  v_mul_f32 v116, v116, v120
  v_mfma_f32_16x16x32_bf16 v[36:39], a[40:43], v[68:71], v[36:39]
  buffer_load_dwordx4 v11, s[60:63], s14 offen offset:0 sc1 lds
  v_mfma_f32_16x16x32_bf16 v[40:43], a[44:47], v[68:71], v[40:43]
  s_waitcnt lgkmcnt(2)
  v_mul_f32 v117, v117, v121
  v_mul_f32 v118, v118, v122
  v_mfma_f32_16x16x32_bf16 v[32:35], a[48:51], v[56:59], v[32:35]
  s_add_u32 s14, s14, 1024
  ds_read_b128 v[68:71], v11 offset:27648
  v_mul_f32 v119, v119, v123
  v_mfma_f32_16x16x32_bf16 v[36:39], a[52:55], v[56:59], v[36:39]
  v_add_f32 v124, 1.0, v124
  v_add_f32 v125, 1.0, v125
  v_mfma_f32_16x16x32_bf16 v[40:43], a[56:59], v[56:59], v[40:43]
  s_waitcnt lgkmcnt(2)
  global_load_dwordx4 v[234:237], v11, s[24:25] offset:2048 sc1
  v_mfma_f32_16x16x32_bf16 v[32:35], a[60:63], v[60:63], v[32:35]
  ds_read_b128 v[56:59], v11 offset:28672
  v_add_f32 v126, 1.0, v126
  v_mfma_f32_16x16x32_bf16 v[36:39], a[64:67], v[60:63], v[36:39]
  v_add_f32 v127, 1.0, v127
  v_mfma_f32_16x16x32_bf16 v[40:43], a[68:71], v[60:63], v[40:43]
  s_waitcnt lgkmcnt(2)
  v_rcp_f32 v124, v124
  v_mfma_f32_16x16x32_bf16 v[32:35], a[72:75], v[64:67], v[32:35]
  ds_read_b128 v[60:63], v11 offset:29696
  v_mfma_f32_16x16x32_bf16 v[36:39], a[76:79], v[64:67], v[36:39]
  global_load_dwordx4 v[238:241], v11, s[24:25] offset:3072 sc1
  v_mfma_f32_16x16x32_bf16 v[40:43], a[80:83], v[64:67], v[40:43]
  s_waitcnt lgkmcnt(2)
  v_rcp_f32 v125, v125
  v_mfma_f32_16x16x32_bf16 v[32:35], a[84:87], v[68:71], v[32:35]
  s_add_u32 s89, s89, 4096
  ds_read_b128 v[64:67], v11 offset:30720
  v_mfma_f32_16x16x32_bf16 v[36:39], a[88:91], v[68:71], v[36:39]
  s_add_u32 s24, s60, s89
  s_addc_u32 s25, s61, 0
  v_rcp_f32 v126, v126
  v_mfma_f32_16x16x32_bf16 v[40:43], a[92:95], v[68:71], v[40:43]
  s_waitcnt lgkmcnt(2)
  global_load_dwordx4 v[242:245], v11, s[24:25] offset:0 sc1
  v_mfma_f32_16x16x32_bf16 v[32:35], a[96:99], v[56:59], v[32:35]
  ds_read_b128 v[68:71], v11 offset:31744
  v_mfma_f32_16x16x32_bf16 v[36:39], a[100:103], v[56:59], v[36:39]
  v_rcp_f32 v127, v127
  v_mfma_f32_16x16x32_bf16 v[40:43], a[104:107], v[56:59], v[40:43]
  s_waitcnt lgkmcnt(2)
  v_mul_f32 v116, v116, v124
  v_mul_f32 v117, v117, v125
  v_mfma_f32_16x16x32_bf16 v[32:35], a[108:111], v[60:63], v[32:35]
  ds_read_b128 v[56:59], v11 offset:32768
  v_mul_f32 v118, v118, v126
  v_mfma_f32_16x16x32_bf16 v[36:39], a[112:115], v[60:63], v[36:39]
  global_load_dwordx4 v[246:249], v11, s[24:25] offset:1024 sc1
  v_mfma_f32_16x16x32_bf16 v[40:43], a[116:119], v[60:63], v[40:43]
  s_waitcnt lgkmcnt(2)
  v_mul_f32 v119, v119, v127
  v_cvt_pk_bf16_f32 v108, v116, v117
  v_mfma_f32_16x16x32_bf16 v[32:35], a[120:123], v[64:67], v[32:35]
  s_waitcnt vmcnt(7)
  ds_read_b128 v[60:63], v11 offset:33792
  v_cvt_pk_bf16_f32 v109, v118, v119
  v_mfma_f32_16x16x32_bf16 v[36:39], a[124:127], v[64:67], v[36:39]
  buffer_store_dword v19, v15, s[60:63], 0 offen offset:1024
  v_mfma_f32_16x16x32_bf16 v[40:43], a[128:131], v[64:67], v[40:43]
  s_waitcnt lgkmcnt(2)
  v_mul_f32 v124, s19, v94
  v_mul_f32 v125, s18, v94
  v_mfma_f32_16x16x32_bf16 v[32:35], a[132:135], v[68:71], v[32:35]
  ds_read_b128 v[64:67], v11 offset:34816
  v_mul_f32 v126, v16, v94
  v_mfma_f32_16x16x32_bf16 v[36:39], a[136:139], v[68:71], v[36:39]
  v_fma_f32 v44, -v95, v72, v44
  v_fma_f32 v45, -v95, v73, v45
  v_mfma_f32_16x16x32_bf16 v[40:43], a[140:143], v[68:71], v[40:43]
  s_waitcnt lgkmcnt(2)
  buffer_load_dword v26, v27, s[60:63], 0 offen offset:0 sc1
  v_mfma_f32_16x16x32_bf16 v[32:35], a[144:147], v[56:59], v[32:35]
  ds_read_b128 v[68:71], v11 offset:35840
  v_fma_f32 v46, -v95, v74, v46
  v_mfma_f32_16x16x32_bf16 v[36:39], a[148:151], v[56:59], v[36:39]
  v_fma_f32 v47, -v95, v75, v47
  v_fma_f32 v48, -v95, v76, v48
  v_mfma_f32_16x16x32_bf16 v[40:43], a[152:155], v[56:59], v[40:43]
  s_waitcnt lgkmcnt(2)
  v_fma_f32 v49, -v95, v77, v49
  v_fma_f32 v50, -v95, v78, v50
  v_mfma_f32_16x16x32_bf16 v[32:35], a[156:159], v[60:63], v[32:35]
  ds_read_b128 v[56:59], v11 offset:36864
  v_fma_f32 v51, -v95, v79, v51
  v_mfma_f32_16x16x32_bf16 v[36:39], a[160:163], v[60:63], v[36:39]
  v_fma_f32 v52, -v95, v80, v52
  v_fma_f32 v53, -v95, v81, v53
  v_mfma_f32_16x16x32_bf16 v[40:43], a[164:167], v[60:63], v[40:43]
  s_waitcnt lgkmcnt(2)
  v_fma_f32 v54, -v95, v82, v54
  v_fma_f32 v55, -v95, v83, v55
  v_mfma_f32_16x16x32_bf16 v[32:35], a[168:171], v[64:67], v[32:35]
  ds_read_b128 v[60:63], v11 offset:37888
  v_mul_f32 v116, v44, v124
  v_mfma_f32_16x16x32_bf16 v[36:39], a[172:175], v[64:67], v[36:39]
  v_mul_f32 v117, v45, v124
  v_mul_f32 v118, v46, v124
  v_mfma_f32_16x16x32_bf16 v[40:43], a[176:179], v[64:67], v[40:43]
  s_waitcnt lgkmcnt(2)
  v_mul_f32 v119, v47, v124
  v_mul_f32 v120, v48, v125
  v_mfma_f32_16x16x32_bf16 v[32:35], a[180:183], v[68:71], v[32:35]
  ds_read_b128 v[64:67], v11 offset:38912
  v_mul_f32 v121, v49, v125
  v_mfma_f32_16x16x32_bf16 v[36:39], a[184:187], v[68:71], v[36:39]
  v_mul_f32 v122, v50, v125
  v_mul_f32 v123, v51, v125
  v_mfma_f32_16x16x32_bf16 v[40:43], a[188:191], v[68:71], v[40:43]
  v_mul_f32 v104, v52, v126
  v_mul_f32 v105, v53, v126
  s_barrier
  s_waitcnt lgkmcnt(2)
  v_mfma_f32_16x16x32_bf16 v[32:35], a[192:195], v[56:59], v[32:35]
  ds_read_b128 v[68:71], v11 offset:39936
  v_mul_f32 v106, v54, v126
  v_mfma_f32_16x16x32_bf16 v[36:39], a[196:199], v[56:59], v[36:39]
  s_add_u32 m0, s88, 0
  v_mul_f32 v107, v55, v126
  v_mfma_f32_16x16x32_bf16 v[40:43], a[200:203], v[56:59], v[40:43]
  s_waitcnt lgkmcnt(2)
  buffer_load_dwordx4 v11, s[60:63], s14 offen offset:0 sc1 lds
  v_mfma_f32_16x16x32_bf16 v[32:35], a[204:207], v[60:63], v[32:35]
  ds_read_b128 v[56:59], v11 offset:40960
  v_mfma_f32_16x16x32_bf16 v[36:39], a[208:211], v[60:63], v[36:39]
  v_exp_f32 v124, v116
  v_mfma_f32_16x16x32_bf16 v[40:43], a[212:215], v[60:63], v[40:43]
  s_waitcnt lgkmcnt(2)
  v_exp_f32 v125, v117
  v_mfma_f32_16x16x32_bf16 v[32:35], a[216:219], v[64:67], v[32:35]
  ds_read_b128 v[60:63], v11 offset:41984
  v_mfma_f32_16x16x32_bf16 v[36:39], a[220:223], v[64:67], v[36:39]
  buffer_load_dwordx4 v11, s[60:63], s14 offen offset:1024 sc1 lds
  v_mfma_f32_16x16x32_bf16 v[40:43], a[224:227], v[64:67], v[40:43]
  s_waitcnt lgkmcnt(2)
  v_exp_f32 v126, v118
  v_mfma_f32_16x16x32_bf16 v[32:35], a[228:231], v[68:71], v[32:35]
  ds_read_b128 v[64:67], v11 offset:43008
  v_mfma_f32_16x16x32_bf16 v[36:39], a[232:235], v[68:71], v[36:39]
  v_exp_f32 v127, v119
  v_mfma_f32_16x16x32_bf16 v[40:43], a[236:239], v[68:71], v[40:43]
  s_waitcnt lgkmcnt(2)
  buffer_load_dwordx4 v11, s[60:63], s14 offen offset:2048 sc1 lds
  v_mfma_f32_16x16x32_bf16 v[44:47], a[0:3], v[56:59], 0
  ds_read_b128 v[68:71], v11 offset:44032
  s_waitcnt vmcnt(3)
  v_cmp_ne_u32 vcc, v26, v19
  v_mfma_f32_16x16x32_bf16 v[48:51], a[4:7], v[56:59], 0
  v_mul_f32 v116, v116, v120
  v_mul_f32 v117, v117, v121
  v_mfma_f32_16x16x32_bf16 v[52:55], a[8:11], v[56:59], 0
  s_waitcnt lgkmcnt(2)
  buffer_load_dwordx4 v11, s[60:63], s14 offen offset:3072 sc1 lds
  v_mfma_f32_16x16x32_bf16 v[44:47], a[12:15], v[60:63], v[44:47]
  s_cbranch_vccnz L_g01L
L_g01L_back:
  ds_read_b128 v[56:59], v11 offset:45056
  v_mul_f32 v118, v118, v122
  v_mfma_f32_16x16x32_bf16 v[48:51], a[16:19], v[60:63], v[48:51]
  s_add_u32 s22, s60, s9
  s_addc_u32 s23, s61, 0
  v_mul_f32 v119, v119, v123
  v_add_f32 v124, 1.0, v124
  v_mfma_f32_16x16x32_bf16 v[52:55], a[20:23], v[60:63], v[52:55]
  s_waitcnt lgkmcnt(2)
  global_load_dwordx4 a[240:243], v11, s[22:23] offset:0 sc1
  v_mfma_f32_16x16x32_bf16 v[44:47], a[24:27], v[64:67], v[44:47]
  s_add_u32 s14, s14, 4096
  ds_read_b128 v[60:63], v11 offset:46080
  v_add_f32 v125, 1.0, v125
  v_mfma_f32_16x16x32_bf16 v[48:51], a[28:31], v[64:67], v[48:51]
  s_add_u32 m0, s88, 4096
  v_add_f32 v126, 1.0, v126
  v_add_f32 v127, 1.0, v127
  v_mfma_f32_16x16x32_bf16 v[52:55], a[32:35], v[64:67], v[52:55]
  s_waitcnt lgkmcnt(2)
  buffer_load_dwordx4 v11, s[60:63], s14 offen offset:0 sc1 lds
  v_mfma_f32_16x16x32_bf16 v[44:47], a[36:39], v[68:71], v[44:47]
  s_add_u32 s14, s14, 1024
  ds_read_b128 v[64:67], v11 offset:47104
  v_mfma_f32_16x16x32_bf16 v[48:51], a[40:43], v[68:71], v[48:51]
  v_rcp_f32 v124, v124
  v_mfma_f32_16x16x32_bf16 v[52:55], a[44:47], v[68:71], v[52:55]
  s_waitcnt lgkmcnt(2)
  global_load_dwordx4 a[244:247], v11, s[22:23] offset:1024 sc1
  v_mfma_f32_16x16x32_bf16 v[44:47], a[48:51], v[56:59], v[44:47]
  ds_read_b128 v[68:71], v11 offset:48128
  v_mfma_f32_16x16x32_bf16 v[48:51], a[52:55], v[56:59], v[48:51]
  v_rcp_f32 v125, v125
  v_mfma_f32_16x16x32_bf16 v[52:55], a[56:59], v[56:59], v[52:55]
  s_waitcnt lgkmcnt(2)
  global_load_dwordx4 a[248:251], v11, s[22:23] offset:2048 sc1
  v_mfma_f32_16x16x32_bf16 v[44:47], a[60:63], v[60:63], v[44:47]
  ds_read_b128 v[56:59], v11 offset:49152
  v_mfma_f32_16x16x32_bf16 v[48:51], a[64:67], v[60:63], v[48:51]
  v_rcp_f32 v126, v126
  v_mfma_f32_16x16x32_bf16 v[52:55], a[68:71], v[60:63], v[52:55]
  s_waitcnt lgkmcnt(2)
  global_load_dwordx4 a[0:3], v11, s[22:23] offset:3072 sc1
  v_mfma_f32_16x16x32_bf16 v[44:47], a[72:75], v[64:67], v[44:47]
  s_add_u32 s9, s9, 4096
  ds_read_b128 v[60:63], v11 offset:50176
  v_mfma_f32_16x16x32_bf16 v[48:51], a[76:79], v[64:67], v[48:51]
  s_add_u32 s22, s60, s9
  s_addc_u32 s23, s61, 0
  v_rcp_f32 v127, v127
  v_mfma_f32_16x16x32_bf16 v[52:55], a[80:83], v[64:67], v[52:55]
  s_waitcnt lgkmcnt(2)
  global_load_dwordx4 a[4:7], v11, s[22:23] offset:0 sc1
  v_mfma_f32_16x16x32_bf16 v[44:47], a[84:87], v[68:71], v[44:47]
  ds_read_b128 v[64:67], v11 offset:51200
  v_mul_f32 v116, v116, v124
  v_mfma_f32_16x16x32_bf16 v[48:51], a[88:91], v[68:71], v[48:51]
  v_mul_f32 v117, v117, v125
  v_mul_f32 v118, v118, v126
  v_mfma_f32_16x16x32_bf16 v[52:55], a[92:95], v[68:71], v[52:55]
  s_waitcnt lgkmcnt(2)
  global_load_dwordx4 a[8:11], v11, s[22:23] offset:1024 sc1
  v_mfma_f32_16x16x32_bf16 v[44:47], a[96:99], v[56:59], v[44:47]
  ds_read_b128 v[68:71], v11 offset:52224
  ds_read_b128 a[84:87], v4 offset:0
  v_mfma_f32_16x16x32_bf16 v[48:51], a[100:103], v[56:59], v[48:51]
  ds_read_b128 a[88:91], v4 offset:1024
  ds_read_b128 a[92:95], v4 offset:2048
  v_mfma_f32_16x16x32_bf16 v[52:55], a[104:107], v[56:59], v[52:55]
  s_waitcnt lgkmcnt(5)
  global_load_dwordx4 a[12:15], v11, s[22:23] offset:2048 sc1
  v_mfma_f32_16x16x32_bf16 v[44:47], a[108:111], v[60:63], v[44:47]
  ds_read_b128 v[56:59], v11 offset:53248
  ds_read_b128 a[96:99], v4 offset:3072
  v_mfma_f32_16x16x32_bf16 v[48:51], a[112:115], v[60:63], v[48:51]
  ds_read_b128 a[100:103], v4 offset:4096
  ds_read_b128 a[104:107], v4 offset:5120
  v_mfma_f32_16x16x32_bf16 v[52:55], a[116:119], v[60:63], v[52:55]
  s_waitcnt lgkmcnt(8)
  global_load_dwordx4 a[16:19], v11, s[22:23] offset:3072 sc1
  v_mfma_f32_16x16x32_bf16 v[44:47], a[120:123], v[64:67], v[44:47]
  s_add_u32 s9, s9, 4096
  ds_read_b128 v[60:63], v11 offset:54272
  ds_read_b128 a[108:111], v4 offset:6144
  v_mfma_f32_16x16x32_bf16 v[48:51], a[124:127], v[64:67], v[48:51]
  s_add_u32 s22, s60, s9
  s_addc_u32 s23, s61, 0
  ds_read_b128 a[112:115], v4 offset:7168
  ds_read_b128 a[116:119], v4 offset:8192
  v_mfma_f32_16x16x32_bf16 v[52:55], a[128:131], v[64:67], v[52:55]
  s_waitcnt lgkmcnt(11)
  global_load_dwordx4 a[20:23], v11, s[22:23] offset:0 sc1
  v_mfma_f32_16x16x32_bf16 v[44:47], a[132:135], v[68:71], v[44:47]
  ds_read_b128 v[64:67], v11 offset:55296
  ds_read_b128 a[120:123], v4 offset:9216
  v_mfma_f32_16x16x32_bf16 v[48:51], a[136:139], v[68:71], v[48:51]
  ds_read_b128 a[124:127], v4 offset:10240
  s_waitcnt lgkmcnt(13)
  ds_read_b128 a[128:131], v4 offset:11264
  v_mfma_f32_16x16x32_bf16 v[52:55], a[140:143], v[68:71], v[52:55]
  s_waitcnt lgkmcnt(11)
  global_load_dwordx4 a[24:27], v11, s[22:23] offset:1024 sc1
  v_mfma_f32_16x16x32_bf16 v[44:47], a[144:147], v[56:59], v[44:47]
  ds_read_b128 v[68:71], v11 offset:56320
  ds_read_b128 a[132:135], v4 offset:12288
  v_mfma_f32_16x16x32_bf16 v[48:51], a[148:151], v[56:59], v[48:51]
  ds_read_b128 a[136:139], v4 offset:13312
  s_waitcnt lgkmcnt(13)
  ds_read_b128 a[140:143], v4 offset:14336
  v_mfma_f32_16x16x32_bf16 v[52:55], a[152:155], v[56:59], v[52:55]
  s_waitcnt lgkmcnt(11)
  global_load_dwordx4 a[28:31], v11, s[22:23] offset:2048 sc1
  v_mfma_f32_16x16x32_bf16 v[44:47], a[156:159], v[60:63], v[44:47]
  ds_read_b128 v[56:59], v11 offset:57344
  ds_read_b128 a[144:147], v5 offset:0
  v_mfma_f32_16x16x32_bf16 v[48:51], a[160:163], v[60:63], v[48:51]
  ds_read_b128 a[148:151], v5 offset:1024
  s_waitcnt lgkmcnt(13)
  ds_read_b128 a[152:155], v5 offset:2048
  v_mfma_f32_16x16x32_bf16 v[52:55], a[164:167], v[60:63], v[52:55]
  s_waitcnt lgkmcnt(11)
  global_load_dwordx4 a[32:35], v11, s[22:23] offset:3072 sc1
  v_mfma_f32_16x16x32_bf16 v[44:47], a[168:171], v[64:67], v[44:47]
  s_add_u32 s9, s9, 90112
  ds_read_b128 v[60:63], v11 offset:58368
  ds_read_b128 a[156:159], v5 offset:3072
  v_mfma_f32_16x16x32_bf16 v[48:51], a[172:175], v[64:67], v[48:51]
  s_add_u32 s22, s60, s9
  s_addc_u32 s23, s61, 0
  ds_read_b128 a[160:163], v5 offset:4096
  s_waitcnt lgkmcnt(13)
  ds_read_b128 a[164:167], v5 offset:5120
  v_mfma_f32_16x16x32_bf16 v[52:55], a[176:179], v[64:67], v[52:55]
  s_waitcnt lgkmcnt(11)
  global_load_dwordx4 a[36:39], v11, s[22:23] offset:0 sc1
  v_mfma_f32_16x16x32_bf16 v[44:47], a[180:183], v[68:71], v[44:47]
  ds_read_b128 v[64:67], v11 offset:59392
  ds_read_b128 a[168:171], v5 offset:6144
  v_mfma_f32_16x16x32_bf16 v[48:51], a[184:187], v[68:71], v[48:51]
  ds_read_b128 a[172:175], v5 offset:7168
  s_waitcnt lgkmcnt(13)
  ds_read_b128 a[176:179], v5 offset:8192
  v_mfma_f32_16x16x32_bf16 v[52:55], a[188:191], v[68:71], v[52:55]
  s_waitcnt lgkmcnt(11)
  global_load_dwordx4 a[40:43], v11, s[22:23] offset:1024 sc1
  v_mfma_f32_16x16x32_bf16 v[44:47], a[192:195], v[56:59], v[44:47]
  ds_read_b128 v[68:71], v11 offset:60416
  ds_read_b128 a[180:183], v5 offset:9216
  v_mfma_f32_16x16x32_bf16 v[48:51], a[196:199], v[56:59], v[48:51]
  v_mul_f32 v119, v119, v127
  v_cvt_pk_bf16_f32 v110, v116, v117
  v_mfma_f32_16x16x32_bf16 v[52:55], a[200:203], v[56:59], v[52:55]
  s_waitcnt lgkmcnt(9)
  global_load_dwordx4 a[44:47], v11, s[22:23] offset:2048 sc1
  v_mfma_f32_16x16x32_bf16 v[44:47], a[204:207], v[60:63], v[44:47]
  v_cvt_pk_bf16_f32 v111, v118, v119
  v_mfma_f32_16x16x32_bf16 v[48:51], a[208:211], v[60:63], v[48:51]
  v_permlane32_swap_b32 v100, v104
  v_mfma_f32_16x16x32_bf16 v[52:55], a[212:215], v[60:63], v[52:55]
  s_waitcnt lgkmcnt(5)
  global_load_dwordx4 a[48:51], v11, s[22:23] offset:3072 sc1
  v_mfma_f32_16x16x32_bf16 v[44:47], a[216:219], v[64:67], v[44:47]
  s_add_u32 s9, s9, 4096
  v_permlane32_swap_b32 v101, v105
  v_mfma_f32_16x16x32_bf16 v[48:51], a[220:223], v[64:67], v[48:51]
  s_add_u32 s22, s60, s9
  s_addc_u32 s23, s61, 0
  v_permlane32_swap_b32 v102, v106
  v_mfma_f32_16x16x32_bf16 v[52:55], a[224:227], v[64:67], v[52:55]
  s_waitcnt lgkmcnt(1)
  global_load_dwordx4 a[52:55], v11, s[22:23] offset:0 sc1
  v_mfma_f32_16x16x32_bf16 v[44:47], a[228:231], v[68:71], v[44:47]
  v_permlane32_swap_b32 v103, v107
  v_mfma_f32_16x16x32_bf16 v[48:51], a[232:235], v[68:71], v[48:51]
  v_permlane16_swap_b32 v108, v110
  v_mfma_f32_16x16x32_bf16 v[52:55], a[236:239], v[68:71], v[52:55]
  global_load_dwordx4 a[56:59], v11, s[22:23] offset:1024 sc1
  v_permlane16_swap_b32 v109, v111
  s_mov_b32 s92, 196608
  buffer_store_dwordx4 v[108:111], v13, s[60:63], s92 offen sc1
  v_exp_f32 v124, v100
  v_exp_f32 v125, v101
  v_exp_f32 v126, v102
  v_exp_f32 v127, v103
  v_mul_f32 v100, v100, v104
  v_mul_f32 v101, v101, v105
  v_mul_f32 v102, v102, v106
  v_mul_f32 v103, v103, v107
  v_add_f32 v124, 1.0, v124
  v_add_f32 v125, 1.0, v125
  v_add_f32 v126, 1.0, v126
  v_add_f32 v127, 1.0, v127
  v_rcp_f32 v124, v124
  v_rcp_f32 v125, v125
  v_rcp_f32 v126, v126
  v_rcp_f32 v127, v127
  v_mul_f32 v100, v100, v124
  v_mul_f32 v101, v101, v125
  v_mul_f32 v102, v102, v126
  v_mul_f32 v103, v103, v127
  v_cvt_pk_bf16_f32 v112, v100, v101
  v_cvt_pk_bf16_f32 v113, v102, v103
  buffer_store_dwordx2 v[112:113], v14, s[60:63], s92 offen sc1
  v_mul_f32 v124, s19, v96
  v_mul_f32 v125, s18, v96
  v_mul_f32 v126, v16, v96
  v_fma_f32 v32, -v97, v72, v32
  v_fma_f32 v33, -v97, v73, v33
  v_fma_f32 v34, -v97, v74, v34
  v_fma_f32 v35, -v97, v75, v35
  v_fma_f32 v36, -v97, v76, v36
  v_fma_f32 v37, -v97, v77, v37
  v_fma_f32 v38, -v97, v78, v38
  v_fma_f32 v39, -v97, v79, v39
  v_fma_f32 v40, -v97, v80, v40
  v_fma_f32 v41, -v97, v81, v41
  v_fma_f32 v42, -v97, v82, v42
  v_fma_f32 v43, -v97, v83, v43
  v_mul_f32 v116, v32, v124
  v_mul_f32 v117, v33, v124
  v_mul_f32 v118, v34, v124
  v_mul_f32 v119, v35, v124
  v_mul_f32 v120, v36, v125
  v_mul_f32 v121, v37, v125
  v_mul_f32 v122, v38, v125
  v_mul_f32 v123, v39, v125
  v_mul_f32 v100, v40, v126
  v_mul_f32 v101, v41, v126
  v_mul_f32 v102, v42, v126
  v_mul_f32 v103, v43, v126
  s_waitcnt vmcnt(20)
  v_mfma_f32_16x16x32_bf16 v[56:59], v[130:133], a[240:243], 0
  v_exp_f32 v124, v116
  v_mfma_f32_16x16x32_bf16 v[60:63], v[134:137], a[240:243], 0
  v_exp_f32 v125, v117
  v_mfma_f32_16x16x32_bf16 v[64:67], v[138:141], a[240:243], 0
  global_load_dwordx4 a[60:63], v11, s[22:23] offset:2048 sc1
  v_mfma_f32_16x16x32_bf16 v[68:71], v[142:145], a[240:243], 0
  v_exp_f32 v126, v118
  v_mfma_f32_16x16x32_bf16 v[32:35], v[146:149], a[240:243], 0
  s_waitcnt vmcnt(19)
  v_exp_f32 v127, v119
  v_mfma_f32_16x16x32_bf16 v[56:59], v[150:153], a[244:247], v[56:59]
  global_load_dwordx4 a[64:67], v11, s[22:23] offset:3072 sc1
  v_mfma_f32_16x16x32_bf16 v[60:63], v[154:157], a[244:247], v[60:63]
  s_add_u32 s9, s9, 4096
  v_mul_f32 v116, v116, v120
  v_mul_f32 v117, v117, v121
  v_mfma_f32_16x16x32_bf16 v[64:67], v[158:161], a[244:247], v[64:67]
  s_add_u32 s22, s60, s9
  s_addc_u32 s23, s61, 0
  v_mul_f32 v118, v118, v122
  v_mul_f32 v119, v119, v123
  v_mfma_f32_16x16x32_bf16 v[68:71], v[162:165], a[244:247], v[68:71]
  global_load_dwordx4 a[68:71], v11, s[22:23] offset:0 sc1
  v_mfma_f32_16x16x32_bf16 v[32:35], v[166:169], a[244:247], v[32:35]
  s_waitcnt vmcnt(20)
  v_add_f32 v124, 1.0, v124
  v_add_f32 v125, 1.0, v125
  v_mfma_f32_16x16x32_bf16 v[56:59], v[170:173], a[248:251], v[56:59]
  v_add_f32 v126, 1.0, v126
  v_add_f32 v127, 1.0, v127
  v_mfma_f32_16x16x32_bf16 v[60:63], v[174:177], a[248:251], v[60:63]
  global_load_dwordx4 a[72:75], v11, s[22:23] offset:1024 sc1
  v_mfma_f32_16x16x32_bf16 v[64:67], v[178:181], a[248:251], v[64:67]
  v_rcp_f32 v124, v124
  v_mfma_f32_16x16x32_bf16 v[68:71], v[182:185], a[248:251], v[68:71]
  v_rcp_f32 v125, v125
  v_mfma_f32_16x16x32_bf16 v[32:35], v[186:189], a[248:251], v[32:35]
  s_waitcnt vmcnt(20)
  global_load_dwordx4 a[76:79], v11, s[22:23] offset:2048 sc1
  v_mfma_f32_16x16x32_bf16 v[56:59], v[190:193], a[0:3], v[56:59]
  v_rcp_f32 v126, v126
  v_mfma_f32_16x16x32_bf16 v[60:63], v[194:197], a[0:3], v[60:63]
  v_rcp_f32 v127, v127
  v_mfma_f32_16x16x32_bf16 v[64:67], v[198:201], a[0:3], v[64:67]
  global_load_dwordx4 a[80:83], v11, s[22:23] offset:3072 sc1
  v_mfma_f32_16x16x32_bf16 v[68:71], v[202:205], a[0:3], v[68:71]
  s_add_u32 s9, s9, 90112
  v_mul_f32 v116, v116, v124
  v_mul_f32 v117, v117, v125
  v_mfma_f32_16x16x32_bf16 v[32:35], v[206:209], a[0:3], v[32:35]
  s_waitcnt vmcnt(21)
  v_mul_f32 v118, v118, v126
  v_mul_f32 v119, v119, v127
  v_mfma_f32_16x16x32_bf16 v[56:59], v[210:213], a[4:7], v[56:59]
  ds_read_b128 a[184:187], v6 offset:0
  ds_read_b128 a[188:191], v6 offset:1024
  v_mfma_f32_16x16x32_bf16 v[60:63], v[214:217], a[4:7], v[60:63]
  ds_read_b128 a[192:195], v6 offset:2048
  ds_read_b128 a[196:199], v6 offset:3072
  v_mfma_f32_16x16x32_bf16 v[64:67], v[218:221], a[4:7], v[64:67]
  ds_read_b128 a[200:203], v6 offset:4096
  v_cvt_pk_bf16_f32 v108, v116, v117
  v_mfma_f32_16x16x32_bf16 v[68:71], v[222:225], a[4:7], v[68:71]
  buffer_load_dword v26, v28, s[60:63], 0 offen offset:2048 sc1
  v_mfma_f32_16x16x32_bf16 v[32:35], v[226:229], a[4:7], v[32:35]
  v_cvt_pk_bf16_f32 v109, v118, v119
  s_waitcnt vmcnt(7)
  s_barrier
  v_mfma_f32_16x16x32_bf16 v[56:59], v[230:233], a[8:11], v[56:59]
  buffer_store_dword v19, v15, s[60:63], 0 offen offset:2048
  v_mfma_f32_16x16x32_bf16 v[60:63], v[234:237], a[8:11], v[60:63]
  v_mul_f32 v124, s19, v98
  v_mul_f32 v125, s18, v98
  v_mfma_f32_16x16x32_bf16 v[64:67], v[238:241], a[8:11], v[64:67]
  v_mul_f32 v126, v16, v98
  v_fma_f32 v44, -v99, v72, v44
  v_mfma_f32_16x16x32_bf16 v[68:71], v[242:245], a[8:11], v[68:71]
  v_fma_f32 v45, -v99, v73, v45
  v_fma_f32 v46, -v99, v74, v46
  v_mfma_f32_16x16x32_bf16 v[32:35], v[246:249], a[8:11], v[32:35]
  v_fma_f32 v47, -v99, v75, v47
  v_fma_f32 v48, -v99, v76, v48
  v_mfma_f32_16x16x32_bf16 v[56:59], a[84:87], a[12:15], v[56:59]
  v_fma_f32 v49, -v99, v77, v49
  v_fma_f32 v50, -v99, v78, v50
  v_mfma_f32_16x16x32_bf16 v[60:63], a[88:91], a[12:15], v[60:63]
  v_fma_f32 v51, -v99, v79, v51
  v_fma_f32 v52, -v99, v80, v52
  v_mfma_f32_16x16x32_bf16 v[64:67], a[92:95], a[12:15], v[64:67]
  v_fma_f32 v53, -v99, v81, v53
  v_fma_f32 v54, -v99, v82, v54
  v_mfma_f32_16x16x32_bf16 v[68:71], a[96:99], a[12:15], v[68:71]
  v_fma_f32 v55, -v99, v83, v55
  v_mul_f32 v116, v44, v124
  v_mfma_f32_16x16x32_bf16 v[32:35], a[100:103], a[12:15], v[32:35]
  v_mul_f32 v117, v45, v124
  v_mul_f32 v118, v46, v124
  v_mfma_f32_16x16x32_bf16 v[56:59], a[104:107], a[16:19], v[56:59]
  v_mul_f32 v119, v47, v124
  v_mul_f32 v120, v48, v125
  v_mfma_f32_16x16x32_bf16 v[60:63], a[108:111], a[16:19], v[60:63]
  v_mul_f32 v121, v49, v125
  v_mul_f32 v122, v50, v125
  v_mfma_f32_16x16x32_bf16 v[64:67], a[112:115], a[16:19], v[64:67]
  v_mul_f32 v123, v51, v125
  v_mul_f32 v104, v52, v126
  v_mfma_f32_16x16x32_bf16 v[68:71], a[116:119], a[16:19], v[68:71]
  v_mul_f32 v105, v53, v126
  v_mul_f32 v106, v54, v126
  v_mfma_f32_16x16x32_bf16 v[32:35], a[120:123], a[16:19], v[32:35]
  v_mul_f32 v107, v55, v126
  v_mfma_f32_16x16x32_bf16 v[56:59], a[124:127], a[20:23], v[56:59]
  s_waitcnt vmcnt(1)
  v_cmp_ne_u32 vcc, v26, v19
  v_mfma_f32_16x16x32_bf16 v[60:63], a[128:131], a[20:23], v[60:63]
  v_exp_f32 v124, v116
  v_mfma_f32_16x16x32_bf16 v[64:67], a[132:135], a[20:23], v[64:67]
  v_exp_f32 v125, v117
  v_mfma_f32_16x16x32_bf16 v[68:71], a[136:139], a[20:23], v[68:71]
  s_cbranch_vccnz L_g2L
L_g2L_back:
  v_exp_f32 v126, v118
  v_mfma_f32_16x16x32_bf16 v[32:35], a[140:143], a[20:23], v[32:35]
  v_exp_f32 v127, v119
  v_mfma_f32_16x16x32_bf16 v[56:59], a[144:147], a[24:27], v[56:59]
  s_add_u32 s22, s60, s9
  s_addc_u32 s23, s61, 0
  global_load_dwordx4 a[240:243], v11, s[22:23] offset:0 sc1
  v_mfma_f32_16x16x32_bf16 v[60:63], a[148:151], a[24:27], v[60:63]
  v_mul_f32 v116, v116, v120
  v_mul_f32 v117, v117, v121
  v_mfma_f32_16x16x32_bf16 v[64:67], a[152:155], a[24:27], v[64:67]
  v_mul_f32 v118, v118, v122
  v_mul_f32 v119, v119, v123
  v_mfma_f32_16x16x32_bf16 v[68:71], a[156:159], a[24:27], v[68:71]
  global_load_dwordx4 a[244:247], v11, s[22:23] offset:1024 sc1
  v_mfma_f32_16x16x32_bf16 v[32:35], a[160:163], a[24:27], v[32:35]
  v_add_f32 v124, 1.0, v124
  v_add_f32 v125, 1.0, v125
  v_mfma_f32_16x16x32_bf16 v[56:59], a[164:167], a[28:31], v[56:59]
  v_add_f32 v126, 1.0, v126
  v_add_f32 v127, 1.0, v127
  v_mfma_f32_16x16x32_bf16 v[60:63], a[168:171], a[28:31], v[60:63]
  global_load_dwordx4 a[248:251], v11, s[22:23] offset:2048 sc1
  v_mfma_f32_16x16x32_bf16 v[64:67], a[172:175], a[28:31], v[64:67]
  v_rcp_f32 v124, v124
  v_mfma_f32_16x16x32_bf16 v[68:71], a[176:179], a[28:31], v[68:71]
  s_waitcnt lgkmcnt(5)
  v_rcp_f32 v125, v125
  v_mfma_f32_16x16x32_bf16 v[32:35], a[180:183], a[28:31], v[32:35]
  s_waitcnt lgkmcnt(4)
  global_load_dwordx4 a[0:3], v11, s[22:23] offset:3072 sc1
  v_mfma_f32_16x16x32_bf16 v[56:59], a[184:187], a[32:35], v[56:59]
  s_add_u32 s9, s9, 4096
  v_rcp_f32 v126, v126
  s_waitcnt lgkmcnt(3)
  v_mfma_f32_16x16x32_bf16 v[60:63], a[188:191], a[32:35], v[60:63]
  s_add_u32 s22, s60, s9
  s_addc_u32 s23, s61, 0
  v_rcp_f32 v127, v127
  s_waitcnt lgkmcnt(2)
  v_mfma_f32_16x16x32_bf16 v[64:67], a[192:195], a[32:35], v[64:67]
  s_waitcnt lgkmcnt(1)
  global_load_dwordx4 a[4:7], v11, s[22:23] offset:0 sc1
  v_mfma_f32_16x16x32_bf16 v[68:71], a[196:199], a[32:35], v[68:71]
  s_waitcnt lgkmcnt(0)
  v_mul_f32 v116, v116, v124
  v_mul_f32 v117, v117, v125
  v_mfma_f32_16x16x32_bf16 v[32:35], a[200:203], a[32:35], v[32:35]
  v_mul_f32 v118, v118, v126
  v_mul_f32 v119, v119, v127
  v_mfma_f32_16x16x32_bf16 v[36:39], v[130:133], a[36:39], 0
  global_load_dwordx4 a[8:11], v11, s[22:23] offset:1024 sc1
  v_mfma_f32_16x16x32_bf16 v[40:43], v[134:137], a[36:39], 0
  v_cvt_pk_bf16_f32 v110, v116, v117
  v_cvt_pk_bf16_f32 v111, v118, v119
  v_mfma_f32_16x16x32_bf16 v[44:47], v[138:141], a[36:39], 0
  v_permlane32_swap_b32 v100, v104
  v_mfma_f32_16x16x32_bf16 v[48:51], v[142:145], a[36:39], 0
  ds_write_b128 v17, v[56:59] offset:0
  v_mfma_f32_16x16x32_bf16 v[52:55], v[146:149], a[36:39], 0
  global_load_dwordx4 a[12:15], v11, s[22:23] offset:2048 sc1
  v_mfma_f32_16x16x32_bf16 v[36:39], v[150:153], a[40:43], v[36:39]
  v_permlane32_swap_b32 v101, v105
  v_mfma_f32_16x16x32_bf16 v[40:43], v[154:157], a[40:43], v[40:43]
  v_permlane32_swap_b32 v102, v106
  v_mfma_f32_16x16x32_bf16 v[44:47], v[158:161], a[40:43], v[44:47]
  ds_write_b128 v17, v[60:63] offset:1152
  v_mfma_f32_16x16x32_bf16 v[48:51], v[162:165], a[40:43], v[48:51]
  global_load_dwordx4 a[16:19], v11, s[22:23] offset:3072 sc1
  v_mfma_f32_16x16x32_bf16 v[52:55], v[166:169], a[40:43], v[52:55]
  v_permlane32_swap_b32 v103, v107
  v_mfma_f32_16x16x32_bf16 v[36:39], v[170:173], a[44:47], v[36:39]
  s_add_u32 s9, s9, 4096
  v_permlane16_swap_b32 v108, v110
  v_mfma_f32_16x16x32_bf16 v[40:43], v[174:177], a[44:47], v[40:43]
  s_add_u32 s22, s60, s9
  s_addc_u32 s23, s61, 0
  ds_write_b128 v17, v[64:67] offset:2304
  v_mfma_f32_16x16x32_bf16 v[44:47], v[178:181], a[44:47], v[44:47]
  global_load_dwordx4 a[20:23], v11, s[22:23] offset:0 sc1
  v_mfma_f32_16x16x32_bf16 v[48:51], v[182:185], a[44:47], v[48:51]
  v_permlane16_swap_b32 v109, v111
  v_mfma_f32_16x16x32_bf16 v[52:55], v[186:189], a[44:47], v[52:55]
  v_mfma_f32_16x16x32_bf16 v[36:39], v[190:193], a[48:51], v[36:39]
  s_mov_b32 s92, 294912
  ds_write_b128 v17, v[68:71] offset:3456
  v_mfma_f32_16x16x32_bf16 v[40:43], v[194:197], a[48:51], v[40:43]
  global_load_dwordx4 a[24:27], v11, s[22:23] offset:1024 sc1
  v_mfma_f32_16x16x32_bf16 v[44:47], v[198:201], a[48:51], v[44:47]
  buffer_store_dwordx4 v[108:111], v13, s[60:63], s92 offen sc1
  v_mfma_f32_16x16x32_bf16 v[48:51], v[202:205], a[48:51], v[48:51]
  v_exp_f32 v124, v100
  v_mfma_f32_16x16x32_bf16 v[52:55], v[206:209], a[48:51], v[52:55]
  ds_write_b128 v17, v[32:35] offset:4608
  v_mfma_f32_16x16x32_bf16 v[36:39], v[210:213], a[52:55], v[36:39]
  global_load_dwordx4 a[28:31], v11, s[22:23] offset:2048 sc1
  v_mfma_f32_16x16x32_bf16 v[40:43], v[214:217], a[52:55], v[40:43]
  v_exp_f32 v125, v101
  v_mfma_f32_16x16x32_bf16 v[44:47], v[218:221], a[52:55], v[44:47]
  v_exp_f32 v126, v102
  v_mfma_f32_16x16x32_bf16 v[48:51], v[222:225], a[52:55], v[48:51]
  global_load_dwordx4 a[32:35], v11, s[22:23] offset:3072 sc1
  v_mfma_f32_16x16x32_bf16 v[52:55], v[226:229], a[52:55], v[52:55]
  v_exp_f32 v127, v103
  s_waitcnt lgkmcnt(0)
  s_barrier
  v_mfma_f32_16x16x32_bf16 v[36:39], v[230:233], a[56:59], v[36:39]
  s_add_u32 s9, s9, 90112
  v_mul_f32 v100, v100, v104
  v_mul_f32 v101, v101, v105
  v_mfma_f32_16x16x32_bf16 v[40:43], v[234:237], a[56:59], v[40:43]
  v_mul_f32 v102, v102, v106
  v_mul_f32 v103, v103, v107
  v_mfma_f32_16x16x32_bf16 v[44:47], v[238:241], a[56:59], v[44:47]
  v_add_f32 v124, 1.0, v124
  v_add_f32 v125, 1.0, v125
  v_mfma_f32_16x16x32_bf16 v[48:51], v[242:245], a[56:59], v[48:51]
  v_add_f32 v126, 1.0, v126
  v_add_f32 v127, 1.0, v127
  v_mfma_f32_16x16x32_bf16 v[52:55], v[246:249], a[56:59], v[52:55]
  v_rcp_f32 v124, v124
  v_mfma_f32_16x16x32_bf16 v[36:39], a[84:87], a[60:63], v[36:39]
  v_rcp_f32 v125, v125
  v_mfma_f32_16x16x32_bf16 v[40:43], a[88:91], a[60:63], v[40:43]
  v_rcp_f32 v126, v126
  v_mfma_f32_16x16x32_bf16 v[44:47], a[92:95], a[60:63], v[44:47]
  v_rcp_f32 v127, v127
  v_mfma_f32_16x16x32_bf16 v[48:51], a[96:99], a[60:63], v[48:51]
  v_mul_f32 v100, v100, v124
  v_mul_f32 v101, v101, v125
  v_mfma_f32_16x16x32_bf16 v[52:55], a[100:103], a[60:63], v[52:55]
  v_mul_f32 v102, v102, v126
  v_mul_f32 v103, v103, v127
  v_mfma_f32_16x16x32_bf16 v[36:39], a[104:107], a[64:67], v[36:39]
  v_cvt_pk_bf16_f32 v112, v100, v101
  v_cvt_pk_bf16_f32 v113, v102, v103
  v_mfma_f32_16x16x32_bf16 v[40:43], a[108:111], a[64:67], v[40:43]
  buffer_store_dwordx2 v[112:113], v14, s[60:63], s92 offen sc1
  v_mfma_f32_16x16x32_bf16 v[44:47], a[112:115], a[64:67], v[44:47]
  s_mov_b32 s4, 0
  buffer_load_dwordx4 v[104:107], v129, s[60:63], s4 offen sc1
  v_mfma_f32_16x16x32_bf16 v[48:51], a[116:119], a[64:67], v[48:51]
  s_mov_b32 s4, 40960
  buffer_load_dwordx4 v[108:111], v129, s[60:63], s4 offen sc1
  v_mfma_f32_16x16x32_bf16 v[52:55], a[120:123], a[64:67], v[52:55]
  v_mfma_f32_16x16x32_bf16 v[36:39], a[124:127], a[68:71], v[36:39]
  s_mov_b32 s4, 81920
  buffer_load_dwordx4 v[112:115], v129, s[60:63], s4 offen sc1
  v_mfma_f32_16x16x32_bf16 v[40:43], a[128:131], a[68:71], v[40:43]
  s_mov_b32 s4, 122880
  buffer_load_dwordx4 v[116:119], v129, s[60:63], s4 offen sc1
  v_mfma_f32_16x16x32_bf16 v[44:47], a[132:135], a[68:71], v[44:47]
  ds_read_b128 v[72:75], v18 offset:0
  ds_read_b128 v[76:79], v18 offset:288
  v_mfma_f32_16x16x32_bf16 v[48:51], a[136:139], a[68:71], v[48:51]
  ds_read_b128 v[80:83], v18 offset:5760
  ds_read_b128 v[84:87], v18 offset:6048
  v_mfma_f32_16x16x32_bf16 v[52:55], a[140:143], a[68:71], v[52:55]
  ds_read_b128 v[88:91], v18 offset:11520
  ds_read_b128 v[92:95], v18 offset:11808
  v_mfma_f32_16x16x32_bf16 v[36:39], a[144:147], a[72:75], v[36:39]
  ds_read_b128 v[96:99], v18 offset:17280
  ds_read_b128 v[100:103], v18 offset:17568
  v_mfma_f32_16x16x32_bf16 v[40:43], a[148:151], a[72:75], v[40:43]
  s_waitcnt lgkmcnt(5)
  v_add_f32 v72, v72, v80
  v_add_f32 v73, v73, v81
  v_mfma_f32_16x16x32_bf16 v[44:47], a[152:155], a[72:75], v[44:47]
  v_add_f32 v74, v74, v82
  v_add_f32 v75, v75, v83
  v_mfma_f32_16x16x32_bf16 v[48:51], a[156:159], a[72:75], v[48:51]
  s_waitcnt lgkmcnt(4)
  v_add_f32 v76, v76, v84
  v_add_f32 v77, v77, v85
  v_mfma_f32_16x16x32_bf16 v[52:55], a[160:163], a[72:75], v[52:55]
  v_add_f32 v78, v78, v86
  v_add_f32 v79, v79, v87
  v_mfma_f32_16x16x32_bf16 v[36:39], a[164:167], a[76:79], v[36:39]
  s_waitcnt lgkmcnt(1)
  v_add_f32 v88, v88, v96
  v_add_f32 v89, v89, v97
  v_mfma_f32_16x16x32_bf16 v[40:43], a[168:171], a[76:79], v[40:43]
  v_add_f32 v90, v90, v98
  v_add_f32 v91, v91, v99
  v_mfma_f32_16x16x32_bf16 v[44:47], a[172:175], a[76:79], v[44:47]
  s_waitcnt lgkmcnt(0)
  v_add_f32 v92, v92, v100
  v_add_f32 v93, v93, v101
  v_mfma_f32_16x16x32_bf16 v[48:51], a[176:179], a[76:79], v[48:51]
  v_add_f32 v94, v94, v102
  v_add_f32 v95, v95, v103
  v_mfma_f32_16x16x32_bf16 v[52:55], a[180:183], a[76:79], v[52:55]
  v_add_f32 v72, v72, v88
  v_add_f32 v73, v73, v89
  v_mfma_f32_16x16x32_bf16 v[36:39], a[184:187], a[80:83], v[36:39]
  v_add_f32 v74, v74, v90
  v_add_f32 v75, v75, v91
  v_mfma_f32_16x16x32_bf16 v[40:43], a[188:191], a[80:83], v[40:43]
  v_add_f32 v76, v76, v92
  v_add_f32 v77, v77, v93
  v_mfma_f32_16x16x32_bf16 v[44:47], a[192:195], a[80:83], v[44:47]
  v_add_f32 v78, v78, v94
  v_add_f32 v79, v79, v95
  v_mfma_f32_16x16x32_bf16 v[48:51], a[196:199], a[80:83], v[48:51]
  s_waitcnt vmcnt(3)
  v_dot2_f32_bf16 v80, v104, s74, v72
  v_dot2_f32_bf16 v81, v104, s75, v73
  v_mfma_f32_16x16x32_bf16 v[52:55], a[200:203], a[80:83], v[52:55]
  v_dot2_f32_bf16 v82, v105, s74, v74
  v_dot2_f32_bf16 v83, v105, s75, v75
  v_mfma_f32_16x16x32_bf16 v[56:59], v[130:133], a[240:243], 0
  v_dot2_f32_bf16 v84, v106, s74, v76
  v_dot2_f32_bf16 v85, v106, s75, v77
  v_mfma_f32_16x16x32_bf16 v[60:63], v[134:137], a[240:243], 0
  v_dot2_f32_bf16 v86, v107, s74, v78
  v_dot2_f32_bf16 v87, v107, s75, v79
  v_mfma_f32_16x16x32_bf16 v[64:67], v[138:141], a[240:243], 0
  v_cvt_pk_bf16_f32 v72, v80, v81
  v_cvt_pk_bf16_f32 v73, v82, v83
  v_mfma_f32_16x16x32_bf16 v[68:71], v[142:145], a[240:243], 0
  ds_write_b128 v17, v[36:39] offset:23040
  v_mfma_f32_16x16x32_bf16 v[32:35], v[146:149], a[240:243], 0
  v_cvt_pk_bf16_f32 v74, v84, v85
  v_cvt_pk_bf16_f32 v75, v86, v87
  v_mfma_f32_16x16x32_bf16 v[56:59], v[150:153], a[244:247], v[56:59]
  s_mov_b32 s92, 0
  buffer_store_dwordx4 v[72:75], v128, s[56:59], s92 offen
  v_mfma_f32_16x16x32_bf16 v[60:63], v[154:157], a[244:247], v[60:63]
  buffer_store_dword v19, v15, s[60:63], 0 offen offset:3072
  v_mfma_f32_16x16x32_bf16 v[64:67], v[158:161], a[244:247], v[64:67]
  ds_write_b128 v17, v[40:43] offset:24192
  v_mfma_f32_16x16x32_bf16 v[68:71], v[162:165], a[244:247], v[68:71]
  v_mfma_f32_16x16x32_bf16 v[32:35], v[166:169], a[244:247], v[32:35]
  v_mfma_f32_16x16x32_bf16 v[56:59], v[170:173], a[248:251], v[56:59]
  buffer_load_dword v26, v28, s[60:63], 0 offen offset:3072 sc1
  v_mfma_f32_16x16x32_bf16 v[60:63], v[174:177], a[248:251], v[60:63]
  ds_write_b128 v17, v[44:47] offset:25344
  v_mfma_f32_16x16x32_bf16 v[64:67], v[178:181], a[248:251], v[64:67]
  v_mfma_f32_16x16x32_bf16 v[68:71], v[182:185], a[248:251], v[68:71]
  v_mfma_f32_16x16x32_bf16 v[32:35], v[186:189], a[248:251], v[32:35]
  v_mfma_f32_16x16x32_bf16 v[56:59], v[190:193], a[0:3], v[56:59]
  ds_write_b128 v17, v[48:51] offset:26496
  v_mfma_f32_16x16x32_bf16 v[60:63], v[194:197], a[0:3], v[60:63]
  v_mfma_f32_16x16x32_bf16 v[64:67], v[198:201], a[0:3], v[64:67]
  v_mfma_f32_16x16x32_bf16 v[68:71], v[202:205], a[0:3], v[68:71]
  v_mfma_f32_16x16x32_bf16 v[32:35], v[206:209], a[0:3], v[32:35]
  ds_write_b128 v17, v[52:55] offset:27648
  v_mfma_f32_16x16x32_bf16 v[56:59], v[210:213], a[4:7], v[56:59]
  v_mfma_f32_16x16x32_bf16 v[60:63], v[214:217], a[4:7], v[60:63]
  v_mfma_f32_16x16x32_bf16 v[64:67], v[218:221], a[4:7], v[64:67]
  v_mfma_f32_16x16x32_bf16 v[68:71], v[222:225], a[4:7], v[68:71]
  v_mfma_f32_16x16x32_bf16 v[32:35], v[226:229], a[4:7], v[32:35]
  s_waitcnt lgkmcnt(0)
  s_barrier
  v_mfma_f32_16x16x32_bf16 v[56:59], v[230:233], a[8:11], v[56:59]
  v_mfma_f32_16x16x32_bf16 v[60:63], v[234:237], a[8:11], v[60:63]
  ds_read_b128 v[72:75], v18 offset:23040
  ds_read_b128 v[76:79], v18 offset:23328
  v_mfma_f32_16x16x32_bf16 v[64:67], v[238:241], a[8:11], v[64:67]
  ds_read_b128 v[80:83], v18 offset:28800
  ds_read_b128 v[84:87], v18 offset:29088
  v_mfma_f32_16x16x32_bf16 v[68:71], v[242:245], a[8:11], v[68:71]
  ds_read_b128 v[88:91], v18 offset:34560
  ds_read_b128 v[92:95], v18 offset:34848
  v_mfma_f32_16x16x32_bf16 v[32:35], v[246:249], a[8:11], v[32:35]
  ds_read_b128 v[96:99], v18 offset:40320
  ds_read_b128 v[100:103], v18 offset:40608
  v_mfma_f32_16x16x32_bf16 v[56:59], a[84:87], a[12:15], v[56:59]
  s_waitcnt lgkmcnt(5)
  v_add_f32 v72, v72, v80
  v_add_f32 v73, v73, v81
  v_mfma_f32_16x16x32_bf16 v[60:63], a[88:91], a[12:15], v[60:63]
  v_add_f32 v74, v74, v82
  v_add_f32 v75, v75, v83
  v_mfma_f32_16x16x32_bf16 v[64:67], a[92:95], a[12:15], v[64:67]
  s_waitcnt vmcnt(0)
  v_cmp_ne_u32 vcc, v26, v19
  s_waitcnt lgkmcnt(4)
  v_add_f32 v76, v76, v84
  v_mfma_f32_16x16x32_bf16 v[68:71], a[96:99], a[12:15], v[68:71]
  v_add_f32 v77, v77, v85
  v_add_f32 v78, v78, v86
  v_mfma_f32_16x16x32_bf16 v[32:35], a[100:103], a[12:15], v[32:35]
  v_add_f32 v79, v79, v87
  s_waitcnt lgkmcnt(1)
  v_add_f32 v88, v88, v96
  v_mfma_f32_16x16x32_bf16 v[56:59], a[104:107], a[16:19], v[56:59]
  s_cbranch_vccnz L_g3L
L_g3L_back:
  v_add_f32 v89, v89, v97
  v_add_f32 v90, v90, v98
  v_mfma_f32_16x16x32_bf16 v[60:63], a[108:111], a[16:19], v[60:63]
  s_add_u32 s22, s60, s9
  s_addc_u32 s23, s61, 0
  global_load_dwordx4 a[36:39], v11, s[22:23] offset:0 sc1
  v_mfma_f32_16x16x32_bf16 v[64:67], a[112:115], a[16:19], v[64:67]
  v_add_f32 v91, v91, v99
  s_waitcnt lgkmcnt(0)
  v_add_f32 v92, v92, v100
  v_mfma_f32_16x16x32_bf16 v[68:71], a[116:119], a[16:19], v[68:71]
  v_add_f32 v93, v93, v101
  v_add_f32 v94, v94, v102
  v_mfma_f32_16x16x32_bf16 v[32:35], a[120:123], a[16:19], v[32:35]
  global_load_dwordx4 a[40:43], v11, s[22:23] offset:1024 sc1
  v_mfma_f32_16x16x32_bf16 v[56:59], a[124:127], a[20:23], v[56:59]
  v_add_f32 v95, v95, v103
  v_add_f32 v72, v72, v88
  v_mfma_f32_16x16x32_bf16 v[60:63], a[128:131], a[20:23], v[60:63]
  v_add_f32 v73, v73, v89
  v_add_f32 v74, v74, v90
  v_mfma_f32_16x16x32_bf16 v[64:67], a[132:135], a[20:23], v[64:67]
  global_load_dwordx4 a[44:47], v11, s[22:23] offset:2048 sc1
  v_mfma_f32_16x16x32_bf16 v[68:71], a[136:139], a[20:23], v[68:71]
  v_add_f32 v75, v75, v91
  v_add_f32 v76, v76, v92
  v_mfma_f32_16x16x32_bf16 v[32:35], a[140:143], a[20:23], v[32:35]
  v_add_f32 v77, v77, v93
  v_add_f32 v78, v78, v94
  v_mfma_f32_16x16x32_bf16 v[56:59], a[144:147], a[24:27], v[56:59]
  global_load_dwordx4 a[48:51], v11, s[22:23] offset:3072 sc1
  v_mfma_f32_16x16x32_bf16 v[60:63], a[148:151], a[24:27], v[60:63]
  s_add_u32 s9, s9, 4096
  v_add_f32 v79, v79, v95
  v_dot2_f32_bf16 v80, v108, s74, v72
  v_mfma_f32_16x16x32_bf16 v[64:67], a[152:155], a[24:27], v[64:67]
  s_add_u32 s22, s60, s9
  s_addc_u32 s23, s61, 0
  v_dot2_f32_bf16 v81, v108, s75, v73
  v_dot2_f32_bf16 v82, v109, s74, v74
  v_mfma_f32_16x16x32_bf16 v[68:71], a[156:159], a[24:27], v[68:71]
  global_load_dwordx4 a[52:55], v11, s[22:23] offset:0 sc1
  v_mfma_f32_16x16x32_bf16 v[32:35], a[160:163], a[24:27], v[32:35]
  v_dot2_f32_bf16 v83, v109, s75, v75
  v_dot2_f32_bf16 v84, v110, s74, v76
  v_mfma_f32_16x16x32_bf16 v[56:59], a[164:167], a[28:31], v[56:59]
  v_dot2_f32_bf16 v85, v110, s75, v77
  v_dot2_f32_bf16 v86, v111, s74, v78
  v_mfma_f32_16x16x32_bf16 v[60:63], a[168:171], a[28:31], v[60:63]
  global_load_dwordx4 a[56:59], v11, s[22:23] offset:1024 sc1
  v_mfma_f32_16x16x32_bf16 v[64:67], a[172:175], a[28:31], v[64:67]
  v_dot2_f32_bf16 v87, v111, s75, v79
  v_cvt_pk_bf16_f32 v72, v80, v81
  v_mfma_f32_16x16x32_bf16 v[68:71], a[176:179], a[28:31], v[68:71]
  v_cvt_pk_bf16_f32 v73, v82, v83
  v_cvt_pk_bf16_f32 v74, v84, v85
  v_mfma_f32_16x16x32_bf16 v[32:35], a[180:183], a[28:31], v[32:35]
  global_load_dwordx4 a[60:63], v11, s[22:23] offset:2048 sc1
  v_mfma_f32_16x16x32_bf16 v[56:59], a[184:187], a[32:35], v[56:59]
  v_cvt_pk_bf16_f32 v75, v86, v87
  v_mfma_f32_16x16x32_bf16 v[60:63], a[188:191], a[32:35], v[60:63]
  s_mov_b32 s92, 40960
  buffer_store_dwordx4 v[72:75], v128, s[56:59], s92 offen
  v_mfma_f32_16x16x32_bf16 v[64:67], a[192:195], a[32:35], v[64:67]
  v_mfma_f32_16x16x32_bf16 v[68:71], a[196:199], a[32:35], v[68:71]
  v_mfma_f32_16x16x32_bf16 v[32:35], a[200:203], a[32:35], v[32:35]
  s_waitcnt vmcnt(7)
  global_load_dwordx4 a[64:67], v11, s[22:23] offset:3072 sc1
  v_mfma_f32_16x16x32_bf16 v[36:39], v[130:133], a[36:39], 0
  s_add_u32 s9, s9, 4096
  v_mfma_f32_16x16x32_bf16 v[40:43], v[134:137], a[36:39], 0
  s_add_u32 s22, s60, s9
  s_addc_u32 s23, s61, 0
  v_mfma_f32_16x16x32_bf16 v[44:47], v[138:141], a[36:39], 0
  global_load_dwordx4 a[68:71], v11, s[22:23] offset:0 sc1
  v_mfma_f32_16x16x32_bf16 v[48:51], v[142:145], a[36:39], 0
  ds_write_b128 v17, v[56:59] offset:0
  v_mfma_f32_16x16x32_bf16 v[52:55], v[146:149], a[36:39], 0
  s_waitcnt vmcnt(8)
  v_mfma_f32_16x16x32_bf16 v[36:39], v[150:153], a[40:43], v[36:39]
  global_load_dwordx4 a[72:75], v11, s[22:23] offset:1024 sc1
  v_mfma_f32_16x16x32_bf16 v[40:43], v[154:157], a[40:43], v[40:43]
  v_mfma_f32_16x16x32_bf16 v[44:47], v[158:161], a[40:43], v[44:47]
  ds_write_b128 v17, v[60:63] offset:1152
  v_mfma_f32_16x16x32_bf16 v[48:51], v[162:165], a[40:43], v[48:51]
  global_load_dwordx4 a[76:79], v11, s[22:23] offset:2048 sc1
  v_mfma_f32_16x16x32_bf16 v[52:55], v[166:169], a[40:43], v[52:55]
  s_waitcnt vmcnt(9)
  v_mfma_f32_16x16x32_bf16 v[36:39], v[170:173], a[44:47], v[36:39]
  v_mfma_f32_16x16x32_bf16 v[40:43], v[174:177], a[44:47], v[40:43]
  ds_write_b128 v17, v[64:67] offset:2304
  v_mfma_f32_16x16x32_bf16 v[44:47], v[178:181], a[44:47], v[44:47]
  global_load_dwordx4 a[80:83], v11, s[22:23] offset:3072 sc1
  v_mfma_f32_16x16x32_bf16 v[48:51], v[182:185], a[44:47], v[48:51]
  s_add_u32 s9, s9, 90112
  v_mfma_f32_16x16x32_bf16 v[52:55], v[186:189], a[44:47], v[52:55]
  s_waitcnt vmcnt(9)
  v_mfma_f32_16x16x32_bf16 v[36:39], v[190:193], a[48:51], v[36:39]
  ds_write_b128 v17, v[68:71] offset:3456
  v_mfma_f32_16x16x32_bf16 v[40:43], v[194:197], a[48:51], v[40:43]
  v_mfma_f32_16x16x32_bf16 v[44:47], v[198:201], a[48:51], v[44:47]
  v_mfma_f32_16x16x32_bf16 v[48:51], v[202:205], a[48:51], v[48:51]
  v_mfma_f32_16x16x32_bf16 v[52:55], v[206:209], a[48:51], v[52:55]
  s_waitcnt vmcnt(8)
  ds_write_b128 v17, v[32:35] offset:4608
  v_mfma_f32_16x16x32_bf16 v[36:39], v[210:213], a[52:55], v[36:39]
  v_mfma_f32_16x16x32_bf16 v[40:43], v[214:217], a[52:55], v[40:43]
  v_mfma_f32_16x16x32_bf16 v[44:47], v[218:221], a[52:55], v[44:47]
  v_mfma_f32_16x16x32_bf16 v[48:51], v[222:225], a[52:55], v[48:51]
  v_mfma_f32_16x16x32_bf16 v[52:55], v[226:229], a[52:55], v[52:55]
  s_waitcnt lgkmcnt(0)
  s_barrier
  s_waitcnt vmcnt(7)
  v_mfma_f32_16x16x32_bf16 v[36:39], v[230:233], a[56:59], v[36:39]
  v_mfma_f32_16x16x32_bf16 v[40:43], v[234:237], a[56:59], v[40:43]
  ds_read_b128 v[72:75], v18 offset:0
  ds_read_b128 v[76:79], v18 offset:288
  v_mfma_f32_16x16x32_bf16 v[44:47], v[238:241], a[56:59], v[44:47]
  ds_read_b128 v[80:83], v18 offset:5760
  ds_read_b128 v[84:87], v18 offset:6048
  v_mfma_f32_16x16x32_bf16 v[48:51], v[242:245], a[56:59], v[48:51]
  ds_read_b128 v[88:91], v18 offset:11520
  ds_read_b128 v[92:95], v18 offset:11808
  v_mfma_f32_16x16x32_bf16 v[52:55], v[246:249], a[56:59], v[52:55]
  s_waitcnt vmcnt(6)
  ds_read_b128 v[96:99], v18 offset:17280
  ds_read_b128 v[100:103], v18 offset:17568
  v_mfma_f32_16x16x32_bf16 v[36:39], a[84:87], a[60:63], v[36:39]
  s_waitcnt lgkmcnt(5)
  v_add_f32 v72, v72, v80
  v_add_f32 v73, v73, v81
  v_mfma_f32_16x16x32_bf16 v[40:43], a[88:91], a[60:63], v[40:43]
  v_add_f32 v74, v74, v82
  v_add_f32 v75, v75, v83
  v_mfma_f32_16x16x32_bf16 v[44:47], a[92:95], a[60:63], v[44:47]
  s_waitcnt lgkmcnt(4)
  v_add_f32 v76, v76, v84
  v_add_f32 v77, v77, v85
  v_mfma_f32_16x16x32_bf16 v[48:51], a[96:99], a[60:63], v[48:51]
  v_add_f32 v78, v78, v86
  v_add_f32 v79, v79, v87
  v_mfma_f32_16x16x32_bf16 v[52:55], a[100:103], a[60:63], v[52:55]
  s_waitcnt lgkmcnt(1)
  v_add_f32 v88, v88, v96
  v_add_f32 v89, v89, v97
  s_waitcnt vmcnt(4)
  v_mfma_f32_16x16x32_bf16 v[36:39], a[104:107], a[64:67], v[36:39]
  v_add_f32 v90, v90, v98
  v_add_f32 v91, v91, v99
  v_mfma_f32_16x16x32_bf16 v[40:43], a[108:111], a[64:67], v[40:43]
  s_waitcnt lgkmcnt(0)
  v_add_f32 v92, v92, v100
  v_add_f32 v93, v93, v101
  v_mfma_f32_16x16x32_bf16 v[44:47], a[112:115], a[64:67], v[44:47]
  v_add_f32 v94, v94, v102
  v_add_f32 v95, v95, v103
  v_mfma_f32_16x16x32_bf16 v[48:51], a[116:119], a[64:67], v[48:51]
  v_add_f32 v72, v72, v88
  v_add_f32 v73, v73, v89
  v_mfma_f32_16x16x32_bf16 v[52:55], a[120:123], a[64:67], v[52:55]
  s_waitcnt vmcnt(3)
  v_add_f32 v74, v74, v90
  v_add_f32 v75, v75, v91
  v_mfma_f32_16x16x32_bf16 v[36:39], a[124:127], a[68:71], v[36:39]
  v_add_f32 v76, v76, v92
  v_add_f32 v77, v77, v93
  v_mfma_f32_16x16x32_bf16 v[40:43], a[128:131], a[68:71], v[40:43]
  v_add_f32 v78, v78, v94
  v_add_f32 v79, v79, v95
  v_mfma_f32_16x16x32_bf16 v[44:47], a[132:135], a[68:71], v[44:47]
  v_dot2_f32_bf16 v80, v112, s74, v72
  v_dot2_f32_bf16 v81, v112, s75, v73
  v_mfma_f32_16x16x32_bf16 v[48:51], a[136:139], a[68:71], v[48:51]
  v_dot2_f32_bf16 v82, v113, s74, v74
  v_dot2_f32_bf16 v83, v113, s75, v75
  v_mfma_f32_16x16x32_bf16 v[52:55], a[140:143], a[68:71], v[52:55]
  s_waitcnt vmcnt(2)
  v_dot2_f32_bf16 v84, v114, s74, v76
  v_dot2_f32_bf16 v85, v114, s75, v77
  v_mfma_f32_16x16x32_bf16 v[36:39], a[144:147], a[72:75], v[36:39]
  v_dot2_f32_bf16 v86, v115, s74, v78
  v_dot2_f32_bf16 v87, v115, s75, v79
  v_mfma_f32_16x16x32_bf16 v[40:43], a[148:151], a[72:75], v[40:43]
  v_cvt_pk_bf16_f32 v72, v80, v81
  v_cvt_pk_bf16_f32 v73, v82, v83
  v_mfma_f32_16x16x32_bf16 v[44:47], a[152:155], a[72:75], v[44:47]
  v_cvt_pk_bf16_f32 v74, v84, v85
  v_cvt_pk_bf16_f32 v75, v86, v87
  v_mfma_f32_16x16x32_bf16 v[48:51], a[156:159], a[72:75], v[48:51]
  s_mov_b32 s92, 81920
  buffer_store_dwordx4 v[72:75], v128, s[56:59], s92 offen
  v_mfma_f32_16x16x32_bf16 v[52:55], a[160:163], a[72:75], v[52:55]
  s_waitcnt vmcnt(2)
  v_mfma_f32_16x16x32_bf16 v[36:39], a[164:167], a[76:79], v[36:39]
  v_mfma_f32_16x16x32_bf16 v[40:43], a[168:171], a[76:79], v[40:43]
  v_mfma_f32_16x16x32_bf16 v[44:47], a[172:175], a[76:79], v[44:47]
  v_mfma_f32_16x16x32_bf16 v[48:51], a[176:179], a[76:79], v[48:51]
  v_mfma_f32_16x16x32_bf16 v[52:55], a[180:183], a[76:79], v[52:55]
  s_waitcnt vmcnt(1)
  v_mfma_f32_16x16x32_bf16 v[36:39], a[184:187], a[80:83], v[36:39]
  v_mfma_f32_16x16x32_bf16 v[40:43], a[188:191], a[80:83], v[40:43]
  v_mfma_f32_16x16x32_bf16 v[44:47], a[192:195], a[80:83], v[44:47]
  v_mfma_f32_16x16x32_bf16 v[48:51], a[196:199], a[80:83], v[48:51]
  v_mfma_f32_16x16x32_bf16 v[52:55], a[200:203], a[80:83], v[52:55]
  s_nop 3
  ds_write_b128 v17, v[36:39] offset:23040
  ds_write_b128 v17, v[40:43] offset:24192
  ds_write_b128 v17, v[44:47] offset:25344
  ds_write_b128 v17, v[48:51] offset:26496
  ds_write_b128 v17, v[52:55] offset:27648
  s_waitcnt lgkmcnt(0)
  s_barrier
  ds_read_b128 v[72:75], v18 offset:23040
  ds_read_b128 v[76:79], v18 offset:23328
  ds_read_b128 v[80:83], v18 offset:28800
  ds_read_b128 v[84:87], v18 offset:29088
  ds_read_b128 v[88:91], v18 offset:34560
  ds_read_b128 v[92:95], v18 offset:34848
  ds_read_b128 v[96:99], v18 offset:40320
  ds_read_b128 v[100:103], v18 offset:40608
  s_waitcnt lgkmcnt(5)
  v_add_f32 v72, v72, v80
  v_add_f32 v73, v73, v81
  v_add_f32 v74, v74, v82
  v_add_f32 v75, v75, v83
  s_waitcnt lgkmcnt(4)
  v_add_f32 v76, v76, v84
  v_add_f32 v77, v77, v85
  v_add_f32 v78, v78, v86
  v_add_f32 v79, v79, v87
  s_waitcnt lgkmcnt(1)
  v_add_f32 v88, v88, v96
  v_add_f32 v89, v89, v97
  v_add_f32 v90, v90, v98
  v_add_f32 v91, v91, v99
  s_waitcnt lgkmcnt(0)
  v_add_f32 v92, v92, v100
  v_add_f32 v93, v93, v101
  v_add_f32 v94, v94, v102
  v_add_f32 v95, v95, v103
  v_add_f32 v72, v72, v88
  v_add_f32 v73, v73, v89
  v_add_f32 v74, v74, v90
  v_add_f32 v75, v75, v91
  v_add_f32 v76, v76, v92
  v_add_f32 v77, v77, v93
  v_add_f32 v78, v78, v94
  v_add_f32 v79, v79, v95
  v_dot2_f32_bf16 v80, v116, s74, v72
  v_dot2_f32_bf16 v81, v116, s75, v73
  v_dot2_f32_bf16 v82, v117, s74, v74
  v_dot2_f32_bf16 v83, v117, s75, v75
  v_dot2_f32_bf16 v84, v118, s74, v76
  v_dot2_f32_bf16 v85, v118, s75, v77
  v_dot2_f32_bf16 v86, v119, s74, v78
  v_dot2_f32_bf16 v87, v119, s75, v79
  v_cvt_pk_bf16_f32 v72, v80, v81
  v_cvt_pk_bf16_f32 v73, v82, v83
  v_cvt_pk_bf16_f32 v74, v84, v85
  v_cvt_pk_bf16_f32 v75, v86, v87
  s_mov_b32 s92, 122880
  buffer_store_dwordx4 v[72:75], v128, s[56:59], s92 offen
L_exit:
  s_endpgm
L_g01L:
  s_mov_b32 s93, 0x40000
L_g01L_poll:
  buffer_load_dword v26, v27, s[60:63], 0 offen offset:0 sc1
  s_waitcnt vmcnt(0)
  v_cmp_ne_u32 vcc, v26, v19
  s_nop 3
  s_cmp_eq_u64 vcc, 0
  s_cbranch_scc1 L_g01L_poll_ok
  s_sub_u32 s93, s93, 1
  s_cbranch_scc0 L_g01L_poll
L_g01L_poll_ok:
  s_branch L_g01L_back
L_g2L:
  s_mov_b32 s93, 0x40000
L_g2L_poll:
  buffer_load_dword v26, v28, s[60:63], 0 offen offset:2048 sc1
  s_waitcnt vmcnt(0)
  v_cmp_ne_u32 vcc, v26, v19
  s_nop 3
  s_cmp_eq_u64 vcc, 0
  s_cbranch_scc1 L_g2L_poll_ok
  s_sub_u32 s93, s93, 1
  s_cbranch_scc0 L_g2L_poll
L_g2L_poll_ok:
  s_branch L_g2L_back
L_g3L:
  s_mov_b32 s93, 0x40000
L_g3L_poll:
  buffer_load_dword v26, v28, s[60:63], 0 offen offset:3072 sc1
  s_waitcnt vmcnt(0)
  v_cmp_ne_u32 vcc, v26, v19
  s_nop 3
  s_cmp_eq_u64 vcc, 0
  s_cbranch_scc1 L_g3L_poll_ok
  s_sub_u32 s93, s93, 1
  s_cbranch_scc0 L_g3L_poll
L_g3L_poll_ok:
  s_branch L_g3L_back
L_tailG:
  s_waitcnt vmcnt(0) lgkmcnt(0)
  buffer_store_dwordx4 v[124:127], v250, s[60:63], 0 offen sc1
  buffer_store_dwordx4 v[128:131], v250, s[60:63], 0 offen offset:512 sc1
  buffer_store_dwordx4 v[132:135], v251, s[60:63], 0 offen offset:768 sc1
  v_mov_b32 v232, s76
  v_mov_b32 v233, s76
  v_mov_b32 v234, s76
  v_mov_b32 v235, s76
  v_mov_b32 v24, 1073741824
  v_and_b32 v21, 1, v3
  v_cmp_eq_u32 vcc, 1, v21
  s_nop 1
  v_cndmask_b32 v246, v252, v24, vcc
  s_lshl_b32 s4, s90, 10
  s_lshl_b32 s5, s71, 3
  s_add_u32 s4, s4, s5
  s_add_u32 s4, s4, 10485760
  v_lshl_add_u32 v20, v2, 6, s4
  v_cmp_eq_u32 vcc, 0, v3
  s_nop 1
  v_cndmask_b32 v247, v24, v20, vcc
  s_or_b32 s4, s2, s68
  s_cmp_eq_u32 s4, 0
  s_mov_b32 s5, 1073741824
  s_cselect_b32 s4, 18874368, s5
  v_mov_b32 v26, 1073741824
  v_mov_b32 v20, s4
  v_cmp_eq_u32 vcc, 0, v1
  s_nop 1
  v_cndmask_b32 v26, v26, v20, vcc
  s_lshl_b32 s4, s90, 7
  s_lshl_b32 s5, s71, 4
  s_add_u32 s4, s4, s5
  s_add_u32 s4, s4, 18923520
  v_lshl_add_u32 v20, v2, 4, s17
  v_mov_b32 v27, v20
  v_mov_b32 v28, 1073741824
  v_mov_b32 v20, s4
  v_cmp_eq_u32 vcc, 0, v1
  s_nop 1
  v_cndmask_b32 v28, v28, v20, vcc
  s_mul_i32 s6, s90, 20480
  s_add_u32 s6, s6, 4194304
  v_add_u32 v12, 61440, v11
  s_mul_i32 s88, s68, 5120
  s_lshl_b32 s91, s69, 3
  s_mul_i32 s87, s91, 20480
  s_add_u32 s87, s87, s88
  s_add_u32 s87, s87, 7340032
  s_lshl_b32 s4, s91, 7
  s_add_u32 s4, s4, 18923520
  v_add_u32 v30, s4, v11
  s_lshl_b32 s10, s91, 10
  s_lshl_b32 s11, s68, 11
  s_add_u32 s10, s10, s11
  s_add_u32 s10, s10, 10485760
  v_lshlrev_b32 v31, 6, v2
  v_add_u32 v31, 65536, v31
  v_lshrrev_b32 v20, 2, v1
  v_and_b32 v21, 1, v1
  v_lshlrev_b32 v20, 6, v20
  v_lshl_add_u32 v20, v21, 3, v20
  s_lshl_b32 s11, s68, 4
  s_add_u32 s11, s11, 65536
  v_add_u32 v25, s11, v20
  v_min_u32 v20, 11, v2
  v_lshl_add_u32 v29, v20, 4, s27
  s_lshl_b32 s4, s73, 2
  s_add_u32 s4, s4, s68
  s_lshl_b32 s7, s4, 4
  s_mul_i32 s4, s4, 768
  s_mul_i32 s5, s91, 49152
  s_add_u32 s4, s4, s5
  s_add_u32 s4, s4, 11534336
  v_and_b32 v20, 1, v3
  v_lshrrev_b32 v21, 1, v3
  v_mul_u32_u24 v22, 49152, v20
  v_lshl_add_u32 v22, v21, 8, v22
  v_lshl_add_u32 v22, v2, 4, v22
  v_add_u32 v13, s4, v22
  v_mul_u32_u24 v21, 49152, v21
  v_lshl_add_u32 v21, v20, 3, v21
  v_lshl_add_u32 v20, v2, 4, v21
  v_add_u32 v14, s4, v20
  v_add_u32 v14, 512, v14
  s_lshl_b32 s4, s69, 12
  s_add_u32 s4, s4, s7
  s_add_u32 s4, s4, 18939904
  v_mov_b32 v15, 1073741824
  v_mov_b32 v20, s4
  v_cmp_eq_u32 vcc, 0, v1
  s_nop 1
  v_cndmask_b32 v15, v15, v20, vcc
  v_mov_b32 v16, 0xbfb8aa3b
  v_mov_b32 v20, 0xbf317218
  v_cmp_lt_u32 vcc, 31, v1
  s_nop 1
  v_cndmask_b32 v16, v16, v20, vcc
  s_mov_b32 s19, 0xbfb8aa3b
  s_mov_b32 s18, 0xbf317218
  v_and_b32 v20, 3, v1
  v_lshrrev_b32 v21, 2, v1
  v_min_u32 v21, 9, v21
  s_lshl_b32 s4, s68, 2
  v_add_u32 v20, s4, v20
  v_mul_u32_u24 v22, 576, v21
  v_lshl_add_u32 v18, v20, 4, v22
  v_add_u32 v18, 102400, v18
  v_mul_u32_u24 v22, 288, v3
  v_lshl_add_u32 v22, v2, 4, v22
  s_mul_i32 s4, s68, 5760
  s_add_u32 s4, s4, 102400
  v_add_u32 v17, s4, v22
  s_add_u32 s8, s91, s70
  s_lshl_b32 s4, s8, 4
  v_add_u32 v22, s4, v20
  v_mul_u32_u24 v22, 1280, v22
  v_lshl_add_u32 v22, v21, 4, v22
  s_mul_i32 s4, s71, 160
  v_add_u32 v22, s4, v22
  v_mov_b32 v23, 1073741824
  v_cmp_gt_u32 vcc, 40, v1
  s_nop 1
  v_cndmask_b32 v22, v23, v22, vcc
  v_accvgpr_write_b32 a252, v22
  s_mul_i32 s4, s8, 20480
  s_mul_i32 s5, s71, 2560
  s_add_u32 s4, s4, s5
  s_add_u32 s4, s4, 7340032
  v_lshlrev_b32 v22, 8, v21
  v_lshl_add_u32 v22, v20, 4, v22
  v_add_u32 v22, s4, v22
  v_cndmask_b32 v22, v23, v22, vcc
  v_accvgpr_write_b32 a253, v22
  s_mul_i32 s9, s8, 49152
  s_mul_i32 s5, s68, 12288
  s_add_u32 s9, s9, s5
  s_add_u32 s9, s9, 11534336
  v_mov_b32 v214, 0
  v_mov_b32 v215, 0
  v_mov_b32 v216, 0
  v_mov_b32 v217, 0
  v_accvgpr_read_b32 v236, a192
  v_accvgpr_read_b32 v237, a193
  v_accvgpr_read_b32 v238, a194
  v_accvgpr_read_b32 v239, a195
  v_accvgpr_read_b32 v240, a196
  v_accvgpr_read_b32 v241, a197
  v_accvgpr_read_b32 v242, a198
  v_accvgpr_read_b32 v243, a199
  v_accvgpr_read_b32 v244, a200
  v_accvgpr_read_b32 v245, a201
  v_dot2_f32_bf16 v172, v236, s74, 0
  v_dot2_f32_bf16 v173, v236, s75, 0
  v_dot2_f32_bf16 v174, v237, s74, 0
  v_dot2_f32_bf16 v175, v237, s75, 0
  v_dot2_f32_bf16 v176, v238, s74, 0
  v_dot2_f32_bf16 v177, v238, s75, 0
  v_dot2_f32_bf16 v178, v239, s74, 0
  v_dot2_f32_bf16 v179, v239, s75, 0
  v_dot2_f32_bf16 v180, v240, s74, 0
  v_dot2_f32_bf16 v181, v240, s75, 0
  v_dot2_f32_bf16 v182, v241, s74, 0
  v_dot2_f32_bf16 v183, v241, s75, 0
  v_dot2_f32_bf16 v184, v242, s74, 0
  v_dot2_f32_bf16 v185, v242, s75, 0
  v_dot2_f32_bf16 v186, v243, s74, 0
  v_dot2_f32_bf16 v187, v243, s75, 0
  v_dot2_f32_bf16 v188, v244, s74, 0
  v_dot2_f32_bf16 v189, v244, s75, 0
  v_dot2_f32_bf16 v190, v245, s74, 0
  v_dot2_f32_bf16 v191, v245, s75, 0
  s_waitcnt vmcnt(0)
  buffer_store_dword v19, v253, s[60:63], 0 offen offset:0 sc1
  buffer_store_dword v19, v26, s[60:63], 0 offen sc1
  ds_read_b64_tr_b16 v[112:113], v9 offset:0
  ds_read_b64_tr_b16 v[114:115], v9 offset:1280
  ds_read_b64_tr_b16 v[116:117], v9 offset:32
  ds_read_b64_tr_b16 v[118:119], v9 offset:1312
  ds_read_b64_tr_b16 v[120:121], v9 offset:64
  ds_read_b64_tr_b16 v[122:123], v9 offset:1344
  ds_read_b64_tr_b16 v[124:125], v9 offset:96
  ds_read_b64_tr_b16 v[126:127], v9 offset:1376
  ds_read_b64_tr_b16 v[128:129], v9 offset:128
  ds_read_b64_tr_b16 v[130:131], v9 offset:1408
  ds_read_b64_tr_b16 v[132:133], v9 offset:5120
  ds_read_b64_tr_b16 v[134:135], v9 offset:6400
  ds_read_b64_tr_b16 v[136:137], v9 offset:5152
  ds_read_b64_tr_b16 v[138:139], v9 offset:6432
  s_mov_b32 s93, 0x40000
L_polloG:
  buffer_load_dword v20, v27, s[60:63], 0 offen offset:0 sc1
  s_waitcnt vmcnt(0)
  v_cmp_ne_u32 vcc, v20, v19
  s_nop 3
  s_cmp_eq_u64 vcc, 0
  s_cbranch_scc1 L_polloG_ok
  s_sub_u32 s93, s93, 1
  s_cbranch_scc0 L_polloG
L_polloG_ok:
  buffer_load_dwordx4 v[32:35], v11, s[60:63], s6 offen offset:0 sc1
  buffer_load_dwordx4 v[36:39], v11, s[60:63], s6 offen offset:1024 sc1
  buffer_load_dwordx4 v[40:43], v11, s[60:63], s6 offen offset:2048 sc1
  buffer_load_dwordx4 v[44:47], v11, s[60:63], s6 offen offset:3072 sc1
  s_add_u32 s6, s6, 4096
  buffer_load_dwordx4 v[48:51], v11, s[60:63], s6 offen offset:0 sc1
  buffer_load_dwordx4 v[52:55], v11, s[60:63], s6 offen offset:1024 sc1
  buffer_load_dwordx4 v[56:59], v11, s[60:63], s6 offen offset:2048 sc1
  buffer_load_dwordx4 v[60:63], v11, s[60:63], s6 offen offset:3072 sc1
  s_add_u32 s6, s6, 4096
  buffer_load_dwordx4 v[64:67], v11, s[60:63], s6 offen offset:0 sc1
  buffer_load_dwordx4 v[68:71], v11, s[60:63], s6 offen offset:1024 sc1
  buffer_load_dwordx4 v[72:75], v11, s[60:63], s6 offen offset:2048 sc1
  buffer_load_dwordx4 v[76:79], v11, s[60:63], s6 offen offset:3072 sc1
  s_add_u32 s6, s6, 4096
  buffer_load_dwordx4 v[80:83], v11, s[60:63], s6 offen offset:0 sc1
  buffer_load_dwordx4 v[84:87], v11, s[60:63], s6 offen offset:1024 sc1
  buffer_load_dwordx4 v[88:91], v11, s[60:63], s6 offen offset:2048 sc1
  buffer_load_dwordx4 v[92:95], v11, s[60:63], s6 offen offset:3072 sc1
  s_add_u32 s6, s6, 4096
  buffer_load_dwordx4 v[96:99], v11, s[60:63], s6 offen offset:0 sc1
  buffer_load_dwordx4 v[100:103], v11, s[60:63], s6 offen offset:1024 sc1
  buffer_load_dwordx4 v[104:107], v11, s[60:63], s6 offen offset:2048 sc1
  buffer_load_dwordx4 v[108:111], v11, s[60:63], s6 offen offset:3072 sc1
  s_waitcnt vmcnt(19) lgkmcnt(12)
  v_mfma_f32_16x16x32_bf16 v[172:175], v[112:115], v[32:35], v[172:175]
  s_waitcnt lgkmcnt(10)
  ds_read_b64_tr_b16 v[140:141], v9 offset:5184
  ds_read_b64_tr_b16 v[142:143], v9 offset:6464
  v_mfma_f32_16x16x32_bf16 v[176:179], v[116:119], v[32:35], v[176:179]
  s_waitcnt lgkmcnt(10)
  ds_read_b64_tr_b16 v[112:113], v9 offset:5216
  ds_read_b64_tr_b16 v[114:115], v9 offset:6496
  v_mfma_f32_16x16x32_bf16 v[180:183], v[120:123], v[32:35], v[180:183]
  s_waitcnt lgkmcnt(10)
  ds_read_b64_tr_b16 v[116:117], v9 offset:5248
  ds_read_b64_tr_b16 v[118:119], v9 offset:6528
  v_mfma_f32_16x16x32_bf16 v[184:187], v[124:127], v[32:35], v[184:187]
  s_waitcnt lgkmcnt(10)
  ds_read_b64_tr_b16 v[120:121], v9 offset:10240
  ds_read_b64_tr_b16 v[122:123], v9 offset:11520
  v_mfma_f32_16x16x32_bf16 v[188:191], v[128:131], v[32:35], v[188:191]
  s_waitcnt vmcnt(18) lgkmcnt(10)
  ds_read_b64_tr_b16 v[124:125], v9 offset:10272
  ds_read_b64_tr_b16 v[126:127], v9 offset:11552
  v_mfma_f32_16x16x32_bf16 v[172:175], v[132:135], v[36:39], v[172:175]
  s_waitcnt lgkmcnt(10)
  ds_read_b64_tr_b16 v[128:129], v9 offset:10304
  ds_read_b64_tr_b16 v[130:131], v9 offset:11584
  v_mfma_f32_16x16x32_bf16 v[176:179], v[136:139], v[36:39], v[176:179]
  s_waitcnt lgkmcnt(10)
  ds_read_b64_tr_b16 v[132:133], v9 offset:10336
  ds_read_b64_tr_b16 v[134:135], v9 offset:11616
  v_mfma_f32_16x16x32_bf16 v[180:183], v[140:143], v[36:39], v[180:183]
  s_waitcnt lgkmcnt(10)
  ds_read_b64_tr_b16 v[136:137], v9 offset:10368
  ds_read_b64_tr_b16 v[138:139], v9 offset:11648
  v_mfma_f32_16x16x32_bf16 v[184:187], v[112:115], v[36:39], v[184:187]
  s_waitcnt lgkmcnt(10)
  ds_read_b64_tr_b16 v[140:141], v9 offset:15360
  ds_read_b64_tr_b16 v[142:143], v9 offset:16640
  v_mfma_f32_16x16x32_bf16 v[188:191], v[116:119], v[36:39], v[188:191]
  s_waitcnt vmcnt(17) lgkmcnt(10)
  ds_read_b64_tr_b16 v[112:113], v9 offset:15392
  ds_read_b64_tr_b16 v[114:115], v9 offset:16672
  s_add_u32 s24, s60, s83
  s_addc_u32 s25, s61, 0
  global_load_dwordx4 a[192:195], v11, s[24:25] offset:0 sc1
  v_mfma_f32_16x16x32_bf16 v[172:175], v[120:123], v[40:43], v[172:175]
  s_waitcnt lgkmcnt(10)
  ds_read_b64_tr_b16 v[116:117], v9 offset:15424
  ds_read_b64_tr_b16 v[118:119], v9 offset:16704
  v_mfma_f32_16x16x32_bf16 v[176:179], v[124:127], v[40:43], v[176:179]
  s_waitcnt lgkmcnt(10)
  ds_read_b64_tr_b16 v[120:121], v9 offset:15456
  ds_read_b64_tr_b16 v[122:123], v9 offset:16736
  v_mfma_f32_16x16x32_bf16 v[180:183], v[128:131], v[40:43], v[180:183]
  s_waitcnt lgkmcnt(10)
  ds_read_b64_tr_b16 v[124:125], v9 offset:15488
  ds_read_b64_tr_b16 v[126:127], v9 offset:16768
  v_mfma_f32_16x16x32_bf16 v[184:187], v[132:135], v[40:43], v[184:187]
  s_waitcnt lgkmcnt(10)
  ds_read_b64_tr_b16 v[128:129], v9 offset:20480
  ds_read_b64_tr_b16 v[130:131], v9 offset:21760
  v_mfma_f32_16x16x32_bf16 v[188:191], v[136:139], v[40:43], v[188:191]
  s_waitcnt vmcnt(17) lgkmcnt(10)
  ds_read_b64_tr_b16 v[132:133], v9 offset:20512
  ds_read_b64_tr_b16 v[134:135], v9 offset:21792
  global_load_dwordx4 a[196:199], v11, s[24:25] offset:1024 sc1
  v_mfma_f32_16x16x32_bf16 v[172:175], v[140:143], v[44:47], v[172:175]
  s_waitcnt lgkmcnt(10)
  ds_read_b64_tr_b16 v[136:137], v9 offset:20544
  ds_read_b64_tr_b16 v[138:139], v9 offset:21824
  v_mfma_f32_16x16x32_bf16 v[176:179], v[112:115], v[44:47], v[176:179]
  s_waitcnt lgkmcnt(10)
  ds_read_b64_tr_b16 v[140:141], v9 offset:20576
  ds_read_b64_tr_b16 v[142:143], v9 offset:21856
  v_mfma_f32_16x16x32_bf16 v[180:183], v[116:119], v[44:47], v[180:183]
  s_waitcnt lgkmcnt(10)
  ds_read_b64_tr_b16 v[112:113], v9 offset:20608
  ds_read_b64_tr_b16 v[114:115], v9 offset:21888
  v_mfma_f32_16x16x32_bf16 v[184:187], v[120:123], v[44:47], v[184:187]
  s_waitcnt lgkmcnt(10)
  ds_read_b64_tr_b16 v[116:117], v9 offset:25600
  ds_read_b64_tr_b16 v[118:119], v9 offset:26880
  v_mfma_f32_16x16x32_bf16 v[188:191], v[124:127], v[44:47], v[188:191]
  s_waitcnt vmcnt(17) lgkmcnt(10)
  ds_read_b64_tr_b16 v[120:121], v9 offset:25632
  ds_read_b64_tr_b16 v[122:123], v9 offset:26912
  global_load_dwordx4 a[200:203], v11, s[24:25] offset:2048 sc1
  v_mfma_f32_16x16x32_bf16 v[172:175], v[128:131], v[48:51], v[172:175]
  s_waitcnt lgkmcnt(10)
  ds_read_b64_tr_b16 v[124:125], v9 offset:25664
  ds_read_b64_tr_b16 v[126:127], v9 offset:26944
  v_mfma_f32_16x16x32_bf16 v[176:179], v[132:135], v[48:51], v[176:179]
  s_waitcnt lgkmcnt(10)
  ds_read_b64_tr_b16 v[128:129], v9 offset:25696
  ds_read_b64_tr_b16 v[130:131], v9 offset:26976
  v_mfma_f32_16x16x32_bf16 v[180:183], v[136:139], v[48:51], v[180:183]
  s_waitcnt lgkmcnt(10)
  ds_read_b64_tr_b16 v[132:133], v9 offset:25728
  ds_read_b64_tr_b16 v[134:135], v9 offset:27008
  v_mfma_f32_16x16x32_bf16 v[184:187], v[140:143], v[48:51], v[184:187]
  s_waitcnt lgkmcnt(10)
  ds_read_b64_tr_b16 v[136:137], v9 offset:30720
  ds_read_b64_tr_b16 v[138:139], v9 offset:32000
  v_mfma_f32_16x16x32_bf16 v[188:191], v[112:115], v[48:51], v[188:191]
  s_waitcnt vmcnt(17) lgkmcnt(10)
  ds_read_b64_tr_b16 v[140:141], v9 offset:30752
  ds_read_b64_tr_b16 v[142:143], v9 offset:32032
  v_mfma_f32_16x16x32_bf16 v[172:175], v[116:119], v[52:55], v[172:175]
  s_waitcnt lgkmcnt(10)
  ds_read_b64_tr_b16 v[112:113], v9 offset:30784
  ds_read_b64_tr_b16 v[114:115], v9 offset:32064
  v_mfma_f32_16x16x32_bf16 v[176:179], v[120:123], v[52:55], v[176:179]
  s_waitcnt lgkmcnt(10)
  ds_read_b64_tr_b16 v[116:117], v9 offset:30816
  ds_read_b64_tr_b16 v[118:119], v9 offset:32096
  v_mfma_f32_16x16x32_bf16 v[180:183], v[124:127], v[52:55], v[180:183]
  s_waitcnt lgkmcnt(10)
  ds_read_b64_tr_b16 v[120:121], v9 offset:30848
  ds_read_b64_tr_b16 v[122:123], v9 offset:32128
  v_mfma_f32_16x16x32_bf16 v[184:187], v[128:131], v[52:55], v[184:187]
  s_waitcnt lgkmcnt(10)
  ds_read_b64_tr_b16 v[124:125], v9 offset:35840
  ds_read_b64_tr_b16 v[126:127], v9 offset:37120
  v_mfma_f32_16x16x32_bf16 v[188:191], v[132:135], v[52:55], v[188:191]
  s_waitcnt vmcnt(16) lgkmcnt(10)
  ds_read_b64_tr_b16 v[128:129], v9 offset:35872
  ds_read_b64_tr_b16 v[130:131], v9 offset:37152
  global_load_dwordx4 a[204:207], v11, s[24:25] offset:3072 sc1
  v_mfma_f32_16x16x32_bf16 v[172:175], v[136:139], v[56:59], v[172:175]
  s_waitcnt lgkmcnt(10)
  ds_read_b64_tr_b16 v[132:133], v9 offset:35904
  ds_read_b64_tr_b16 v[134:135], v9 offset:37184
  v_mfma_f32_16x16x32_bf16 v[176:179], v[140:143], v[56:59], v[176:179]
  s_waitcnt lgkmcnt(10)
  ds_read_b64_tr_b16 v[136:137], v9 offset:35936
  ds_read_b64_tr_b16 v[138:139], v9 offset:37216
  v_mfma_f32_16x16x32_bf16 v[180:183], v[112:115], v[56:59], v[180:183]
  s_waitcnt lgkmcnt(10)
  ds_read_b64_tr_b16 v[140:141], v9 offset:35968
  ds_read_b64_tr_b16 v[142:143], v9 offset:37248
  v_mfma_f32_16x16x32_bf16 v[184:187], v[116:119], v[56:59], v[184:187]
  s_waitcnt lgkmcnt(10)
  ds_read_b64_tr_b16 v[112:113], v9 offset:40960
  ds_read_b64_tr_b16 v[114:115], v9 offset:42240
  v_mfma_f32_16x16x32_bf16 v[188:191], v[120:123], v[56:59], v[188:191]
  s_waitcnt vmcnt(16) lgkmcnt(10)
  ds_read_b64_tr_b16 v[116:117], v9 offset:40992
  ds_read_b64_tr_b16 v[118:119], v9 offset:42272
  s_add_u32 s83, s83, 4096
  s_add_u32 s24, s60, s83
  s_addc_u32 s25, s61, 0
  global_load_dwordx4 a[208:211], v11, s[24:25] offset:0 sc1
  v_mfma_f32_16x16x32_bf16 v[172:175], v[124:127], v[60:63], v[172:175]
  s_waitcnt lgkmcnt(10)
  ds_read_b64_tr_b16 v[120:121], v9 offset:41024
  ds_read_b64_tr_b16 v[122:123], v9 offset:42304
  v_mfma_f32_16x16x32_bf16 v[176:179], v[128:131], v[60:63], v[176:179]
  s_waitcnt lgkmcnt(10)
  ds_read_b64_tr_b16 v[124:125], v9 offset:41056
  ds_read_b64_tr_b16 v[126:127], v9 offset:42336
  v_mfma_f32_16x16x32_bf16 v[180:183], v[132:135], v[60:63], v[180:183]
  s_waitcnt lgkmcnt(10)
  ds_read_b64_tr_b16 v[128:129], v9 offset:41088
  ds_read_b64_tr_b16 v[130:131], v9 offset:42368
  v_mfma_f32_16x16x32_bf16 v[184:187], v[136:139], v[60:63], v[184:187]
  s_waitcnt lgkmcnt(10)
  ds_read_b64_tr_b16 v[132:133], v9 offset:46080
  ds_read_b64_tr_b16 v[134:135], v9 offset:47360
  v_mfma_f32_16x16x32_bf16 v[188:191], v[140:143], v[60:63], v[188:191]
  s_waitcnt vmcnt(16) lgkmcnt(10)
  ds_read_b64_tr_b16 v[136:137], v9 offset:46112
  ds_read_b64_tr_b16 v[138:139], v9 offset:47392
  v_mfma_f32_16x16x32_bf16 v[172:175], v[112:115], v[64:67], v[172:175]
  s_waitcnt lgkmcnt(10)
  ds_read_b64_tr_b16 v[140:141], v9 offset:46144
  ds_read_b64_tr_b16 v[142:143], v9 offset:47424
  v_mfma_f32_16x16x32_bf16 v[176:179], v[116:119], v[64:67], v[176:179]
  s_waitcnt lgkmcnt(10)
  ds_read_b64_tr_b16 v[112:113], v9 offset:46176
  ds_read_b64_tr_b16 v[114:115], v9 offset:47456
  v_mfma_f32_16x16x32_bf16 v[180:183], v[120:123], v[64:67], v[180:183]
  s_waitcnt lgkmcnt(10)
  ds_read_b64_tr_b16 v[116:117], v9 offset:46208
  ds_read_b64_tr_b16 v[118:119], v9 offset:47488
  v_mfma_f32_16x16x32_bf16 v[184:187], v[124:127], v[64:67], v[184:187]
  s_waitcnt lgkmcnt(10)
  ds_read_b64_tr_b16 v[120:121], v10 offset:0
  ds_read_b64_tr_b16 v[122:123], v10 offset:1280
  v_mfma_f32_16x16x32_bf16 v[188:191], v[128:131], v[64:67], v[188:191]
  s_waitcnt vmcnt(15) lgkmcnt(10)
  ds_read_b64_tr_b16 v[124:125], v10 offset:32
  ds_read_b64_tr_b16 v[126:127], v10 offset:1312
  global_load_dwordx4 a[212:215], v11, s[24:25] offset:1024 sc1
  v_mfma_f32_16x16x32_bf16 v[172:175], v[132:135], v[68:71], v[172:175]
  s_waitcnt lgkmcnt(10)
  ds_read_b64_tr_b16 v[128:129], v10 offset:64
  ds_read_b64_tr_b16 v[130:131], v10 offset:1344
  v_mfma_f32_16x16x32_bf16 v[176:179], v[136:139], v[68:71], v[176:179]
  s_waitcnt lgkmcnt(10)
  ds_read_b64_tr_b16 v[132:133], v10 offset:96
  ds_read_b64_tr_b16 v[134:135], v10 offset:1376
  v_mfma_f32_16x16x32_bf16 v[180:183], v[140:143], v[68:71], v[180:183]
  s_waitcnt lgkmcnt(10)
  ds_read_b64_tr_b16 v[136:137], v10 offset:128
  ds_read_b64_tr_b16 v[138:139], v10 offset:1408
  v_mfma_f32_16x16x32_bf16 v[184:187], v[112:115], v[68:71], v[184:187]
  s_waitcnt lgkmcnt(10)
  ds_read_b64_tr_b16 v[140:141], v10 offset:5120
  ds_read_b64_tr_b16 v[142:143], v10 offset:6400
  v_mfma_f32_16x16x32_bf16 v[188:191], v[116:119], v[68:71], v[188:191]
  s_waitcnt vmcnt(15) lgkmcnt(10)
  ds_read_b64_tr_b16 v[112:113], v10 offset:5152
  ds_read_b64_tr_b16 v[114:115], v10 offset:6432
  global_load_dwordx4 a[216:219], v11, s[24:25] offset:2048 sc1
  v_mfma_f32_16x16x32_bf16 v[172:175], v[120:123], v[72:75], v[172:175]
  s_waitcnt lgkmcnt(10)
  ds_read_b64_tr_b16 v[116:117], v10 offset:5184
  ds_read_b64_tr_b16 v[118:119], v10 offset:6464
  v_mfma_f32_16x16x32_bf16 v[176:179], v[124:127], v[72:75], v[176:179]
  s_waitcnt lgkmcnt(10)
  ds_read_b64_tr_b16 v[120:121], v10 offset:5216
  ds_read_b64_tr_b16 v[122:123], v10 offset:6496
  v_mfma_f32_16x16x32_bf16 v[180:183], v[128:131], v[72:75], v[180:183]
  s_waitcnt lgkmcnt(10)
  ds_read_b64_tr_b16 v[124:125], v10 offset:5248
  ds_read_b64_tr_b16 v[126:127], v10 offset:6528
  v_mfma_f32_16x16x32_bf16 v[184:187], v[132:135], v[72:75], v[184:187]
  s_waitcnt lgkmcnt(10)
  ds_read_b64_tr_b16 v[128:129], v10 offset:10240
  ds_read_b64_tr_b16 v[130:131], v10 offset:11520
  v_mfma_f32_16x16x32_bf16 v[188:191], v[136:139], v[72:75], v[188:191]
  s_waitcnt vmcnt(15) lgkmcnt(10)
  ds_read_b64_tr_b16 v[132:133], v10 offset:10272
  ds_read_b64_tr_b16 v[134:135], v10 offset:11552
  global_load_dwordx4 a[220:223], v11, s[24:25] offset:3072 sc1
  v_mfma_f32_16x16x32_bf16 v[172:175], v[140:143], v[76:79], v[172:175]
  s_waitcnt lgkmcnt(10)
  ds_read_b64_tr_b16 v[136:137], v10 offset:10304
  ds_read_b64_tr_b16 v[138:139], v10 offset:11584
  v_mfma_f32_16x16x32_bf16 v[176:179], v[112:115], v[76:79], v[176:179]
  s_waitcnt lgkmcnt(10)
  ds_read_b64_tr_b16 v[140:141], v10 offset:10336
  ds_read_b64_tr_b16 v[142:143], v10 offset:11616
  v_mfma_f32_16x16x32_bf16 v[180:183], v[116:119], v[76:79], v[180:183]
  s_waitcnt lgkmcnt(10)
  ds_read_b64_tr_b16 v[112:113], v10 offset:10368
  ds_read_b64_tr_b16 v[114:115], v10 offset:11648
  v_mfma_f32_16x16x32_bf16 v[184:187], v[120:123], v[76:79], v[184:187]
  s_waitcnt lgkmcnt(10)
  ds_read_b64_tr_b16 v[116:117], v10 offset:15360
  ds_read_b64_tr_b16 v[118:119], v10 offset:16640
  v_mfma_f32_16x16x32_bf16 v[188:191], v[124:127], v[76:79], v[188:191]
  s_waitcnt vmcnt(15) lgkmcnt(10)
  ds_read_b64_tr_b16 v[120:121], v10 offset:15392
  ds_read_b64_tr_b16 v[122:123], v10 offset:16672
  v_mfma_f32_16x16x32_bf16 v[172:175], v[128:131], v[80:83], v[172:175]
  s_waitcnt lgkmcnt(10)
  ds_read_b64_tr_b16 v[124:125], v10 offset:15424
  ds_read_b64_tr_b16 v[126:127], v10 offset:16704
  v_mfma_f32_16x16x32_bf16 v[176:179], v[132:135], v[80:83], v[176:179]
  s_waitcnt lgkmcnt(10)
  ds_read_b64_tr_b16 v[128:129], v10 offset:15456
  ds_read_b64_tr_b16 v[130:131], v10 offset:16736
  v_mfma_f32_16x16x32_bf16 v[180:183], v[136:139], v[80:83], v[180:183]
  s_waitcnt lgkmcnt(10)
  ds_read_b64_tr_b16 v[132:133], v10 offset:15488
  ds_read_b64_tr_b16 v[134:135], v10 offset:16768
  v_mfma_f32_16x16x32_bf16 v[184:187], v[140:143], v[80:83], v[184:187]
  s_waitcnt lgkmcnt(10)
  ds_read_b64_tr_b16 v[136:137], v10 offset:20480
  ds_read_b64_tr_b16 v[138:139], v10 offset:21760
  v_mfma_f32_16x16x32_bf16 v[188:191], v[112:115], v[80:83], v[188:191]
  s_waitcnt vmcnt(14) lgkmcnt(10)
  ds_read_b64_tr_b16 v[140:141], v10 offset:20512
  ds_read_b64_tr_b16 v[142:143], v10 offset:21792
  s_add_u32 s83, s83, 4096
  s_add_u32 s24, s60, s83
  s_addc_u32 s25, s61, 0
  global_load_dwordx4 a[224:227], v11, s[24:25] offset:0 sc1
  v_mfma_f32_16x16x32_bf16 v[172:175], v[116:119], v[84:87], v[172:175]
  s_waitcnt lgkmcnt(10)
  ds_read_b64_tr_b16 v[112:113], v10 offset:20544
  ds_read_b64_tr_b16 v[114:115], v10 offset:21824
  v_mfma_f32_16x16x32_bf16 v[176:179], v[120:123], v[84:87], v[176:179]
  s_waitcnt lgkmcnt(10)
  ds_read_b64_tr_b16 v[116:117], v10 offset:20576
  ds_read_b64_tr_b16 v[118:119], v10 offset:21856
  v_mfma_f32_16x16x32_bf16 v[180:183], v[124:127], v[84:87], v[180:183]
  s_waitcnt lgkmcnt(10)
  ds_read_b64_tr_b16 v[120:121], v10 offset:20608
  ds_read_b64_tr_b16 v[122:123], v10 offset:21888
  v_mfma_f32_16x16x32_bf16 v[184:187], v[128:131], v[84:87], v[184:187]
  s_waitcnt lgkmcnt(10)
  ds_read_b64_tr_b16 v[124:125], v10 offset:25600
  ds_read_b64_tr_b16 v[126:127], v10 offset:26880
  v_mfma_f32_16x16x32_bf16 v[188:191], v[132:135], v[84:87], v[188:191]
  s_waitcnt vmcnt(14) lgkmcnt(10)
  ds_read_b64_tr_b16 v[128:129], v10 offset:25632
  ds_read_b64_tr_b16 v[130:131], v10 offset:26912
  global_load_dwordx4 a[228:231], v11, s[24:25] offset:1024 sc1
  v_mfma_f32_16x16x32_bf16 v[172:175], v[136:139], v[88:91], v[172:175]
  s_waitcnt lgkmcnt(10)
  ds_read_b64_tr_b16 v[132:133], v10 offset:25664
  ds_read_b64_tr_b16 v[134:135], v10 offset:26944
  v_mfma_f32_16x16x32_bf16 v[176:179], v[140:143], v[88:91], v[176:179]
  s_waitcnt lgkmcnt(10)
  ds_read_b64_tr_b16 v[136:137], v10 offset:25696
  ds_read_b64_tr_b16 v[138:139], v10 offset:26976
  v_mfma_f32_16x16x32_bf16 v[180:183], v[112:115], v[88:91], v[180:183]
  s_waitcnt lgkmcnt(10)
  ds_read_b64_tr_b16 v[140:141], v10 offset:25728
  ds_read_b64_tr_b16 v[142:143], v10 offset:27008
  v_mfma_f32_16x16x32_bf16 v[184:187], v[116:119], v[88:91], v[184:187]
  s_waitcnt lgkmcnt(10)
  ds_read_b64_tr_b16 v[112:113], v10 offset:30720
  ds_read_b64_tr_b16 v[114:115], v10 offset:32000
  v_mfma_f32_16x16x32_bf16 v[188:191], v[120:123], v[88:91], v[188:191]
  s_waitcnt vmcnt(14) lgkmcnt(10)
  ds_read_b64_tr_b16 v[116:117], v10 offset:30752
  ds_read_b64_tr_b16 v[118:119], v10 offset:32032
  v_mfma_f32_16x16x32_bf16 v[172:175], v[124:127], v[92:95], v[172:175]
  s_waitcnt lgkmcnt(10)
  ds_read_b64_tr_b16 v[120:121], v10 offset:30784
  ds_read_b64_tr_b16 v[122:123], v10 offset:32064
  v_mfma_f32_16x16x32_bf16 v[176:179], v[128:131], v[92:95], v[176:179]
  s_waitcnt lgkmcnt(10)
  ds_read_b64_tr_b16 v[124:125], v10 offset:30816
  ds_read_b64_tr_b16 v[126:127], v10 offset:32096
  v_mfma_f32_16x16x32_bf16 v[180:183], v[132:135], v[92:95], v[180:183]
  s_waitcnt lgkmcnt(10)
  ds_read_b64_tr_b16 v[128:129], v10 offset:30848
  ds_read_b64_tr_b16 v[130:131], v10 offset:32128
  v_mfma_f32_16x16x32_bf16 v[184:187], v[136:139], v[92:95], v[184:187]
  s_waitcnt lgkmcnt(10)
  ds_read_b64_tr_b16 v[132:133], v10 offset:35840
  ds_read_b64_tr_b16 v[134:135], v10 offset:37120
  v_mfma_f32_16x16x32_bf16 v[188:191], v[140:143], v[92:95], v[188:191]
  s_waitcnt vmcnt(13) lgkmcnt(10)
  ds_read_b64_tr_b16 v[136:137], v10 offset:35872
  ds_read_b64_tr_b16 v[138:139], v10 offset:37152
  global_load_dwordx4 a[232:235], v11, s[24:25] offset:2048 sc1
  v_mfma_f32_16x16x32_bf16 v[172:175], v[112:115], v[96:99], v[172:175]
  s_waitcnt lgkmcnt(10)
  ds_read_b64_tr_b16 v[140:141], v10 offset:35904
  ds_read_b64_tr_b16 v[142:143], v10 offset:37184
  v_mfma_f32_16x16x32_bf16 v[176:179], v[116:119], v[96:99], v[176:179]
  s_waitcnt lgkmcnt(10)
  ds_read_b64_tr_b16 v[112:113], v10 offset:35936
  ds_read_b64_tr_b16 v[114:115], v10 offset:37216
  v_mfma_f32_16x16x32_bf16 v[180:183], v[120:123], v[96:99], v[180:183]
  s_waitcnt lgkmcnt(10)
  ds_read_b64_tr_b16 v[116:117], v10 offset:35968
  ds_read_b64_tr_b16 v[118:119], v10 offset:37248
  v_mfma_f32_16x16x32_bf16 v[184:187], v[124:127], v[96:99], v[184:187]
  s_waitcnt lgkmcnt(10)
  ds_read_b64_tr_b16 v[120:121], v10 offset:40960
  ds_read_b64_tr_b16 v[122:123], v10 offset:42240
  v_mfma_f32_16x16x32_bf16 v[188:191], v[128:131], v[96:99], v[188:191]
  s_waitcnt vmcnt(13) lgkmcnt(10)
  ds_read_b64_tr_b16 v[124:125], v10 offset:40992
  ds_read_b64_tr_b16 v[126:127], v10 offset:42272
  global_load_dwordx4 a[236:239], v11, s[24:25] offset:3072 sc1
  v_mfma_f32_16x16x32_bf16 v[172:175], v[132:135], v[100:103], v[172:175]
  s_waitcnt lgkmcnt(10)
  ds_read_b64_tr_b16 v[128:129], v10 offset:41024
  ds_read_b64_tr_b16 v[130:131], v10 offset:42304
  v_mfma_f32_16x16x32_bf16 v[176:179], v[136:139], v[100:103], v[176:179]
  s_waitcnt lgkmcnt(10)
  ds_read_b64_tr_b16 v[132:133], v10 offset:41056
  ds_read_b64_tr_b16 v[134:135], v10 offset:42336
  v_mfma_f32_16x16x32_bf16 v[180:183], v[140:143], v[100:103], v[180:183]
  s_waitcnt lgkmcnt(10)
  ds_read_b64_tr_b16 v[136:137], v10 offset:41088
  ds_read_b64_tr_b16 v[138:139], v10 offset:42368
  v_mfma_f32_16x16x32_bf16 v[184:187], v[112:115], v[100:103], v[184:187]
  s_waitcnt lgkmcnt(10)
  ds_read_b64_tr_b16 v[140:141], v10 offset:46080
  ds_read_b64_tr_b16 v[142:143], v10 offset:47360
  v_mfma_f32_16x16x32_bf16 v[188:191], v[116:119], v[100:103], v[188:191]
  s_waitcnt vmcnt(13) lgkmcnt(10)
  ds_read_b64_tr_b16 v[112:113], v10 offset:46112
  ds_read_b64_tr_b16 v[114:115], v10 offset:47392
  v_mfma_f32_16x16x32_bf16 v[172:175], v[120:123], v[104:107], v[172:175]
  s_waitcnt lgkmcnt(10)
  ds_read_b64_tr_b16 v[116:117], v10 offset:46144
  ds_read_b64_tr_b16 v[118:119], v10 offset:47424
  v_mfma_f32_16x16x32_bf16 v[176:179], v[124:127], v[104:107], v[176:179]
  s_waitcnt lgkmcnt(10)
  ds_read_b64_tr_b16 v[120:121], v10 offset:46176
  ds_read_b64_tr_b16 v[122:123], v10 offset:47456
  v_mfma_f32_16x16x32_bf16 v[180:183], v[128:131], v[104:107], v[180:183]
  s_waitcnt lgkmcnt(10)
  ds_read_b64_tr_b16 v[124:125], v10 offset:46208
  ds_read_b64_tr_b16 v[126:127], v10 offset:47488
  v_mfma_f32_16x16x32_bf16 v[184:187], v[132:135], v[104:107], v[184:187]
  s_waitcnt lgkmcnt(10)
  v_mfma_f32_16x16x32_bf16 v[188:191], v[136:139], v[104:107], v[188:191]
  s_add_u32 s83, s83, 4096
  s_waitcnt vmcnt(12) lgkmcnt(8)
  v_mfma_f32_16x16x32_bf16 v[172:175], v[140:143], v[108:111], v[172:175]
  s_waitcnt lgkmcnt(6)
  v_mfma_f32_16x16x32_bf16 v[176:179], v[112:115], v[108:111], v[176:179]
  s_waitcnt lgkmcnt(4)
  v_mfma_f32_16x16x32_bf16 v[180:183], v[116:119], v[108:111], v[180:183]
  s_waitcnt lgkmcnt(2)
  v_mfma_f32_16x16x32_bf16 v[184:187], v[120:123], v[108:111], v[184:187]
  s_waitcnt lgkmcnt(0)
  v_mfma_f32_16x16x32_bf16 v[188:191], v[124:127], v[108:111], v[188:191]
  v_cvt_pk_bf16_f32 v204, v172, v173
  v_cvt_pk_bf16_f32 v205, v174, v175
  v_cvt_pk_bf16_f32 v206, v176, v177
  v_cvt_pk_bf16_f32 v207, v178, v179
  v_cvt_pk_bf16_f32 v208, v180, v181
  v_cvt_pk_bf16_f32 v209, v182, v183
  v_cvt_pk_bf16_f32 v210, v184, v185
  v_cvt_pk_bf16_f32 v211, v186, v187
  v_cvt_pk_bf16_f32 v212, v188, v189
  v_cvt_pk_bf16_f32 v213, v190, v191
  v_permlane16_swap_b32 v204, v206
  v_permlane16_swap_b32 v205, v207
  v_permlane16_swap_b32 v208, v210
  v_permlane16_swap_b32 v209, v211
  v_permlane16_swap_b32 v212, v214
  v_permlane16_swap_b32 v213, v215
  buffer_store_dwordx4 v[204:207], v252, s[60:63], 0 offen sc1
  buffer_store_dwordx4 v[208:211], v252, s[60:63], 0 offen offset:1024 sc1
  buffer_store_dwordx4 v[212:215], v246, s[60:63], 0 offen offset:2048 sc1
  v_dot2_f32_bf16 v216, v204, s76, v216
  v_dot2_f32_bf16 v217, v204, v204, v217
  v_dot2_f32_bf16 v216, v205, s76, v216
  v_dot2_f32_bf16 v217, v205, v205, v217
  v_dot2_f32_bf16 v216, v206, s76, v216
  v_dot2_f32_bf16 v217, v206, v206, v217
  v_dot2_f32_bf16 v216, v207, s76, v216
  v_dot2_f32_bf16 v217, v207, v207, v217
  v_dot2_f32_bf16 v216, v208, s76, v216
  v_dot2_f32_bf16 v217, v208, v208, v217
  v_dot2_f32_bf16 v216, v209, s76, v216
  v_dot2_f32_bf16 v217, v209, v209, v217
  v_dot2_f32_bf16 v216, v210, s76, v216
  v_dot2_f32_bf16 v217, v210, v210, v217
  v_dot2_f32_bf16 v216, v211, s76, v216
  v_dot2_f32_bf16 v217, v211, v211, v217
  v_dot2_f32_bf16 v216, v212, s76, v216
  v_dot2_f32_bf16 v217, v212, v212, v217
  v_dot2_f32_bf16 v216, v213, s76, v216
  v_dot2_f32_bf16 v217, v213, v213, v217
  v_dot2_f32_bf16 v216, v214, s76, v216
  v_dot2_f32_bf16 v217, v214, v214, v217
  v_dot2_f32_bf16 v216, v215, s76, v216
  v_dot2_f32_bf16 v217, v215, v215, v217
  s_nop 1
  v_mov_b32 v20, v216
  v_mov_b32 v21, v217
  s_nop 0
  v_permlane32_swap_b32 v20, v216
  v_permlane32_swap_b32 v21, v217
  v_add_f32 v216, v216, v20
  v_add_f32 v217, v217, v21
  v_mov_b32 v20, v216
  v_mov_b32 v21, v217
  s_nop 0
  v_permlane16_swap_b32 v20, v216
  v_permlane16_swap_b32 v21, v217
  v_add_f32 v216, v216, v20
  v_add_f32 v217, v217, v21
  buffer_store_dwordx2 v[216:217], v247, s[60:63], 0 offen sc1
  v_accvgpr_read_b32 v128, a252
  v_accvgpr_read_b32 v129, a253
  v_mfma_f32_16x16x32_bf16 a[240:243], a[0:3], v[232:235], 0
  v_mfma_f32_16x16x32_bf16 a[244:247], a[4:7], v[232:235], 0
  v_mfma_f32_16x16x32_bf16 a[248:251], a[8:11], v[232:235], 0
  v_mfma_f32_16x16x32_bf16 a[240:243], a[12:15], v[232:235], a[240:243]
  v_mfma_f32_16x16x32_bf16 a[244:247], a[16:19], v[232:235], a[244:247]
  v_mfma_f32_16x16x32_bf16 a[248:251], a[20:23], v[232:235], a[248:251]
  v_mfma_f32_16x16x32_bf16 a[240:243], a[24:27], v[232:235], a[240:243]
  v_mfma_f32_16x16x32_bf16 a[244:247], a[28:31], v[232:235], a[244:247]
  v_mfma_f32_16x16x32_bf16 a[248:251], a[32:35], v[232:235], a[248:251]
  v_mfma_f32_16x16x32_bf16 a[240:243], a[36:39], v[232:235], a[240:243]
  v_mfma_f32_16x16x32_bf16 a[244:247], a[40:43], v[232:235], a[244:247]
  v_mfma_f32_16x16x32_bf16 a[248:251], a[44:47], v[232:235], a[248:251]
  v_mfma_f32_16x16x32_bf16 a[240:243], a[48:51], v[232:235], a[240:243]
  v_mfma_f32_16x16x32_bf16 a[244:247], a[52:55], v[232:235], a[244:247]
  v_mfma_f32_16x16x32_bf16 a[248:251], a[56:59], v[232:235], a[248:251]
  v_mfma_f32_16x16x32_bf16 a[240:243], a[60:63], v[232:235], a[240:243]
  v_mfma_f32_16x16x32_bf16 a[244:247], a[64:67], v[232:235], a[244:247]
  v_mfma_f32_16x16x32_bf16 a[248:251], a[68:71], v[232:235], a[248:251]
  v_mfma_f32_16x16x32_bf16 a[240:243], a[72:75], v[232:235], a[240:243]
  v_mfma_f32_16x16x32_bf16 a[244:247], a[76:79], v[232:235], a[244:247]
  v_mfma_f32_16x16x32_bf16 a[248:251], a[80:83], v[232:235], a[248:251]
  v_mfma_f32_16x16x32_bf16 a[240:243], a[84:87], v[232:235], a[240:243]
  v_mfma_f32_16x16x32_bf16 a[244:247], a[88:91], v[232:235], a[244:247]
  v_mfma_f32_16x16x32_bf16 a[248:251], a[92:95], v[232:235], a[248:251]
  v_mfma_f32_16x16x32_bf16 a[240:243], a[96:99], v[232:235], a[240:243]
  v_mfma_f32_16x16x32_bf16 a[244:247], a[100:103], v[232:235], a[244:247]
  v_mfma_f32_16x16x32_bf16 a[248:251], a[104:107], v[232:235], a[248:251]
  v_mfma_f32_16x16x32_bf16 a[240:243], a[108:111], v[232:235], a[240:243]
  v_mfma_f32_16x16x32_bf16 a[244:247], a[112:115], v[232:235], a[244:247]
  v_mfma_f32_16x16x32_bf16 a[248:251], a[116:119], v[232:235], a[248:251]
  v_mfma_f32_16x16x32_bf16 a[240:243], a[120:123], v[232:235], a[240:243]
  v_mfma_f32_16x16x32_bf16 a[244:247], a[124:127], v[232:235], a[244:247]
  v_mfma_f32_16x16x32_bf16 a[248:251], a[128:131], v[232:235], a[248:251]
  v_mfma_f32_16x16x32_bf16 a[240:243], a[132:135], v[232:235], a[240:243]
  v_mfma_f32_16x16x32_bf16 a[244:247], a[136:139], v[232:235], a[244:247]
  v_mfma_f32_16x16x32_bf16 a[248:251], a[140:143], v[232:235], a[248:251]
  s_waitcnt vmcnt(0)
  buffer_store_dword v19, v28, s[60:63], 0 offen offset:0 sc1
  s_mov_b32 s93, 0x40000
L_pollhG:
  buffer_load_dword v20, v30, s[60:63], 0 offen offset:0 sc1
  buffer_load_dword v21, v29, s[60:63], 0 offen offset:0 sc1
  s_waitcnt vmcnt(0)
  v_cmp_ne_u32 vcc, v20, v19
  v_cmp_ne_u32 s[94:95], v21, v19
  s_nop 3
  s_or_b64 vcc, vcc, s[94:95]
  s_cmp_eq_u64 vcc, 0
  s_cbranch_scc1 L_pollhG_ok
  s_sub_u32 s93, s93, 1
  s_cbranch_scc0 L_pollhG
L_pollhG_ok:
  buffer_load_dwordx4 v[200:203], v11, s[60:63], s10 offen offset:0 sc1
  buffer_load_dwordx4 v[204:207], v11, s[60:63], s10 offen offset:1024 sc1
  s_add_u32 m0, s88, 0
  s_nop 0
  buffer_load_dwordx4 v11, s[60:63], s87 offen offset:0 sc1 lds
  buffer_load_dwordx4 v11, s[60:63], s87 offen offset:1024 sc1 lds
  buffer_load_dwordx4 v11, s[60:63], s87 offen offset:2048 sc1 lds
  buffer_load_dwordx4 v11, s[60:63], s87 offen offset:3072 sc1 lds
  s_add_u32 s87, s87, 4096
  s_add_u32 m0, s88, 4096
  s_nop 0
  buffer_load_dwordx4 v11, s[60:63], s87 offen offset:0 sc1 lds
  s_add_u32 s87, s87, 16384
  s_add_u32 m0, s88, 20480
  s_nop 0
  buffer_load_dwordx4 v11, s[60:63], s87 offen offset:0 sc1 lds
  buffer_load_dwordx4 v11, s[60:63], s87 offen offset:1024 sc1 lds
  buffer_load_dwordx4 v11, s[60:63], s87 offen offset:2048 sc1 lds
  buffer_load_dwordx4 v11, s[60:63], s87 offen offset:3072 sc1 lds
  s_add_u32 s87, s87, 4096
  s_add_u32 m0, s88, 24576
  s_nop 0
  buffer_load_dwordx4 v11, s[60:63], s87 offen offset:0 sc1 lds
  s_add_u32 s87, s87, 16384
  v_mfma_f32_16x16x32_bf16 a[240:243], a[144:147], v[232:235], a[240:243]
  v_mfma_f32_16x16x32_bf16 a[244:247], a[148:151], v[232:235], a[244:247]
  v_mfma_f32_16x16x32_bf16 a[248:251], a[152:155], v[232:235], a[248:251]
  v_mfma_f32_16x16x32_bf16 a[240:243], a[156:159], v[232:235], a[240:243]
  v_mfma_f32_16x16x32_bf16 a[244:247], a[160:163], v[232:235], a[244:247]
  v_mfma_f32_16x16x32_bf16 a[248:251], a[164:167], v[232:235], a[248:251]
  v_mfma_f32_16x16x32_bf16 a[240:243], a[168:171], v[232:235], a[240:243]
  v_mfma_f32_16x16x32_bf16 a[244:247], a[172:175], v[232:235], a[244:247]
  v_mfma_f32_16x16x32_bf16 a[248:251], a[176:179], v[232:235], a[248:251]
  v_mfma_f32_16x16x32_bf16 a[240:243], a[180:183], v[232:235], a[240:243]
  v_mfma_f32_16x16x32_bf16 a[244:247], a[184:187], v[232:235], a[244:247]
  v_mfma_f32_16x16x32_bf16 a[248:251], a[188:191], v[232:235], a[248:251]
  v_mfma_f32_16x16x32_bf16 a[240:243], a[192:195], v[232:235], a[240:243]
  v_mfma_f32_16x16x32_bf16 a[244:247], a[196:199], v[232:235], a[244:247]
  v_mfma_f32_16x16x32_bf16 a[248:251], a[200:203], v[232:235], a[248:251]
  v_mfma_f32_16x16x32_bf16 a[240:243], a[204:207], v[232:235], a[240:243]
  v_mfma_f32_16x16x32_bf16 a[244:247], a[208:211], v[232:235], a[244:247]
  v_mfma_f32_16x16x32_bf16 a[248:251], a[212:215], v[232:235], a[248:251]
  v_mfma_f32_16x16x32_bf16 a[240:243], a[216:219], v[232:235], a[240:243]
  v_mfma_f32_16x16x32_bf16 a[244:247], a[220:223], v[232:235], a[244:247]
  v_mfma_f32_16x16x32_bf16 a[248:251], a[224:227], v[232:235], a[248:251]
  v_mfma_f32_16x16x32_bf16 a[240:243], a[228:231], v[232:235], a[240:243]
  v_mfma_f32_16x16x32_bf16 a[244:247], a[232:235], v[232:235], a[244:247]
  v_mfma_f32_16x16x32_bf16 a[248:251], a[236:239], v[232:235], a[248:251]
  s_mov_b32 s94, 0xaaaaaaaa
  s_mov_b32 s95, 0xaaaaaaaa
  s_waitcnt vmcnt(11)
  v_add_f32 v200, v200, v202
  v_add_f32 v201, v201, v203
  s_waitcnt vmcnt(10)
  v_add_f32 v204, v204, v206
  v_add_f32 v205, v205, v207
  v_add_f32_dpp v200, v200, v200 quad_perm:[1,0,3,2] row_mask:0xf bank_mask:0xf
  v_add_f32_dpp v201, v201, v201 quad_perm:[1,0,3,2] row_mask:0xf bank_mask:0xf
  v_add_f32_dpp v204, v204, v204 quad_perm:[1,0,3,2] row_mask:0xf bank_mask:0xf
  v_add_f32_dpp v205, v205, v205 quad_perm:[1,0,3,2] row_mask:0xf bank_mask:0xf
  v_add_f32_dpp v200, v200, v200 quad_perm:[2,3,0,1] row_mask:0xf bank_mask:0xf
  v_add_f32_dpp v201, v201, v201 quad_perm:[2,3,0,1] row_mask:0xf bank_mask:0xf
  v_add_f32_dpp v204, v204, v204 quad_perm:[2,3,0,1] row_mask:0xf bank_mask:0xf
  v_add_f32_dpp v205, v205, v205 quad_perm:[2,3,0,1] row_mask:0xf bank_mask:0xf
  v_cndmask_b32 v200, v200, v204, s[94:95]
  v_cndmask_b32 v201, v201, v205, s[94:95]
  v_mul_f32 v205, 0x3acccccd, v200
  v_mul_f32 v202, v205, v205
  v_mov_b32 v204, 0x3acccccd
  v_fma_f32 v202, v201, v204, -v202
  v_max_f32 v202, 0, v202
  v_add_f32 v202, 0x3727c5ac, v202
  v_rsq_f32 v204, v202
  ds_write_b64 v25, v[204:205] offset:36864
  v_accvgpr_read_b32 v72, a240
  v_accvgpr_read_b32 v73, a241
  v_accvgpr_read_b32 v74, a242
  v_accvgpr_read_b32 v75, a243
  v_accvgpr_read_b32 v76, a244
  v_accvgpr_read_b32 v77, a245
  v_accvgpr_read_b32 v78, a246
  v_accvgpr_read_b32 v79, a247
  v_accvgpr_read_b32 v80, a248
  v_accvgpr_read_b32 v81, a249
  v_accvgpr_read_b32 v82, a250
  v_accvgpr_read_b32 v83, a251
  s_lshl_b32 s4, s69, 12
  s_lshl_b32 s5, s68, 8
  s_add_u32 s4, s4, s5
  s_add_u32 s4, s4, 18939904
  v_lshl_add_u32 v28, v2, 4, s4
  v_lshrrev_b32 v20, 5, v1
  v_lshl_add_u32 v27, v20, 10, v28
  s_mul_i32 s12, s68, 15360
  s_add_u32 s12, s12, 102400
  s_mul_i32 s13, s68, 10240
  s_add_u32 s13, s13, 61440
  s_add_u32 s14, s89, 30720
  v_add_u32 v4, s12, v11
  v_add_u32 v5, s13, v11
  v_add_u32 v6, s88, v11
  s_waitcnt vmcnt(5)
  s_waitcnt lgkmcnt(0)
  s_barrier
  ds_read_b128 v[56:59], v11 offset:0
  ds_read_b128 v[60:63], v11 offset:1024
  ds_read_b128 v[64:67], v11 offset:2048
  s_waitcnt lgkmcnt(2)
  v_mfma_f32_16x16x32_bf16 v[32:35], a[0:3], v[56:59], 0
  s_add_u32 m0, s88, 40960
  ds_read_b128 v[68:71], v11 offset:3072
  v_mfma_f32_16x16x32_bf16 v[36:39], a[4:7], v[56:59], 0
  buffer_load_dwordx4 v11, s[60:63], s87 offen offset:0 sc1 lds
  v_mfma_f32_16x16x32_bf16 v[40:43], a[8:11], v[56:59], 0
  s_waitcnt lgkmcnt(2)
  ds_read_b128 v[84:87], v31 offset:36864
  ds_read_b128 v[88:91], v31 offset:36880
  v_mfma_f32_16x16x32_bf16 v[32:35], a[12:15], v[60:63], v[32:35]
  ds_read_b128 v[56:59], v11 offset:4096
  ds_read_b128 v[92:95], v31 offset:36896
  v_mfma_f32_16x16x32_bf16 v[36:39], a[16:19], v[60:63], v[36:39]
  ds_read_b128 v[96:99], v31 offset:36912
  v_mfma_f32_16x16x32_bf16 v[40:43], a[20:23], v[60:63], v[40:43]
  s_waitcnt lgkmcnt(6)
  buffer_load_dwordx4 v11, s[60:63], s87 offen offset:1024 sc1 lds
  v_mfma_f32_16x16x32_bf16 v[32:35], a[24:27], v[64:67], v[32:35]
  ds_read_b128 v[60:63], v11 offset:5120
  v_mfma_f32_16x16x32_bf16 v[36:39], a[28:31], v[64:67], v[36:39]
  v_mfma_f32_16x16x32_bf16 v[40:43], a[32:35], v[64:67], v[40:43]
  s_waitcnt lgkmcnt(6)
  v_mfma_f32_16x16x32_bf16 v[32:35], a[36:39], v[68:71], v[32:35]
  ds_read_b128 v[64:67], v11 offset:6144
  v_mfma_f32_16x16x32_bf16 v[36:39], a[40:43], v[68:71], v[36:39]
  buffer_load_dwordx4 v11, s[60:63], s87 offen offset:2048 sc1 lds
  v_mfma_f32_16x16x32_bf16 v[40:43], a[44:47], v[68:71], v[40:43]
  s_waitcnt lgkmcnt(4)
  v_mfma_f32_16x16x32_bf16 v[32:35], a[48:51], v[56:59], v[32:35]
  ds_read_b128 v[68:71], v11 offset:7168
  v_mfma_f32_16x16x32_bf16 v[36:39], a[52:55], v[56:59], v[36:39]
  v_mfma_f32_16x16x32_bf16 v[40:43], a[56:59], v[56:59], v[40:43]
  s_waitcnt lgkmcnt(2)
  buffer_load_dwordx4 v11, s[60:63], s87 offen offset:3072 sc1 lds
  v_mfma_f32_16x16x32_bf16 v[32:35], a[60:63], v[60:63], v[32:35]
  s_add_u32 s87, s87, 4096
  ds_read_b128 v[56:59], v11 offset:8192
  v_mfma_f32_16x16x32_bf16 v[36:39], a[64:67], v[60:63], v[36:39]
  s_add_u32 m0, s88, 45056
  v_mfma_f32_16x16x32_bf16 v[40:43], a[68:71], v[60:63], v[40:43]
  s_waitcnt lgkmcnt(2)
  v_mfma_f32_16x16x32_bf16 v[32:35], a[72:75], v[64:67], v[32:35]
  ds_read_b128 v[60:63], v11 offset:9216
  v_mfma_f32_16x16x32_bf16 v[36:39], a[76:79], v[64:67], v[36:39]
  buffer_load_dwordx4 v11, s[60:63], s87 offen offset:0 sc1 lds
  v_mfma_f32_16x16x32_bf16 v[40:43], a[80:83], v[64:67], v[40:43]
  s_waitcnt lgkmcnt(2)
  v_mfma_f32_16x16x32_bf16 v[32:35], a[84:87], v[68:71], v[32:35]
  s_add_u32 s87, s87, 16384
  ds_read_b128 v[64:67], v11 offset:10240
  v_mfma_f32_16x16x32_bf16 v[36:39], a[88:91], v[68:71], v[36:39]
  s_add_u32 m0, s88, 61440
  v_mfma_f32_16x16x32_bf16 v[40:43], a[92:95], v[68:71], v[40:43]
  s_waitcnt lgkmcnt(2)
  buffer_load_dwordx4 v11, s[60:63], s87 offen offset:0 sc1 lds
  v_mfma_f32_16x16x32_bf16 v[32:35], a[96:99], v[56:59], v[32:35]
  s_add_u32 s24, s60, s89
  s_addc_u32 s25, s61, 0
  ds_read_b128 v[68:71], v11 offset:11264
  v_mfma_f32_16x16x32_bf16 v[36:39], a[100:103], v[56:59], v[36:39]
  v_mfma_f32_16x16x32_bf16 v[40:43], a[104:107], v[56:59], v[40:43]
  s_waitcnt lgkmcnt(2)
  v_mfma_f32_16x16x32_bf16 v[32:35], a[108:111], v[60:63], v[32:35]
  ds_read_b128 v[56:59], v11 offset:12288
  v_mfma_f32_16x16x32_bf16 v[36:39], a[112:115], v[60:63], v[36:39]
  buffer_load_dwordx4 v11, s[60:63], s87 offen offset:1024 sc1 lds
  v_mfma_f32_16x16x32_bf16 v[40:43], a[116:119], v[60:63], v[40:43]
  s_waitcnt lgkmcnt(2)
  v_mfma_f32_16x16x32_bf16 v[32:35], a[120:123], v[64:67], v[32:35]
  ds_read_b128 v[60:63], v11 offset:13312
  v_mfma_f32_16x16x32_bf16 v[36:39], a[124:127], v[64:67], v[36:39]
  v_mfma_f32_16x16x32_bf16 v[40:43], a[128:131], v[64:67], v[40:43]
  s_waitcnt lgkmcnt(2)
  buffer_load_dwordx4 v11, s[60:63], s87 offen offset:2048 sc1 lds
  v_mfma_f32_16x16x32_bf16 v[32:35], a[132:135], v[68:71], v[32:35]
  ds_read_b128 v[64:67], v11 offset:14336
  v_mfma_f32_16x16x32_bf16 v[36:39], a[136:139], v[68:71], v[36:39]
  v_mfma_f32_16x16x32_bf16 v[40:43], a[140:143], v[68:71], v[40:43]
  s_waitcnt lgkmcnt(2)
  v_mfma_f32_16x16x32_bf16 v[32:35], a[144:147], v[56:59], v[32:35]
  ds_read_b128 v[68:71], v11 offset:15360
  v_mfma_f32_16x16x32_bf16 v[36:39], a[148:151], v[56:59], v[36:39]
  buffer_load_dwordx4 v11, s[60:63], s87 offen offset:3072 sc1 lds
  v_mfma_f32_16x16x32_bf16 v[40:43], a[152:155], v[56:59], v[40:43]
  s_waitcnt lgkmcnt(2)
  v_mfma_f32_16x16x32_bf16 v[32:35], a[156:159], v[60:63], v[32:35]
  s_add_u32 s87, s87, 4096
  ds_read_b128 v[56:59], v11 offset:16384
  v_mfma_f32_16x16x32_bf16 v[36:39], a[160:163], v[60:63], v[36:39]
  s_add_u32 m0, s88, 65536
  v_mfma_f32_16x16x32_bf16 v[40:43], a[164:167], v[60:63], v[40:43]
  s_waitcnt lgkmcnt(2)
  buffer_load_dwordx4 v11, s[60:63], s87 offen offset:0 sc1 lds
  v_mfma_f32_16x16x32_bf16 v[32:35], a[168:171], v[64:67], v[32:35]
  s_add_u32 s87, s87, 16384
  ds_read_b128 v[60:63], v11 offset:17408
  v_mfma_f32_16x16x32_bf16 v[36:39], a[172:175], v[64:67], v[36:39]
  s_add_u32 m0, s88, 81920
  v_mfma_f32_16x16x32_bf16 v[40:43], a[176:179], v[64:67], v[40:43]
  s_waitcnt lgkmcnt(2)
  v_mfma_f32_16x16x32_bf16 v[32:35], a[180:183], v[68:71], v[32:35]
  ds_read_b128 v[64:67], v11 offset:18432
  v_mfma_f32_16x16x32_bf16 v[36:39], a[184:187], v[68:71], v[36:39]
  buffer_load_dwordx4 v11, s[60:63], s87 offen offset:0 sc1 lds
  v_mfma_f32_16x16x32_bf16 v[40:43], a[188:191], v[68:71], v[40:43]
  s_waitcnt vmcnt(11)
  s_barrier
  s_waitcnt lgkmcnt(2)
  v_mfma_f32_16x16x32_bf16 v[32:35], a[192:195], v[56:59], v[32:35]
  ds_read_b128 v[68:71], v11 offset:19456
  v_mfma_f32_16x16x32_bf16 v[36:39], a[196:199], v[56:59], v[36:39]
  v_mfma_f32_16x16x32_bf16 v[40:43], a[200:203], v[56:59], v[40:43]
  s_waitcnt lgkmcnt(2)
  buffer_load_dwordx4 v11, s[60:63], s87 offen offset:1024 sc1 lds
  v_mfma_f32_16x16x32_bf16 v[32:35], a[204:207], v[60:63], v[32:35]
  ds_read_b128 v[56:59], v11 offset:20480
  v_mfma_f32_16x16x32_bf16 v[36:39], a[208:211], v[60:63], v[36:39]
  v_mfma_f32_16x16x32_bf16 v[40:43], a[212:215], v[60:63], v[40:43]
  s_waitcnt lgkmcnt(2)
  v_mfma_f32_16x16x32_bf16 v[32:35], a[216:219], v[64:67], v[32:35]
  ds_read_b128 v[60:63], v11 offset:21504
  v_mfma_f32_16x16x32_bf16 v[36:39], a[220:223], v[64:67], v[36:39]
  buffer_load_dwordx4 v11, s[60:63], s87 offen offset:2048 sc1 lds
  v_mfma_f32_16x16x32_bf16 v[40:43], a[224:227], v[64:67], v[40:43]
  s_waitcnt lgkmcnt(2)
  v_mfma_f32_16x16x32_bf16 v[32:35], a[228:231], v[68:71], v[32:35]
  ds_read_b128 v[64:67], v11 offset:22528
  v_mfma_f32_16x16x32_bf16 v[36:39], a[232:235], v[68:71], v[36:39]
  v_mfma_f32_16x16x32_bf16 v[40:43], a[236:239], v[68:71], v[40:43]
  s_waitcnt lgkmcnt(2)
  buffer_load_dwordx4 v11, s[60:63], s87 offen offset:3072 sc1 lds
  v_mfma_f32_16x16x32_bf16 v[44:47], a[0:3], v[56:59], 0
  s_add_u32 s87, s87, 4096
  ds_read_b128 v[68:71], v11 offset:23552
  v_mfma_f32_16x16x32_bf16 v[48:51], a[4:7], v[56:59], 0
  s_add_u32 m0, s88, 86016
  v_mfma_f32_16x16x32_bf16 v[52:55], a[8:11], v[56:59], 0
  s_waitcnt lgkmcnt(2)
  v_mul_f32 v124, s19, v84
  v_mul_f32 v125, s18, v84
  v_mfma_f32_16x16x32_bf16 v[44:47], a[12:15], v[60:63], v[44:47]
  ds_read_b128 v[56:59], v11 offset:24576
  v_mul_f32 v126, v16, v84
  v_mfma_f32_16x16x32_bf16 v[48:51], a[16:19], v[60:63], v[48:51]
  buffer_load_dwordx4 v11, s[60:63], s87 offen offset:0 sc1 lds
  v_mfma_f32_16x16x32_bf16 v[52:55], a[20:23], v[60:63], v[52:55]
  s_waitcnt lgkmcnt(2)
  v_fma_f32 v32, -v85, v72, v32
  v_fma_f32 v33, -v85, v73, v33
  v_mfma_f32_16x16x32_bf16 v[44:47], a[24:27], v[64:67], v[44:47]
  s_add_u32 s87, s87, 16384
  ds_read_b128 v[60:63], v11 offset:25600
  v_fma_f32 v34, -v85, v74, v34
  v_mfma_f32_16x16x32_bf16 v[48:51], a[28:31], v[64:67], v[48:51]
  s_add_u32 m0, s12, 0
  v_fma_f32 v35, -v85, v75, v35
  v_fma_f32 v36, -v85, v76, v36
  v_mfma_f32_16x16x32_bf16 v[52:55], a[32:35], v[64:67], v[52:55]
  s_waitcnt lgkmcnt(2)
  buffer_load_dwordx4 v11, s[60:63], s14 offen offset:0 sc1 lds
  v_mfma_f32_16x16x32_bf16 v[44:47], a[36:39], v[68:71], v[44:47]
  ds_read_b128 v[64:67], v11 offset:26624
  v_fma_f32 v37, -v85, v77, v37
  v_mfma_f32_16x16x32_bf16 v[48:51], a[40:43], v[68:71], v[48:51]
  v_fma_f32 v38, -v85, v78, v38
  v_fma_f32 v39, -v85, v79, v39
  v_mfma_f32_16x16x32_bf16 v[52:55], a[44:47], v[68:71], v[52:55]
  s_waitcnt lgkmcnt(2)
  v_fma_f32 v40, -v85, v80, v40
  v_fma_f32 v41, -v85, v81, v41
  v_mfma_f32_16x16x32_bf16 v[44:47], a[48:51], v[56:59], v[44:47]
  ds_read_b128 v[68:71], v11 offset:27648
  v_fma_f32 v42, -v85, v82, v42
  v_mfma_f32_16x16x32_bf16 v[48:51], a[52:55], v[56:59], v[48:51]
  buffer_load_dwordx4 v11, s[60:63], s14 offen offset:1024 sc1 lds
  v_mfma_f32_16x16x32_bf16 v[52:55], a[56:59], v[56:59], v[52:55]
  s_waitcnt lgkmcnt(2)
  v_fma_f32 v43, -v85, v83, v43
  v_mul_f32 v116, v32, v124
  v_mfma_f32_16x16x32_bf16 v[44:47], a[60:63], v[60:63], v[44:47]
  ds_read_b128 v[56:59], v11 offset:28672
  v_mul_f32 v117, v33, v124
  v_mfma_f32_16x16x32_bf16 v[48:51], a[64:67], v[60:63], v[48:51]
  v_mul_f32 v118, v34, v124
  v_mul_f32 v119, v35, v124
  v_mfma_f32_16x16x32_bf16 v[52:55], a[68:71], v[60:63], v[52:55]
  s_waitcnt lgkmcnt(2)
  global_load_dwordx4 v[130:133], v11, s[24:25] offset:0 sc1
  v_mfma_f32_16x16x32_bf16 v[44:47], a[72:75], v[64:67], v[44:47]
  ds_read_b128 v[60:63], v11 offset:29696
  v_mul_f32 v120, v36, v125
  v_mfma_f32_16x16x32_bf16 v[48:51], a[76:79], v[64:67], v[48:51]
  v_mul_f32 v121, v37, v125
  v_mul_f32 v122, v38, v125
  v_mfma_f32_16x16x32_bf16 v[52:55], a[80:83], v[64:67], v[52:55]
  s_waitcnt lgkmcnt(2)
  v_mul_f32 v123, v39, v125
  v_mul_f32 v100, v40, v126
  v_mfma_f32_16x16x32_bf16 v[44:47], a[84:87], v[68:71], v[44:47]
  ds_read_b128 v[64:67], v11 offset:30720
  v_mul_f32 v101, v41, v126
  v_mfma_f32_16x16x32_bf16 v[48:51], a[88:91], v[68:71], v[48:51]
  buffer_load_dwordx4 v11, s[60:63], s14 offen offset:2048 sc1 lds
  v_mfma_f32_16x16x32_bf16 v[52:55], a[92:95], v[68:71], v[52:55]
  s_waitcnt lgkmcnt(2)
  v_mul_f32 v102, v42, v126
  v_mul_f32 v103, v43, v126
  v_mfma_f32_16x16x32_bf16 v[44:47], a[96:99], v[56:59], v[44:47]
  ds_read_b128 v[68:71], v11 offset:31744
  v_mfma_f32_16x16x32_bf16 v[48:51], a[100:103], v[56:59], v[48:51]
  v_exp_f32 v124, v116
  v_mfma_f32_16x16x32_bf16 v[52:55], a[104:107], v[56:59], v[52:55]
  s_waitcnt lgkmcnt(2)
  buffer_load_dwordx4 v11, s[60:63], s14 offen offset:3072 sc1 lds
  v_mfma_f32_16x16x32_bf16 v[44:47], a[108:111], v[60:63], v[44:47]
  s_add_u32 s14, s14, 4096
  ds_read_b128 v[56:59], v11 offset:32768
  v_mfma_f32_16x16x32_bf16 v[48:51], a[112:115], v[60:63], v[48:51]
  v_exp_f32 v125, v117
  v_mfma_f32_16x16x32_bf16 v[52:55], a[116:119], v[60:63], v[52:55]
  s_waitcnt lgkmcnt(2)
  v_exp_f32 v126, v118
  v_mfma_f32_16x16x32_bf16 v[44:47], a[120:123], v[64:67], v[44:47]
  ds_read_b128 v[60:63], v11 offset:33792
  v_mfma_f32_16x16x32_bf16 v[48:51], a[124:127], v[64:67], v[48:51]
  global_load_dwordx4 v[134:137], v11, s[24:25] offset:1024 sc1
  v_mfma_f32_16x16x32_bf16 v[52:55], a[128:131], v[64:67], v[52:55]
  s_waitcnt lgkmcnt(2)
  v_exp_f32 v127, v119
  v_mfma_f32_16x16x32_bf16 v[44:47], a[132:135], v[68:71], v[44:47]
  ds_read_b128 v[64:67], v11 offset:34816
  v_mul_f32 v116, v116, v120
  v_mfma_f32_16x16x32_bf16 v[48:51], a[136:139], v[68:71], v[48:51]
  s_add_u32 m0, s12, 4096
  v_mul_f32 v117, v117, v121
  v_mul_f32 v118, v118, v122
  v_mfma_f32_16x16x32_bf16 v[52:55], a[140:143], v[68:71], v[52:55]
  s_waitcnt lgkmcnt(2)
  buffer_load_dwordx4 v11, s[60:63], s14 offen offset:0 sc1 lds
  v_mfma_f32_16x16x32_bf16 v[44:47], a[144:147], v[56:59], v[44:47]
  ds_read_b128 v[68:71], v11 offset:35840
  v_mul_f32 v119, v119, v123
  v_mfma_f32_16x16x32_bf16 v[48:51], a[148:151], v[56:59], v[48:51]
  v_add_f32 v124, 1.0, v124
  v_add_f32 v125, 1.0, v125
  v_mfma_f32_16x16x32_bf16 v[52:55], a[152:155], v[56:59], v[52:55]
  s_waitcnt lgkmcnt(2)
  v_add_f32 v126, 1.0, v126
  v_add_f32 v127, 1.0, v127
  v_mfma_f32_16x16x32_bf16 v[44:47], a[156:159], v[60:63], v[44:47]
  ds_read_b128 v[56:59], v11 offset:36864
  v_mfma_f32_16x16x32_bf16 v[48:51], a[160:163], v[60:63], v[48:51]
  global_load_dwordx4 v[138:141], v11, s[24:25] offset:2048 sc1
  v_mfma_f32_16x16x32_bf16 v[52:55], a[164:167], v[60:63], v[52:55]
  s_waitcnt lgkmcnt(2)
  v_rcp_f32 v124, v124
  v_mfma_f32_16x16x32_bf16 v[44:47], a[168:171], v[64:67], v[44:47]
  ds_read_b128 v[60:63], v11 offset:37888
  v_mfma_f32_16x16x32_bf16 v[48:51], a[172:175], v[64:67], v[48:51]
  v_rcp_f32 v125, v125
  v_mfma_f32_16x16x32_bf16 v[52:55], a[176:179], v[64:67], v[52:55]
  s_waitcnt lgkmcnt(2)
  buffer_load_dwordx4 v11, s[60:63], s14 offen offset:1024 sc1 lds
  v_mfma_f32_16x16x32_bf16 v[44:47], a[180:183], v[68:71], v[44:47]
  ds_read_b128 v[64:67], v11 offset:38912
  v_mfma_f32_16x16x32_bf16 v[48:51], a[184:187], v[68:71], v[48:51]
  v_rcp_f32 v126, v126
  v_mfma_f32_16x16x32_bf16 v[52:55], a[188:191], v[68:71], v[52:55]
  v_rcp_f32 v127, v127
  s_waitcnt vmcnt(19)
  s_barrier
  s_waitcnt lgkmcnt(2)
  v_mfma_f32_16x16x32_bf16 v[44:47], a[192:195], v[56:59], v[44:47]
  ds_read_b128 v[68:71], v11 offset:39936
  v_mul_f32 v116, v116, v124
  v_mfma_f32_16x16x32_bf16 v[48:51], a[196:199], v[56:59], v[48:51]
  global_load_dwordx4 v[142:145], v11, s[24:25] offset:3072 sc1
  v_mfma_f32_16x16x32_bf16 v[52:55], a[200:203], v[56:59], v[52:55]
  s_waitcnt lgkmcnt(2)
  v_mul_f32 v117, v117, v125
  v_mul_f32 v118, v118, v126
  v_mfma_f32_16x16x32_bf16 v[44:47], a[204:207], v[60:63], v[44:47]
  s_add_u32 s89, s89, 4096
  ds_read_b128 v[56:59], v11 offset:40960
  v_mul_f32 v119, v119, v127
  v_mfma_f32_16x16x32_bf16 v[48:51], a[208:211], v[60:63], v[48:51]
  s_add_u32 s24, s60, s89
  s_addc_u32 s25, s61, 0
  v_cvt_pk_bf16_f32 v108, v116, v117
  v_cvt_pk_bf16_f32 v109, v118, v119
  v_mfma_f32_16x16x32_bf16 v[52:55], a[212:215], v[60:63], v[52:55]
  s_waitcnt lgkmcnt(2)
  buffer_load_dwordx4 v11, s[60:63], s14 offen offset:2048 sc1 lds
  v_mfma_f32_16x16x32_bf16 v[44:47], a[216:219], v[64:67], v[44:47]
  ds_read_b128 v[60:63], v11 offset:41984
  v_mfma_f32_16x16x32_bf16 v[48:51], a[220:223], v[64:67], v[48:51]
  v_mfma_f32_16x16x32_bf16 v[52:55], a[224:227], v[64:67], v[52:55]
  s_waitcnt lgkmcnt(2)
  v_mfma_f32_16x16x32_bf16 v[44:47], a[228:231], v[68:71], v[44:47]
  ds_read_b128 v[64:67], v11 offset:43008
  v_mfma_f32_16x16x32_bf16 v[48:51], a[232:235], v[68:71], v[48:51]
  buffer_load_dwordx4 v11, s[60:63], s14 offen offset:3072 sc1 lds
  v_mfma_f32_16x16x32_bf16 v[52:55], a[236:239], v[68:71], v[52:55]
  s_waitcnt lgkmcnt(2)
  v_mfma_f32_16x16x32_bf16 v[32:35], a[0:3], v[56:59], 0
  s_add_u32 m0, s88, 0
  ds_read_b128 v[68:71], v11 offset:44032
  v_mfma_f32_16x16x32_bf16 v[36:39], a[4:7], v[56:59], 0
  s_add_u32 s14, s14, 4096
  v_mfma_f32_16x16x32_bf16 v[40:43], a[8:11], v[56:59], 0
  s_waitcnt lgkmcnt(2)
  buffer_load_dwordx4 v11, s[60:63], s87 offen offset:0 sc1 lds
  v_mfma_f32_16x16x32_bf16 v[32:35], a[12:15], v[60:63], v[32:35]
  ds_read_b128 v[56:59], v11 offset:45056
  v_mul_f32 v124, s19, v86
  v_mfma_f32_16x16x32_bf16 v[36:39], a[16:19], v[60:63], v[36:39]
  v_mul_f32 v125, s18, v86
  v_mul_f32 v126, v16, v86
  v_mfma_f32_16x16x32_bf16 v[40:43], a[20:23], v[60:63], v[40:43]
  s_waitcnt lgkmcnt(2)
  v_fma_f32 v44, -v87, v72, v44
  v_fma_f32 v45, -v87, v73, v45
  v_mfma_f32_16x16x32_bf16 v[32:35], a[24:27], v[64:67], v[32:35]
  ds_read_b128 v[60:63], v11 offset:46080
  v_fma_f32 v46, -v87, v74, v46
  v_mfma_f32_16x16x32_bf16 v[36:39], a[28:31], v[64:67], v[36:39]
  buffer_load_dwordx4 v11, s[60:63], s87 offen offset:1024 sc1 lds
  v_mfma_f32_16x16x32_bf16 v[40:43], a[32:35], v[64:67], v[40:43]
  s_waitcnt lgkmcnt(2)
  v_fma_f32 v47, -v87, v75, v47
  v_fma_f32 v48, -v87, v76, v48
  v_mfma_f32_16x16x32_bf16 v[32:35], a[36:39], v[68:71], v[32:35]
  ds_read_b128 v[64:67], v11 offset:47104
  v_fma_f32 v49, -v87, v77, v49
  v_mfma_f32_16x16x32_bf16 v[36:39], a[40:43], v[68:71], v[36:39]
  v_fma_f32 v50, -v87, v78, v50
  v_fma_f32 v51, -v87, v79, v51
  v_mfma_f32_16x16x32_bf16 v[40:43], a[44:47], v[68:71], v[40:43]
  s_waitcnt lgkmcnt(2)
  buffer_load_dwordx4 v11, s[60:63], s87 offen offset:2048 sc1 lds
  v_mfma_f32_16x16x32_bf16 v[32:35], a[48:51], v[56:59], v[32:35]
  ds_read_b128 v[68:71], v11 offset:48128
  v_fma_f32 v52, -v87, v80, v52
  v_mfma_f32_16x16x32_bf16 v[36:39], a[52:55], v[56:59], v[36:39]
  v_fma_f32 v53, -v87, v81, v53
  v_fma_f32 v54, -v87, v82, v54
  v_mfma_f32_16x16x32_bf16 v[40:43], a[56:59], v[56:59], v[40:43]
  s_waitcnt lgkmcnt(2)
  v_fma_f32 v55, -v87, v83, v55
  v_mul_f32 v116, v44, v124
  v_mfma_f32_16x16x32_bf16 v[32:35], a[60:63], v[60:63], v[32:35]
  ds_read_b128 v[56:59], v11 offset:49152
  v_mul_f32 v117, v45, v124
  v_mfma_f32_16x16x32_bf16 v[36:39], a[64:67], v[60:63], v[36:39]
  buffer_load_dwordx4 v11, s[60:63], s87 offen offset:3072 sc1 lds
  v_mfma_f32_16x16x32_bf16 v[40:43], a[68:71], v[60:63], v[40:43]
  s_waitcnt lgkmcnt(2)
  v_mul_f32 v118, v46, v124
  v_mul_f32 v119, v47, v124
  v_mfma_f32_16x16x32_bf16 v[32:35], a[72:75], v[64:67], v[32:35]
  s_add_u32 s87, s87, 4096
  ds_read_b128 v[60:63], v11 offset:50176
  v_mul_f32 v120, v48, v125
  v_mfma_f32_16x16x32_bf16 v[36:39], a[76:79], v[64:67], v[36:39]
  s_add_u32 m0, s88, 4096
  v_mul_f32 v121, v49, v125
  v_mul_f32 v122, v50, v125
  v_mfma_f32_16x16x32_bf16 v[40:43], a[80:83], v[64:67], v[40:43]
  s_waitcnt lgkmcnt(2)
  buffer_load_dwordx4 v11, s[60:63], s87 offen offset:0 sc1 lds
  v_mfma_f32_16x16x32_bf16 v[32:35], a[84:87], v[68:71], v[32:35]
  s_add_u32 s87, s87, 16384
  ds_read_b128 v[64:67], v11 offset:51200
  v_mul_f32 v123, v51, v125
  v_mfma_f32_16x16x32_bf16 v[36:39], a[88:91], v[68:71], v[36:39]
  s_add_u32 m0, s12, 8192
  v_mul_f32 v104, v52, v126
  v_mul_f32 v105, v53, v126
  v_mfma_f32_16x16x32_bf16 v[40:43], a[92:95], v[68:71], v[40:43]
  s_waitcnt lgkmcnt(2)
  v_mul_f32 v106, v54, v126
  v_mul_f32 v107, v55, v126
  v_mfma_f32_16x16x32_bf16 v[32:35], a[96:99], v[56:59], v[32:35]
  ds_read_b128 v[68:71], v11 offset:52224
  v_mfma_f32_16x16x32_bf16 v[36:39], a[100:103], v[56:59], v[36:39]
  buffer_load_dwordx4 v11, s[60:63], s14 offen offset:0 sc1 lds
  v_mfma_f32_16x16x32_bf16 v[40:43], a[104:107], v[56:59], v[40:43]
  s_waitcnt lgkmcnt(2)
  v_exp_f32 v124, v116
  v_mfma_f32_16x16x32_bf16 v[32:35], a[108:111], v[60:63], v[32:35]
  ds_read_b128 v[56:59], v11 offset:53248
  v_mfma_f32_16x16x32_bf16 v[36:39], a[112:115], v[60:63], v[36:39]
  v_exp_f32 v125, v117
  v_mfma_f32_16x16x32_bf16 v[40:43], a[116:119], v[60:63], v[40:43]
  s_waitcnt lgkmcnt(2)
  buffer_load_dwordx4 v11, s[60:63], s14 offen offset:1024 sc1 lds
  v_mfma_f32_16x16x32_bf16 v[32:35], a[120:123], v[64:67], v[32:35]
  ds_read_b128 v[60:63], v11 offset:54272
  v_mfma_f32_16x16x32_bf16 v[36:39], a[124:127], v[64:67], v[36:39]
  v_exp_f32 v126, v118
  v_mfma_f32_16x16x32_bf16 v[40:43], a[128:131], v[64:67], v[40:43]
  s_waitcnt lgkmcnt(2)
  v_exp_f32 v127, v119
  v_mfma_f32_16x16x32_bf16 v[32:35], a[132:135], v[68:71], v[32:35]
  ds_read_b128 v[64:67], v11 offset:55296
  v_mul_f32 v116, v116, v120
  v_mfma_f32_16x16x32_bf16 v[36:39], a[136:139], v[68:71], v[36:39]
  buffer_load_dwordx4 v11, s[60:63], s14 offen offset:2048 sc1 lds
  v_mfma_f32_16x16x32_bf16 v[40:43], a[140:143], v[68:71], v[40:43]
  s_waitcnt lgkmcnt(2)
  v_mul_f32 v117, v117, v121
  v_mul_f32 v118, v118, v122
  v_mfma_f32_16x16x32_bf16 v[32:35], a[144:147], v[56:59], v[32:35]
  ds_read_b128 v[68:71], v11 offset:56320
  v_mul_f32 v119, v119, v123
  v_mfma_f32_16x16x32_bf16 v[36:39], a[148:151], v[56:59], v[36:39]
  v_add_f32 v124, 1.0, v124
  v_add_f32 v125, 1.0, v125
  v_mfma_f32_16x16x32_bf16 v[40:43], a[152:155], v[56:59], v[40:43]
  s_waitcnt lgkmcnt(2)
  buffer_load_dwordx4 v11, s[60:63], s14 offen offset:3072 sc1 lds
  v_mfma_f32_16x16x32_bf16 v[32:35], a[156:159], v[60:63], v[32:35]
  s_add_u32 s14, s14, 4096
  ds_read_b128 v[56:59], v11 offset:57344
  v_add_f32 v126, 1.0, v126
  v_mfma_f32_16x16x32_bf16 v[36:39], a[160:163], v[60:63], v[36:39]
  s_add_u32 m0, s12, 12288
  v_add_f32 v127, 1.0, v127
  v_mfma_f32_16x16x32_bf16 v[40:43], a[164:167], v[60:63], v[40:43]
  s_waitcnt lgkmcnt(2)
  v_rcp_f32 v124, v124
  v_mfma_f32_16x16x32_bf16 v[32:35], a[168:171], v[64:67], v[32:35]
  ds_read_b128 v[60:63], v11 offset:58368
  v_mfma_f32_16x16x32_bf16 v[36:39], a[172:175], v[64:67], v[36:39]
  buffer_load_dwordx4 v11, s[60:63], s14 offen offset:0 sc1 lds
  v_mfma_f32_16x16x32_bf16 v[40:43], a[176:179], v[64:67], v[40:43]
  s_waitcnt lgkmcnt(2)
  v_rcp_f32 v125, v125
  v_mfma_f32_16x16x32_bf16 v[32:35], a[180:183], v[68:71], v[32:35]
  ds_read_b128 v[64:67], v11 offset:59392
  v_mfma_f32_16x16x32_bf16 v[36:39], a[184:187], v[68:71], v[36:39]
  v_rcp_f32 v126, v126
  v_mfma_f32_16x16x32_bf16 v[40:43], a[188:191], v[68:71], v[40:43]
  buffer_load_dwordx4 v11, s[60:63], s14 offen offset:1024 sc1 lds
  s_waitcnt vmcnt(28)
  s_barrier
  s_waitcnt lgkmcnt(2)
  v_mfma_f32_16x16x32_bf16 v[32:35], a[192:195], v[56:59], v[32:35]
  ds_read_b128 v[68:71], v11 offset:60416
  v_mfma_f32_16x16x32_bf16 v[36:39], a[196:199], v[56:59], v[36:39]
  v_rcp_f32 v127, v127
  v_mfma_f32_16x16x32_bf16 v[40:43], a[200:203], v[56:59], v[40:43]
  s_waitcnt lgkmcnt(2)
  v_mul_f32 v116, v116, v124
  v_mul_f32 v117, v117, v125
  v_mfma_f32_16x16x32_bf16 v[32:35], a[204:207], v[60:63], v[32:35]
  ds_read_b128 v[56:59], v12 offset:0
  v_mul_f32 v118, v118, v126
  v_mfma_f32_16x16x32_bf16 v[36:39], a[208:211], v[60:63], v[36:39]
  global_load_dwordx4 v[146:149], v11, s[24:25] offset:0 sc1
  v_mfma_f32_16x16x32_bf16 v[40:43], a[212:215], v[60:63], v[40:43]
  s_waitcnt lgkmcnt(2)
  v_mul_f32 v119, v119, v127
  v_cvt_pk_bf16_f32 v110, v116, v117
  v_mfma_f32_16x16x32_bf16 v[32:35], a[216:219], v[64:67], v[32:35]
  ds_read_b128 v[60:63], v12 offset:1024
  v_cvt_pk_bf16_f32 v111, v118, v119
  v_mfma_f32_16x16x32_bf16 v[36:39], a[220:223], v[64:67], v[36:39]
  v_permlane32_swap_b32 v100, v104
  v_mfma_f32_16x16x32_bf16 v[40:43], a[224:227], v[64:67], v[40:43]
  s_waitcnt lgkmcnt(2)
  buffer_load_dwordx4 v11, s[60:63], s14 offen offset:2048 sc1 lds
  v_mfma_f32_16x16x32_bf16 v[32:35], a[228:231], v[68:71], v[32:35]
  s_add_u32 m0, s88, 20480
  ds_read_b128 v[64:67], v12 offset:2048
  v_mfma_f32_16x16x32_bf16 v[36:39], a[232:235], v[68:71], v[36:39]
  s_add_u32 s14, s14, 3072
  v_permlane32_swap_b32 v101, v105
  v_mfma_f32_16x16x32_bf16 v[40:43], a[236:239], v[68:71], v[40:43]
  s_waitcnt lgkmcnt(2)
  v_permlane32_swap_b32 v102, v106
  v_mfma_f32_16x16x32_bf16 v[44:47], a[0:3], v[56:59], 0
  ds_read_b128 v[68:71], v12 offset:3072
  v_mfma_f32_16x16x32_bf16 v[48:51], a[4:7], v[56:59], 0
  buffer_load_dwordx4 v11, s[60:63], s87 offen offset:0 sc1 lds
  v_mfma_f32_16x16x32_bf16 v[52:55], a[8:11], v[56:59], 0
  s_waitcnt lgkmcnt(2)
  v_permlane32_swap_b32 v103, v107
  v_mfma_f32_16x16x32_bf16 v[44:47], a[12:15], v[60:63], v[44:47]
  ds_read_b128 v[56:59], v12 offset:4096
  v_mfma_f32_16x16x32_bf16 v[48:51], a[16:19], v[60:63], v[48:51]
  v_permlane16_swap_b32 v108, v110
  v_mfma_f32_16x16x32_bf16 v[52:55], a[20:23], v[60:63], v[52:55]
  s_waitcnt lgkmcnt(2)
  buffer_load_dwordx4 v11, s[60:63], s87 offen offset:1024 sc1 lds
  v_mfma_f32_16x16x32_bf16 v[44:47], a[24:27], v[64:67], v[44:47]
  ds_read_b128 v[60:63], v12 offset:5120
  v_mfma_f32_16x16x32_bf16 v[48:51], a[28:31], v[64:67], v[48:51]
  v_permlane16_swap_b32 v109, v111
  v_mfma_f32_16x16x32_bf16 v[52:55], a[32:35], v[64:67], v[52:55]
  s_waitcnt lgkmcnt(2)
  v_mfma_f32_16x16x32_bf16 v[44:47], a[36:39], v[68:71], v[44:47]
  s_mov_b32 s92, 0
  ds_read_b128 v[64:67], v12 offset:6144
  v_mfma_f32_16x16x32_bf16 v[48:51], a[40:43], v[68:71], v[48:51]
  buffer_load_dwordx4 v11, s[60:63], s87 offen offset:2048 sc1 lds
  v_mfma_f32_16x16x32_bf16 v[52:55], a[44:47], v[68:71], v[52:55]
  s_waitcnt lgkmcnt(2)
  buffer_store_dwordx4 v[108:111], v13, s[60:63], s92 offen sc1
  v_mfma_f32_16x16x32_bf16 v[44:47], a[48:51], v[56:59], v[44:47]
  ds_read_b128 v[68:71], v12 offset:7168
  v_mfma_f32_16x16x32_bf16 v[48:51], a[52:55], v[56:59], v[48:51]
  v_exp_f32 v124, v100
  v_mfma_f32_16x16x32_bf16 v[52:55], a[56:59], v[56:59], v[52:55]
  s_waitcnt lgkmcnt(2)
  v_exp_f32 v125, v101
  v_mfma_f32_16x16x32_bf16 v[44:47], a[60:63], v[60:63], v[44:47]
  ds_read_b128 v[56:59], v12 offset:8192
  v_mfma_f32_16x16x32_bf16 v[48:51], a[64:67], v[60:63], v[48:51]
  buffer_load_dwordx4 v11, s[60:63], s87 offen offset:3072 sc1 lds
  v_mfma_f32_16x16x32_bf16 v[52:55], a[68:71], v[60:63], v[52:55]
  s_waitcnt lgkmcnt(2)
  v_exp_f32 v126, v102
  v_mfma_f32_16x16x32_bf16 v[44:47], a[72:75], v[64:67], v[44:47]
  s_add_u32 s87, s87, 4096
  ds_read_b128 v[60:63], v12 offset:9216
  v_mfma_f32_16x16x32_bf16 v[48:51], a[76:79], v[64:67], v[48:51]
  s_add_u32 m0, s88, 24576
  v_exp_f32 v127, v103
  v_mfma_f32_16x16x32_bf16 v[52:55], a[80:83], v[64:67], v[52:55]
  s_waitcnt lgkmcnt(2)
  buffer_load_dwordx4 v11, s[60:63], s87 offen offset:0 sc1 lds
  v_mfma_f32_16x16x32_bf16 v[44:47], a[84:87], v[68:71], v[44:47]
  s_add_u32 s87, s87, 16384
  ds_read_b128 v[64:67], v12 offset:10240
  v_mul_f32 v100, v100, v104
  v_mfma_f32_16x16x32_bf16 v[48:51], a[88:91], v[68:71], v[48:51]
  v_mul_f32 v101, v101, v105
  v_mul_f32 v102, v102, v106
  v_mfma_f32_16x16x32_bf16 v[52:55], a[92:95], v[68:71], v[52:55]
  s_waitcnt lgkmcnt(2)
  v_mul_f32 v103, v103, v107
  v_add_f32 v124, 1.0, v124
  v_mfma_f32_16x16x32_bf16 v[44:47], a[96:99], v[56:59], v[44:47]
  ds_read_b128 v[68:71], v12 offset:11264
  v_add_f32 v125, 1.0, v125
  v_mfma_f32_16x16x32_bf16 v[48:51], a[100:103], v[56:59], v[48:51]
  global_load_dwordx4 v[150:153], v11, s[24:25] offset:1024 sc1
  v_mfma_f32_16x16x32_bf16 v[52:55], a[104:107], v[56:59], v[52:55]
  s_waitcnt lgkmcnt(2)
  v_add_f32 v126, 1.0, v126
  v_add_f32 v127, 1.0, v127
  v_mfma_f32_16x16x32_bf16 v[44:47], a[108:111], v[60:63], v[44:47]
  ds_read_b128 v[56:59], v12 offset:12288
  v_mfma_f32_16x16x32_bf16 v[48:51], a[112:115], v[60:63], v[48:51]
  v_rcp_f32 v124, v124
  v_mfma_f32_16x16x32_bf16 v[52:55], a[116:119], v[60:63], v[52:55]
  s_waitcnt lgkmcnt(2)
  global_load_dwordx4 v[154:157], v11, s[24:25] offset:2048 sc1
  v_mfma_f32_16x16x32_bf16 v[44:47], a[120:123], v[64:67], v[44:47]
  ds_read_b128 v[60:63], v12 offset:13312
  v_mfma_f32_16x16x32_bf16 v[48:51], a[124:127], v[64:67], v[48:51]
  v_rcp_f32 v125, v125
  v_mfma_f32_16x16x32_bf16 v[52:55], a[128:131], v[64:67], v[52:55]
  s_waitcnt lgkmcnt(2)
  v_rcp_f32 v126, v126
  v_mfma_f32_16x16x32_bf16 v[44:47], a[132:135], v[68:71], v[44:47]
  ds_read_b128 v[64:67], v12 offset:14336
  v_mfma_f32_16x16x32_bf16 v[48:51], a[136:139], v[68:71], v[48:51]
  global_load_dwordx4 v[158:161], v11, s[24:25] offset:3072 sc1
  v_mfma_f32_16x16x32_bf16 v[52:55], a[140:143], v[68:71], v[52:55]
  s_waitcnt lgkmcnt(2)
  v_rcp_f32 v127, v127
  v_mfma_f32_16x16x32_bf16 v[44:47], a[144:147], v[56:59], v[44:47]
  s_add_u32 s89, s89, 4096
  ds_read_b128 v[68:71], v12 offset:15360
  v_mul_f32 v100, v100, v124
  v_mfma_f32_16x16x32_bf16 v[48:51], a[148:151], v[56:59], v[48:51]
  s_add_u32 s24, s60, s89
  s_addc_u32 s25, s61, 0
  v_mul_f32 v101, v101, v125
  v_mul_f32 v102, v102, v126
  v_mfma_f32_16x16x32_bf16 v[52:55], a[152:155], v[56:59], v[52:55]
  s_waitcnt lgkmcnt(2)
  global_load_dwordx4 v[162:165], v11, s[24:25] offset:0 sc1
  v_mfma_f32_16x16x32_bf16 v[44:47], a[156:159], v[60:63], v[44:47]
  ds_read_b128 v[56:59], v12 offset:16384
  v_mul_f32 v103, v103, v127
  v_mfma_f32_16x16x32_bf16 v[48:51], a[160:163], v[60:63], v[48:51]
  v_cvt_pk_bf16_f32 v112, v100, v101
  v_cvt_pk_bf16_f32 v113, v102, v103
  v_mfma_f32_16x16x32_bf16 v[52:55], a[164:167], v[60:63], v[52:55]
  s_waitcnt lgkmcnt(2)
  buffer_store_dwordx2 v[112:113], v14, s[60:63], s92 offen sc1
  v_mfma_f32_16x16x32_bf16 v[44:47], a[168:171], v[64:67], v[44:47]
  ds_read_b128 v[60:63], v12 offset:17408
  v_mul_f32 v124, s19, v88
  v_mfma_f32_16x16x32_bf16 v[48:51], a[172:175], v[64:67], v[48:51]
  v_mul_f32 v125, s18, v88
  v_mul_f32 v126, v16, v88
  v_mfma_f32_16x16x32_bf16 v[52:55], a[176:179], v[64:67], v[52:55]
  s_waitcnt lgkmcnt(2)
  v_fma_f32 v32, -v89, v72, v32
  v_fma_f32 v33, -v89, v73, v33
  v_mfma_f32_16x16x32_bf16 v[44:47], a[180:183], v[68:71], v[44:47]
  ds_read_b128 v[64:67], v12 offset:18432
  v_fma_f32 v34, -v89, v74, v34
  v_mfma_f32_16x16x32_bf16 v[48:51], a[184:187], v[68:71], v[48:51]
  global_load_dwordx4 v[166:169], v11, s[24:25] offset:1024 sc1
  v_mfma_f32_16x16x32_bf16 v[52:55], a[188:191], v[68:71], v[52:55]
  v_fma_f32 v35, -v89, v75, v35
  v_fma_f32 v36, -v89, v76, v36
  s_waitcnt vmcnt(37)
  s_barrier
  s_waitcnt lgkmcnt(2)
  v_mfma_f32_16x16x32_bf16 v[44:47], a[192:195], v[56:59], v[44:47]
  ds_read_b128 v[68:71], v12 offset:19456
  v_fma_f32 v37, -v89, v77, v37
  v_mfma_f32_16x16x32_bf16 v[48:51], a[196:199], v[56:59], v[48:51]
  s_add_u32 m0, s88, 40960
  v_fma_f32 v38, -v89, v78, v38
  v_fma_f32 v39, -v89, v79, v39
  v_mfma_f32_16x16x32_bf16 v[52:55], a[200:203], v[56:59], v[52:55]
  s_waitcnt lgkmcnt(2)
  buffer_load_dwordx4 v11, s[60:63], s87 offen offset:0 sc1 lds
  v_mfma_f32_16x16x32_bf16 v[44:47], a[204:207], v[60:63], v[44:47]
  ds_read_b128 v[56:59], v12 offset:20480
  v_fma_f32 v40, -v89, v80, v40
  v_mfma_f32_16x16x32_bf16 v[48:51], a[208:211], v[60:63], v[48:51]
  v_fma_f32 v41, -v89, v81, v41
  v_fma_f32 v42, -v89, v82, v42
  v_mfma_f32_16x16x32_bf16 v[52:55], a[212:215], v[60:63], v[52:55]
  s_waitcnt lgkmcnt(2)
  v_fma_f32 v43, -v89, v83, v43
  v_mul_f32 v116, v32, v124
  v_mfma_f32_16x16x32_bf16 v[44:47], a[216:219], v[64:67], v[44:47]
  ds_read_b128 v[60:63], v12 offset:21504
  v_mul_f32 v117, v33, v124
  v_mfma_f32_16x16x32_bf16 v[48:51], a[220:223], v[64:67], v[48:51]
  buffer_load_dwordx4 v11, s[60:63], s87 offen offset:1024 sc1 lds
  v_mfma_f32_16x16x32_bf16 v[52:55], a[224:227], v[64:67], v[52:55]
  s_waitcnt lgkmcnt(2)
  v_mul_f32 v118, v34, v124
  v_mul_f32 v119, v35, v124
  v_mfma_f32_16x16x32_bf16 v[44:47], a[228:231], v[68:71], v[44:47]
  ds_read_b128 v[64:67], v12 offset:22528
  v_mul_f32 v120, v36, v125
  v_mfma_f32_16x16x32_bf16 v[48:51], a[232:235], v[68:71], v[48:51]
  v_mul_f32 v121, v37, v125
  v_mul_f32 v122, v38, v125
  v_mfma_f32_16x16x32_bf16 v[52:55], a[236:239], v[68:71], v[52:55]
  s_waitcnt lgkmcnt(2)
  buffer_load_dwordx4 v11, s[60:63], s87 offen offset:2048 sc1 lds
  v_mul_f32 v123, v39, v125
  v_mul_f32 v100, v40, v126
  v_mul_f32 v101, v41, v126
  v_mul_f32 v102, v42, v126
  v_mul_f32 v103, v43, v126
  v_mfma_f32_16x16x32_bf16 v[32:35], a[0:3], v[56:59], 0
  ds_read_b128 v[68:71], v12 offset:23552
  v_mfma_f32_16x16x32_bf16 v[36:39], a[4:7], v[56:59], 0
  v_exp_f32 v124, v116
  v_mfma_f32_16x16x32_bf16 v[40:43], a[8:11], v[56:59], 0
  s_waitcnt lgkmcnt(2)
  v_exp_f32 v125, v117
  v_mfma_f32_16x16x32_bf16 v[32:35], a[12:15], v[60:63], v[32:35]
  ds_read_b128 v[56:59], v12 offset:24576
  v_mfma_f32_16x16x32_bf16 v[36:39], a[16:19], v[60:63], v[36:39]
  buffer_load_dwordx4 v11, s[60:63], s87 offen offset:3072 sc1 lds
  v_mfma_f32_16x16x32_bf16 v[40:43], a[20:23], v[60:63], v[40:43]
  s_waitcnt lgkmcnt(2)
  v_exp_f32 v126, v118
  v_mfma_f32_16x16x32_bf16 v[32:35], a[24:27], v[64:67], v[32:35]
  s_add_u32 s87, s87, 4096
  ds_read_b128 v[60:63], v12 offset:25600
  v_mfma_f32_16x16x32_bf16 v[36:39], a[28:31], v[64:67], v[36:39]
  s_add_u32 m0, s88, 45056
  v_exp_f32 v127, v119
  v_mfma_f32_16x16x32_bf16 v[40:43], a[32:35], v[64:67], v[40:43]
  s_waitcnt lgkmcnt(2)
  buffer_load_dwordx4 v11, s[60:63], s87 offen offset:0 sc1 lds
  v_mfma_f32_16x16x32_bf16 v[32:35], a[36:39], v[68:71], v[32:35]
  s_add_u32 s87, s87, 16384
  ds_read_b128 v[64:67], v12 offset:26624
  v_mul_f32 v116, v116, v120
  v_mfma_f32_16x16x32_bf16 v[36:39], a[40:43], v[68:71], v[36:39]
  v_mul_f32 v117, v117, v121
  v_mul_f32 v118, v118, v122
  v_mfma_f32_16x16x32_bf16 v[40:43], a[44:47], v[68:71], v[40:43]
  s_waitcnt lgkmcnt(2)
  v_mul_f32 v119, v119, v123
  v_add_f32 v124, 1.0, v124
  v_mfma_f32_16x16x32_bf16 v[32:35], a[48:51], v[56:59], v[32:35]
  ds_read_b128 v[68:71], v12 offset:27648
  v_add_f32 v125, 1.0, v125
  v_mfma_f32_16x16x32_bf16 v[36:39], a[52:55], v[56:59], v[36:39]
  global_load_dwordx4 v[170:173], v11, s[24:25] offset:2048 sc1
  v_mfma_f32_16x16x32_bf16 v[40:43], a[56:59], v[56:59], v[40:43]
  s_waitcnt lgkmcnt(2)
  v_add_f32 v126, 1.0, v126
  v_add_f32 v127, 1.0, v127
  v_mfma_f32_16x16x32_bf16 v[32:35], a[60:63], v[60:63], v[32:35]
  ds_read_b128 v[56:59], v12 offset:28672
  v_mfma_f32_16x16x32_bf16 v[36:39], a[64:67], v[60:63], v[36:39]
  v_rcp_f32 v124, v124
  v_mfma_f32_16x16x32_bf16 v[40:43], a[68:71], v[60:63], v[40:43]
  s_waitcnt lgkmcnt(2)
  global_load_dwordx4 v[174:177], v11, s[24:25] offset:3072 sc1
  v_mfma_f32_16x16x32_bf16 v[32:35], a[72:75], v[64:67], v[32:35]
  s_add_u32 s89, s89, 4096
  ds_read_b128 v[60:63], v12 offset:29696
  v_mfma_f32_16x16x32_bf16 v[36:39], a[76:79], v[64:67], v[36:39]
  s_add_u32 s24, s60, s89
  s_addc_u32 s25, s61, 0
  v_rcp_f32 v125, v125
  v_mfma_f32_16x16x32_bf16 v[40:43], a[80:83], v[64:67], v[40:43]
  s_waitcnt lgkmcnt(2)
  v_rcp_f32 v126, v126
  v_mfma_f32_16x16x32_bf16 v[32:35], a[84:87], v[68:71], v[32:35]
  ds_read_b128 v[64:67], v12 offset:30720
  v_mfma_f32_16x16x32_bf16 v[36:39], a[88:91], v[68:71], v[36:39]
  global_load_dwordx4 v[178:181], v11, s[24:25] offset:0 sc1
  v_mfma_f32_16x16x32_bf16 v[40:43], a[92:95], v[68:71], v[40:43]
  s_waitcnt lgkmcnt(2)
  v_rcp_f32 v127, v127
  v_mfma_f32_16x16x32_bf16 v[32:35], a[96:99], v[56:59], v[32:35]
  ds_read_b128 v[68:71], v12 offset:31744
  v_mul_f32 v116, v116, v124
  v_mfma_f32_16x16x32_bf16 v[36:39], a[100:103], v[56:59], v[36:39]
  v_mul_f32 v117, v117, v125
  v_mul_f32 v118, v118, v126
  v_mfma_f32_16x16x32_bf16 v[40:43], a[104:107], v[56:59], v[40:43]
  s_waitcnt lgkmcnt(2)
  global_load_dwordx4 v[182:185], v11, s[24:25] offset:1024 sc1
  v_mfma_f32_16x16x32_bf16 v[32:35], a[108:111], v[60:63], v[32:35]
  ds_read_b128 v[56:59], v12 offset:32768
  v_mul_f32 v119, v119, v127
  v_mfma_f32_16x16x32_bf16 v[36:39], a[112:115], v[60:63], v[36:39]
  s_waitcnt vmcnt(10)
  v_cvt_pk_bf16_f32 v108, v116, v117
  v_cvt_pk_bf16_f32 v109, v118, v119
  v_mfma_f32_16x16x32_bf16 v[40:43], a[116:119], v[60:63], v[40:43]
  s_waitcnt lgkmcnt(2)
  buffer_store_dword v19, v15, s[60:63], 0 offen offset:0 sc1
  v_mfma_f32_16x16x32_bf16 v[32:35], a[120:123], v[64:67], v[32:35]
  ds_read_b128 v[60:63], v12 offset:33792
  v_mul_f32 v124, s19, v90
  v_mfma_f32_16x16x32_bf16 v[36:39], a[124:127], v[64:67], v[36:39]
  v_mul_f32 v125, s18, v90
  v_mul_f32 v126, v16, v90
  v_mfma_f32_16x16x32_bf16 v[40:43], a[128:131], v[64:67], v[40:43]
  s_waitcnt lgkmcnt(2)
  v_fma_f32 v44, -v91, v72, v44
  v_fma_f32 v45, -v91, v73, v45
  v_mfma_f32_16x16x32_bf16 v[32:35], a[132:135], v[68:71], v[32:35]
  ds_read_b128 v[64:67], v12 offset:34816
  v_fma_f32 v46, -v91, v74, v46
  v_mfma_f32_16x16x32_bf16 v[36:39], a[136:139], v[68:71], v[36:39]
  global_load_dwordx4 v[186:189], v11, s[24:25] offset:2048 sc1
  v_mfma_f32_16x16x32_bf16 v[40:43], a[140:143], v[68:71], v[40:43]
  s_waitcnt lgkmcnt(2)
  v_fma_f32 v47, -v91, v75, v47
  v_fma_f32 v48, -v91, v76, v48
  v_mfma_f32_16x16x32_bf16 v[32:35], a[144:147], v[56:59], v[32:35]
  ds_read_b128 v[68:71], v12 offset:35840
  v_fma_f32 v49, -v91, v77, v49
  v_mfma_f32_16x16x32_bf16 v[36:39], a[148:151], v[56:59], v[36:39]
  v_fma_f32 v50, -v91, v78, v50
  v_fma_f32 v51, -v91, v79, v51
  v_mfma_f32_16x16x32_bf16 v[40:43], a[152:155], v[56:59], v[40:43]
  s_waitcnt lgkmcnt(2)
  global_load_dwordx4 v[190:193], v11, s[24:25] offset:3072 sc1
  v_mfma_f32_16x16x32_bf16 v[32:35], a[156:159], v[60:63], v[32:35]
  s_add_u32 s89, s89, 4096
  ds_read_b128 v[56:59], v12 offset:36864
  v_fma_f32 v52, -v91, v80, v52
  v_mfma_f32_16x16x32_bf16 v[36:39], a[160:163], v[60:63], v[36:39]
  s_add_u32 s24, s60, s89
  s_addc_u32 s25, s61, 0
  v_fma_f32 v53, -v91, v81, v53
  v_fma_f32 v54, -v91, v82, v54
  v_mfma_f32_16x16x32_bf16 v[40:43], a[164:167], v[60:63], v[40:43]
  s_waitcnt lgkmcnt(2)
  v_fma_f32 v55, -v91, v83, v55
  v_mul_f32 v116, v44, v124
  v_mfma_f32_16x16x32_bf16 v[32:35], a[168:171], v[64:67], v[32:35]
  ds_read_b128 v[60:63], v12 offset:37888
  v_mul_f32 v117, v45, v124
  v_mfma_f32_16x16x32_bf16 v[36:39], a[172:175], v[64:67], v[36:39]
  global_load_dwordx4 v[194:197], v11, s[24:25] offset:0 sc1
  v_mfma_f32_16x16x32_bf16 v[40:43], a[176:179], v[64:67], v[40:43]
  s_waitcnt lgkmcnt(2)
  v_mul_f32 v118, v46, v124
  v_mul_f32 v119, v47, v124
  v_mfma_f32_16x16x32_bf16 v[32:35], a[180:183], v[68:71], v[32:35]
  ds_read_b128 v[64:67], v12 offset:38912
  v_mul_f32 v120, v48, v125
  v_mfma_f32_16x16x32_bf16 v[36:39], a[184:187], v[68:71], v[36:39]
  v_mul_f32 v121, v49, v125
  v_mul_f32 v122, v50, v125
  v_mfma_f32_16x16x32_bf16 v[40:43], a[188:191], v[68:71], v[40:43]
  global_load_dwordx4 v[198:201], v11, s[24:25] offset:1024 sc1
  s_barrier
  s_waitcnt lgkmcnt(2)
  v_mfma_f32_16x16x32_bf16 v[32:35], a[192:195], v[56:59], v[32:35]
  ds_read_b128 v[68:71], v12 offset:39936
  v_mul_f32 v123, v51, v125
  v_mfma_f32_16x16x32_bf16 v[36:39], a[196:199], v[56:59], v[36:39]
  s_add_u32 m0, s13, 0
  v_mul_f32 v104, v52, v126
  v_mul_f32 v105, v53, v126
  v_mfma_f32_16x16x32_bf16 v[40:43], a[200:203], v[56:59], v[40:43]
  s_waitcnt lgkmcnt(2)
  v_mul_f32 v106, v54, v126
  v_mul_f32 v107, v55, v126
  v_mfma_f32_16x16x32_bf16 v[32:35], a[204:207], v[60:63], v[32:35]
  ds_read_b128 v[56:59], v11 offset:0
  v_mfma_f32_16x16x32_bf16 v[36:39], a[208:211], v[60:63], v[36:39]
  buffer_load_dwordx4 v11, s[60:63], s14 offen offset:0 sc1 lds
  v_mfma_f32_16x16x32_bf16 v[40:43], a[212:215], v[60:63], v[40:43]
  s_waitcnt lgkmcnt(2)
  v_exp_f32 v124, v116
  v_mfma_f32_16x16x32_bf16 v[32:35], a[216:219], v[64:67], v[32:35]
  ds_read_b128 v[60:63], v11 offset:1024
  v_mfma_f32_16x16x32_bf16 v[36:39], a[220:223], v[64:67], v[36:39]
  v_exp_f32 v125, v117
  v_mfma_f32_16x16x32_bf16 v[40:43], a[224:227], v[64:67], v[40:43]
  s_waitcnt lgkmcnt(2)
  buffer_load_dwordx4 v11, s[60:63], s14 offen offset:1024 sc1 lds
  v_mfma_f32_16x16x32_bf16 v[32:35], a[228:231], v[68:71], v[32:35]
  ds_read_b128 v[64:67], v11 offset:2048
  v_mfma_f32_16x16x32_bf16 v[36:39], a[232:235], v[68:71], v[36:39]
  v_exp_f32 v126, v118
  v_mfma_f32_16x16x32_bf16 v[40:43], a[236:239], v[68:71], v[40:43]
  s_waitcnt lgkmcnt(2)
  v_exp_f32 v127, v119
  v_mfma_f32_16x16x32_bf16 v[44:47], a[0:3], v[56:59], 0
  ds_read_b128 v[68:71], v11 offset:3072
  v_mul_f32 v116, v116, v120
  v_mfma_f32_16x16x32_bf16 v[48:51], a[4:7], v[56:59], 0
  buffer_load_dwordx4 v11, s[60:63], s14 offen offset:2048 sc1 lds
  v_mfma_f32_16x16x32_bf16 v[52:55], a[8:11], v[56:59], 0
  s_waitcnt lgkmcnt(2)
  v_mul_f32 v117, v117, v121
  v_mul_f32 v118, v118, v122
  v_mfma_f32_16x16x32_bf16 v[44:47], a[12:15], v[60:63], v[44:47]
  ds_read_b128 v[56:59], v11 offset:4096
  v_mul_f32 v119, v119, v123
  v_mfma_f32_16x16x32_bf16 v[48:51], a[16:19], v[60:63], v[48:51]
  v_add_f32 v124, 1.0, v124
  v_add_f32 v125, 1.0, v125
  v_mfma_f32_16x16x32_bf16 v[52:55], a[20:23], v[60:63], v[52:55]
  s_waitcnt lgkmcnt(2)
  buffer_load_dwordx4 v11, s[60:63], s14 offen offset:3072 sc1 lds
  v_mfma_f32_16x16x32_bf16 v[44:47], a[24:27], v[64:67], v[44:47]
  s_add_u32 s14, s14, 4096
  ds_read_b128 v[60:63], v11 offset:5120
  v_add_f32 v126, 1.0, v126
  v_mfma_f32_16x16x32_bf16 v[48:51], a[28:31], v[64:67], v[48:51]
  s_add_u32 m0, s13, 4096
  v_add_f32 v127, 1.0, v127
  v_mfma_f32_16x16x32_bf16 v[52:55], a[32:35], v[64:67], v[52:55]
  s_waitcnt lgkmcnt(2)
  v_rcp_f32 v124, v124
  v_mfma_f32_16x16x32_bf16 v[44:47], a[36:39], v[68:71], v[44:47]
  ds_read_b128 v[64:67], v11 offset:6144
  v_mfma_f32_16x16x32_bf16 v[48:51], a[40:43], v[68:71], v[48:51]
  buffer_load_dwordx4 v11, s[60:63], s14 offen offset:0 sc1 lds
  v_mfma_f32_16x16x32_bf16 v[52:55], a[44:47], v[68:71], v[52:55]
  s_waitcnt lgkmcnt(2)
  v_rcp_f32 v125, v125
  v_mfma_f32_16x16x32_bf16 v[44:47], a[48:51], v[56:59], v[44:47]
  s_add_u32 s14, s14, 1024
  ds_read_b128 v[68:71], v11 offset:7168
  v_mfma_f32_16x16x32_bf16 v[48:51], a[52:55], v[56:59], v[48:51]
  v_rcp_f32 v126, v126
  v_mfma_f32_16x16x32_bf16 v[52:55], a[56:59], v[56:59], v[52:55]
  s_waitcnt lgkmcnt(2)
  global_load_dwordx4 v[202:205], v11, s[24:25] offset:2048 sc1
  v_mfma_f32_16x16x32_bf16 v[44:47], a[60:63], v[60:63], v[44:47]
  ds_read_b128 v[56:59], v11 offset:8192
  v_mfma_f32_16x16x32_bf16 v[48:51], a[64:67], v[60:63], v[48:51]
  v_rcp_f32 v127, v127
  v_mfma_f32_16x16x32_bf16 v[52:55], a[68:71], v[60:63], v[52:55]
  s_waitcnt lgkmcnt(2)
  v_mul_f32 v116, v116, v124
  v_mul_f32 v117, v117, v125
  v_mfma_f32_16x16x32_bf16 v[44:47], a[72:75], v[64:67], v[44:47]
  ds_read_b128 v[60:63], v11 offset:9216
  v_mul_f32 v118, v118, v126
  v_mfma_f32_16x16x32_bf16 v[48:51], a[76:79], v[64:67], v[48:51]
  global_load_dwordx4 v[206:209], v11, s[24:25] offset:3072 sc1
  v_mfma_f32_16x16x32_bf16 v[52:55], a[80:83], v[64:67], v[52:55]
  s_waitcnt lgkmcnt(2)
  v_mul_f32 v119, v119, v127
  v_cvt_pk_bf16_f32 v110, v116, v117
  v_mfma_f32_16x16x32_bf16 v[44:47], a[84:87], v[68:71], v[44:47]
  s_add_u32 s89, s89, 4096
  ds_read_b128 v[64:67], v11 offset:10240
  v_cvt_pk_bf16_f32 v111, v118, v119
  v_mfma_f32_16x16x32_bf16 v[48:51], a[88:91], v[68:71], v[48:51]
  s_add_u32 s24, s60, s89
  s_addc_u32 s25, s61, 0
  v_permlane32_swap_b32 v100, v104
  v_mfma_f32_16x16x32_bf16 v[52:55], a[92:95], v[68:71], v[52:55]
  s_waitcnt lgkmcnt(2)
  global_load_dwordx4 v[210:213], v11, s[24:25] offset:0 sc1
  v_mfma_f32_16x16x32_bf16 v[44:47], a[96:99], v[56:59], v[44:47]
  ds_read_b128 v[68:71], v11 offset:11264
  v_mfma_f32_16x16x32_bf16 v[48:51], a[100:103], v[56:59], v[48:51]
  v_permlane32_swap_b32 v101, v105
  v_mfma_f32_16x16x32_bf16 v[52:55], a[104:107], v[56:59], v[52:55]
  s_waitcnt lgkmcnt(2)
  v_permlane32_swap_b32 v102, v106
  v_mfma_f32_16x16x32_bf16 v[44:47], a[108:111], v[60:63], v[44:47]
  ds_read_b128 v[56:59], v11 offset:12288
  v_mfma_f32_16x16x32_bf16 v[48:51], a[112:115], v[60:63], v[48:51]
  global_load_dwordx4 v[214:217], v11, s[24:25] offset:1024 sc1
  v_mfma_f32_16x16x32_bf16 v[52:55], a[116:119], v[60:63], v[52:55]
  s_waitcnt lgkmcnt(2)
  v_permlane32_swap_b32 v103, v107
  v_mfma_f32_16x16x32_bf16 v[44:47], a[120:123], v[64:67], v[44:47]
  ds_read_b128 v[60:63], v11 offset:13312
  v_mfma_f32_16x16x32_bf16 v[48:51], a[124:127], v[64:67], v[48:51]
  v_permlane16_swap_b32 v108, v110
  v_mfma_f32_16x16x32_bf16 v[52:55], a[128:131], v[64:67], v[52:55]
  s_waitcnt lgkmcnt(2)
  global_load_dwordx4 v[218:221], v11, s[24:25] offset:2048 sc1
  v_mfma_f32_16x16x32_bf16 v[44:47], a[132:135], v[68:71], v[44:47]
  ds_read_b128 v[64:67], v11 offset:14336
  v_mfma_f32_16x16x32_bf16 v[48:51], a[136:139], v[68:71], v[48:51]
  v_permlane16_swap_b32 v109, v111
  v_mfma_f32_16x16x32_bf16 v[52:55], a[140:143], v[68:71], v[52:55]
  s_waitcnt lgkmcnt(2)
  v_mfma_f32_16x16x32_bf16 v[44:47], a[144:147], v[56:59], v[44:47]
  s_mov_b32 s92, 98304
  ds_read_b128 v[68:71], v11 offset:15360
  v_mfma_f32_16x16x32_bf16 v[48:51], a[148:151], v[56:59], v[48:51]
  global_load_dwordx4 v[222:225], v11, s[24:25] offset:3072 sc1
  v_mfma_f32_16x16x32_bf16 v[52:55], a[152:155], v[56:59], v[52:55]
  s_waitcnt lgkmcnt(2)
  buffer_store_dwordx4 v[108:111], v13, s[60:63], s92 offen sc1
  v_mfma_f32_16x16x32_bf16 v[44:47], a[156:159], v[60:63], v[44:47]
  s_add_u32 s89, s89, 4096
  ds_read_b128 v[56:59], v11 offset:16384
  v_mfma_f32_16x16x32_bf16 v[48:51], a[160:163], v[60:63], v[48:51]
  s_add_u32 s24, s60, s89
  s_addc_u32 s25, s61, 0
  v_exp_f32 v124, v100
  v_mfma_f32_16x16x32_bf16 v[52:55], a[164:167], v[60:63], v[52:55]
  s_waitcnt lgkmcnt(2)
  v_exp_f32 v125, v101
  v_mfma_f32_16x16x32_bf16 v[44:47], a[168:171], v[64:67], v[44:47]
  ds_read_b128 v[60:63], v11 offset:17408
  v_mfma_f32_16x16x32_bf16 v[48:51], a[172:175], v[64:67], v[48:51]
  global_load_dwordx4 v[226:229], v11, s[24:25] offset:0 sc1
  v_mfma_f32_16x16x32_bf16 v[52:55], a[176:179], v[64:67], v[52:55]
  s_waitcnt lgkmcnt(2)
  v_exp_f32 v126, v102
  v_mfma_f32_16x16x32_bf16 v[44:47], a[180:183], v[68:71], v[44:47]
  ds_read_b128 v[64:67], v11 offset:18432
  v_mfma_f32_16x16x32_bf16 v[48:51], a[184:187], v[68:71], v[48:51]
  v_exp_f32 v127, v103
  v_mfma_f32_16x16x32_bf16 v[52:55], a[188:191], v[68:71], v[52:55]
  global_load_dwordx4 v[230:233], v11, s[24:25] offset:1024 sc1
  s_barrier
  s_waitcnt lgkmcnt(2)
  v_mfma_f32_16x16x32_bf16 v[44:47], a[192:195], v[56:59], v[44:47]
  ds_read_b128 v[68:71], v11 offset:19456
  v_mul_f32 v100, v100, v104
  v_mfma_f32_16x16x32_bf16 v[48:51], a[196:199], v[56:59], v[48:51]
  s_add_u32 m0, s13, 5120
  v_mul_f32 v101, v101, v105
  v_mul_f32 v102, v102, v106
  v_mfma_f32_16x16x32_bf16 v[52:55], a[200:203], v[56:59], v[52:55]
  s_waitcnt lgkmcnt(2)
  v_mul_f32 v103, v103, v107
  v_add_f32 v124, 1.0, v124
  v_mfma_f32_16x16x32_bf16 v[44:47], a[204:207], v[60:63], v[44:47]
  ds_read_b128 v[56:59], v11 offset:20480
  v_add_f32 v125, 1.0, v125
  v_mfma_f32_16x16x32_bf16 v[48:51], a[208:211], v[60:63], v[48:51]
  buffer_load_dwordx4 v11, s[60:63], s14 offen offset:0 sc1 lds
  v_mfma_f32_16x16x32_bf16 v[52:55], a[212:215], v[60:63], v[52:55]
  s_waitcnt lgkmcnt(2)
  v_add_f32 v126, 1.0, v126
  v_add_f32 v127, 1.0, v127
  v_mfma_f32_16x16x32_bf16 v[44:47], a[216:219], v[64:67], v[44:47]
  ds_read_b128 v[60:63], v11 offset:21504
  v_mfma_f32_16x16x32_bf16 v[48:51], a[220:223], v[64:67], v[48:51]
  v_rcp_f32 v124, v124
  v_mfma_f32_16x16x32_bf16 v[52:55], a[224:227], v[64:67], v[52:55]
  s_waitcnt lgkmcnt(2)
  buffer_load_dwordx4 v11, s[60:63], s14 offen offset:1024 sc1 lds
  v_mfma_f32_16x16x32_bf16 v[44:47], a[228:231], v[68:71], v[44:47]
  ds_read_b128 v[64:67], v11 offset:22528
  v_mfma_f32_16x16x32_bf16 v[48:51], a[232:235], v[68:71], v[48:51]
  v_rcp_f32 v125, v125
  v_mfma_f32_16x16x32_bf16 v[52:55], a[236:239], v[68:71], v[52:55]
  v_rcp_f32 v126, v126
  v_rcp_f32 v127, v127
  v_mul_f32 v100, v100, v124
  v_mul_f32 v101, v101, v125
  v_mul_f32 v102, v102, v126
  v_mul_f32 v103, v103, v127
  v_cvt_pk_bf16_f32 v112, v100, v101
  v_cvt_pk_bf16_f32 v113, v102, v103
  buffer_store_dwordx2 v[112:113], v14, s[60:63], s92 offen sc1
  v_mul_f32 v124, s19, v92
  v_mul_f32 v125, s18, v92
  v_mul_f32 v126, v16, v92
  v_fma_f32 v32, -v93, v72, v32
  v_fma_f32 v33, -v93, v73, v33
  v_fma_f32 v34, -v93, v74, v34
  v_fma_f32 v35, -v93, v75, v35
  v_fma_f32 v36, -v93, v76, v36
  v_fma_f32 v37, -v93, v77, v37
  v_fma_f32 v38, -v93, v78, v38
  v_fma_f32 v39, -v93, v79, v39
  v_fma_f32 v40, -v93, v80, v40
  v_fma_f32 v41, -v93, v81, v41
  v_fma_f32 v42, -v93, v82, v42
  v_fma_f32 v43, -v93, v83, v43
  v_mul_f32 v116, v32, v124
  v_mul_f32 v117, v33, v124
  v_mul_f32 v118, v34, v124
  v_mul_f32 v119, v35, v124
  v_mul_f32 v120, v36, v125
  v_mul_f32 v121, v37, v125
  v_mul_f32 v122, v38, v125
  v_mul_f32 v123, v39, v125
  v_mul_f32 v100, v40, v126
  v_mul_f32 v101, v41, v126
  v_mul_f32 v102, v42, v126
  v_mul_f32 v103, v43, v126
  s_waitcnt lgkmcnt(2)
  v_mfma_f32_16x16x32_bf16 v[32:35], a[0:3], v[56:59], 0
  ds_read_b128 v[68:71], v11 offset:23552
  v_mfma_f32_16x16x32_bf16 v[36:39], a[4:7], v[56:59], 0
  buffer_load_dwordx4 v11, s[60:63], s14 offen offset:2048 sc1 lds
  v_mfma_f32_16x16x32_bf16 v[40:43], a[8:11], v[56:59], 0
  s_waitcnt lgkmcnt(2)
  v_exp_f32 v124, v116
  v_mfma_f32_16x16x32_bf16 v[32:35], a[12:15], v[60:63], v[32:35]
  ds_read_b128 v[56:59], v11 offset:24576
  v_mfma_f32_16x16x32_bf16 v[36:39], a[16:19], v[60:63], v[36:39]
  v_exp_f32 v125, v117
  v_mfma_f32_16x16x32_bf16 v[40:43], a[20:23], v[60:63], v[40:43]
  s_waitcnt lgkmcnt(2)
  buffer_load_dwordx4 v11, s[60:63], s14 offen offset:3072 sc1 lds
  v_mfma_f32_16x16x32_bf16 v[32:35], a[24:27], v[64:67], v[32:35]
  s_add_u32 s14, s14, 4096
  ds_read_b128 v[60:63], v11 offset:25600
  v_mfma_f32_16x16x32_bf16 v[36:39], a[28:31], v[64:67], v[36:39]
  s_add_u32 m0, s13, 9216
  v_exp_f32 v126, v118
  v_mfma_f32_16x16x32_bf16 v[40:43], a[32:35], v[64:67], v[40:43]
  s_waitcnt lgkmcnt(2)
  v_exp_f32 v127, v119
  v_mfma_f32_16x16x32_bf16 v[32:35], a[36:39], v[68:71], v[32:35]
  ds_read_b128 v[64:67], v11 offset:26624
  v_mul_f32 v116, v116, v120
  v_mfma_f32_16x16x32_bf16 v[36:39], a[40:43], v[68:71], v[36:39]
  buffer_load_dwordx4 v11, s[60:63], s14 offen offset:0 sc1 lds
  v_mfma_f32_16x16x32_bf16 v[40:43], a[44:47], v[68:71], v[40:43]
  s_waitcnt lgkmcnt(2)
  v_mul_f32 v117, v117, v121
  v_mul_f32 v118, v118, v122
  v_mfma_f32_16x16x32_bf16 v[32:35], a[48:51], v[56:59], v[32:35]
  s_add_u32 s14, s14, 1024
  ds_read_b128 v[68:71], v11 offset:27648
  v_mul_f32 v119, v119, v123
  v_mfma_f32_16x16x32_bf16 v[36:39], a[52:55], v[56:59], v[36:39]
  v_add_f32 v124, 1.0, v124
  v_add_f32 v125, 1.0, v125
  v_mfma_f32_16x16x32_bf16 v[40:43], a[56:59], v[56:59], v[40:43]
  s_waitcnt lgkmcnt(2)
  global_load_dwordx4 v[234:237], v11, s[24:25] offset:2048 sc1
  v_mfma_f32_16x16x32_bf16 v[32:35], a[60:63], v[60:63], v[32:35]
  ds_read_b128 v[56:59], v11 offset:28672
  v_add_f32 v126, 1.0, v126
  v_mfma_f32_16x16x32_bf16 v[36:39], a[64:67], v[60:63], v[36:39]
  v_add_f32 v127, 1.0, v127
  v_mfma_f32_16x16x32_bf16 v[40:43], a[68:71], v[60:63], v[40:43]
  s_waitcnt lgkmcnt(2)
  v_rcp_f32 v124, v124
  v_mfma_f32_16x16x32_bf16 v[32:35], a[72:75], v[64:67], v[32:35]
  ds_read_b128 v[60:63], v11 offset:29696
  v_mfma_f32_16x16x32_bf16 v[36:39], a[76:79], v[64:67], v[36:39]
  global_load_dwordx4 v[238:241], v11, s[24:25] offset:3072 sc1
  v_mfma_f32_16x16x32_bf16 v[40:43], a[80:83], v[64:67], v[40:43]
  s_waitcnt lgkmcnt(2)
  v_rcp_f32 v125, v125
  v_mfma_f32_16x16x32_bf16 v[32:35], a[84:87], v[68:71], v[32:35]
  s_add_u32 s89, s89, 4096
  ds_read_b128 v[64:67], v11 offset:30720
  v_mfma_f32_16x16x32_bf16 v[36:39], a[88:91], v[68:71], v[36:39]
  s_add_u32 s24, s60, s89
  s_addc_u32 s25, s61, 0
  v_rcp_f32 v126, v126
  v_mfma_f32_16x16x32_bf16 v[40:43], a[92:95], v[68:71], v[40:43]
  s_waitcnt lgkmcnt(2)
  global_load_dwordx4 v[242:245], v11, s[24:25] offset:0 sc1
  v_mfma_f32_16x16x32_bf16 v[32:35], a[96:99], v[56:59], v[32:35]
  ds_read_b128 v[68:71], v11 offset:31744
  v_mfma_f32_16x16x32_bf16 v[36:39], a[100:103], v[56:59], v[36:39]
  v_rcp_f32 v127, v127
  v_mfma_f32_16x16x32_bf16 v[40:43], a[104:107], v[56:59], v[40:43]
  s_waitcnt lgkmcnt(2)
  v_mul_f32 v116, v116, v124
  v_mul_f32 v117, v117, v125
  v_mfma_f32_16x16x32_bf16 v[32:35], a[108:111], v[60:63], v[32:35]
  ds_read_b128 v[56:59], v11 offset:32768
  v_mul_f32 v118, v118, v126
  v_mfma_f32_16x16x32_bf16 v[36:39], a[112:115], v[60:63], v[36:39]
  global_load_dwordx4 v[246:249], v11, s[24:25] offset:1024 sc1
  v_mfma_f32_16x16x32_bf16 v[40:43], a[116:119], v[60:63], v[40:43]
  s_waitcnt lgkmcnt(2)
  v_mul_f32 v119, v119, v127
  v_cvt_pk_bf16_f32 v108, v116, v117
  v_mfma_f32_16x16x32_bf16 v[32:35], a[120:123], v[64:67], v[32:35]
  s_waitcnt vmcnt(7)
  ds_read_b128 v[60:63], v11 offset:33792
  v_cvt_pk_bf16_f32 v109, v118, v119
  v_mfma_f32_16x16x32_bf16 v[36:39], a[124:127], v[64:67], v[36:39]
  buffer_store_dword v19, v15, s[60:63], 0 offen offset:1024 sc1
  v_mfma_f32_16x16x32_bf16 v[40:43], a[128:131], v[64:67], v[40:43]
  s_waitcnt lgkmcnt(2)
  v_mul_f32 v124, s19, v94
  v_mul_f32 v125, s18, v94
  v_mfma_f32_16x16x32_bf16 v[32:35], a[132:135], v[68:71], v[32:35]
  ds_read_b128 v[64:67], v11 offset:34816
  v_mul_f32 v126, v16, v94
  v_mfma_f32_16x16x32_bf16 v[36:39], a[136:139], v[68:71], v[36:39]
  v_fma_f32 v44, -v95, v72, v44
  v_fma_f32 v45, -v95, v73, v45
  v_mfma_f32_16x16x32_bf16 v[40:43], a[140:143], v[68:71], v[40:43]
  s_waitcnt lgkmcnt(2)
  buffer_load_dword v26, v27, s[60:63], 0 offen offset:0 sc1
  v_mfma_f32_16x16x32_bf16 v[32:35], a[144:147], v[56:59], v[32:35]
  ds_read_b128 v[68:71], v11 offset:35840
  v_fma_f32 v46, -v95, v74, v46
  v_mfma_f32_16x16x32_bf16 v[36:39], a[148:151], v[56:59], v[36:39]
  v_fma_f32 v47, -v95, v75, v47
  v_fma_f32 v48, -v95, v76, v48
  v_mfma_f32_16x16x32_bf16 v[40:43], a[152:155], v[56:59], v[40:43]
  s_waitcnt lgkmcnt(2)
  v_fma_f32 v49, -v95, v77, v49
  v_fma_f32 v50, -v95, v78, v50
  v_mfma_f32_16x16x32_bf16 v[32:35], a[156:159], v[60:63], v[32:35]
  ds_read_b128 v[56:59], v11 offset:36864
  v_fma_f32 v51, -v95, v79, v51
  v_mfma_f32_16x16x32_bf16 v[36:39], a[160:163], v[60:63], v[36:39]
  v_fma_f32 v52, -v95, v80, v52
  v_fma_f32 v53, -v95, v81, v53
  v_mfma_f32_16x16x32_bf16 v[40:43], a[164:167], v[60:63], v[40:43]
  s_waitcnt lgkmcnt(2)
  v_fma_f32 v54, -v95, v82, v54
  v_fma_f32 v55, -v95, v83, v55
  v_mfma_f32_16x16x32_bf16 v[32:35], a[168:171], v[64:67], v[32:35]
  ds_read_b128 v[60:63], v11 offset:37888
  v_mul_f32 v116, v44, v124
  v_mfma_f32_16x16x32_bf16 v[36:39], a[172:175], v[64:67], v[36:39]
  v_mul_f32 v117, v45, v124
  v_mul_f32 v118, v46, v124
  v_mfma_f32_16x16x32_bf16 v[40:43], a[176:179], v[64:67], v[40:43]
  s_waitcnt lgkmcnt(2)
  v_mul_f32 v119, v47, v124
  v_mul_f32 v120, v48, v125
  v_mfma_f32_16x16x32_bf16 v[32:35], a[180:183], v[68:71], v[32:35]
  ds_read_b128 v[64:67], v11 offset:38912
  v_mul_f32 v121, v49, v125
  v_mfma_f32_16x16x32_bf16 v[36:39], a[184:187], v[68:71], v[36:39]
  v_mul_f32 v122, v50, v125
  v_mul_f32 v123, v51, v125
  v_mfma_f32_16x16x32_bf16 v[40:43], a[188:191], v[68:71], v[40:43]
  v_mul_f32 v104, v52, v126
  v_mul_f32 v105, v53, v126
  s_barrier
  s_waitcnt lgkmcnt(2)
  v_mfma_f32_16x16x32_bf16 v[32:35], a[192:195], v[56:59], v[32:35]
  ds_read_b128 v[68:71], v11 offset:39936
  v_mul_f32 v106, v54, v126
  v_mfma_f32_16x16x32_bf16 v[36:39], a[196:199], v[56:59], v[36:39]
  s_add_u32 m0, s88, 0
  v_mul_f32 v107, v55, v126
  v_mfma_f32_16x16x32_bf16 v[40:43], a[200:203], v[56:59], v[40:43]
  s_waitcnt lgkmcnt(2)
  buffer_load_dwordx4 v11, s[60:63], s14 offen offset:0 sc1 lds
  v_mfma_f32_16x16x32_bf16 v[32:35], a[204:207], v[60:63], v[32:35]
  ds_read_b128 v[56:59], v11 offset:40960
  v_mfma_f32_16x16x32_bf16 v[36:39], a[208:211], v[60:63], v[36:39]
  v_exp_f32 v124, v116
  v_mfma_f32_16x16x32_bf16 v[40:43], a[212:215], v[60:63], v[40:43]
  s_waitcnt lgkmcnt(2)
  v_exp_f32 v125, v117
  v_mfma_f32_16x16x32_bf16 v[32:35], a[216:219], v[64:67], v[32:35]
  ds_read_b128 v[60:63], v11 offset:41984
  v_mfma_f32_16x16x32_bf16 v[36:39], a[220:223], v[64:67], v[36:39]
  buffer_load_dwordx4 v11, s[60:63], s14 offen offset:1024 sc1 lds
  v_mfma_f32_16x16x32_bf16 v[40:43], a[224:227], v[64:67], v[40:43]
  s_waitcnt lgkmcnt(2)
  v_exp_f32 v126, v118
  v_mfma_f32_16x16x32_bf16 v[32:35], a[228:231], v[68:71], v[32:35]
  ds_read_b128 v[64:67], v11 offset:43008
  v_mfma_f32_16x16x32_bf16 v[36:39], a[232:235], v[68:71], v[36:39]
  v_exp_f32 v127, v119
  v_mfma_f32_16x16x32_bf16 v[40:43], a[236:239], v[68:71], v[40:43]
  s_waitcnt lgkmcnt(2)
  buffer_load_dwordx4 v11, s[60:63], s14 offen offset:2048 sc1 lds
  v_mfma_f32_16x16x32_bf16 v[44:47], a[0:3], v[56:59], 0
  ds_read_b128 v[68:71], v11 offset:44032
  s_waitcnt vmcnt(3)
  v_cmp_ne_u32 vcc, v26, v19
  v_mfma_f32_16x16x32_bf16 v[48:51], a[4:7], v[56:59], 0
  v_mul_f32 v116, v116, v120
  v_mul_f32 v117, v117, v121
  v_mfma_f32_16x16x32_bf16 v[52:55], a[8:11], v[56:59], 0
  s_waitcnt lgkmcnt(2)
  buffer_load_dwordx4 v11, s[60:63], s14 offen offset:3072 sc1 lds
  v_mfma_f32_16x16x32_bf16 v[44:47], a[12:15], v[60:63], v[44:47]
  s_cbranch_vccnz L_g01G
L_g01G_back:
  ds_read_b128 v[56:59], v11 offset:45056
  v_mul_f32 v118, v118, v122
  v_mfma_f32_16x16x32_bf16 v[48:51], a[16:19], v[60:63], v[48:51]
  s_add_u32 s22, s60, s9
  s_addc_u32 s23, s61, 0
  v_mul_f32 v119, v119, v123
  v_add_f32 v124, 1.0, v124
  v_mfma_f32_16x16x32_bf16 v[52:55], a[20:23], v[60:63], v[52:55]
  s_waitcnt lgkmcnt(2)
  global_load_dwordx4 a[240:243], v11, s[22:23] offset:0 sc1
  v_mfma_f32_16x16x32_bf16 v[44:47], a[24:27], v[64:67], v[44:47]
  s_add_u32 s14, s14, 4096
  ds_read_b128 v[60:63], v11 offset:46080
  v_add_f32 v125, 1.0, v125
  v_mfma_f32_16x16x32_bf16 v[48:51], a[28:31], v[64:67], v[48:51]
  s_add_u32 m0, s88, 4096
  v_add_f32 v126, 1.0, v126
  v_add_f32 v127, 1.0, v127
  v_mfma_f32_16x16x32_bf16 v[52:55], a[32:35], v[64:67], v[52:55]
  s_waitcnt lgkmcnt(2)
  buffer_load_dwordx4 v11, s[60:63], s14 offen offset:0 sc1 lds
  v_mfma_f32_16x16x32_bf16 v[44:47], a[36:39], v[68:71], v[44:47]
  s_add_u32 s14, s14, 1024
  ds_read_b128 v[64:67], v11 offset:47104
  v_mfma_f32_16x16x32_bf16 v[48:51], a[40:43], v[68:71], v[48:51]
  v_rcp_f32 v124, v124
  v_mfma_f32_16x16x32_bf16 v[52:55], a[44:47], v[68:71], v[52:55]
  s_waitcnt lgkmcnt(2)
  global_load_dwordx4 a[244:247], v11, s[22:23] offset:1024 sc1
  v_mfma_f32_16x16x32_bf16 v[44:47], a[48:51], v[56:59], v[44:47]
  ds_read_b128 v[68:71], v11 offset:48128
  v_mfma_f32_16x16x32_bf16 v[48:51], a[52:55], v[56:59], v[48:51]
  v_rcp_f32 v125, v125
  v_mfma_f32_16x16x32_bf16 v[52:55], a[56:59], v[56:59], v[52:55]
  s_waitcnt lgkmcnt(2)
  global_load_dwordx4 a[248:251], v11, s[22:23] offset:2048 sc1
  v_mfma_f32_16x16x32_bf16 v[44:47], a[60:63], v[60:63], v[44:47]
  ds_read_b128 v[56:59], v11 offset:49152
  v_mfma_f32_16x16x32_bf16 v[48:51], a[64:67], v[60:63], v[48:51]
  v_rcp_f32 v126, v126
  v_mfma_f32_16x16x32_bf16 v[52:55], a[68:71], v[60:63], v[52:55]
  s_waitcnt lgkmcnt(2)
  global_load_dwordx4 a[0:3], v11, s[22:23] offset:3072 sc1
  v_mfma_f32_16x16x32_bf16 v[44:47], a[72:75], v[64:67], v[44:47]
  s_add_u32 s9, s9, 4096
  ds_read_b128 v[60:63], v11 offset:50176
  v_mfma_f32_16x16x32_bf16 v[48:51], a[76:79], v[64:67], v[48:51]
  s_add_u32 s22, s60, s9
  s_addc_u32 s23, s61, 0
  v_rcp_f32 v127, v127
  v_mfma_f32_16x16x32_bf16 v[52:55], a[80:83], v[64:67], v[52:55]
  s_waitcnt lgkmcnt(2)
  global_load_dwordx4 a[4:7], v11, s[22:23] offset:0 sc1
  v_mfma_f32_16x16x32_bf16 v[44:47], a[84:87], v[68:71], v[44:47]
  ds_read_b128 v[64:67], v11 offset:51200
  v_mul_f32 v116, v116, v124
  v_mfma_f32_16x16x32_bf16 v[48:51], a[88:91], v[68:71], v[48:51]
  v_mul_f32 v117, v117, v125
  v_mul_f32 v118, v118, v126
  v_mfma_f32_16x16x32_bf16 v[52:55], a[92:95], v[68:71], v[52:55]
  s_waitcnt lgkmcnt(2)
  global_load_dwordx4 a[8:11], v11, s[22:23] offset:1024 sc1
  v_mfma_f32_16x16x32_bf16 v[44:47], a[96:99], v[56:59], v[44:47]
  ds_read_b128 v[68:71], v11 offset:52224
  ds_read_b128 a[84:87], v4 offset:0
  v_mfma_f32_16x16x32_bf16 v[48:51], a[100:103], v[56:59], v[48:51]
  ds_read_b128 a[88:91], v4 offset:1024
  ds_read_b128 a[92:95], v4 offset:2048
  v_mfma_f32_16x16x32_bf16 v[52:55], a[104:107], v[56:59], v[52:55]
  s_waitcnt lgkmcnt(5)
  global_load_dwordx4 a[12:15], v11, s[22:23] offset:2048 sc1
  v_mfma_f32_16x16x32_bf16 v[44:47], a[108:111], v[60:63], v[44:47]
  ds_read_b128 v[56:59], v11 offset:53248
  ds_read_b128 a[96:99], v4 offset:3072
  v_mfma_f32_16x16x32_bf16 v[48:51], a[112:115], v[60:63], v[48:51]
  ds_read_b128 a[100:103], v4 offset:4096
  ds_read_b128 a[104:107], v4 offset:5120
  v_mfma_f32_16x16x32_bf16 v[52:55], a[116:119], v[60:63], v[52:55]
  s_waitcnt lgkmcnt(8)
  global_load_dwordx4 a[16:19], v11, s[22:23] offset:3072 sc1
  v_mfma_f32_16x16x32_bf16 v[44:47], a[120:123], v[64:67], v[44:47]
  s_add_u32 s9, s9, 4096
  ds_read_b128 v[60:63], v11 offset:54272
  ds_read_b128 a[108:111], v4 offset:6144
  v_mfma_f32_16x16x32_bf16 v[48:51], a[124:127], v[64:67], v[48:51]
  s_add_u32 s22, s60, s9
  s_addc_u32 s23, s61, 0
  ds_read_b128 a[112:115], v4 offset:7168
  ds_read_b128 a[116:119], v4 offset:8192
  v_mfma_f32_16x16x32_bf16 v[52:55], a[128:131], v[64:67], v[52:55]
  s_waitcnt lgkmcnt(11)
  global_load_dwordx4 a[20:23], v11, s[22:23] offset:0 sc1
  v_mfma_f32_16x16x32_bf16 v[44:47], a[132:135], v[68:71], v[44:47]
  ds_read_b128 v[64:67], v11 offset:55296
  ds_read_b128 a[120:123], v4 offset:9216
  v_mfma_f32_16x16x32_bf16 v[48:51], a[136:139], v[68:71], v[48:51]
  ds_read_b128 a[124:127], v4 offset:10240
  s_waitcnt lgkmcnt(13)
  ds_read_b128 a[128:131], v4 offset:11264
  v_mfma_f32_16x16x32_bf16 v[52:55], a[140:143], v[68:71], v[52:55]
  s_waitcnt lgkmcnt(11)
  global_load_dwordx4 a[24:27], v11, s[22:23] offset:1024 sc1
  v_mfma_f32_16x16x32_bf16 v[44:47], a[144:147], v[56:59], v[44:47]
  ds_read_b128 v[68:71], v11 offset:56320
  ds_read_b128 a[132:135], v4 offset:12288
  v_mfma_f32_16x16x32_bf16 v[48:51], a[148:151], v[56:59], v[48:51]
  ds_read_b128 a[136:139], v4 offset:13312
  s_waitcnt lgkmcnt(13)
  ds_read_b128 a[140:143], v4 offset:14336
  v_mfma_f32_16x16x32_bf16 v[52:55], a[152:155], v[56:59], v[52:55]
  s_waitcnt lgkmcnt(11)
  global_load_dwordx4 a[28:31], v11, s[22:23] offset:2048 sc1
  v_mfma_f32_16x16x32_bf16 v[44:47], a[156:159], v[60:63], v[44:47]
  ds_read_b128 v[56:59], v11 offset:57344
  ds_read_b128 a[144:147], v5 offset:0
  v_mfma_f32_16x16x32_bf16 v[48:51], a[160:163], v[60:63], v[48:51]
  ds_read_b128 a[148:151], v5 offset:1024
  s_waitcnt lgkmcnt(13)
  ds_read_b128 a[152:155], v5 offset:2048
  v_mfma_f32_16x16x32_bf16 v[52:55], a[164:167], v[60:63], v[52:55]
  s_waitcnt lgkmcnt(11)
  global_load_dwordx4 a[32:35], v11, s[22:23] offset:3072 sc1
  v_mfma_f32_16x16x32_bf16 v[44:47], a[168:171], v[64:67], v[44:47]
  s_add_u32 s9, s9, 90112
  ds_read_b128 v[60:63], v11 offset:58368
  ds_read_b128 a[156:159], v5 offset:3072
  v_mfma_f32_16x16x32_bf16 v[48:51], a[172:175], v[64:67], v[48:51]
  s_add_u32 s22, s60, s9
  s_addc_u32 s23, s61, 0
  ds_read_b128 a[160:163], v5 offset:4096
  s_waitcnt lgkmcnt(13)
  ds_read_b128 a[164:167], v5 offset:5120
  v_mfma_f32_16x16x32_bf16 v[52:55], a[176:179], v[64:67], v[52:55]
  s_waitcnt lgkmcnt(11)
  global_load_dwordx4 a[36:39], v11, s[22:23] offset:0 sc1
  v_mfma_f32_16x16x32_bf16 v[44:47], a[180:183], v[68:71], v[44:47]
  ds_read_b128 v[64:67], v11 offset:59392
  ds_read_b128 a[168:171], v5 offset:6144
  v_mfma_f32_16x16x32_bf16 v[48:51], a[184:187], v[68:71], v[48:51]
  ds_read_b128 a[172:175], v5 offset:7168
  s_waitcnt lgkmcnt(13)
  ds_read_b128 a[176:179], v5 offset:8192
  v_mfma_f32_16x16x32_bf16 v[52:55], a[188:191], v[68:71], v[52:55]
  s_waitcnt lgkmcnt(11)
  global_load_dwordx4 a[40:43], v11, s[22:23] offset:1024 sc1
  v_mfma_f32_16x16x32_bf16 v[44:47], a[192:195], v[56:59], v[44:47]
  ds_read_b128 v[68:71], v11 offset:60416
  ds_read_b128 a[180:183], v5 offset:9216
  v_mfma_f32_16x16x32_bf16 v[48:51], a[196:199], v[56:59], v[48:51]
  v_mul_f32 v119, v119, v127
  v_cvt_pk_bf16_f32 v110, v116, v117
  v_mfma_f32_16x16x32_bf16 v[52:55], a[200:203], v[56:59], v[52:55]
  s_waitcnt lgkmcnt(9)
  global_load_dwordx4 a[44:47], v11, s[22:23] offset:2048 sc1
  v_mfma_f32_16x16x32_bf16 v[44:47], a[204:207], v[60:63], v[44:47]
  v_cvt_pk_bf16_f32 v111, v118, v119
  v_mfma_f32_16x16x32_bf16 v[48:51], a[208:211], v[60:63], v[48:51]
  v_permlane32_swap_b32 v100, v104
  v_mfma_f32_16x16x32_bf16 v[52:55], a[212:215], v[60:63], v[52:55]
  s_waitcnt lgkmcnt(5)
  global_load_dwordx4 a[48:51], v11, s[22:23] offset:3072 sc1
  v_mfma_f32_16x16x32_bf16 v[44:47], a[216:219], v[64:67], v[44:47]
  s_add_u32 s9, s9, 4096
  v_permlane32_swap_b32 v101, v105
  v_mfma_f32_16x16x32_bf16 v[48:51], a[220:223], v[64:67], v[48:51]
  s_add_u32 s22, s60, s9
  s_addc_u32 s23, s61, 0
  v_permlane32_swap_b32 v102, v106
  v_mfma_f32_16x16x32_bf16 v[52:55], a[224:227], v[64:67], v[52:55]
  s_waitcnt lgkmcnt(1)
  global_load_dwordx4 a[52:55], v11, s[22:23] offset:0 sc1
  v_mfma_f32_16x16x32_bf16 v[44:47], a[228:231], v[68:71], v[44:47]
  v_permlane32_swap_b32 v103, v107
  v_mfma_f32_16x16x32_bf16 v[48:51], a[232:235], v[68:71], v[48:51]
  v_permlane16_swap_b32 v108, v110
  v_mfma_f32_16x16x32_bf16 v[52:55], a[236:239], v[68:71], v[52:55]
  global_load_dwordx4 a[56:59], v11, s[22:23] offset:1024 sc1
  v_permlane16_swap_b32 v109, v111
  s_mov_b32 s92, 196608
  buffer_store_dwordx4 v[108:111], v13, s[60:63], s92 offen sc1
  v_exp_f32 v124, v100
  v_exp_f32 v125, v101
  v_exp_f32 v126, v102
  v_exp_f32 v127, v103
  v_mul_f32 v100, v100, v104
  v_mul_f32 v101, v101, v105
  v_mul_f32 v102, v102, v106
  v_mul_f32 v103, v103, v107
  v_add_f32 v124, 1.0, v124
  v_add_f32 v125, 1.0, v125
  v_add_f32 v126, 1.0, v126
  v_add_f32 v127, 1.0, v127
  v_rcp_f32 v124, v124
  v_rcp_f32 v125, v125
  v_rcp_f32 v126, v126
  v_rcp_f32 v127, v127
  v_mul_f32 v100, v100, v124
  v_mul_f32 v101, v101, v125
  v_mul_f32 v102, v102, v126
  v_mul_f32 v103, v103, v127
  v_cvt_pk_bf16_f32 v112, v100, v101
  v_cvt_pk_bf16_f32 v113, v102, v103
  buffer_store_dwordx2 v[112:113], v14, s[60:63], s92 offen sc1
  v_mul_f32 v124, s19, v96
  v_mul_f32 v125, s18, v96
  v_mul_f32 v126, v16, v96
  v_fma_f32 v32, -v97, v72, v32
  v_fma_f32 v33, -v97, v73, v33
  v_fma_f32 v34, -v97, v74, v34
  v_fma_f32 v35, -v97, v75, v35
  v_fma_f32 v36, -v97, v76, v36
  v_fma_f32 v37, -v97, v77, v37
  v_fma_f32 v38, -v97, v78, v38
  v_fma_f32 v39, -v97, v79, v39
  v_fma_f32 v40, -v97, v80, v40
  v_fma_f32 v41, -v97, v81, v41
  v_fma_f32 v42, -v97, v82, v42
  v_fma_f32 v43, -v97, v83, v43
  v_mul_f32 v116, v32, v124
  v_mul_f32 v117, v33, v124
  v_mul_f32 v118, v34, v124
  v_mul_f32 v119, v35, v124
  v_mul_f32 v120, v36, v125
  v_mul_f32 v121, v37, v125
  v_mul_f32 v122, v38, v125
  v_mul_f32 v123, v39, v125
  v_mul_f32 v100, v40, v126
  v_mul_f32 v101, v41, v126
  v_mul_f32 v102, v42, v126
  v_mul_f32 v103, v43, v126
  s_waitcnt vmcnt(20)
  v_mfma_f32_16x16x32_bf16 v[56:59], v[130:133], a[240:243], 0
  v_exp_f32 v124, v116
  v_mfma_f32_16x16x32_bf16 v[60:63], v[134:137], a[240:243], 0
  v_exp_f32 v125, v117
  v_mfma_f32_16x16x32_bf16 v[64:67], v[138:141], a[240:243], 0
  global_load_dwordx4 a[60:63], v11, s[22:23] offset:2048 sc1
  v_mfma_f32_16x16x32_bf16 v[68:71], v[142:145], a[240:243], 0
  v_exp_f32 v126, v118
  v_mfma_f32_16x16x32_bf16 v[32:35], v[146:149], a[240:243], 0
  s_waitcnt vmcnt(19)
  v_exp_f32 v127, v119
  v_mfma_f32_16x16x32_bf16 v[56:59], v[150:153], a[244:247], v[56:59]
  global_load_dwordx4 a[64:67], v11, s[22:23] offset:3072 sc1
  v_mfma_f32_16x16x32_bf16 v[60:63], v[154:157], a[244:247], v[60:63]
  s_add_u32 s9, s9, 4096
  v_mul_f32 v116, v116, v120
  v_mul_f32 v117, v117, v121
  v_mfma_f32_16x16x32_bf16 v[64:67], v[158:161], a[244:247], v[64:67]
  s_add_u32 s22, s60, s9
  s_addc_u32 s23, s61, 0
  v_mul_f32 v118, v118, v122
  v_mul_f32 v119, v119, v123
  v_mfma_f32_16x16x32_bf16 v[68:71], v[162:165], a[244:247], v[68:71]
  global_load_dwordx4 a[68:71], v11, s[22:23] offset:0 sc1
  v_mfma_f32_16x16x32_bf16 v[32:35], v[166:169], a[244:247], v[32:35]
  s_waitcnt vmcnt(20)
  v_add_f32 v124, 1.0, v124
  v_add_f32 v125, 1.0, v125
  v_mfma_f32_16x16x32_bf16 v[56:59], v[170:173], a[248:251], v[56:59]
  v_add_f32 v126, 1.0, v126
  v_add_f32 v127, 1.0, v127
  v_mfma_f32_16x16x32_bf16 v[60:63], v[174:177], a[248:251], v[60:63]
  global_load_dwordx4 a[72:75], v11, s[22:23] offset:1024 sc1
  v_mfma_f32_16x16x32_bf16 v[64:67], v[178:181], a[248:251], v[64:67]
  v_rcp_f32 v124, v124
  v_mfma_f32_16x16x32_bf16 v[68:71], v[182:185], a[248:251], v[68:71]
  v_rcp_f32 v125, v125
  v_mfma_f32_16x16x32_bf16 v[32:35], v[186:189], a[248:251], v[32:35]
  s_waitcnt vmcnt(20)
  global_load_dwordx4 a[76:79], v11, s[22:23] offset:2048 sc1
  v_mfma_f32_16x16x32_bf16 v[56:59], v[190:193], a[0:3], v[56:59]
  v_rcp_f32 v126, v126
  v_mfma_f32_16x16x32_bf16 v[60:63], v[194:197], a[0:3], v[60:63]
  v_rcp_f32 v127, v127
  v_mfma_f32_16x16x32_bf16 v[64:67], v[198:201], a[0:3], v[64:67]
  global_load_dwordx4 a[80:83], v11, s[22:23] offset:3072 sc1
  v_mfma_f32_16x16x32_bf16 v[68:71], v[202:205], a[0:3], v[68:71]
  s_add_u32 s9, s9, 90112
  v_mul_f32 v116, v116, v124
  v_mul_f32 v117, v117, v125
  v_mfma_f32_16x16x32_bf16 v[32:35], v[206:209], a[0:3], v[32:35]
  s_waitcnt vmcnt(21)
  v_mul_f32 v118, v118, v126
  v_mul_f32 v119, v119, v127
  v_mfma_f32_16x16x32_bf16 v[56:59], v[210:213], a[4:7], v[56:59]
  ds_read_b128 a[184:187], v6 offset:0
  ds_read_b128 a[188:191], v6 offset:1024
  v_mfma_f32_16x16x32_bf16 v[60:63], v[214:217], a[4:7], v[60:63]
  ds_read_b128 a[192:195], v6 offset:2048
  ds_read_b128 a[196:199], v6 offset:3072
  v_mfma_f32_16x16x32_bf16 v[64:67], v[218:221], a[4:7], v[64:67]
  ds_read_b128 a[200:203], v6 offset:4096
  v_cvt_pk_bf16_f32 v108, v116, v117
  v_mfma_f32_16x16x32_bf16 v[68:71], v[222:225], a[4:7], v[68:71]
  buffer_load_dword v26, v28, s[60:63], 0 offen offset:2048 sc1
  v_mfma_f32_16x16x32_bf16 v[32:35], v[226:229], a[4:7], v[32:35]
  v_cvt_pk_bf16_f32 v109, v118, v119
  s_waitcnt vmcnt(7)
  s_barrier
  v_mfma_f32_16x16x32_bf16 v[56:59], v[230:233], a[8:11], v[56:59]
  buffer_store_dword v19, v15, s[60:63], 0 offen offset:2048 sc1
  v_mfma_f32_16x16x32_bf16 v[60:63], v[234:237], a[8:11], v[60:63]
  v_mul_f32 v124, s19, v98
  v_mul_f32 v125, s18, v98
  v_mfma_f32_16x16x32_bf16 v[64:67], v[238:241], a[8:11], v[64:67]
  v_mul_f32 v126, v16, v98
  v_fma_f32 v44, -v99, v72, v44
  v_mfma_f32_16x16x32_bf16 v[68:71], v[242:245], a[8:11], v[68:71]
  v_fma_f32 v45, -v99, v73, v45
  v_fma_f32 v46, -v99, v74, v46
  v_mfma_f32_16x16x32_bf16 v[32:35], v[246:249], a[8:11], v[32:35]
  v_fma_f32 v47, -v99, v75, v47
  v_fma_f32 v48, -v99, v76, v48
  v_mfma_f32_16x16x32_bf16 v[56:59], a[84:87], a[12:15], v[56:59]
  v_fma_f32 v49, -v99, v77, v49
  v_fma_f32 v50, -v99, v78, v50
  v_mfma_f32_16x16x32_bf16 v[60:63], a[88:91], a[12:15], v[60:63]
  v_fma_f32 v51, -v99, v79, v51
  v_fma_f32 v52, -v99, v80, v52
  v_mfma_f32_16x16x32_bf16 v[64:67], a[92:95], a[12:15], v[64:67]
  v_fma_f32 v53, -v99, v81, v53
  v_fma_f32 v54, -v99, v82, v54
  v_mfma_f32_16x16x32_bf16 v[68:71], a[96:99], a[12:15], v[68:71]
  v_fma_f32 v55, -v99, v83, v55
  v_mul_f32 v116, v44, v124
  v_mfma_f32_16x16x32_bf16 v[32:35], a[100:103], a[12:15], v[32:35]
  v_mul_f32 v117, v45, v124
  v_mul_f32 v118, v46, v124
  v_mfma_f32_16x16x32_bf16 v[56:59], a[104:107], a[16:19], v[56:59]
  v_mul_f32 v119, v47, v124
  v_mul_f32 v120, v48, v125
  v_mfma_f32_16x16x32_bf16 v[60:63], a[108:111], a[16:19], v[60:63]
  v_mul_f32 v121, v49, v125
  v_mul_f32 v122, v50, v125
  v_mfma_f32_16x16x32_bf16 v[64:67], a[112:115], a[16:19], v[64:67]
  v_mul_f32 v123, v51, v125
  v_mul_f32 v104, v52, v126
  v_mfma_f32_16x16x32_bf16 v[68:71], a[116:119], a[16:19], v[68:71]
  v_mul_f32 v105, v53, v126
  v_mul_f32 v106, v54, v126
  v_mfma_f32_16x16x32_bf16 v[32:35], a[120:123], a[16:19], v[32:35]
  v_mul_f32 v107, v55, v126
  v_mfma_f32_16x16x32_bf16 v[56:59], a[124:127], a[20:23], v[56:59]
  s_waitcnt vmcnt(1)
  v_cmp_ne_u32 vcc, v26, v19
  v_mfma_f32_16x16x32_bf16 v[60:63], a[128:131], a[20:23], v[60:63]
  v_exp_f32 v124, v116
  v_mfma_f32_16x16x32_bf16 v[64:67], a[132:135], a[20:23], v[64:67]
  v_exp_f32 v125, v117
  v_mfma_f32_16x16x32_bf16 v[68:71], a[136:139], a[20:23], v[68:71]
  s_cbranch_vccnz L_g2G
L_g2G_back:
  v_exp_f32 v126, v118
  v_mfma_f32_16x16x32_bf16 v[32:35], a[140:143], a[20:23], v[32:35]
  v_exp_f32 v127, v119
  v_mfma_f32_16x16x32_bf16 v[56:59], a[144:147], a[24:27], v[56:59]
  s_add_u32 s22, s60, s9
  s_addc_u32 s23, s61, 0
  global_load_dwordx4 a[240:243], v11, s[22:23] offset:0 sc1
  v_mfma_f32_16x16x32_bf16 v[60:63], a[148:151], a[24:27], v[60:63]
  v_mul_f32 v116, v116, v120
  v_mul_f32 v117, v117, v121
  v_mfma_f32_16x16x32_bf16 v[64:67], a[152:155], a[24:27], v[64:67]
  v_mul_f32 v118, v118, v122
  v_mul_f32 v119, v119, v123
  v_mfma_f32_16x16x32_bf16 v[68:71], a[156:159], a[24:27], v[68:71]
  global_load_dwordx4 a[244:247], v11, s[22:23] offset:1024 sc1
  v_mfma_f32_16x16x32_bf16 v[32:35], a[160:163], a[24:27], v[32:35]
  v_add_f32 v124, 1.0, v124
  v_add_f32 v125, 1.0, v125
  v_mfma_f32_16x16x32_bf16 v[56:59], a[164:167], a[28:31], v[56:59]
  v_add_f32 v126, 1.0, v126
  v_add_f32 v127, 1.0, v127
  v_mfma_f32_16x16x32_bf16 v[60:63], a[168:171], a[28:31], v[60:63]
  global_load_dwordx4 a[248:251], v11, s[22:23] offset:2048 sc1
  v_mfma_f32_16x16x32_bf16 v[64:67], a[172:175], a[28:31], v[64:67]
  v_rcp_f32 v124, v124
  v_mfma_f32_16x16x32_bf16 v[68:71], a[176:179], a[28:31], v[68:71]
  s_waitcnt lgkmcnt(5)
  v_rcp_f32 v125, v125
  v_mfma_f32_16x16x32_bf16 v[32:35], a[180:183], a[28:31], v[32:35]
  s_waitcnt lgkmcnt(4)
  global_load_dwordx4 a[0:3], v11, s[22:23] offset:3072 sc1
  v_mfma_f32_16x16x32_bf16 v[56:59], a[184:187], a[32:35], v[56:59]
  s_add_u32 s9, s9, 4096
  v_rcp_f32 v126, v126
  s_waitcnt lgkmcnt(3)
  v_mfma_f32_16x16x32_bf16 v[60:63], a[188:191], a[32:35], v[60:63]
  s_add_u32 s22, s60, s9
  s_addc_u32 s23, s61, 0
  v_rcp_f32 v127, v127
  s_waitcnt lgkmcnt(2)
  v_mfma_f32_16x16x32_bf16 v[64:67], a[192:195], a[32:35], v[64:67]
  s_waitcnt lgkmcnt(1)
  global_load_dwordx4 a[4:7], v11, s[22:23] offset:0 sc1
  v_mfma_f32_16x16x32_bf16 v[68:71], a[196:199], a[32:35], v[68:71]
  s_waitcnt lgkmcnt(0)
  v_mul_f32 v116, v116, v124
  v_mul_f32 v117, v117, v125
  v_mfma_f32_16x16x32_bf16 v[32:35], a[200:203], a[32:35], v[32:35]
  v_mul_f32 v118, v118, v126
  v_mul_f32 v119, v119, v127
  v_mfma_f32_16x16x32_bf16 v[36:39], v[130:133], a[36:39], 0
  global_load_dwordx4 a[8:11], v11, s[22:23] offset:1024 sc1
  v_mfma_f32_16x16x32_bf16 v[40:43], v[134:137], a[36:39], 0
  v_cvt_pk_bf16_f32 v110, v116, v117
  v_cvt_pk_bf16_f32 v111, v118, v119
  v_mfma_f32_16x16x32_bf16 v[44:47], v[138:141], a[36:39], 0
  v_permlane32_swap_b32 v100, v104
  v_mfma_f32_16x16x32_bf16 v[48:51], v[142:145], a[36:39], 0
  ds_write_b128 v17, v[56:59] offset:0
  v_mfma_f32_16x16x32_bf16 v[52:55], v[146:149], a[36:39], 0
  global_load_dwordx4 a[12:15], v11, s[22:23] offset:2048 sc1
  v_mfma_f32_16x16x32_bf16 v[36:39], v[150:153], a[40:43], v[36:39]
  v_permlane32_swap_b32 v101, v105
  v_mfma_f32_16x16x32_bf16 v[40:43], v[154:157], a[40:43], v[40:43]
  v_permlane32_swap_b32 v102, v106
  v_mfma_f32_16x16x32_bf16 v[44:47], v[158:161], a[40:43], v[44:47]
  ds_write_b128 v17, v[60:63] offset:1152
  v_mfma_f32_16x16x32_bf16 v[48:51], v[162:165], a[40:43], v[48:51]
  global_load_dwordx4 a[16:19], v11, s[22:23] offset:3072 sc1
  v_mfma_f32_16x16x32_bf16 v[52:55], v[166:169], a[40:43], v[52:55]
  v_permlane32_swap_b32 v103, v107
  v_mfma_f32_16x16x32_bf16 v[36:39], v[170:173], a[44:47], v[36:39]
  s_add_u32 s9, s9, 4096
  v_permlane16_swap_b32 v108, v110
  v_mfma_f32_16x16x32_bf16 v[40:43], v[174:177], a[44:47], v[40:43]
  s_add_u32 s22, s60, s9
  s_addc_u32 s23, s61, 0
  ds_write_b128 v17, v[64:67] offset:2304
  v_mfma_f32_16x16x32_bf16 v[44:47], v[178:181], a[44:47], v[44:47]
  global_load_dwordx4 a[20:23], v11, s[22:23] offset:0 sc1
  v_mfma_f32_16x16x32_bf16 v[48:51], v[182:185], a[44:47], v[48:51]
  v_permlane16_swap_b32 v109, v111
  v_mfma_f32_16x16x32_bf16 v[52:55], v[186:189], a[44:47], v[52:55]
  v_mfma_f32_16x16x32_bf16 v[36:39], v[190:193], a[48:51], v[36:39]
  s_mov_b32 s92, 294912
  ds_write_b128 v17, v[68:71] offset:3456
  v_mfma_f32_16x16x32_bf16 v[40:43], v[194:197], a[48:51], v[40:43]
  global_load_dwordx4 a[24:27], v11, s[22:23] offset:1024 sc1
  v_mfma_f32_16x16x32_bf16 v[44:47], v[198:201], a[48:51], v[44:47]
  buffer_store_dwordx4 v[108:111], v13, s[60:63], s92 offen sc1
  v_mfma_f32_16x16x32_bf16 v[48:51], v[202:205], a[48:51], v[48:51]
  v_exp_f32 v124, v100
  v_mfma_f32_16x16x32_bf16 v[52:55], v[206:209], a[48:51], v[52:55]
  ds_write_b128 v17, v[32:35] offset:4608
  v_mfma_f32_16x16x32_bf16 v[36:39], v[210:213], a[52:55], v[36:39]
  global_load_dwordx4 a[28:31], v11, s[22:23] offset:2048 sc1
  v_mfma_f32_16x16x32_bf16 v[40:43], v[214:217], a[52:55], v[40:43]
  v_exp_f32 v125, v101
  v_mfma_f32_16x16x32_bf16 v[44:47], v[218:221], a[52:55], v[44:47]
  v_exp_f32 v126, v102
  v_mfma_f32_16x16x32_bf16 v[48:51], v[222:225], a[52:55], v[48:51]
  global_load_dwordx4 a[32:35], v11, s[22:23] offset:3072 sc1
  v_mfma_f32_16x16x32_bf16 v[52:55], v[226:229], a[52:55], v[52:55]
  v_exp_f32 v127, v103
  s_waitcnt lgkmcnt(0)
  s_barrier
  v_mfma_f32_16x16x32_bf16 v[36:39], v[230:233], a[56:59], v[36:39]
  s_add_u32 s9, s9, 90112
  v_mul_f32 v100, v100, v104
  v_mul_f32 v101, v101, v105
  v_mfma_f32_16x16x32_bf16 v[40:43], v[234:237], a[56:59], v[40:43]
  v_mul_f32 v102, v102, v106
  v_mul_f32 v103, v103, v107
  v_mfma_f32_16x16x32_bf16 v[44:47], v[238:241], a[56:59], v[44:47]
  v_add_f32 v124, 1.0, v124
  v_add_f32 v125, 1.0, v125
  v_mfma_f32_16x16x32_bf16 v[48:51], v[242:245], a[56:59], v[48:51]
  v_add_f32 v126, 1.0, v126
  v_add_f32 v127, 1.0, v127
  v_mfma_f32_16x16x32_bf16 v[52:55], v[246:249], a[56:59], v[52:55]
  v_rcp_f32 v124, v124
  v_mfma_f32_16x16x32_bf16 v[36:39], a[84:87], a[60:63], v[36:39]
  v_rcp_f32 v125, v125
  v_mfma_f32_16x16x32_bf16 v[40:43], a[88:91], a[60:63], v[40:43]
  v_rcp_f32 v126, v126
  v_mfma_f32_16x16x32_bf16 v[44:47], a[92:95], a[60:63], v[44:47]
  v_rcp_f32 v127, v127
  v_mfma_f32_16x16x32_bf16 v[48:51], a[96:99], a[60:63], v[48:51]
  v_mul_f32 v100, v100, v124
  v_mul_f32 v101, v101, v125
  v_mfma_f32_16x16x32_bf16 v[52:55], a[100:103], a[60:63], v[52:55]
  v_mul_f32 v102, v102, v126
  v_mul_f32 v103, v103, v127
  v_mfma_f32_16x16x32_bf16 v[36:39], a[104:107], a[64:67], v[36:39]
  v_cvt_pk_bf16_f32 v112, v100, v101
  v_cvt_pk_bf16_f32 v113, v102, v103
  v_mfma_f32_16x16x32_bf16 v[40:43], a[108:111], a[64:67], v[40:43]
  buffer_store_dwordx2 v[112:113], v14, s[60:63], s92 offen sc1
  v_mfma_f32_16x16x32_bf16 v[44:47], a[112:115], a[64:67], v[44:47]
  s_mov_b32 s4, 0
  buffer_load_dwordx4 v[104:107], v129, s[60:63], s4 offen sc1
  v_mfma_f32_16x16x32_bf16 v[48:51], a[116:119], a[64:67], v[48:51]
  s_mov_b32 s4, 40960
  buffer_load_dwordx4 v[108:111], v129, s[60:63], s4 offen sc1
  v_mfma_f32_16x16x32_bf16 v[52:55], a[120:123], a[64:67], v[52:55]
  v_mfma_f32_16x16x32_bf16 v[36:39], a[124:127], a[68:71], v[36:39]
  s_mov_b32 s4, 81920
  buffer_load_dwordx4 v[112:115], v129, s[60:63], s4 offen sc1
  v_mfma_f32_16x16x32_bf16 v[40:43], a[128:131], a[68:71], v[40:43]
  s_mov_b32 s4, 122880
  buffer_load_dwordx4 v[116:119], v129, s[60:63], s4 offen sc1
  v_mfma_f32_16x16x32_bf16 v[44:47], a[132:135], a[68:71], v[44:47]
  ds_read_b128 v[72:75], v18 offset:0
  ds_read_b128 v[76:79], v18 offset:288
  v_mfma_f32_16x16x32_bf16 v[48:51], a[136:139], a[68:71], v[48:51]
  ds_read_b128 v[80:83], v18 offset:5760
  ds_read_b128 v[84:87], v18 offset:6048
  v_mfma_f32_16x16x32_bf16 v[52:55], a[140:143], a[68:71], v[52:55]
  ds_read_b128 v[88:91], v18 offset:11520
  ds_read_b128 v[92:95], v18 offset:11808
  v_mfma_f32_16x16x32_bf16 v[36:39], a[144:147], a[72:75], v[36:39]
  ds_read_b128 v[96:99], v18 offset:17280
  ds_read_b128 v[100:103], v18 offset:17568
  v_mfma_f32_16x16x32_bf16 v[40:43], a[148:151], a[72:75], v[40:43]
  s_waitcnt lgkmcnt(5)
  v_add_f32 v72, v72, v80
  v_add_f32 v73, v73, v81
  v_mfma_f32_16x16x32_bf16 v[44:47], a[152:155], a[72:75], v[44:47]
  v_add_f32 v74, v74, v82
  v_add_f32 v75, v75, v83
  v_mfma_f32_16x16x32_bf16 v[48:51], a[156:159], a[72:75], v[48:51]
  s_waitcnt lgkmcnt(4)
  v_add_f32 v76, v76, v84
  v_add_f32 v77, v77, v85
  v_mfma_f32_16x16x32_bf16 v[52:55], a[160:163], a[72:75], v[52:55]
  v_add_f32 v78, v78, v86
  v_add_f32 v79, v79, v87
  v_mfma_f32_16x16x32_bf16 v[36:39], a[164:167], a[76:79], v[36:39]
  s_waitcnt lgkmcnt(1)
  v_add_f32 v88, v88, v96
  v_add_f32 v89, v89, v97
  v_mfma_f32_16x16x32_bf16 v[40:43], a[168:171], a[76:79], v[40:43]
  v_add_f32 v90, v90, v98
  v_add_f32 v91, v91, v99
  v_mfma_f32_16x16x32_bf16 v[44:47], a[172:175], a[76:79], v[44:47]
  s_waitcnt lgkmcnt(0)
  v_add_f32 v92, v92, v100
  v_add_f32 v93, v93, v101
  v_mfma_f32_16x16x32_bf16 v[48:51], a[176:179], a[76:79], v[48:51]
  v_add_f32 v94, v94, v102
  v_add_f32 v95, v95, v103
  v_mfma_f32_16x16x32_bf16 v[52:55], a[180:183], a[76:79], v[52:55]
  v_add_f32 v72, v72, v88
  v_add_f32 v73, v73, v89
  v_mfma_f32_16x16x32_bf16 v[36:39], a[184:187], a[80:83], v[36:39]
  v_add_f32 v74, v74, v90
  v_add_f32 v75, v75, v91
  v_mfma_f32_16x16x32_bf16 v[40:43], a[188:191], a[80:83], v[40:43]
  v_add_f32 v76, v76, v92
  v_add_f32 v77, v77, v93
  v_mfma_f32_16x16x32_bf16 v[44:47], a[192:195], a[80:83], v[44:47]
  v_add_f32 v78, v78, v94
  v_add_f32 v79, v79, v95
  v_mfma_f32_16x16x32_bf16 v[48:51], a[196:199], a[80:83], v[48:51]
  s_waitcnt vmcnt(3)
  v_dot2_f32_bf16 v80, v104, s74, v72
  v_dot2_f32_bf16 v81, v104, s75, v73
  v_mfma_f32_16x16x32_bf16 v[52:55], a[200:203], a[80:83], v[52:55]
  v_dot2_f32_bf16 v82, v105, s74, v74
  v_dot2_f32_bf16 v83, v105, s75, v75
  v_mfma_f32_16x16x32_bf16 v[56:59], v[130:133], a[240:243], 0
  v_dot2_f32_bf16 v84, v106, s74, v76
  v_dot2_f32_bf16 v85, v106, s75, v77
  v_mfma_f32_16x16x32_bf16 v[60:63], v[134:137], a[240:243], 0
  v_dot2_f32_bf16 v86, v107, s74, v78
  v_dot2_f32_bf16 v87, v107, s75, v79
  v_mfma_f32_16x16x32_bf16 v[64:67], v[138:141], a[240:243], 0
  v_cvt_pk_bf16_f32 v72, v80, v81
  v_cvt_pk_bf16_f32 v73, v82, v83
  v_mfma_f32_16x16x32_bf16 v[68:71], v[142:145], a[240:243], 0
  ds_write_b128 v17, v[36:39] offset:23040
  v_mfma_f32_16x16x32_bf16 v[32:35], v[146:149], a[240:243], 0
  v_cvt_pk_bf16_f32 v74, v84, v85
  v_cvt_pk_bf16_f32 v75, v86, v87
  v_mfma_f32_16x16x32_bf16 v[56:59], v[150:153], a[244:247], v[56:59]
  s_mov_b32 s92, 0
  buffer_store_dwordx4 v[72:75], v128, s[56:59], s92 offen
  v_mfma_f32_16x16x32_bf16 v[60:63], v[154:157], a[244:247], v[60:63]
  buffer_store_dword v19, v15, s[60:63], 0 offen offset:3072 sc1
  v_mfma_f32_16x16x32_bf16 v[64:67], v[158:161], a[244:247], v[64:67]
  ds_write_b128 v17, v[40:43] offset:24192
  v_mfma_f32_16x16x32_bf16 v[68:71], v[162:165], a[244:247], v[68:71]
  v_mfma_f32_16x16x32_bf16 v[32:35], v[166:169], a[244:247], v[32:35]
  v_mfma_f32_16x16x32_bf16 v[56:59], v[170:173], a[248:251], v[56:59]
  buffer_load_dword v26, v28, s[60:63], 0 offen offset:3072 sc1
  v_mfma_f32_16x16x32_bf16 v[60:63], v[174:177], a[248:251], v[60:63]
  ds_write_b128 v17, v[44:47] offset:25344
  v_mfma_f32_16x16x32_bf16 v[64:67], v[178:181], a[248:251], v[64:67]
  v_mfma_f32_16x16x32_bf16 v[68:71], v[182:185], a[248:251], v[68:71]
  v_mfma_f32_16x16x32_bf16 v[32:35], v[186:189], a[248:251], v[32:35]
  v_mfma_f32_16x16x32_bf16 v[56:59], v[190:193], a[0:3], v[56:59]
  ds_write_b128 v17, v[48:51] offset:26496
  v_mfma_f32_16x16x32_bf16 v[60:63], v[194:197], a[0:3], v[60:63]
  v_mfma_f32_16x16x32_bf16 v[64:67], v[198:201], a[0:3], v[64:67]
  v_mfma_f32_16x16x32_bf16 v[68:71], v[202:205], a[0:3], v[68:71]
  v_mfma_f32_16x16x32_bf16 v[32:35], v[206:209], a[0:3], v[32:35]
  ds_write_b128 v17, v[52:55] offset:27648
  v_mfma_f32_16x16x32_bf16 v[56:59], v[210:213], a[4:7], v[56:59]
  v_mfma_f32_16x16x32_bf16 v[60:63], v[214:217], a[4:7], v[60:63]
  v_mfma_f32_16x16x32_bf16 v[64:67], v[218:221], a[4:7], v[64:67]
  v_mfma_f32_16x16x32_bf16 v[68:71], v[222:225], a[4:7], v[68:71]
  v_mfma_f32_16x16x32_bf16 v[32:35], v[226:229], a[4:7], v[32:35]
  s_waitcnt lgkmcnt(0)
  s_barrier
  v_mfma_f32_16x16x32_bf16 v[56:59], v[230:233], a[8:11], v[56:59]
  v_mfma_f32_16x16x32_bf16 v[60:63], v[234:237], a[8:11], v[60:63]
  ds_read_b128 v[72:75], v18 offset:23040
  ds_read_b128 v[76:79], v18 offset:23328
  v_mfma_f32_16x16x32_bf16 v[64:67], v[238:241], a[8:11], v[64:67]
  ds_read_b128 v[80:83], v18 offset:28800
  ds_read_b128 v[84:87], v18 offset:29088
  v_mfma_f32_16x16x32_bf16 v[68:71], v[242:245], a[8:11], v[68:71]
  ds_read_b128 v[88:91], v18 offset:34560
  ds_read_b128 v[92:95], v18 offset:34848
  v_mfma_f32_16x16x32_bf16 v[32:35], v[246:249], a[8:11], v[32:35]
  ds_read_b128 v[96:99], v18 offset:40320
  ds_read_b128 v[100:103], v18 offset:40608
  v_mfma_f32_16x16x32_bf16 v[56:59], a[84:87], a[12:15], v[56:59]
  s_waitcnt lgkmcnt(5)
  v_add_f32 v72, v72, v80
  v_add_f32 v73, v73, v81
  v_mfma_f32_16x16x32_bf16 v[60:63], a[88:91], a[12:15], v[60:63]
  v_add_f32 v74, v74, v82
  v_add_f32 v75, v75, v83
  v_mfma_f32_16x16x32_bf16 v[64:67], a[92:95], a[12:15], v[64:67]
  s_waitcnt vmcnt(0)
  v_cmp_ne_u32 vcc, v26, v19
  s_waitcnt lgkmcnt(4)
  v_add_f32 v76, v76, v84
  v_mfma_f32_16x16x32_bf16 v[68:71], a[96:99], a[12:15], v[68:71]
  v_add_f32 v77, v77, v85
  v_add_f32 v78, v78, v86
  v_mfma_f32_16x16x32_bf16 v[32:35], a[100:103], a[12:15], v[32:35]
  v_add_f32 v79, v79, v87
  s_waitcnt lgkmcnt(1)
  v_add_f32 v88, v88, v96
  v_mfma_f32_16x16x32_bf16 v[56:59], a[104:107], a[16:19], v[56:59]
  s_cbranch_vccnz L_g3G
L_g3G_back:
  v_add_f32 v89, v89, v97
  v_add_f32 v90, v90, v98
  v_mfma_f32_16x16x32_bf16 v[60:63], a[108:111], a[16:19], v[60:63]
  s_add_u32 s22, s60, s9
  s_addc_u32 s23, s61, 0
  global_load_dwordx4 a[36:39], v11, s[22:23] offset:0 sc1
  v_mfma_f32_16x16x32_bf16 v[64:67], a[112:115], a[16:19], v[64:67]
  v_add_f32 v91, v91, v99
  s_waitcnt lgkmcnt(0)
  v_add_f32 v92, v92, v100
  v_mfma_f32_16x16x32_bf16 v[68:71], a[116:119], a[16:19], v[68:71]
  v_add_f32 v93, v93, v101
  v_add_f32 v94, v94, v102
  v_mfma_f32_16x16x32_bf16 v[32:35], a[120:123], a[16:19], v[32:35]
  global_load_dwordx4 a[40:43], v11, s[22:23] offset:1024 sc1
  v_mfma_f32_16x16x32_bf16 v[56:59], a[124:127], a[20:23], v[56:59]
  v_add_f32 v95, v95, v103
  v_add_f32 v72, v72, v88
  v_mfma_f32_16x16x32_bf16 v[60:63], a[128:131], a[20:23], v[60:63]
  v_add_f32 v73, v73, v89
  v_add_f32 v74, v74, v90
  v_mfma_f32_16x16x32_bf16 v[64:67], a[132:135], a[20:23], v[64:67]
  global_load_dwordx4 a[44:47], v11, s[22:23] offset:2048 sc1
  v_mfma_f32_16x16x32_bf16 v[68:71], a[136:139], a[20:23], v[68:71]
  v_add_f32 v75, v75, v91
  v_add_f32 v76, v76, v92
  v_mfma_f32_16x16x32_bf16 v[32:35], a[140:143], a[20:23], v[32:35]
  v_add_f32 v77, v77, v93
  v_add_f32 v78, v78, v94
  v_mfma_f32_16x16x32_bf16 v[56:59], a[144:147], a[24:27], v[56:59]
  global_load_dwordx4 a[48:51], v11, s[22:23] offset:3072 sc1
  v_mfma_f32_16x16x32_bf16 v[60:63], a[148:151], a[24:27], v[60:63]
  s_add_u32 s9, s9, 4096
  v_add_f32 v79, v79, v95
  v_dot2_f32_bf16 v80, v108, s74, v72
  v_mfma_f32_16x16x32_bf16 v[64:67], a[152:155], a[24:27], v[64:67]
  s_add_u32 s22, s60, s9
  s_addc_u32 s23, s61, 0
  v_dot2_f32_bf16 v81, v108, s75, v73
  v_dot2_f32_bf16 v82, v109, s74, v74
  v_mfma_f32_16x16x32_bf16 v[68:71], a[156:159], a[24:27], v[68:71]
  global_load_dwordx4 a[52:55], v11, s[22:23] offset:0 sc1
  v_mfma_f32_16x16x32_bf16 v[32:35], a[160:163], a[24:27], v[32:35]
  v_dot2_f32_bf16 v83, v109, s75, v75
  v_dot2_f32_bf16 v84, v110, s74, v76
  v_mfma_f32_16x16x32_bf16 v[56:59], a[164:167], a[28:31], v[56:59]
  v_dot2_f32_bf16 v85, v110, s75, v77
  v_dot2_f32_bf16 v86, v111, s74, v78
  v_mfma_f32_16x16x32_bf16 v[60:63], a[168:171], a[28:31], v[60:63]
  global_load_dwordx4 a[56:59], v11, s[22:23] offset:1024 sc1
  v_mfma_f32_16x16x32_bf16 v[64:67], a[172:175], a[28:31], v[64:67]
  v_dot2_f32_bf16 v87, v111, s75, v79
  v_cvt_pk_bf16_f32 v72, v80, v81
  v_mfma_f32_16x16x32_bf16 v[68:71], a[176:179], a[28:31], v[68:71]
  v_cvt_pk_bf16_f32 v73, v82, v83
  v_cvt_pk_bf16_f32 v74, v84, v85
  v_mfma_f32_16x16x32_bf16 v[32:35], a[180:183], a[28:31], v[32:35]
  global_load_dwordx4 a[60:63], v11, s[22:23] offset:2048 sc1
  v_mfma_f32_16x16x32_bf16 v[56:59], a[184:187], a[32:35], v[56:59]
  v_cvt_pk_bf16_f32 v75, v86, v87
  v_mfma_f32_16x16x32_bf16 v[60:63], a[188:191], a[32:35], v[60:63]
  s_mov_b32 s92, 40960
  buffer_store_dwordx4 v[72:75], v128, s[56:59], s92 offen
  v_mfma_f32_16x16x32_bf16 v[64:67], a[192:195], a[32:35], v[64:67]
  v_mfma_f32_16x16x32_bf16 v[68:71], a[196:199], a[32:35], v[68:71]
  v_mfma_f32_16x16x32_bf16 v[32:35], a[200:203], a[32:35], v[32:35]
  s_waitcnt vmcnt(7)
  global_load_dwordx4 a[64:67], v11, s[22:23] offset:3072 sc1
  v_mfma_f32_16x16x32_bf16 v[36:39], v[130:133], a[36:39], 0
  s_add_u32 s9, s9, 4096
  v_mfma_f32_16x16x32_bf16 v[40:43], v[134:137], a[36:39], 0
  s_add_u32 s22, s60, s9
  s_addc_u32 s23, s61, 0
  v_mfma_f32_16x16x32_bf16 v[44:47], v[138:141], a[36:39], 0
  global_load_dwordx4 a[68:71], v11, s[22:23] offset:0 sc1
  v_mfma_f32_16x16x32_bf16 v[48:51], v[142:145], a[36:39], 0
  ds_write_b128 v17, v[56:59] offset:0
  v_mfma_f32_16x16x32_bf16 v[52:55], v[146:149], a[36:39], 0
  s_waitcnt vmcnt(8)
  v_mfma_f32_16x16x32_bf16 v[36:39], v[150:153], a[40:43], v[36:39]
  global_load_dwordx4 a[72:75], v11, s[22:23] offset:1024 sc1
  v_mfma_f32_16x16x32_bf16 v[40:43], v[154:157], a[40:43], v[40:43]
  v_mfma_f32_16x16x32_bf16 v[44:47], v[158:161], a[40:43], v[44:47]
  ds_write_b128 v17, v[60:63] offset:1152
  v_mfma_f32_16x16x32_bf16 v[48:51], v[162:165], a[40:43], v[48:51]
  global_load_dwordx4 a[76:79], v11, s[22:23] offset:2048 sc1
  v_mfma_f32_16x16x32_bf16 v[52:55], v[166:169], a[40:43], v[52:55]
  s_waitcnt vmcnt(9)
  v_mfma_f32_16x16x32_bf16 v[36:39], v[170:173], a[44:47], v[36:39]
  v_mfma_f32_16x16x32_bf16 v[40:43], v[174:177], a[44:47], v[40:43]
  ds_write_b128 v17, v[64:67] offset:2304
  v_mfma_f32_16x16x32_bf16 v[44:47], v[178:181], a[44:47], v[44:47]
  global_load_dwordx4 a[80:83], v11, s[22:23] offset:3072 sc1
  v_mfma_f32_16x16x32_bf16 v[48:51], v[182:185], a[44:47], v[48:51]
  s_add_u32 s9, s9, 90112
  v_mfma_f32_16x16x32_bf16 v[52:55], v[186:189], a[44:47], v[52:55]
  s_waitcnt vmcnt(9)
  v_mfma_f32_16x16x32_bf16 v[36:39], v[190:193], a[48:51], v[36:39]
  ds_write_b128 v17, v[68:71] offset:3456
  v_mfma_f32_16x16x32_bf16 v[40:43], v[194:197], a[48:51], v[40:43]
  v_mfma_f32_16x16x32_bf16 v[44:47], v[198:201], a[48:51], v[44:47]
  v_mfma_f32_16x16x32_bf16 v[48:51], v[202:205], a[48:51], v[48:51]
  v_mfma_f32_16x16x32_bf16 v[52:55], v[206:209], a[48:51], v[52:55]
  s_waitcnt vmcnt(8)
  ds_write_b128 v17, v[32:35] offset:4608
  v_mfma_f32_16x16x32_bf16 v[36:39], v[210:213], a[52:55], v[36:39]
  v_mfma_f32_16x16x32_bf16 v[40:43], v[214:217], a[52:55], v[40:43]
  v_mfma_f32_16x16x32_bf16 v[44:47], v[218:221], a[52:55], v[44:47]
  v_mfma_f32_16x16x32_bf16 v[48:51], v[222:225], a[52:55], v[48:51]
  v_mfma_f32_16x16x32_bf16 v[52:55], v[226:229], a[52:55], v[52:55]
  s_waitcnt lgkmcnt(0)
  s_barrier
  s_waitcnt vmcnt(7)
  v_mfma_f32_16x16x32_bf16 v[36:39], v[230:233], a[56:59], v[36:39]
  v_mfma_f32_16x16x32_bf16 v[40:43], v[234:237], a[56:59], v[40:43]
  ds_read_b128 v[72:75], v18 offset:0
  ds_read_b128 v[76:79], v18 offset:288
  v_mfma_f32_16x16x32_bf16 v[44:47], v[238:241], a[56:59], v[44:47]
  ds_read_b128 v[80:83], v18 offset:5760
  ds_read_b128 v[84:87], v18 offset:6048
  v_mfma_f32_16x16x32_bf16 v[48:51], v[242:245], a[56:59], v[48:51]
  ds_read_b128 v[88:91], v18 offset:11520
  ds_read_b128 v[92:95], v18 offset:11808
  v_mfma_f32_16x16x32_bf16 v[52:55], v[246:249], a[56:59], v[52:55]
  s_waitcnt vmcnt(6)
  ds_read_b128 v[96:99], v18 offset:17280
  ds_read_b128 v[100:103], v18 offset:17568
  v_mfma_f32_16x16x32_bf16 v[36:39], a[84:87], a[60:63], v[36:39]
  s_waitcnt lgkmcnt(5)
  v_add_f32 v72, v72, v80
  v_add_f32 v73, v73, v81
  v_mfma_f32_16x16x32_bf16 v[40:43], a[88:91], a[60:63], v[40:43]
  v_add_f32 v74, v74, v82
  v_add_f32 v75, v75, v83
  v_mfma_f32_16x16x32_bf16 v[44:47], a[92:95], a[60:63], v[44:47]
  s_waitcnt lgkmcnt(4)
  v_add_f32 v76, v76, v84
  v_add_f32 v77, v77, v85
  v_mfma_f32_16x16x32_bf16 v[48:51], a[96:99], a[60:63], v[48:51]
  v_add_f32 v78, v78, v86
  v_add_f32 v79, v79, v87
  v_mfma_f32_16x16x32_bf16 v[52:55], a[100:103], a[60:63], v[52:55]
  s_waitcnt lgkmcnt(1)
  v_add_f32 v88, v88, v96
  v_add_f32 v89, v89, v97
  s_waitcnt vmcnt(4)
  v_mfma_f32_16x16x32_bf16 v[36:39], a[104:107], a[64:67], v[36:39]
  v_add_f32 v90, v90, v98
  v_add_f32 v91, v91, v99
  v_mfma_f32_16x16x32_bf16 v[40:43], a[108:111], a[64:67], v[40:43]
  s_waitcnt lgkmcnt(0)
  v_add_f32 v92, v92, v100
  v_add_f32 v93, v93, v101
  v_mfma_f32_16x16x32_bf16 v[44:47], a[112:115], a[64:67], v[44:47]
  v_add_f32 v94, v94, v102
  v_add_f32 v95, v95, v103
  v_mfma_f32_16x16x32_bf16 v[48:51], a[116:119], a[64:67], v[48:51]
  v_add_f32 v72, v72, v88
  v_add_f32 v73, v73, v89
  v_mfma_f32_16x16x32_bf16 v[52:55], a[120:123], a[64:67], v[52:55]
  s_waitcnt vmcnt(3)
  v_add_f32 v74, v74, v90
  v_add_f32 v75, v75, v91
  v_mfma_f32_16x16x32_bf16 v[36:39], a[124:127], a[68:71], v[36:39]
  v_add_f32 v76, v76, v92
  v_add_f32 v77, v77, v93
  v_mfma_f32_16x16x32_bf16 v[40:43], a[128:131], a[68:71], v[40:43]
  v_add_f32 v78, v78, v94
  v_add_f32 v79, v79, v95
  v_mfma_f32_16x16x32_bf16 v[44:47], a[132:135], a[68:71], v[44:47]
  v_dot2_f32_bf16 v80, v112, s74, v72
  v_dot2_f32_bf16 v81, v112, s75, v73
  v_mfma_f32_16x16x32_bf16 v[48:51], a[136:139], a[68:71], v[48:51]
  v_dot2_f32_bf16 v82, v113, s74, v74
  v_dot2_f32_bf16 v83, v113, s75, v75
  v_mfma_f32_16x16x32_bf16 v[52:55], a[140:143], a[68:71], v[52:55]
  s_waitcnt vmcnt(2)
  v_dot2_f32_bf16 v84, v114, s74, v76
  v_dot2_f32_bf16 v85, v114, s75, v77
  v_mfma_f32_16x16x32_bf16 v[36:39], a[144:147], a[72:75], v[36:39]
  v_dot2_f32_bf16 v86, v115, s74, v78
  v_dot2_f32_bf16 v87, v115, s75, v79
  v_mfma_f32_16x16x32_bf16 v[40:43], a[148:151], a[72:75], v[40:43]
  v_cvt_pk_bf16_f32 v72, v80, v81
  v_cvt_pk_bf16_f32 v73, v82, v83
  v_mfma_f32_16x16x32_bf16 v[44:47], a[152:155], a[72:75], v[44:47]
  v_cvt_pk_bf16_f32 v74, v84, v85
  v_cvt_pk_bf16_f32 v75, v86, v87
  v_mfma_f32_16x16x32_bf16 v[48:51], a[156:159], a[72:75], v[48:51]
  s_mov_b32 s92, 81920
  buffer_store_dwordx4 v[72:75], v128, s[56:59], s92 offen
  v_mfma_f32_16x16x32_bf16 v[52:55], a[160:163], a[72:75], v[52:55]
  s_waitcnt vmcnt(2)
  v_mfma_f32_16x16x32_bf16 v[36:39], a[164:167], a[76:79], v[36:39]
  v_mfma_f32_16x16x32_bf16 v[40:43], a[168:171], a[76:79], v[40:43]
  v_mfma_f32_16x16x32_bf16 v[44:47], a[172:175], a[76:79], v[44:47]
  v_mfma_f32_16x16x32_bf16 v[48:51], a[176:179], a[76:79], v[48:51]
  v_mfma_f32_16x16x32_bf16 v[52:55], a[180:183], a[76:79], v[52:55]
  s_waitcnt vmcnt(1)
  v_mfma_f32_16x16x32_bf16 v[36:39], a[184:187], a[80:83], v[36:39]
  v_mfma_f32_16x16x32_bf16 v[40:43], a[188:191], a[80:83], v[40:43]
  v_mfma_f32_16x16x32_bf16 v[44:47], a[192:195], a[80:83], v[44:47]
  v_mfma_f32_16x16x32_bf16 v[48:51], a[196:199], a[80:83], v[48:51]
  v_mfma_f32_16x16x32_bf16 v[52:55], a[200:203], a[80:83], v[52:55]
  s_nop 3
  ds_write_b128 v17, v[36:39] offset:23040
  ds_write_b128 v17, v[40:43] offset:24192
  ds_write_b128 v17, v[44:47] offset:25344
  ds_write_b128 v17, v[48:51] offset:26496
  ds_write_b128 v17, v[52:55] offset:27648
  s_waitcnt lgkmcnt(0)
  s_barrier
  ds_read_b128 v[72:75], v18 offset:23040
  ds_read_b128 v[76:79], v18 offset:23328
  ds_read_b128 v[80:83], v18 offset:28800
  ds_read_b128 v[84:87], v18 offset:29088
  ds_read_b128 v[88:91], v18 offset:34560
  ds_read_b128 v[92:95], v18 offset:34848
  ds_read_b128 v[96:99], v18 offset:40320
  ds_read_b128 v[100:103], v18 offset:40608
  s_waitcnt lgkmcnt(5)
  v_add_f32 v72, v72, v80
  v_add_f32 v73, v73, v81
  v_add_f32 v74, v74, v82
  v_add_f32 v75, v75, v83
  s_waitcnt lgkmcnt(4)
  v_add_f32 v76, v76, v84
  v_add_f32 v77, v77, v85
  v_add_f32 v78, v78, v86
  v_add_f32 v79, v79, v87
  s_waitcnt lgkmcnt(1)
  v_add_f32 v88, v88, v96
  v_add_f32 v89, v89, v97
  v_add_f32 v90, v90, v98
  v_add_f32 v91, v91, v99
  s_waitcnt lgkmcnt(0)
  v_add_f32 v92, v92, v100
  v_add_f32 v93, v93, v101
  v_add_f32 v94, v94, v102
  v_add_f32 v95, v95, v103
  v_add_f32 v72, v72, v88
  v_add_f32 v73, v73, v89
  v_add_f32 v74, v74, v90
  v_add_f32 v75, v75, v91
  v_add_f32 v76, v76, v92
  v_add_f32 v77, v77, v93
  v_add_f32 v78, v78, v94
  v_add_f32 v79, v79, v95
  v_dot2_f32_bf16 v80, v116, s74, v72
  v_dot2_f32_bf16 v81, v116, s75, v73
  v_dot2_f32_bf16 v82, v117, s74, v74
  v_dot2_f32_bf16 v83, v117, s75, v75
  v_dot2_f32_bf16 v84, v118, s74, v76
  v_dot2_f32_bf16 v85, v118, s75, v77
  v_dot2_f32_bf16 v86, v119, s74, v78
  v_dot2_f32_bf16 v87, v119, s75, v79
  v_cvt_pk_bf16_f32 v72, v80, v81
  v_cvt_pk_bf16_f32 v73, v82, v83
  v_cvt_pk_bf16_f32 v74, v84, v85
  v_cvt_pk_bf16_f32 v75, v86, v87
  s_mov_b32 s92, 122880
  buffer_store_dwordx4 v[72:75], v128, s[56:59], s92 offen
  s_endpgm
L_g01G:
  s_mov_b32 s93, 0x40000
L_g01G_poll:
  buffer_load_dword v26, v27, s[60:63], 0 offen offset:0 sc1
  s_waitcnt vmcnt(0)
  v_cmp_ne_u32 vcc, v26, v19
  s_nop 3
  s_cmp_eq_u64 vcc, 0
  s_cbranch_scc1 L_g01G_poll_ok
  s_sub_u32 s93, s93, 1
  s_cbranch_scc0 L_g01G_poll
L_g01G_poll_ok:
  s_branch L_g01G_back
L_g2G:
  s_mov_b32 s93, 0x40000
L_g2G_poll:
  buffer_load_dword v26, v28, s[60:63], 0 offen offset:2048 sc1
  s_waitcnt vmcnt(0)
  v_cmp_ne_u32 vcc, v26, v19
  s_nop 3
  s_cmp_eq_u64 vcc, 0
  s_cbranch_scc1 L_g2G_poll_ok
  s_sub_u32 s93, s93, 1
  s_cbranch_scc0 L_g2G_poll
L_g2G_poll_ok:
  s_branch L_g2G_back
L_g3G:
  s_mov_b32 s93, 0x40000
L_g3G_poll:
  buffer_load_dword v26, v28, s[60:63], 0 offen offset:3072 sc1
  s_waitcnt vmcnt(0)
  v_cmp_ne_u32 vcc, v26, v19
  s_nop 3
  s_cmp_eq_u64 vcc, 0
  s_cbranch_scc1 L_g3G_poll_ok
  s_sub_u32 s93, s93, 1
  s_cbranch_scc0 L_g3G_poll
L_g3G_poll_ok:
  s_branch L_g3G_back
L_kvspin:
  s_mov_b32 s93, 0x40000
L_pollkv:
  buffer_load_dword v22, v24, s[60:63], 0 offen offset:0 sc1
  s_waitcnt vmcnt(0)
  v_cmp_ne_u32 vcc, v22, v19
  s_nop 3
  s_cmp_eq_u64 vcc, 0
  s_cbranch_scc1 L_pollkv_ok
  s_sub_u32 s93, s93, 1
  s_cbranch_scc0 L_pollkv
L_pollkv_ok:
  s_branch L_kvspin_back
L_kvall:
  s_mov_b32 s93, 0x40000
L_pollkva:
  buffer_load_dword v22, v20, s[60:63], 0 offen offset:0 sc1
  buffer_load_dword v23, v21, s[60:63], 0 offen offset:0 sc1
  s_waitcnt vmcnt(0)
  v_cmp_ne_u32 vcc, v22, v19
  v_cmp_ne_u32 s[94:95], v23, v19
  s_nop 3
  s_or_b64 vcc, vcc, s[94:95]
  s_cmp_eq_u64 vcc, 0
  s_cbranch_scc1 L_pollkva_ok
  s_sub_u32 s93, s93, 1
  s_cbranch_scc0 L_pollkva
L_pollkva_ok:
  s_branch L_kvall_back
L_rspin:
  s_mov_b32 s93, 0x40000
L_pollr:
  buffer_load_dword v15, v13, s[60:63], 0 offen offset:0 sc1
  s_waitcnt vmcnt(0)
  v_cmp_ne_u32 vcc, v15, v19
  s_nop 3
  s_cmp_eq_u64 vcc, 0
  s_cbranch_scc1 L_pollr_ok
  s_sub_u32 s93, s93, 1
  s_cbranch_scc0 L_pollr
L_pollr_ok:
  s_branch L_rback
L_slow:
  s_waitcnt vmcnt(0) lgkmcnt(0)
  s_nop 15
  v_mov_b32 v20, 0xff800000
  v_mov_b32 v21, 0xff800000
  v_mov_b32 v22, 0xff800000
  v_mov_b32 v23, 0xff800000
  s_mov_b32 s4, 32
L_sloop:
  s_mul_i32 s80, s3, 3584
  s_add_u32 s80, s80, s81
  s_add_u32 s22, s60, s80
  s_addc_u32 s23, s61, 0
  global_load_dwordx4 v[164:167], v11, s[22:23]
  s_add_u32 s3, s3, 1
  global_load_dwordx2 v[176:177], v17, s[22:23]
  s_and_b32 s3, s3, 31
  global_load_dwordx4 v[168:171], v0, s[22:23] offset:1536
  global_load_dwordx4 v[172:175], v0, s[22:23] offset:2560
  s_waitcnt vmcnt(0)
  v_mfma_f32_32x32x4_2b_bf16 v[96:127], v[176:177], v[160:161], 0 cbsz:1
  s_nop 15
  s_nop 1
  v_mfma_f32_32x32x16_bf16 v[96:111], v[164:167], a[240:243], v[96:111]
  v_mfma_f32_32x32x16_bf16 v[112:127], v[164:167], a[244:247], v[112:127]
  s_nop 10
  v_max3_f32 v20, v20, v96, v97
  v_max3_f32 v20, v20, v98, v99
  v_max3_f32 v20, v20, v100, v101
  v_max3_f32 v20, v20, v102, v103
  v_max3_f32 v20, v20, v104, v105
  v_max3_f32 v20, v20, v106, v107
  v_max3_f32 v20, v20, v108, v109
  v_max3_f32 v20, v20, v110, v111
  v_max3_f32 v21, v21, v112, v113
  v_max3_f32 v21, v21, v114, v115
  v_max3_f32 v21, v21, v116, v117
  v_max3_f32 v21, v21, v118, v119
  v_max3_f32 v21, v21, v120, v121
  v_max3_f32 v21, v21, v122, v123
  v_max3_f32 v21, v21, v124, v125
  v_max3_f32 v21, v21, v126, v127
  s_nop 1
  v_mfma_f32_32x32x4_2b_bf16 v[96:127], v[176:177], v[162:163], 0 cbsz:1
  s_nop 15
  s_nop 1
  v_mfma_f32_32x32x16_bf16 v[96:111], v[164:167], a[248:251], v[96:111]
  v_mfma_f32_32x32x16_bf16 v[112:127], v[164:167], a[252:255], v[112:127]
  s_nop 10
  v_max3_f32 v22, v22, v96, v97
  v_max3_f32 v22, v22, v98, v99
  v_max3_f32 v22, v22, v100, v101
  v_max3_f32 v22, v22, v102, v103
  v_max3_f32 v22, v22, v104, v105
  v_max3_f32 v22, v22, v106, v107
  v_max3_f32 v22, v22, v108, v109
  v_max3_f32 v22, v22, v110, v111
  v_max3_f32 v23, v23, v112, v113
  v_max3_f32 v23, v23, v114, v115
  v_max3_f32 v23, v23, v116, v117
  v_max3_f32 v23, v23, v118, v119
  v_max3_f32 v23, v23, v120, v121
  v_max3_f32 v23, v23, v122, v123
  v_max3_f32 v23, v23, v124, v125
  v_max3_f32 v23, v23, v126, v127
  s_nop 1
  s_sub_u32 s4, s4, 1
  s_cmp_lg_u32 s4, 0
  s_cbranch_scc1 L_sloop
  v_mov_b32 v24, v20
  v_mov_b32 v25, v21
  v_mov_b32 v26, v22
  v_mov_b32 v27, v23
  v_permlane32_swap_b32 v24, v20
  v_permlane32_swap_b32 v25, v21
  v_permlane32_swap_b32 v26, v22
  v_permlane32_swap_b32 v27, v23
  v_max_f32 v20, v20, v24
  v_max_f32 v21, v21, v25
  v_max_f32 v22, v22, v26
  v_max_f32 v23, v23, v27
  s_barrier
  ds_write_b128 v248, v[20:23]
  s_waitcnt lgkmcnt(0)
  s_barrier
  ds_read_b128 v[24:27], v249
  s_waitcnt lgkmcnt(0)
  s_barrier
  v_max_f32 v20, v20, v26
  v_sub_f32 v20, 0, v20
  v_max_f32 v21, v21, v27
  v_sub_f32 v21, 0, v21
  v_max_f32 v22, v22, v24
  v_sub_f32 v22, 0, v22
  v_max_f32 v23, v23, v25
  v_sub_f32 v23, 0, v23
  v_mov_b64 v[32:33], 0
  v_mov_b64 v[34:35], 0
  v_mov_b64 v[36:37], 0
  v_mov_b64 v[38:39], 0
  v_mov_b64 v[40:41], 0
  v_mov_b64 v[42:43], 0
  v_mov_b64 v[44:45], 0
  v_mov_b64 v[46:47], 0
  v_mov_b64 v[48:49], 0
  v_mov_b64 v[50:51], 0
  v_mov_b64 v[52:53], 0
  v_mov_b64 v[54:55], 0
  v_mov_b64 v[56:57], 0
  v_mov_b64 v[58:59], 0
  v_mov_b64 v[60:61], 0
  v_mov_b64 v[62:63], 0
  v_mov_b64 v[64:65], 0
  v_mov_b64 v[66:67], 0
  v_mov_b64 v[68:69], 0
  v_mov_b64 v[70:71], 0
  v_mov_b64 v[72:73], 0
  v_mov_b64 v[74:75], 0
  v_mov_b64 v[76:77], 0
  v_mov_b64 v[78:79], 0
  v_mov_b64 v[80:81], 0
  v_mov_b64 v[82:83], 0
  v_mov_b64 v[84:85], 0
  v_mov_b64 v[86:87], 0
  v_mov_b64 v[88:89], 0
  v_mov_b64 v[90:91], 0
  v_mov_b64 v[92:93], 0
  v_mov_b64 v[94:95], 0
  s_mov_b32 s4, 32
L_sloop2:
  s_mul_i32 s80, s3, 3584
  s_add_u32 s80, s80, s81
  s_add_u32 s22, s60, s80
  s_addc_u32 s23, s61, 0
  global_load_dwordx4 v[164:167], v11, s[22:23]
  s_add_u32 s3, s3, 1
  global_load_dwordx2 v[176:177], v17, s[22:23]
  s_and_b32 s3, s3, 31
  global_load_dwordx4 v[168:171], v0, s[22:23] offset:1536
  global_load_dwordx4 v[172:175], v0, s[22:23] offset:2560
  s_waitcnt vmcnt(0)
  v_mov_b32 v128, v20
  v_mov_b32 v129, v20
  v_mov_b32 v130, v20
  v_mov_b32 v131, v20
  v_mov_b32 v132, v20
  v_mov_b32 v133, v20
  v_mov_b32 v134, v20
  v_mov_b32 v135, v20
  v_mov_b32 v136, v20
  v_mov_b32 v137, v20
  v_mov_b32 v138, v20
  v_mov_b32 v139, v20
  v_mov_b32 v140, v20
  v_mov_b32 v141, v20
  v_mov_b32 v142, v20
  v_mov_b32 v143, v20
  v_mov_b32 v144, v21
  v_mov_b32 v145, v21
  v_mov_b32 v146, v21
  v_mov_b32 v147, v21
  v_mov_b32 v148, v21
  v_mov_b32 v149, v21
  v_mov_b32 v150, v21
  v_mov_b32 v151, v21
  v_mov_b32 v152, v21
  v_mov_b32 v153, v21
  v_mov_b32 v154, v21
  v_mov_b32 v155, v21
  v_mov_b32 v156, v21
  v_mov_b32 v157, v21
  v_mov_b32 v158, v21
  v_mov_b32 v159, v21
  s_nop 1
  v_mfma_f32_32x32x4_2b_bf16 v[96:127], v[176:177], v[160:161], v[128:159] cbsz:1
  s_nop 15
  s_nop 1
  v_mfma_f32_32x32x16_bf16 v[96:111], v[164:167], a[240:243], v[96:111]
  v_mfma_f32_32x32x16_bf16 v[112:127], v[164:167], a[244:247], v[112:127]
  s_nop 10
  v_exp_f32 v96, v96
  v_exp_f32 v97, v97
  v_exp_f32 v98, v98
  v_exp_f32 v99, v99
  v_exp_f32 v100, v100
  v_exp_f32 v101, v101
  v_exp_f32 v102, v102
  v_exp_f32 v103, v103
  v_exp_f32 v104, v104
  v_exp_f32 v105, v105
  v_exp_f32 v106, v106
  v_exp_f32 v107, v107
  v_exp_f32 v108, v108
  v_exp_f32 v109, v109
  v_exp_f32 v110, v110
  v_exp_f32 v111, v111
  v_exp_f32 v112, v112
  v_exp_f32 v113, v113
  v_exp_f32 v114, v114
  v_exp_f32 v115, v115
  v_exp_f32 v116, v116
  v_exp_f32 v117, v117
  v_exp_f32 v118, v118
  v_exp_f32 v119, v119
  v_exp_f32 v120, v120
  v_exp_f32 v121, v121
  v_exp_f32 v122, v122
  v_exp_f32 v123, v123
  v_exp_f32 v124, v124
  v_exp_f32 v125, v125
  v_exp_f32 v126, v126
  v_exp_f32 v127, v127
  v_smfmac_f32_32x32x32_bf16 v[32:47], v[168:171], v[96:103], v18
  v_smfmac_f32_32x32x32_bf16 v[32:47], v[172:175], v[104:111], v18
  v_smfmac_f32_32x32x32_bf16 v[48:63], v[168:171], v[112:119], v18
  v_smfmac_f32_32x32x32_bf16 v[48:63], v[172:175], v[120:127], v18
  s_nop 15
  v_mov_b32 v128, v22
  v_mov_b32 v129, v22
  v_mov_b32 v130, v22
  v_mov_b32 v131, v22
  v_mov_b32 v132, v22
  v_mov_b32 v133, v22
  v_mov_b32 v134, v22
  v_mov_b32 v135, v22
  v_mov_b32 v136, v22
  v_mov_b32 v137, v22
  v_mov_b32 v138, v22
  v_mov_b32 v139, v22
  v_mov_b32 v140, v22
  v_mov_b32 v141, v22
  v_mov_b32 v142, v22
  v_mov_b32 v143, v22
  v_mov_b32 v144, v23
  v_mov_b32 v145, v23
  v_mov_b32 v146, v23
  v_mov_b32 v147, v23
  v_mov_b32 v148, v23
  v_mov_b32 v149, v23
  v_mov_b32 v150, v23
  v_mov_b32 v151, v23
  v_mov_b32 v152, v23
  v_mov_b32 v153, v23
  v_mov_b32 v154, v23
  v_mov_b32 v155, v23
  v_mov_b32 v156, v23
  v_mov_b32 v157, v23
  v_mov_b32 v158, v23
  v_mov_b32 v159, v23
  s_nop 1
  v_mfma_f32_32x32x4_2b_bf16 v[96:127], v[176:177], v[162:163], v[128:159] cbsz:1
  s_nop 15
  s_nop 1
  v_mfma_f32_32x32x16_bf16 v[96:111], v[164:167], a[248:251], v[96:111]
  v_mfma_f32_32x32x16_bf16 v[112:127], v[164:167], a[252:255], v[112:127]
  s_nop 10
  v_exp_f32 v96, v96
  v_exp_f32 v97, v97
  v_exp_f32 v98, v98
  v_exp_f32 v99, v99
  v_exp_f32 v100, v100
  v_exp_f32 v101, v101
  v_exp_f32 v102, v102
  v_exp_f32 v103, v103
  v_exp_f32 v104, v104
  v_exp_f32 v105, v105
  v_exp_f32 v106, v106
  v_exp_f32 v107, v107
  v_exp_f32 v108, v108
  v_exp_f32 v109, v109
  v_exp_f32 v110, v110
  v_exp_f32 v111, v111
  v_exp_f32 v112, v112
  v_exp_f32 v113, v113
  v_exp_f32 v114, v114
  v_exp_f32 v115, v115
  v_exp_f32 v116, v116
  v_exp_f32 v117, v117
  v_exp_f32 v118, v118
  v_exp_f32 v119, v119
  v_exp_f32 v120, v120
  v_exp_f32 v121, v121
  v_exp_f32 v122, v122
  v_exp_f32 v123, v123
  v_exp_f32 v124, v124
  v_exp_f32 v125, v125
  v_exp_f32 v126, v126
  v_exp_f32 v127, v127
  v_smfmac_f32_32x32x32_bf16 v[64:79], v[168:171], v[96:103], v18
  v_smfmac_f32_32x32x32_bf16 v[64:79], v[172:175], v[104:111], v18
  v_smfmac_f32_32x32x32_bf16 v[80:95], v[168:171], v[112:119], v18
  v_smfmac_f32_32x32x32_bf16 v[80:95], v[172:175], v[120:127], v18
  s_nop 15
  s_sub_u32 s4, s4, 1
  s_cmp_lg_u32 s4, 0
  s_cbranch_scc1 L_sloop2
  s_nop 15
  ds_write_b128 v248, v[64:67] offset:0
  ds_write_b128 v248, v[68:71] offset:1024
  ds_write_b128 v248, v[72:75] offset:2048
  ds_write_b128 v248, v[80:83] offset:3072
  ds_write_b128 v248, v[84:87] offset:4096
  ds_write_b128 v248, v[88:91] offset:5120
  s_mov_b32 s82, 1
  s_nop 7
  s_branch L_guard
L_end:
.section .rodata,"a"
.p2align 6
.amdhsa_kernel sequential_preLN__grouped_kv_mqa__glu_gated_swiglu__prompt_kernel
  .amdhsa_next_free_vgpr 512
  .amdhsa_next_free_sgpr 102
  .amdhsa_accum_offset 256
  .amdhsa_group_segment_fixed_size 0
  .amdhsa_kernarg_size 96
  .amdhsa_user_sgpr_count 2
  .amdhsa_user_sgpr_kernarg_segment_ptr 1
  .amdhsa_system_sgpr_workgroup_id_x 1
.end_amdhsa_kernel
```
